```python
import torch

def _softmax(x, axis=-1):
    return torch.softmax(x, dim=axis)
def _gelu(x):
    return torch.nn.functional.gelu(x, approximate="tanh")
def _silu(x):
    return torch.nn.functional.silu(x)
def _sigmoid(x):
    return torch.sigmoid(x)
def _layernorm(x, axis=-1, eps=1e-5):
    m = x.mean(dim=axis, keepdim=True)
    v = x.var(dim=axis, keepdim=True, unbiased=False)
    return (x - m) / torch.sqrt(v + eps)
def _scatter_add(tgt, idx, src, axis=0):
    return tgt.clone().index_add_(axis, idx, src)
def _segment_sum(src, seg, n):
    out = torch.zeros((n,) + src.shape[1:], dtype=src.dtype)
    return out.index_add_(0, seg, src)
def _pad(x, pw):
    flat = tuple(v for pair in reversed(pw) for v in pair)
    return torch.nn.functional.pad(x, flat)

kernel_name = 'gated_mix__grouped_kv_mqa__dense_activation_mish__prompt'

def setup_inputs():

    _w = (lambda a: (lambda t: t.to(torch.bfloat16) if t.is_floating_point() else t)(torch.as_tensor(a)))
    def _A_setup():
        B, S, D, H = 1, 2048, 1024, 32
        Dh = D // H
        return {
            "x": _w((lambda *s: torch.randn(*s, dtype=torch.bfloat16) * 0.05)(B, S, D)),
            "wq": _w((lambda *s: torch.randn(*s, dtype=torch.bfloat16) * 0.8)(D, H * Dh)),
            "wk": _w((lambda *s: torch.randn(*s, dtype=torch.bfloat16) * 0.8)(D, Dh)),
            "wv": _w((lambda *s: torch.randn(*s, dtype=torch.bfloat16) * 0.05)(D, Dh)),
            "wo": _w((lambda *s: torch.randn(*s, dtype=torch.bfloat16) * 0.05)(H * Dh, D)),
        }
    _A_in = _A_setup()

    def _B_setup():
        B, S, D, F = 1, 2048, 1024, 3584
        return {
            "x": _w((lambda *s: torch.randn(*s, dtype=torch.bfloat16) * 0.05)(B, S, D)),
            "w1": _w((lambda *s: torch.randn(*s, dtype=torch.bfloat16) * 6.4)(D, F) * (D ** -0.5)),
            "b1": _w((lambda *s: torch.randn(*s, dtype=torch.bfloat16) * 0.1)(F)),
            "w2": _w((lambda *s: torch.randn(*s, dtype=torch.bfloat16) * 0.1)(F, D) * (F ** -0.5)),
        }
    _B_in = _B_setup()

    return {
        "A_x": _A_in["x"],
        "A_wq": _A_in["wq"],
        "A_wk": _A_in["wk"],
        "A_wv": _A_in["wv"],
        "A_wo": _A_in["wo"],
        "B_x": _B_in["x"],
        "B_w1": _B_in["w1"],
        "B_b1": _B_in["b1"],
        "B_w2": _B_in["w2"],
        "gate_w": _w((lambda *s: torch.randn(*s, dtype=torch.bfloat16) * 0.05)(1024) * 16.0),
    }

def reference(A_x, A_wq, A_wk, A_wv, A_wo, B_x, B_w1, B_b1, B_w2, gate_w):
    def _A_ref(x, wq, wk, wv, wo):
        B, S, D = x.shape
        H = 32
        Dh = D // H
        q = (lambda x, *d: x.permute(*d))((x @ wq).reshape(B, S, H, Dh), 0, 2, 1, 3)
        k = x @ wk
        v = x @ wv
        scores = torch.einsum("bhqd,bkd->bhqk", q, k) * (Dh ** -0.5)
        p = _softmax(scores, axis=-1)
        o = torch.einsum("bhqk,bkd->bhqd", p, v)
        return (lambda x, *d: x.permute(*d))(o, 0, 2, 1, 3).reshape(B, S, H * Dh) @ wo

    def _B_ref(x, w1, b1, w2):
        h = torch.einsum("bsd,df->bsf", x, w1) + b1
        sp = torch.log1p(torch.exp(-torch.abs(h))) + torch.where(h > 0, h, torch.zeros_like(h))
        act = h * torch.tanh(sp)
        return torch.einsum("bsf,fd->bsd", act, w2)

    x = A_x
    g = _sigmoid((x * gate_w).sum(-1, keepdims=True))
    a = _A_ref(x, A_wq, A_wk, A_wv, A_wo)
    b = _B_ref(x, B_w1, B_b1, B_w2)
    return g * a + (1 - g) * b
```

```asm
; @launch grid=(512,1,1) block=(256,1,1) lds=81920
.amdgcn_target "amdgcn-amd-amdhsa--gfx950"
.text
.globl gated_mix__grouped_kv_mqa__dense_activation_mish__prompt_kernel
.p2align 8
.type gated_mix__grouped_kv_mqa__dense_activation_mish__prompt_kernel,@function
gated_mix__grouped_kv_mqa__dense_activation_mish__prompt_kernel:

    s_cmp_ge_u32 s2, 512
    s_cbranch_scc1 gated_mix__grouped_kv_mqa__dense_activation_mish__prompt_kernel_exit
    s_load_dwordx8 s[60:67], s[0:1], 0
    s_load_dwordx8 s[72:79], s[0:1], 48
    s_load_dwordx2 s[68:69], s[0:1], 32
    s_load_dwordx4 s[80:83], s[0:1], 80
    s_load_dwordx2 s[84:85], s[0:1], 96
    v_and_b32 v1, 63, v0
    v_lshrrev_b32 v3, 6, v0
    v_lshlrev_b32 v2, 4, v1
    v_readfirstlane_b32 s86, v3
    s_and_b32 s89, s2, 255
    s_and_b32 s90, s89, 7
    s_lshr_b32 s91, s89, 3
    s_lshr_b32 s92, s90, 1
    s_lshl_b32 s92, s92, 2
    s_lshr_b32 s93, s91, 3
    s_add_u32 s87, s92, s93
    s_and_b32 s92, s90, 1
    s_lshl_b32 s92, s92, 3
    s_and_b32 s93, s91, 7
    s_add_u32 s88, s92, s93
    s_cmp_ge_u32 s2, 256
    s_cbranch_scc1 gated_mix__grouped_kv_mqa__dense_activation_mish__prompt_kernel_roleb
    s_setprio 2
    v_lshrrev_b32 v3, 3, v1
    v_lshrrev_b32 v4, 4, v1
    v_and_b32 v5, 7, v1
    v_xor_b32 v4, v4, v5
    v_lshlrev_b32 v4, 4, v4
    v_lshl_add_u32 v204, v3, 11, v4
    v_xor_b32 v205, 64, v204
    v_bfe_u32 v4, v1, 4, 1
    v_lshlrev_b32 v4, 2, v4
    v_xor_b32 v4, v4, v5
    v_lshlrev_b32 v4, 4, v4
    v_lshl_add_u32 v206, v3, 11, v4
    v_lshrrev_b32 v3, 2, v1
    v_and_b32 v4, 3, v1
    v_lshlrev_b32 v4, 4, v4
    v_lshl_add_u32 v207, v3, 6, v4
    s_lshl_b32 s91, s87, 7
    s_lshl_b32 s92, s86, 5
    s_add_u32 s91, s91, s92
    s_lshl_b32 s91, s91, 11
    s_add_u32 s28, s91, 0
    s_add_u32 s29, s91, 15360
    s_add_u32 s30, s91, 30720
    s_add_u32 s31, s91, 46080
    s_lshl_b32 s33, s86, 15
    s_add_u32 s32, s33, 15360
    s_lshl_b32 s34, s86, 10
    s_lshl_b32 s35, s86, 11
    s_lshl_b32 s36, s86, 10
    s_add_u32 s36, s36, 32768
    s_lshl_b32 s37, s86, 13
    s_add_u32 s37, s37, 49152
    s_mov_b32 s44, 0x3e8293ee
    s_mov_b32 s45, s44
    s_lshl_b32 s94, s88, 7
    s_waitcnt lgkmcnt(0)
    s_cmp_lg_u32 s2, 0
    s_cbranch_scc1 gated_mix__grouped_kv_mqa__dense_activation_mish__prompt_kernel_noclr
    s_add_u32 s92, s84, 0x1b00000
    s_addc_u32 s93, s85, 0
    s_mov_b32 s52, s92
    s_mov_b32 s53, s93
    s_mov_b32 s54, 0x4000
    s_mov_b32 s55, 0x00020000
    s_lshl_b32 s91, s86, 12
    v_mov_b32 v8, 0
    v_mov_b32 v9, 0
    v_mov_b32 v10, 0
    v_mov_b32 v11, 0
    buffer_store_dwordx4 v[8:11], v2, s[52:55], s91 offen offset:0 sc1
    buffer_store_dwordx4 v[8:11], v2, s[52:55], s91 offen offset:1024 sc1
    buffer_store_dwordx4 v[8:11], v2, s[52:55], s91 offen offset:2048 sc1
    buffer_store_dwordx4 v[8:11], v2, s[52:55], s91 offen offset:3072 sc1
gated_mix__grouped_kv_mqa__dense_activation_mish__prompt_kernel_noclr:
    s_add_u32 s92, s62, s94
    s_addc_u32 s93, s63, 0
    s_mov_b32 s8, s92
    s_mov_b32 s9, s93
    s_mov_b32 s10, 0x200000
    s_mov_b32 s11, 0x00020000
    s_mov_b32 s4, s60
    s_mov_b32 s5, s61
    s_mov_b32 s6, 0x400000
    s_mov_b32 s7, 0x00020000
    s_mul_i32 s94, s87, 1
    s_add_u32 s59, s94, s88
    s_and_b32 s59, s59, 3
    s_mov_b32 s48, s8
    s_mov_b32 s49, s9
    s_add_u32 s94, s59, 0
    s_and_b32 s94, s94, 3
    s_mul_i32 s94, s94, 262144
    s_add_u32 s8, s48, s94
    s_addc_u32 s9, s49, 0
    s_add_u32 s94, s59, 0
    s_and_b32 s94, s94, 3
    s_mul_i32 s94, s94, 256
    s_add_u32 s4, s60, s94
    s_addc_u32 s5, s61, 0
    s_cmp_eq_u32 s88, 0
    s_cbranch_scc1 gated_mix__grouped_kv_mqa__dense_activation_mish__prompt_kernel_aK
    s_cmp_eq_u32 s88, 1
    s_cbranch_scc1 gated_mix__grouped_kv_mqa__dense_activation_mish__prompt_kernel_aV
    s_add_u32 m0, s35, 0
    s_nop 0
    buffer_load_dwordx4 v206, s[8:11], s33 offen lds
    buffer_load_dwordx4 v206, s[8:11], s32 offen offset:1024 lds
    s_add_u32 s8, s8, 131072
    s_addc_u32 s9, s9, 0
    s_add_u32 m0, s37, 0
    s_nop 0
    buffer_load_dwordx4 v204, s[4:7], s28 offen offset:0 lds
    buffer_load_dwordx4 v205, s[4:7], s29 offen offset:1024 lds
    buffer_load_dwordx4 v204, s[4:7], s30 offen offset:2048 lds
    buffer_load_dwordx4 v205, s[4:7], s31 offen offset:3072 lds
    s_add_u32 s4, s4, 128
    s_addc_u32 s5, s5, 0
    s_add_u32 m0, s37, 4096
    s_nop 0
    buffer_load_dwordx4 v204, s[4:7], s28 offen offset:0 lds
    buffer_load_dwordx4 v205, s[4:7], s29 offen offset:1024 lds
    buffer_load_dwordx4 v204, s[4:7], s30 offen offset:2048 lds
    buffer_load_dwordx4 v205, s[4:7], s31 offen offset:3072 lds
    s_add_u32 s94, s59, 1
    s_and_b32 s94, s94, 3
    s_mul_i32 s94, s94, 256
    s_add_u32 s4, s60, s94
    s_addc_u32 s5, s61, 0
    s_add_u32 m0, s35, 8192
    s_nop 0
    buffer_load_dwordx4 v206, s[8:11], s33 offen lds
    buffer_load_dwordx4 v206, s[8:11], s32 offen offset:1024 lds
    s_add_u32 s94, s59, 1
    s_and_b32 s94, s94, 3
    s_mul_i32 s94, s94, 262144
    s_add_u32 s8, s48, s94
    s_addc_u32 s9, s49, 0
    v_and_b32 v3, 31, v1
    v_lshrrev_b32 v4, 5, v1
    v_bfe_u32 v5, v3, 1, 3
    v_xor_b32 v5, v5, v4
    v_lshlrev_b32 v5, 4, v5
    v_lshl_add_u32 v5, v3, 7, v5
    v_add_u32 v5, s37, v5
    v_xor_b32 v208, 0, v5
    v_xor_b32 v209, 32, v5
    v_xor_b32 v210, 64, v5
    v_xor_b32 v211, 96, v5
    v_bfe_u32 v6, v1, 2, 2
    v_bfe_u32 v5, v1, 4, 1
    v_and_b32 v7, 3, v1
    v_lshlrev_b32 v3, 5, v5
    v_lshl_add_u32 v3, v7, 3, v3
    v_lshl_add_u32 v4, v4, 3, v6
    v_lshrrev_b32 v5, 1, v6
    v_lshl_add_u32 v5, v5, 6, v3
    v_lshl_add_u32 v212, v4, 7, v5
    v_xor_b32 v213, 64, v212
    v_lshl_add_u32 v214, v4, 6, v3
    v_add_u32 v214, 32768, v214
    s_waitcnt vmcnt(6)
    s_cmp_lg_u32 s2, 0
    s_cbranch_scc1 gated_mix__grouped_kv_mqa__dense_activation_mish__prompt_kernel_n_clrw
    s_waitcnt vmcnt(0)
gated_mix__grouped_kv_mqa__dense_activation_mish__prompt_kernel_n_clrw:
    s_barrier
    s_add_u32 m0, s35, 16384
    s_nop 0
    buffer_load_dwordx4 v206, s[8:11], s33 offen lds
    buffer_load_dwordx4 v206, s[8:11], s32 offen offset:1024 lds
    s_add_u32 s8, s8, 131072
    s_addc_u32 s9, s9, 0
    s_cmp_lg_u32 s2, 0
    s_cbranch_scc1 gated_mix__grouped_kv_mqa__dense_activation_mish__prompt_kernel_n_nopub
    s_cmp_lg_u32 s86, 0
    s_cbranch_scc1 gated_mix__grouped_kv_mqa__dense_activation_mish__prompt_kernel_n_nopub
    s_mov_b32 s52, s82
    s_mov_b32 s53, s83
    s_mov_b32 s54, 0x100
    s_mov_b32 s55, 0x00020000
    v_lshlrev_b32 v6, 7, v1
    v_mov_b32 v4, 1
    v_cmp_gt_u32 vcc, 2, v1
    s_nop 1
    s_and_saveexec_b64 s[90:91], vcc
    buffer_store_dword v4, v6, s[52:55], 0 offen sc1
    s_mov_b64 exec, s[90:91]
gated_mix__grouped_kv_mqa__dense_activation_mish__prompt_kernel_n_nopub:
    ds_read_b128 v[32:35], v208 offset:0
    ds_read_b128 v[36:39], v209 offset:0
    ds_read_b128 v[40:43], v210 offset:0
    ds_read_b128 v[44:47], v211 offset:0
    ds_read_b64_tr_b16 v[64:65], v212 offset:0
    ds_read_b64_tr_b16 v[66:67], v212 offset:512
    ds_read_b64_tr_b16 v[68:69], v213 offset:0
    ds_read_b64_tr_b16 v[70:71], v213 offset:512
    ds_read_b64_tr_b16 v[76:77], v212 offset:2048
    ds_read_b64_tr_b16 v[78:79], v212 offset:2560
    ds_read_b64_tr_b16 v[80:81], v213 offset:2048
    ds_read_b64_tr_b16 v[82:83], v213 offset:2560
    ds_read_b64_tr_b16 v[88:89], v212 offset:4096
    ds_read_b64_tr_b16 v[90:91], v212 offset:4608
    ds_read_b64_tr_b16 v[92:93], v213 offset:4096
    ds_read_b64_tr_b16 v[94:95], v213 offset:4608
    s_waitcnt lgkmcnt(8)
    v_mfma_f32_32x32x16_bf16 v[100:115], v[64:67], v[32:35], 0
    s_add_u32 m0, s37, 0
    s_nop 0
    buffer_load_dwordx4 v204, s[4:7], s28 offen offset:0 lds
    v_mfma_f32_32x32x16_bf16 v[116:131], v[68:71], v[32:35], 0
    buffer_load_dwordx4 v205, s[4:7], s29 offen offset:1024 lds
    ds_read_b64_tr_b16 v[64:65], v212 offset:6144
    ds_read_b64_tr_b16 v[66:67], v212 offset:6656
    ds_read_b64_tr_b16 v[68:69], v213 offset:6144
    ds_read_b64_tr_b16 v[70:71], v213 offset:6656
    s_waitcnt lgkmcnt(8)
    v_mfma_f32_32x32x16_bf16 v[100:115], v[76:79], v[36:39], v[100:115]
    buffer_load_dwordx4 v204, s[4:7], s30 offen offset:2048 lds
    v_mfma_f32_32x32x16_bf16 v[116:131], v[80:83], v[36:39], v[116:131]
    buffer_load_dwordx4 v205, s[4:7], s31 offen offset:3072 lds
    s_add_u32 s4, s4, 128
    s_addc_u32 s5, s5, 0
    s_waitcnt vmcnt(6)
    s_barrier
    ds_read_b64_tr_b16 v[76:77], v212 offset:8192
    ds_read_b64_tr_b16 v[78:79], v212 offset:8704
    ds_read_b64_tr_b16 v[80:81], v213 offset:8192
    ds_read_b64_tr_b16 v[82:83], v213 offset:8704
    ds_read_b128 v[48:51], v208 offset:4096
    ds_read_b128 v[52:55], v209 offset:4096
    s_waitcnt lgkmcnt(10)
    v_mfma_f32_32x32x16_bf16 v[100:115], v[88:91], v[40:43], v[100:115]
    s_add_u32 m0, s35, 24576
    s_nop 0
    buffer_load_dwordx4 v206, s[8:11], s33 offen lds
    v_mfma_f32_32x32x16_bf16 v[116:131], v[92:95], v[40:43], v[116:131]
    buffer_load_dwordx4 v206, s[8:11], s32 offen offset:1024 lds
    s_add_u32 s94, s59, 2
    s_and_b32 s94, s94, 3
    s_mul_i32 s94, s94, 262144
    s_add_u32 s8, s48, s94
    s_addc_u32 s9, s49, 0
    ds_read_b64_tr_b16 v[88:89], v212 offset:10240
    ds_read_b64_tr_b16 v[90:91], v212 offset:10752
    ds_read_b64_tr_b16 v[92:93], v213 offset:10240
    ds_read_b64_tr_b16 v[94:95], v213 offset:10752
    ds_read_b128 v[56:59], v210 offset:4096
    ds_read_b128 v[60:63], v211 offset:4096
    s_waitcnt lgkmcnt(12)
    v_mfma_f32_32x32x16_bf16 v[100:115], v[64:67], v[44:47], v[100:115]
    v_mfma_f32_32x32x16_bf16 v[116:131], v[68:71], v[44:47], v[116:131]
    ds_read_b64_tr_b16 v[64:65], v212 offset:12288
    ds_read_b64_tr_b16 v[66:67], v212 offset:12800
    ds_read_b64_tr_b16 v[68:69], v213 offset:12288
    ds_read_b64_tr_b16 v[70:71], v213 offset:12800
    s_waitcnt lgkmcnt(11)
    s_waitcnt lgkmcnt(4)
    v_mfma_f32_32x32x16_bf16 v[100:115], v[76:79], v[48:51], v[100:115]
    s_add_u32 m0, s37, 4096
    s_nop 0
    buffer_load_dwordx4 v204, s[4:7], s28 offen offset:0 lds
    v_mfma_f32_32x32x16_bf16 v[116:131], v[80:83], v[48:51], v[116:131]
    buffer_load_dwordx4 v205, s[4:7], s29 offen offset:1024 lds
    ds_read_b64_tr_b16 v[76:77], v212 offset:14336
    ds_read_b64_tr_b16 v[78:79], v212 offset:14848
    ds_read_b64_tr_b16 v[80:81], v213 offset:14336
    ds_read_b64_tr_b16 v[82:83], v213 offset:14848
    v_mfma_f32_32x32x16_bf16 v[100:115], v[88:91], v[52:55], v[100:115]
    buffer_load_dwordx4 v204, s[4:7], s30 offen offset:2048 lds
    v_mfma_f32_32x32x16_bf16 v[116:131], v[92:95], v[52:55], v[116:131]
    buffer_load_dwordx4 v205, s[4:7], s31 offen offset:3072 lds
    s_add_u32 s94, s59, 2
    s_and_b32 s94, s94, 3
    s_mul_i32 s94, s94, 256
    s_add_u32 s4, s60, s94
    s_addc_u32 s5, s61, 0
    s_waitcnt vmcnt(10)
    s_barrier
    ds_read_b64_tr_b16 v[88:89], v212 offset:16384
    ds_read_b64_tr_b16 v[90:91], v212 offset:16896
    ds_read_b64_tr_b16 v[92:93], v213 offset:16384
    ds_read_b64_tr_b16 v[94:95], v213 offset:16896
    s_waitcnt vmcnt(6)
    ds_read_b128 v[32:35], v208 offset:0
    ds_read_b128 v[36:39], v209 offset:0
    s_waitcnt lgkmcnt(10)
    v_mfma_f32_32x32x16_bf16 v[100:115], v[64:67], v[56:59], v[100:115]
    s_add_u32 m0, s35, 0
    s_nop 0
    buffer_load_dwordx4 v206, s[8:11], s33 offen lds
    v_mfma_f32_32x32x16_bf16 v[116:131], v[68:71], v[56:59], v[116:131]
    buffer_load_dwordx4 v206, s[8:11], s32 offen offset:1024 lds
    s_add_u32 s8, s8, 131072
    s_addc_u32 s9, s9, 0
    ds_read_b64_tr_b16 v[64:65], v212 offset:18432
    ds_read_b64_tr_b16 v[66:67], v212 offset:18944
    ds_read_b64_tr_b16 v[68:69], v213 offset:18432
    ds_read_b64_tr_b16 v[70:71], v213 offset:18944
    ds_read_b128 v[40:43], v210 offset:0
    ds_read_b128 v[44:47], v211 offset:0
    s_waitcnt lgkmcnt(12)
    v_mfma_f32_32x32x16_bf16 v[100:115], v[76:79], v[60:63], v[100:115]
    v_mfma_f32_32x32x16_bf16 v[116:131], v[80:83], v[60:63], v[116:131]
    ds_read_b64_tr_b16 v[76:77], v212 offset:20480
    ds_read_b64_tr_b16 v[78:79], v212 offset:20992
    ds_read_b64_tr_b16 v[80:81], v213 offset:20480
    ds_read_b64_tr_b16 v[82:83], v213 offset:20992
    s_waitcnt lgkmcnt(11)
    s_waitcnt lgkmcnt(4)
    v_mfma_f32_32x32x16_bf16 v[100:115], v[88:91], v[32:35], v[100:115]
    s_add_u32 m0, s37, 0
    s_nop 0
    buffer_load_dwordx4 v204, s[4:7], s28 offen offset:0 lds
    v_mfma_f32_32x32x16_bf16 v[116:131], v[92:95], v[32:35], v[116:131]
    buffer_load_dwordx4 v205, s[4:7], s29 offen offset:1024 lds
    ds_read_b64_tr_b16 v[88:89], v212 offset:22528
    ds_read_b64_tr_b16 v[90:91], v212 offset:23040
    ds_read_b64_tr_b16 v[92:93], v213 offset:22528
    ds_read_b64_tr_b16 v[94:95], v213 offset:23040
    v_mfma_f32_32x32x16_bf16 v[100:115], v[64:67], v[36:39], v[100:115]
    buffer_load_dwordx4 v204, s[4:7], s30 offen offset:2048 lds
    v_mfma_f32_32x32x16_bf16 v[116:131], v[68:71], v[36:39], v[116:131]
    buffer_load_dwordx4 v205, s[4:7], s31 offen offset:3072 lds
    s_add_u32 s4, s4, 128
    s_addc_u32 s5, s5, 0
    s_waitcnt vmcnt(10)
    s_barrier
    ds_read_b64_tr_b16 v[64:65], v212 offset:24576
    ds_read_b64_tr_b16 v[66:67], v212 offset:25088
    ds_read_b64_tr_b16 v[68:69], v213 offset:24576
    ds_read_b64_tr_b16 v[70:71], v213 offset:25088
    s_waitcnt vmcnt(6)
    ds_read_b128 v[48:51], v208 offset:4096
    ds_read_b128 v[52:55], v209 offset:4096
    s_waitcnt lgkmcnt(10)
    v_mfma_f32_32x32x16_bf16 v[100:115], v[76:79], v[40:43], v[100:115]
    s_add_u32 m0, s35, 8192
    s_nop 0
    buffer_load_dwordx4 v206, s[8:11], s33 offen lds
    v_mfma_f32_32x32x16_bf16 v[116:131], v[80:83], v[40:43], v[116:131]
    buffer_load_dwordx4 v206, s[8:11], s32 offen offset:1024 lds
    s_add_u32 s94, s59, 3
    s_and_b32 s94, s94, 3
    s_mul_i32 s94, s94, 262144
    s_add_u32 s8, s48, s94
    s_addc_u32 s9, s49, 0
    ds_read_b64_tr_b16 v[76:77], v212 offset:26624
    ds_read_b64_tr_b16 v[78:79], v212 offset:27136
    ds_read_b64_tr_b16 v[80:81], v213 offset:26624
    ds_read_b64_tr_b16 v[82:83], v213 offset:27136
    ds_read_b128 v[56:59], v210 offset:4096
    ds_read_b128 v[60:63], v211 offset:4096
    s_waitcnt lgkmcnt(12)
    v_mfma_f32_32x32x16_bf16 v[100:115], v[88:91], v[44:47], v[100:115]
    v_mfma_f32_32x32x16_bf16 v[116:131], v[92:95], v[44:47], v[116:131]
    ds_read_b64_tr_b16 v[88:89], v212 offset:28672
    ds_read_b64_tr_b16 v[90:91], v212 offset:29184
    ds_read_b64_tr_b16 v[92:93], v213 offset:28672
    ds_read_b64_tr_b16 v[94:95], v213 offset:29184
    s_waitcnt lgkmcnt(11)
    s_waitcnt lgkmcnt(4)
    v_mfma_f32_32x32x16_bf16 v[100:115], v[64:67], v[48:51], v[100:115]
    s_add_u32 m0, s37, 4096
    s_nop 0
    buffer_load_dwordx4 v204, s[4:7], s28 offen offset:0 lds
    v_mfma_f32_32x32x16_bf16 v[116:131], v[68:71], v[48:51], v[116:131]
    buffer_load_dwordx4 v205, s[4:7], s29 offen offset:1024 lds
    ds_read_b64_tr_b16 v[64:65], v212 offset:30720
    ds_read_b64_tr_b16 v[66:67], v212 offset:31232
    ds_read_b64_tr_b16 v[68:69], v213 offset:30720
    ds_read_b64_tr_b16 v[70:71], v213 offset:31232
    v_mfma_f32_32x32x16_bf16 v[100:115], v[76:79], v[52:55], v[100:115]
    buffer_load_dwordx4 v204, s[4:7], s30 offen offset:2048 lds
    v_mfma_f32_32x32x16_bf16 v[116:131], v[80:83], v[52:55], v[116:131]
    buffer_load_dwordx4 v205, s[4:7], s31 offen offset:3072 lds
    s_add_u32 s94, s59, 3
    s_and_b32 s94, s94, 3
    s_mul_i32 s94, s94, 256
    s_add_u32 s4, s60, s94
    s_addc_u32 s5, s61, 0
    s_waitcnt vmcnt(10)
    s_barrier
    ds_read_b64_tr_b16 v[76:77], v212 offset:0
    ds_read_b64_tr_b16 v[78:79], v212 offset:512
    ds_read_b64_tr_b16 v[80:81], v213 offset:0
    ds_read_b64_tr_b16 v[82:83], v213 offset:512
    s_waitcnt vmcnt(6)
    ds_read_b128 v[32:35], v208 offset:0
    ds_read_b128 v[36:39], v209 offset:0
    s_waitcnt lgkmcnt(10)
    v_mfma_f32_32x32x16_bf16 v[100:115], v[88:91], v[56:59], v[100:115]
    s_add_u32 m0, s35, 16384
    s_nop 0
    buffer_load_dwordx4 v206, s[8:11], s33 offen lds
    v_mfma_f32_32x32x16_bf16 v[116:131], v[92:95], v[56:59], v[116:131]
    buffer_load_dwordx4 v206, s[8:11], s32 offen offset:1024 lds
    s_add_u32 s8, s8, 131072
    s_addc_u32 s9, s9, 0
    ds_read_b64_tr_b16 v[88:89], v212 offset:2048
    ds_read_b64_tr_b16 v[90:91], v212 offset:2560
    ds_read_b64_tr_b16 v[92:93], v213 offset:2048
    ds_read_b64_tr_b16 v[94:95], v213 offset:2560
    ds_read_b128 v[40:43], v210 offset:0
    ds_read_b128 v[44:47], v211 offset:0
    s_waitcnt lgkmcnt(12)
    v_mfma_f32_32x32x16_bf16 v[100:115], v[64:67], v[60:63], v[100:115]
    v_mfma_f32_32x32x16_bf16 v[116:131], v[68:71], v[60:63], v[116:131]
    ds_read_b64_tr_b16 v[64:65], v212 offset:4096
    ds_read_b64_tr_b16 v[66:67], v212 offset:4608
    ds_read_b64_tr_b16 v[68:69], v213 offset:4096
    ds_read_b64_tr_b16 v[70:71], v213 offset:4608
    s_waitcnt lgkmcnt(11)
    s_waitcnt lgkmcnt(4)
    v_mfma_f32_32x32x16_bf16 v[100:115], v[76:79], v[32:35], v[100:115]
    s_add_u32 m0, s37, 0
    s_nop 0
    buffer_load_dwordx4 v204, s[4:7], s28 offen offset:0 lds
    v_mfma_f32_32x32x16_bf16 v[116:131], v[80:83], v[32:35], v[116:131]
    buffer_load_dwordx4 v205, s[4:7], s29 offen offset:1024 lds
    ds_read_b64_tr_b16 v[76:77], v212 offset:6144
    ds_read_b64_tr_b16 v[78:79], v212 offset:6656
    ds_read_b64_tr_b16 v[80:81], v213 offset:6144
    ds_read_b64_tr_b16 v[82:83], v213 offset:6656
    v_mfma_f32_32x32x16_bf16 v[100:115], v[88:91], v[36:39], v[100:115]
    buffer_load_dwordx4 v204, s[4:7], s30 offen offset:2048 lds
    v_mfma_f32_32x32x16_bf16 v[116:131], v[92:95], v[36:39], v[116:131]
    buffer_load_dwordx4 v205, s[4:7], s31 offen offset:3072 lds
    s_add_u32 s4, s4, 128
    s_addc_u32 s5, s5, 0
    s_waitcnt vmcnt(10)
    s_barrier
    ds_read_b64_tr_b16 v[88:89], v212 offset:8192
    ds_read_b64_tr_b16 v[90:91], v212 offset:8704
    ds_read_b64_tr_b16 v[92:93], v213 offset:8192
    ds_read_b64_tr_b16 v[94:95], v213 offset:8704
    s_waitcnt vmcnt(6)
    ds_read_b128 v[48:51], v208 offset:4096
    ds_read_b128 v[52:55], v209 offset:4096
    s_waitcnt lgkmcnt(10)
    v_mfma_f32_32x32x16_bf16 v[100:115], v[64:67], v[40:43], v[100:115]
    s_add_u32 m0, s35, 24576
    s_nop 0
    buffer_load_dwordx4 v206, s[8:11], s33 offen lds
    v_mfma_f32_32x32x16_bf16 v[116:131], v[68:71], v[40:43], v[116:131]
    buffer_load_dwordx4 v206, s[8:11], s32 offen offset:1024 lds
    s_add_u32 s94, s59, 0
    s_and_b32 s94, s94, 3
    s_add_u32 s94, s94, 4
    s_mul_i32 s94, s94, 262144
    s_add_u32 s8, s48, s94
    s_addc_u32 s9, s49, 0
    ds_read_b64_tr_b16 v[64:65], v212 offset:10240
    ds_read_b64_tr_b16 v[66:67], v212 offset:10752
    ds_read_b64_tr_b16 v[68:69], v213 offset:10240
    ds_read_b64_tr_b16 v[70:71], v213 offset:10752
    ds_read_b128 v[56:59], v210 offset:4096
    ds_read_b128 v[60:63], v211 offset:4096
    s_waitcnt lgkmcnt(12)
    v_mfma_f32_32x32x16_bf16 v[100:115], v[76:79], v[44:47], v[100:115]
    v_mfma_f32_32x32x16_bf16 v[116:131], v[80:83], v[44:47], v[116:131]
    ds_read_b64_tr_b16 v[76:77], v212 offset:12288
    ds_read_b64_tr_b16 v[78:79], v212 offset:12800
    ds_read_b64_tr_b16 v[80:81], v213 offset:12288
    ds_read_b64_tr_b16 v[82:83], v213 offset:12800
    s_waitcnt lgkmcnt(11)
    s_waitcnt lgkmcnt(4)
    v_mfma_f32_32x32x16_bf16 v[100:115], v[88:91], v[48:51], v[100:115]
    s_add_u32 m0, s37, 4096
    s_nop 0
    buffer_load_dwordx4 v204, s[4:7], s28 offen offset:0 lds
    v_mfma_f32_32x32x16_bf16 v[116:131], v[92:95], v[48:51], v[116:131]
    buffer_load_dwordx4 v205, s[4:7], s29 offen offset:1024 lds
    ds_read_b64_tr_b16 v[88:89], v212 offset:14336
    ds_read_b64_tr_b16 v[90:91], v212 offset:14848
    ds_read_b64_tr_b16 v[92:93], v213 offset:14336
    ds_read_b64_tr_b16 v[94:95], v213 offset:14848
    v_mfma_f32_32x32x16_bf16 v[100:115], v[64:67], v[52:55], v[100:115]
    buffer_load_dwordx4 v204, s[4:7], s30 offen offset:2048 lds
    v_mfma_f32_32x32x16_bf16 v[116:131], v[68:71], v[52:55], v[116:131]
    buffer_load_dwordx4 v205, s[4:7], s31 offen offset:3072 lds
    s_add_u32 s94, s59, 0
    s_and_b32 s94, s94, 3
    s_add_u32 s94, s94, 4
    s_mul_i32 s94, s94, 256
    s_add_u32 s4, s60, s94
    s_addc_u32 s5, s61, 0
    s_waitcnt vmcnt(10)
    s_barrier
    ds_read_b64_tr_b16 v[64:65], v212 offset:16384
    ds_read_b64_tr_b16 v[66:67], v212 offset:16896
    ds_read_b64_tr_b16 v[68:69], v213 offset:16384
    ds_read_b64_tr_b16 v[70:71], v213 offset:16896
    s_waitcnt vmcnt(6)
    ds_read_b128 v[32:35], v208 offset:0
    ds_read_b128 v[36:39], v209 offset:0
    s_waitcnt lgkmcnt(10)
    v_mfma_f32_32x32x16_bf16 v[100:115], v[76:79], v[56:59], v[100:115]
    s_add_u32 m0, s35, 0
    s_nop 0
    buffer_load_dwordx4 v206, s[8:11], s33 offen lds
    v_mfma_f32_32x32x16_bf16 v[116:131], v[80:83], v[56:59], v[116:131]
    buffer_load_dwordx4 v206, s[8:11], s32 offen offset:1024 lds
    s_add_u32 s8, s8, 131072
    s_addc_u32 s9, s9, 0
    ds_read_b64_tr_b16 v[76:77], v212 offset:18432
    ds_read_b64_tr_b16 v[78:79], v212 offset:18944
    ds_read_b64_tr_b16 v[80:81], v213 offset:18432
    ds_read_b64_tr_b16 v[82:83], v213 offset:18944
    ds_read_b128 v[40:43], v210 offset:0
    ds_read_b128 v[44:47], v211 offset:0
    s_waitcnt lgkmcnt(12)
    v_mfma_f32_32x32x16_bf16 v[100:115], v[88:91], v[60:63], v[100:115]
    v_mfma_f32_32x32x16_bf16 v[116:131], v[92:95], v[60:63], v[116:131]
    ds_read_b64_tr_b16 v[88:89], v212 offset:20480
    ds_read_b64_tr_b16 v[90:91], v212 offset:20992
    ds_read_b64_tr_b16 v[92:93], v213 offset:20480
    ds_read_b64_tr_b16 v[94:95], v213 offset:20992
    s_waitcnt lgkmcnt(11)
    s_waitcnt lgkmcnt(4)
    v_mfma_f32_32x32x16_bf16 v[100:115], v[64:67], v[32:35], v[100:115]
    s_add_u32 m0, s37, 0
    s_nop 0
    buffer_load_dwordx4 v204, s[4:7], s28 offen offset:0 lds
    v_mfma_f32_32x32x16_bf16 v[116:131], v[68:71], v[32:35], v[116:131]
    buffer_load_dwordx4 v205, s[4:7], s29 offen offset:1024 lds
    ds_read_b64_tr_b16 v[64:65], v212 offset:22528
    ds_read_b64_tr_b16 v[66:67], v212 offset:23040
    ds_read_b64_tr_b16 v[68:69], v213 offset:22528
    ds_read_b64_tr_b16 v[70:71], v213 offset:23040
    v_mfma_f32_32x32x16_bf16 v[100:115], v[76:79], v[36:39], v[100:115]
    buffer_load_dwordx4 v204, s[4:7], s30 offen offset:2048 lds
    v_mfma_f32_32x32x16_bf16 v[116:131], v[80:83], v[36:39], v[116:131]
    buffer_load_dwordx4 v205, s[4:7], s31 offen offset:3072 lds
    s_add_u32 s4, s4, 128
    s_addc_u32 s5, s5, 0
    s_waitcnt vmcnt(10)
    s_barrier
    ds_read_b64_tr_b16 v[76:77], v212 offset:24576
    ds_read_b64_tr_b16 v[78:79], v212 offset:25088
    ds_read_b64_tr_b16 v[80:81], v213 offset:24576
    ds_read_b64_tr_b16 v[82:83], v213 offset:25088
    s_waitcnt vmcnt(6)
    ds_read_b128 v[48:51], v208 offset:4096
    ds_read_b128 v[52:55], v209 offset:4096
    s_waitcnt lgkmcnt(10)
    v_mfma_f32_32x32x16_bf16 v[100:115], v[88:91], v[40:43], v[100:115]
    s_add_u32 m0, s35, 8192
    s_nop 0
    buffer_load_dwordx4 v206, s[8:11], s33 offen lds
    v_mfma_f32_32x32x16_bf16 v[116:131], v[92:95], v[40:43], v[116:131]
    buffer_load_dwordx4 v206, s[8:11], s32 offen offset:1024 lds
    s_add_u32 s94, s59, 1
    s_and_b32 s94, s94, 3
    s_add_u32 s94, s94, 4
    s_mul_i32 s94, s94, 262144
    s_add_u32 s8, s48, s94
    s_addc_u32 s9, s49, 0
    ds_read_b64_tr_b16 v[88:89], v212 offset:26624
    ds_read_b64_tr_b16 v[90:91], v212 offset:27136
    ds_read_b64_tr_b16 v[92:93], v213 offset:26624
    ds_read_b64_tr_b16 v[94:95], v213 offset:27136
    ds_read_b128 v[56:59], v210 offset:4096
    ds_read_b128 v[60:63], v211 offset:4096
    s_waitcnt lgkmcnt(12)
    v_mfma_f32_32x32x16_bf16 v[100:115], v[64:67], v[44:47], v[100:115]
    v_mfma_f32_32x32x16_bf16 v[116:131], v[68:71], v[44:47], v[116:131]
    ds_read_b64_tr_b16 v[64:65], v212 offset:28672
    ds_read_b64_tr_b16 v[66:67], v212 offset:29184
    ds_read_b64_tr_b16 v[68:69], v213 offset:28672
    ds_read_b64_tr_b16 v[70:71], v213 offset:29184
    s_waitcnt lgkmcnt(11)
    s_waitcnt lgkmcnt(4)
    v_mfma_f32_32x32x16_bf16 v[100:115], v[76:79], v[48:51], v[100:115]
    s_add_u32 m0, s37, 4096
    s_nop 0
    buffer_load_dwordx4 v204, s[4:7], s28 offen offset:0 lds
    v_mfma_f32_32x32x16_bf16 v[116:131], v[80:83], v[48:51], v[116:131]
    buffer_load_dwordx4 v205, s[4:7], s29 offen offset:1024 lds
    ds_read_b64_tr_b16 v[76:77], v212 offset:30720
    ds_read_b64_tr_b16 v[78:79], v212 offset:31232
    ds_read_b64_tr_b16 v[80:81], v213 offset:30720
    ds_read_b64_tr_b16 v[82:83], v213 offset:31232
    v_mfma_f32_32x32x16_bf16 v[100:115], v[88:91], v[52:55], v[100:115]
    buffer_load_dwordx4 v204, s[4:7], s30 offen offset:2048 lds
    v_mfma_f32_32x32x16_bf16 v[116:131], v[92:95], v[52:55], v[116:131]
    buffer_load_dwordx4 v205, s[4:7], s31 offen offset:3072 lds
    s_add_u32 s94, s59, 1
    s_and_b32 s94, s94, 3
    s_add_u32 s94, s94, 4
    s_mul_i32 s94, s94, 256
    s_add_u32 s4, s60, s94
    s_addc_u32 s5, s61, 0
    s_waitcnt vmcnt(10)
    s_barrier
    ds_read_b64_tr_b16 v[88:89], v212 offset:0
    ds_read_b64_tr_b16 v[90:91], v212 offset:512
    ds_read_b64_tr_b16 v[92:93], v213 offset:0
    ds_read_b64_tr_b16 v[94:95], v213 offset:512
    s_waitcnt vmcnt(6)
    ds_read_b128 v[32:35], v208 offset:0
    ds_read_b128 v[36:39], v209 offset:0
    s_waitcnt lgkmcnt(10)
    v_mfma_f32_32x32x16_bf16 v[100:115], v[64:67], v[56:59], v[100:115]
    s_add_u32 m0, s35, 16384
    s_nop 0
    buffer_load_dwordx4 v206, s[8:11], s33 offen lds
    v_mfma_f32_32x32x16_bf16 v[116:131], v[68:71], v[56:59], v[116:131]
    buffer_load_dwordx4 v206, s[8:11], s32 offen offset:1024 lds
    s_add_u32 s8, s8, 131072
    s_addc_u32 s9, s9, 0
    ds_read_b64_tr_b16 v[64:65], v212 offset:2048
    ds_read_b64_tr_b16 v[66:67], v212 offset:2560
    ds_read_b64_tr_b16 v[68:69], v213 offset:2048
    ds_read_b64_tr_b16 v[70:71], v213 offset:2560
    ds_read_b128 v[40:43], v210 offset:0
    ds_read_b128 v[44:47], v211 offset:0
    s_waitcnt lgkmcnt(12)
    v_mfma_f32_32x32x16_bf16 v[100:115], v[76:79], v[60:63], v[100:115]
    v_mfma_f32_32x32x16_bf16 v[116:131], v[80:83], v[60:63], v[116:131]
    ds_read_b64_tr_b16 v[76:77], v212 offset:4096
    ds_read_b64_tr_b16 v[78:79], v212 offset:4608
    ds_read_b64_tr_b16 v[80:81], v213 offset:4096
    ds_read_b64_tr_b16 v[82:83], v213 offset:4608
    s_waitcnt lgkmcnt(11)
    s_waitcnt lgkmcnt(4)
    v_mfma_f32_32x32x16_bf16 v[100:115], v[88:91], v[32:35], v[100:115]
    s_add_u32 m0, s37, 0
    s_nop 0
    buffer_load_dwordx4 v204, s[4:7], s28 offen offset:0 lds
    v_mfma_f32_32x32x16_bf16 v[116:131], v[92:95], v[32:35], v[116:131]
    buffer_load_dwordx4 v205, s[4:7], s29 offen offset:1024 lds
    ds_read_b64_tr_b16 v[88:89], v212 offset:6144
    ds_read_b64_tr_b16 v[90:91], v212 offset:6656
    ds_read_b64_tr_b16 v[92:93], v213 offset:6144
    ds_read_b64_tr_b16 v[94:95], v213 offset:6656
    v_mfma_f32_32x32x16_bf16 v[100:115], v[64:67], v[36:39], v[100:115]
    buffer_load_dwordx4 v204, s[4:7], s30 offen offset:2048 lds
    v_mfma_f32_32x32x16_bf16 v[116:131], v[68:71], v[36:39], v[116:131]
    buffer_load_dwordx4 v205, s[4:7], s31 offen offset:3072 lds
    s_add_u32 s4, s4, 128
    s_addc_u32 s5, s5, 0
    s_waitcnt vmcnt(10)
    s_barrier
    ds_read_b64_tr_b16 v[64:65], v212 offset:8192
    ds_read_b64_tr_b16 v[66:67], v212 offset:8704
    ds_read_b64_tr_b16 v[68:69], v213 offset:8192
    ds_read_b64_tr_b16 v[70:71], v213 offset:8704
    s_waitcnt vmcnt(6)
    ds_read_b128 v[48:51], v208 offset:4096
    ds_read_b128 v[52:55], v209 offset:4096
    s_waitcnt lgkmcnt(10)
    v_mfma_f32_32x32x16_bf16 v[100:115], v[76:79], v[40:43], v[100:115]
    s_add_u32 m0, s35, 24576
    s_nop 0
    buffer_load_dwordx4 v206, s[8:11], s33 offen lds
    v_mfma_f32_32x32x16_bf16 v[116:131], v[80:83], v[40:43], v[116:131]
    buffer_load_dwordx4 v206, s[8:11], s32 offen offset:1024 lds
    s_add_u32 s94, s59, 2
    s_and_b32 s94, s94, 3
    s_add_u32 s94, s94, 4
    s_mul_i32 s94, s94, 262144
    s_add_u32 s8, s48, s94
    s_addc_u32 s9, s49, 0
    ds_read_b64_tr_b16 v[76:77], v212 offset:10240
    ds_read_b64_tr_b16 v[78:79], v212 offset:10752
    ds_read_b64_tr_b16 v[80:81], v213 offset:10240
    ds_read_b64_tr_b16 v[82:83], v213 offset:10752
    ds_read_b128 v[56:59], v210 offset:4096
    ds_read_b128 v[60:63], v211 offset:4096
    s_waitcnt lgkmcnt(12)
    v_mfma_f32_32x32x16_bf16 v[100:115], v[88:91], v[44:47], v[100:115]
    v_mfma_f32_32x32x16_bf16 v[116:131], v[92:95], v[44:47], v[116:131]
    ds_read_b64_tr_b16 v[88:89], v212 offset:12288
    ds_read_b64_tr_b16 v[90:91], v212 offset:12800
    ds_read_b64_tr_b16 v[92:93], v213 offset:12288
    ds_read_b64_tr_b16 v[94:95], v213 offset:12800
    s_waitcnt lgkmcnt(11)
    s_waitcnt lgkmcnt(4)
    v_mfma_f32_32x32x16_bf16 v[100:115], v[64:67], v[48:51], v[100:115]
    s_add_u32 m0, s37, 4096
    s_nop 0
    buffer_load_dwordx4 v204, s[4:7], s28 offen offset:0 lds
    v_mfma_f32_32x32x16_bf16 v[116:131], v[68:71], v[48:51], v[116:131]
    buffer_load_dwordx4 v205, s[4:7], s29 offen offset:1024 lds
    ds_read_b64_tr_b16 v[64:65], v212 offset:14336
    ds_read_b64_tr_b16 v[66:67], v212 offset:14848
    ds_read_b64_tr_b16 v[68:69], v213 offset:14336
    ds_read_b64_tr_b16 v[70:71], v213 offset:14848
    v_mfma_f32_32x32x16_bf16 v[100:115], v[76:79], v[52:55], v[100:115]
    buffer_load_dwordx4 v204, s[4:7], s30 offen offset:2048 lds
    v_mfma_f32_32x32x16_bf16 v[116:131], v[80:83], v[52:55], v[116:131]
    buffer_load_dwordx4 v205, s[4:7], s31 offen offset:3072 lds
    s_add_u32 s94, s59, 2
    s_and_b32 s94, s94, 3
    s_add_u32 s94, s94, 4
    s_mul_i32 s94, s94, 256
    s_add_u32 s4, s60, s94
    s_addc_u32 s5, s61, 0
    s_waitcnt vmcnt(10)
    s_barrier
    ds_read_b64_tr_b16 v[76:77], v212 offset:16384
    ds_read_b64_tr_b16 v[78:79], v212 offset:16896
    ds_read_b64_tr_b16 v[80:81], v213 offset:16384
    ds_read_b64_tr_b16 v[82:83], v213 offset:16896
    s_waitcnt vmcnt(6)
    ds_read_b128 v[32:35], v208 offset:0
    ds_read_b128 v[36:39], v209 offset:0
    s_waitcnt lgkmcnt(10)
    v_mfma_f32_32x32x16_bf16 v[100:115], v[88:91], v[56:59], v[100:115]
    s_add_u32 m0, s35, 0
    s_nop 0
    buffer_load_dwordx4 v206, s[8:11], s33 offen lds
    v_mfma_f32_32x32x16_bf16 v[116:131], v[92:95], v[56:59], v[116:131]
    buffer_load_dwordx4 v206, s[8:11], s32 offen offset:1024 lds
    s_add_u32 s8, s8, 131072
    s_addc_u32 s9, s9, 0
    ds_read_b64_tr_b16 v[88:89], v212 offset:18432
    ds_read_b64_tr_b16 v[90:91], v212 offset:18944
    ds_read_b64_tr_b16 v[92:93], v213 offset:18432
    ds_read_b64_tr_b16 v[94:95], v213 offset:18944
    ds_read_b128 v[40:43], v210 offset:0
    ds_read_b128 v[44:47], v211 offset:0
    s_waitcnt lgkmcnt(12)
    v_mfma_f32_32x32x16_bf16 v[100:115], v[64:67], v[60:63], v[100:115]
    v_mfma_f32_32x32x16_bf16 v[116:131], v[68:71], v[60:63], v[116:131]
    s_cmp_lg_u32 s86, 0
    s_cbranch_scc1 gated_mix__grouped_kv_mqa__dense_activation_mish__prompt_kernel_n_ec
    s_mov_b32 s52, s82
    s_mov_b32 s53, s83
    s_mov_b32 s54, 0x100
    s_mov_b32 s55, 0x00020000
    s_and_b32 s97, s2, 1
    s_lshl_b32 s97, s97, 7
    v_mov_b32 v4, s97
    buffer_load_dword v253, v4, s[52:55], 0 offen sc1
gated_mix__grouped_kv_mqa__dense_activation_mish__prompt_kernel_n_ec:
    ds_read_b64_tr_b16 v[64:65], v212 offset:20480
    ds_read_b64_tr_b16 v[66:67], v212 offset:20992
    ds_read_b64_tr_b16 v[68:69], v213 offset:20480
    ds_read_b64_tr_b16 v[70:71], v213 offset:20992
    s_waitcnt lgkmcnt(11)
    s_waitcnt lgkmcnt(4)
    v_mfma_f32_32x32x16_bf16 v[100:115], v[76:79], v[32:35], v[100:115]
    s_add_u32 m0, s37, 0
    s_nop 0
    buffer_load_dwordx4 v204, s[4:7], s28 offen offset:0 lds
    v_mfma_f32_32x32x16_bf16 v[116:131], v[80:83], v[32:35], v[116:131]
    buffer_load_dwordx4 v205, s[4:7], s29 offen offset:1024 lds
    ds_read_b64_tr_b16 v[76:77], v212 offset:22528
    ds_read_b64_tr_b16 v[78:79], v212 offset:23040
    ds_read_b64_tr_b16 v[80:81], v213 offset:22528
    ds_read_b64_tr_b16 v[82:83], v213 offset:23040
    v_mfma_f32_32x32x16_bf16 v[100:115], v[88:91], v[36:39], v[100:115]
    buffer_load_dwordx4 v204, s[4:7], s30 offen offset:2048 lds
    v_mfma_f32_32x32x16_bf16 v[116:131], v[92:95], v[36:39], v[116:131]
    buffer_load_dwordx4 v205, s[4:7], s31 offen offset:3072 lds
    s_add_u32 s4, s4, 128
    s_addc_u32 s5, s5, 0
    s_waitcnt vmcnt(10)
    s_barrier
    ds_read_b64_tr_b16 v[88:89], v212 offset:24576
    ds_read_b64_tr_b16 v[90:91], v212 offset:25088
    ds_read_b64_tr_b16 v[92:93], v213 offset:24576
    ds_read_b64_tr_b16 v[94:95], v213 offset:25088
    s_waitcnt vmcnt(6)
    ds_read_b128 v[48:51], v208 offset:4096
    ds_read_b128 v[52:55], v209 offset:4096
    s_waitcnt lgkmcnt(10)
    v_mfma_f32_32x32x16_bf16 v[100:115], v[64:67], v[40:43], v[100:115]
    s_add_u32 m0, s35, 8192
    s_nop 0
    buffer_load_dwordx4 v206, s[8:11], s33 offen lds
    v_mfma_f32_32x32x16_bf16 v[116:131], v[68:71], v[40:43], v[116:131]
    buffer_load_dwordx4 v206, s[8:11], s32 offen offset:1024 lds
    s_add_u32 s94, s59, 3
    s_and_b32 s94, s94, 3
    s_add_u32 s94, s94, 4
    s_mul_i32 s94, s94, 262144
    s_add_u32 s8, s48, s94
    s_addc_u32 s9, s49, 0
    ds_read_b64_tr_b16 v[64:65], v212 offset:26624
    ds_read_b64_tr_b16 v[66:67], v212 offset:27136
    ds_read_b64_tr_b16 v[68:69], v213 offset:26624
    ds_read_b64_tr_b16 v[70:71], v213 offset:27136
    ds_read_b128 v[56:59], v210 offset:4096
    ds_read_b128 v[60:63], v211 offset:4096
    s_waitcnt lgkmcnt(12)
    v_mfma_f32_32x32x16_bf16 v[100:115], v[76:79], v[44:47], v[100:115]
    v_mfma_f32_32x32x16_bf16 v[116:131], v[80:83], v[44:47], v[116:131]
    ds_read_b64_tr_b16 v[76:77], v212 offset:28672
    ds_read_b64_tr_b16 v[78:79], v212 offset:29184
    ds_read_b64_tr_b16 v[80:81], v213 offset:28672
    ds_read_b64_tr_b16 v[82:83], v213 offset:29184
    s_waitcnt lgkmcnt(11)
    s_waitcnt lgkmcnt(4)
    v_mfma_f32_32x32x16_bf16 v[100:115], v[88:91], v[48:51], v[100:115]
    s_add_u32 m0, s37, 4096
    s_nop 0
    buffer_load_dwordx4 v204, s[4:7], s28 offen offset:0 lds
    v_mfma_f32_32x32x16_bf16 v[116:131], v[92:95], v[48:51], v[116:131]
    buffer_load_dwordx4 v205, s[4:7], s29 offen offset:1024 lds
    ds_read_b64_tr_b16 v[88:89], v212 offset:30720
    ds_read_b64_tr_b16 v[90:91], v212 offset:31232
    ds_read_b64_tr_b16 v[92:93], v213 offset:30720
    ds_read_b64_tr_b16 v[94:95], v213 offset:31232
    v_mfma_f32_32x32x16_bf16 v[100:115], v[64:67], v[52:55], v[100:115]
    buffer_load_dwordx4 v204, s[4:7], s30 offen offset:2048 lds
    v_mfma_f32_32x32x16_bf16 v[116:131], v[68:71], v[52:55], v[116:131]
    buffer_load_dwordx4 v205, s[4:7], s31 offen offset:3072 lds
    s_add_u32 s94, s59, 3
    s_and_b32 s94, s94, 3
    s_add_u32 s94, s94, 4
    s_mul_i32 s94, s94, 256
    s_add_u32 s4, s60, s94
    s_addc_u32 s5, s61, 0
    s_waitcnt vmcnt(10)
    s_barrier
    ds_read_b64_tr_b16 v[64:65], v212 offset:0
    ds_read_b64_tr_b16 v[66:67], v212 offset:512
    ds_read_b64_tr_b16 v[68:69], v213 offset:0
    ds_read_b64_tr_b16 v[70:71], v213 offset:512
    s_waitcnt vmcnt(6)
    ds_read_b128 v[32:35], v208 offset:0
    ds_read_b128 v[36:39], v209 offset:0
    s_waitcnt lgkmcnt(10)
    v_mfma_f32_32x32x16_bf16 v[100:115], v[76:79], v[56:59], v[100:115]
    s_add_u32 m0, s35, 16384
    s_nop 0
    buffer_load_dwordx4 v206, s[8:11], s33 offen lds
    v_mfma_f32_32x32x16_bf16 v[116:131], v[80:83], v[56:59], v[116:131]
    buffer_load_dwordx4 v206, s[8:11], s32 offen offset:1024 lds
    s_add_u32 s8, s8, 131072
    s_addc_u32 s9, s9, 0
    ds_read_b64_tr_b16 v[76:77], v212 offset:2048
    ds_read_b64_tr_b16 v[78:79], v212 offset:2560
    ds_read_b64_tr_b16 v[80:81], v213 offset:2048
    ds_read_b64_tr_b16 v[82:83], v213 offset:2560
    ds_read_b128 v[40:43], v210 offset:0
    ds_read_b128 v[44:47], v211 offset:0
    s_waitcnt lgkmcnt(12)
    v_mfma_f32_32x32x16_bf16 v[100:115], v[88:91], v[60:63], v[100:115]
    v_mfma_f32_32x32x16_bf16 v[116:131], v[92:95], v[60:63], v[116:131]
    ds_read_b64_tr_b16 v[88:89], v212 offset:4096
    ds_read_b64_tr_b16 v[90:91], v212 offset:4608
    ds_read_b64_tr_b16 v[92:93], v213 offset:4096
    ds_read_b64_tr_b16 v[94:95], v213 offset:4608
    s_waitcnt lgkmcnt(11)
    s_waitcnt lgkmcnt(4)
    v_mfma_f32_32x32x16_bf16 v[100:115], v[64:67], v[32:35], v[100:115]
    s_add_u32 m0, s37, 0
    s_nop 0
    buffer_load_dwordx4 v204, s[4:7], s28 offen offset:0 lds
    v_mfma_f32_32x32x16_bf16 v[116:131], v[68:71], v[32:35], v[116:131]
    buffer_load_dwordx4 v205, s[4:7], s29 offen offset:1024 lds
    ds_read_b64_tr_b16 v[64:65], v212 offset:6144
    ds_read_b64_tr_b16 v[66:67], v212 offset:6656
    ds_read_b64_tr_b16 v[68:69], v213 offset:6144
    ds_read_b64_tr_b16 v[70:71], v213 offset:6656
    v_mfma_f32_32x32x16_bf16 v[100:115], v[76:79], v[36:39], v[100:115]
    buffer_load_dwordx4 v204, s[4:7], s30 offen offset:2048 lds
    v_mfma_f32_32x32x16_bf16 v[116:131], v[80:83], v[36:39], v[116:131]
    buffer_load_dwordx4 v205, s[4:7], s31 offen offset:3072 lds
    s_add_u32 s4, s4, 128
    s_addc_u32 s5, s5, 0
    s_waitcnt vmcnt(10)
    s_barrier
    ds_read_b64_tr_b16 v[76:77], v212 offset:8192
    ds_read_b64_tr_b16 v[78:79], v212 offset:8704
    ds_read_b64_tr_b16 v[80:81], v213 offset:8192
    ds_read_b64_tr_b16 v[82:83], v213 offset:8704
    s_waitcnt vmcnt(6)
    ds_read_b128 v[48:51], v208 offset:4096
    ds_read_b128 v[52:55], v209 offset:4096
    s_waitcnt lgkmcnt(10)
    v_mfma_f32_32x32x16_bf16 v[100:115], v[88:91], v[40:43], v[100:115]
    s_add_u32 m0, s35, 24576
    s_nop 0
    buffer_load_dwordx4 v206, s[8:11], s33 offen lds
    v_mfma_f32_32x32x16_bf16 v[116:131], v[92:95], v[40:43], v[116:131]
    buffer_load_dwordx4 v206, s[8:11], s32 offen offset:1024 lds
    ds_read_b64_tr_b16 v[88:89], v212 offset:10240
    ds_read_b64_tr_b16 v[90:91], v212 offset:10752
    ds_read_b64_tr_b16 v[92:93], v213 offset:10240
    ds_read_b64_tr_b16 v[94:95], v213 offset:10752
    ds_read_b128 v[56:59], v210 offset:4096
    ds_read_b128 v[60:63], v211 offset:4096
    s_waitcnt lgkmcnt(12)
    v_mfma_f32_32x32x16_bf16 v[100:115], v[64:67], v[44:47], v[100:115]
    v_mfma_f32_32x32x16_bf16 v[116:131], v[68:71], v[44:47], v[116:131]
    ds_read_b64_tr_b16 v[64:65], v212 offset:12288
    ds_read_b64_tr_b16 v[66:67], v212 offset:12800
    ds_read_b64_tr_b16 v[68:69], v213 offset:12288
    ds_read_b64_tr_b16 v[70:71], v213 offset:12800
    s_waitcnt lgkmcnt(11)
    s_waitcnt lgkmcnt(4)
    v_mfma_f32_32x32x16_bf16 v[100:115], v[76:79], v[48:51], v[100:115]
    s_add_u32 m0, s37, 4096
    s_nop 0
    buffer_load_dwordx4 v204, s[4:7], s28 offen offset:0 lds
    v_mfma_f32_32x32x16_bf16 v[116:131], v[80:83], v[48:51], v[116:131]
    buffer_load_dwordx4 v205, s[4:7], s29 offen offset:1024 lds
    ds_read_b64_tr_b16 v[76:77], v212 offset:14336
    ds_read_b64_tr_b16 v[78:79], v212 offset:14848
    ds_read_b64_tr_b16 v[80:81], v213 offset:14336
    ds_read_b64_tr_b16 v[82:83], v213 offset:14848
    v_mfma_f32_32x32x16_bf16 v[100:115], v[88:91], v[52:55], v[100:115]
    buffer_load_dwordx4 v204, s[4:7], s30 offen offset:2048 lds
    v_mfma_f32_32x32x16_bf16 v[116:131], v[92:95], v[52:55], v[116:131]
    buffer_load_dwordx4 v205, s[4:7], s31 offen offset:3072 lds
    s_waitcnt vmcnt(10)
    s_barrier
    ds_read_b64_tr_b16 v[88:89], v212 offset:16384
    ds_read_b64_tr_b16 v[90:91], v212 offset:16896
    ds_read_b64_tr_b16 v[92:93], v213 offset:16384
    ds_read_b64_tr_b16 v[94:95], v213 offset:16896
    s_waitcnt vmcnt(6)
    ds_read_b128 v[32:35], v208 offset:0
    ds_read_b128 v[36:39], v209 offset:0
    s_waitcnt lgkmcnt(10)
    v_mfma_f32_32x32x16_bf16 v[100:115], v[64:67], v[56:59], v[100:115]
    v_mfma_f32_32x32x16_bf16 v[116:131], v[68:71], v[56:59], v[116:131]
    ds_read_b64_tr_b16 v[64:65], v212 offset:18432
    ds_read_b64_tr_b16 v[66:67], v212 offset:18944
    ds_read_b64_tr_b16 v[68:69], v213 offset:18432
    ds_read_b64_tr_b16 v[70:71], v213 offset:18944
    ds_read_b128 v[40:43], v210 offset:0
    ds_read_b128 v[44:47], v211 offset:0
    s_waitcnt lgkmcnt(12)
    v_mfma_f32_32x32x16_bf16 v[100:115], v[76:79], v[60:63], v[100:115]
    v_mfma_f32_32x32x16_bf16 v[116:131], v[80:83], v[60:63], v[116:131]
    ds_read_b64_tr_b16 v[76:77], v212 offset:20480
    ds_read_b64_tr_b16 v[78:79], v212 offset:20992
    ds_read_b64_tr_b16 v[80:81], v213 offset:20480
    ds_read_b64_tr_b16 v[82:83], v213 offset:20992
    s_waitcnt lgkmcnt(11)
    v_mfma_f32_32x32x16_bf16 v[100:115], v[88:91], v[32:35], v[100:115]
    v_mfma_f32_32x32x16_bf16 v[116:131], v[92:95], v[32:35], v[116:131]
    ds_read_b64_tr_b16 v[88:89], v212 offset:22528
    ds_read_b64_tr_b16 v[90:91], v212 offset:23040
    ds_read_b64_tr_b16 v[92:93], v213 offset:22528
    ds_read_b64_tr_b16 v[94:95], v213 offset:23040
    s_waitcnt lgkmcnt(10)
    v_mfma_f32_32x32x16_bf16 v[100:115], v[64:67], v[36:39], v[100:115]
    v_mfma_f32_32x32x16_bf16 v[116:131], v[68:71], v[36:39], v[116:131]
    s_waitcnt vmcnt(4)
    s_barrier
    ds_read_b64_tr_b16 v[64:65], v212 offset:24576
    ds_read_b64_tr_b16 v[66:67], v212 offset:25088
    ds_read_b64_tr_b16 v[68:69], v213 offset:24576
    ds_read_b64_tr_b16 v[70:71], v213 offset:25088
    s_waitcnt vmcnt(0)
    ds_read_b128 v[48:51], v208 offset:4096
    ds_read_b128 v[52:55], v209 offset:4096
    s_waitcnt lgkmcnt(10)
    v_mfma_f32_32x32x16_bf16 v[100:115], v[76:79], v[40:43], v[100:115]
    v_mfma_f32_32x32x16_bf16 v[116:131], v[80:83], v[40:43], v[116:131]
    ds_read_b64_tr_b16 v[76:77], v212 offset:26624
    ds_read_b64_tr_b16 v[78:79], v212 offset:27136
    ds_read_b64_tr_b16 v[80:81], v213 offset:26624
    ds_read_b64_tr_b16 v[82:83], v213 offset:27136
    ds_read_b128 v[56:59], v210 offset:4096
    ds_read_b128 v[60:63], v211 offset:4096
    s_waitcnt lgkmcnt(12)
    v_mfma_f32_32x32x16_bf16 v[100:115], v[88:91], v[44:47], v[100:115]
    v_mfma_f32_32x32x16_bf16 v[116:131], v[92:95], v[44:47], v[116:131]
    ds_read_b64_tr_b16 v[88:89], v212 offset:28672
    ds_read_b64_tr_b16 v[90:91], v212 offset:29184
    ds_read_b64_tr_b16 v[92:93], v213 offset:28672
    ds_read_b64_tr_b16 v[94:95], v213 offset:29184
    s_waitcnt lgkmcnt(11)
    v_mfma_f32_32x32x16_bf16 v[100:115], v[64:67], v[48:51], v[100:115]
    v_mfma_f32_32x32x16_bf16 v[116:131], v[68:71], v[48:51], v[116:131]
    ds_read_b64_tr_b16 v[64:65], v212 offset:30720
    ds_read_b64_tr_b16 v[66:67], v212 offset:31232
    ds_read_b64_tr_b16 v[68:69], v213 offset:30720
    ds_read_b64_tr_b16 v[70:71], v213 offset:31232
    s_waitcnt lgkmcnt(10)
    v_mfma_f32_32x32x16_bf16 v[100:115], v[76:79], v[52:55], v[100:115]
    v_mfma_f32_32x32x16_bf16 v[116:131], v[80:83], v[52:55], v[116:131]
    s_waitcnt lgkmcnt(4)
    v_mfma_f32_32x32x16_bf16 v[100:115], v[88:91], v[56:59], v[100:115]
    v_mfma_f32_32x32x16_bf16 v[116:131], v[92:95], v[56:59], v[116:131]
    s_waitcnt lgkmcnt(0)
    v_mfma_f32_32x32x16_bf16 v[100:115], v[64:67], v[60:63], v[100:115]
    v_mfma_f32_32x32x16_bf16 v[116:131], v[68:71], v[60:63], v[116:131]
    s_nop 15
    v_pk_mul_f32 v[100:101], v[100:101], s[44:45]
    v_pk_mul_f32 v[102:103], v[102:103], s[44:45]
    v_pk_mul_f32 v[104:105], v[104:105], s[44:45]
    v_pk_mul_f32 v[106:107], v[106:107], s[44:45]
    v_pk_mul_f32 v[108:109], v[108:109], s[44:45]
    v_pk_mul_f32 v[110:111], v[110:111], s[44:45]
    v_pk_mul_f32 v[112:113], v[112:113], s[44:45]
    v_pk_mul_f32 v[114:115], v[114:115], s[44:45]
    v_cvt_pk_bf16_f32 v8, v100, v101
    v_cvt_pk_bf16_f32 v9, v102, v103
    v_cvt_pk_bf16_f32 v10, v104, v105
    v_cvt_pk_bf16_f32 v11, v106, v107
    v_cvt_pk_bf16_f32 v12, v108, v109
    v_cvt_pk_bf16_f32 v13, v110, v111
    v_cvt_pk_bf16_f32 v14, v112, v113
    v_cvt_pk_bf16_f32 v15, v114, v115
    v_pk_mul_f32 v[116:117], v[116:117], s[44:45]
    v_pk_mul_f32 v[118:119], v[118:119], s[44:45]
    v_pk_mul_f32 v[120:121], v[120:121], s[44:45]
    v_pk_mul_f32 v[122:123], v[122:123], s[44:45]
    v_pk_mul_f32 v[124:125], v[124:125], s[44:45]
    v_pk_mul_f32 v[126:127], v[126:127], s[44:45]
    v_pk_mul_f32 v[128:129], v[128:129], s[44:45]
    v_pk_mul_f32 v[130:131], v[130:131], s[44:45]
    v_cvt_pk_bf16_f32 v16, v116, v117
    v_cvt_pk_bf16_f32 v17, v118, v119
    v_cvt_pk_bf16_f32 v18, v120, v121
    v_cvt_pk_bf16_f32 v19, v122, v123
    v_cvt_pk_bf16_f32 v20, v124, v125
    v_cvt_pk_bf16_f32 v21, v126, v127
    v_cvt_pk_bf16_f32 v22, v128, v129
    v_cvt_pk_bf16_f32 v23, v130, v131
    s_waitcnt vmcnt(0) lgkmcnt(0)
    s_barrier
    s_branch gated_mix__grouped_kv_mqa__dense_activation_mish__prompt_kernel_attn
gated_mix__grouped_kv_mqa__dense_activation_mish__prompt_kernel_aK:
    s_mov_b32 s12, s64
    s_mov_b32 s13, s65
    s_mov_b32 s14, 0x10000
    s_mov_b32 s15, 0x00020000
    s_mov_b32 s50, s12
    s_mov_b32 s51, s13
    s_add_u32 s94, s59, 0
    s_and_b32 s94, s94, 3
    s_mul_i32 s94, s94, 8192
    s_add_u32 s12, s50, s94
    s_addc_u32 s13, s51, 0
    s_add_u32 m0, s35, 0
    s_nop 0
    buffer_load_dwordx4 v206, s[8:11], s33 offen lds
    buffer_load_dwordx4 v206, s[8:11], s32 offen offset:1024 lds
    s_add_u32 s8, s8, 131072
    s_addc_u32 s9, s9, 0
    s_add_u32 m0, s36, 0
    s_nop 0
    buffer_load_dwordx4 v207, s[12:15], s34 offen lds
    s_add_u32 s12, s12, 4096
    s_addc_u32 s13, s13, 0
    s_add_u32 m0, s37, 0
    s_nop 0
    buffer_load_dwordx4 v204, s[4:7], s28 offen offset:0 lds
    buffer_load_dwordx4 v205, s[4:7], s29 offen offset:1024 lds
    buffer_load_dwordx4 v204, s[4:7], s30 offen offset:2048 lds
    buffer_load_dwordx4 v205, s[4:7], s31 offen offset:3072 lds
    s_add_u32 s4, s4, 128
    s_addc_u32 s5, s5, 0
    s_add_u32 m0, s37, 4096
    s_nop 0
    buffer_load_dwordx4 v204, s[4:7], s28 offen offset:0 lds
    buffer_load_dwordx4 v205, s[4:7], s29 offen offset:1024 lds
    buffer_load_dwordx4 v204, s[4:7], s30 offen offset:2048 lds
    buffer_load_dwordx4 v205, s[4:7], s31 offen offset:3072 lds
    s_add_u32 s94, s59, 1
    s_and_b32 s94, s94, 3
    s_mul_i32 s94, s94, 256
    s_add_u32 s4, s60, s94
    s_addc_u32 s5, s61, 0
    s_add_u32 m0, s35, 8192
    s_nop 0
    buffer_load_dwordx4 v206, s[8:11], s33 offen lds
    buffer_load_dwordx4 v206, s[8:11], s32 offen offset:1024 lds
    s_add_u32 s94, s59, 1
    s_and_b32 s94, s94, 3
    s_mul_i32 s94, s94, 262144
    s_add_u32 s8, s48, s94
    s_addc_u32 s9, s49, 0
    s_add_u32 m0, s36, 4096
    s_nop 0
    buffer_load_dwordx4 v207, s[12:15], s34 offen lds
    s_add_u32 s94, s59, 1
    s_and_b32 s94, s94, 3
    s_mul_i32 s94, s94, 8192
    s_add_u32 s12, s50, s94
    s_addc_u32 s13, s51, 0
    v_and_b32 v3, 31, v1
    v_lshrrev_b32 v4, 5, v1
    v_bfe_u32 v5, v3, 1, 3
    v_xor_b32 v5, v5, v4
    v_lshlrev_b32 v5, 4, v5
    v_lshl_add_u32 v5, v3, 7, v5
    v_add_u32 v5, s37, v5
    v_xor_b32 v208, 0, v5
    v_xor_b32 v209, 32, v5
    v_xor_b32 v210, 64, v5
    v_xor_b32 v211, 96, v5
    v_bfe_u32 v6, v1, 2, 2
    v_bfe_u32 v5, v1, 4, 1
    v_and_b32 v7, 3, v1
    v_lshlrev_b32 v3, 5, v5
    v_lshl_add_u32 v3, v7, 3, v3
    v_lshl_add_u32 v4, v4, 3, v6
    v_lshrrev_b32 v5, 1, v6
    v_lshl_add_u32 v5, v5, 6, v3
    v_lshl_add_u32 v212, v4, 7, v5
    v_xor_b32 v213, 64, v212
    v_lshl_add_u32 v214, v4, 6, v3
    v_add_u32 v214, 32768, v214
    s_waitcnt vmcnt(7)
    s_cmp_lg_u32 s2, 0
    s_cbranch_scc1 gated_mix__grouped_kv_mqa__dense_activation_mish__prompt_kernel_k_clrw
    s_waitcnt vmcnt(0)
gated_mix__grouped_kv_mqa__dense_activation_mish__prompt_kernel_k_clrw:
    s_barrier
    s_add_u32 m0, s35, 16384
    s_nop 0
    buffer_load_dwordx4 v206, s[8:11], s33 offen lds
    buffer_load_dwordx4 v206, s[8:11], s32 offen offset:1024 lds
    s_add_u32 s8, s8, 131072
    s_addc_u32 s9, s9, 0
    s_add_u32 m0, s36, 8192
    s_nop 0
    buffer_load_dwordx4 v207, s[12:15], s34 offen lds
    s_add_u32 s12, s12, 4096
    s_addc_u32 s13, s13, 0
    s_cmp_lg_u32 s2, 0
    s_cbranch_scc1 gated_mix__grouped_kv_mqa__dense_activation_mish__prompt_kernel_k_nopub
    s_cmp_lg_u32 s86, 0
    s_cbranch_scc1 gated_mix__grouped_kv_mqa__dense_activation_mish__prompt_kernel_k_nopub
    s_mov_b32 s52, s82
    s_mov_b32 s53, s83
    s_mov_b32 s54, 0x100
    s_mov_b32 s55, 0x00020000
    v_lshlrev_b32 v6, 7, v1
    v_mov_b32 v4, 1
    v_cmp_gt_u32 vcc, 2, v1
    s_nop 1
    s_and_saveexec_b64 s[90:91], vcc
    buffer_store_dword v4, v6, s[52:55], 0 offen sc1
    s_mov_b64 exec, s[90:91]
gated_mix__grouped_kv_mqa__dense_activation_mish__prompt_kernel_k_nopub:
    ds_read_b128 v[32:35], v208 offset:0
    ds_read_b128 v[36:39], v209 offset:0
    ds_read_b128 v[40:43], v210 offset:0
    ds_read_b128 v[44:47], v211 offset:0
    ds_read_b64_tr_b16 v[64:65], v212 offset:0
    ds_read_b64_tr_b16 v[66:67], v212 offset:512
    ds_read_b64_tr_b16 v[68:69], v213 offset:0
    ds_read_b64_tr_b16 v[70:71], v213 offset:512
    ds_read_b64_tr_b16 v[72:73], v214 offset:0
    ds_read_b64_tr_b16 v[74:75], v214 offset:256
    ds_read_b64_tr_b16 v[76:77], v212 offset:2048
    ds_read_b64_tr_b16 v[78:79], v212 offset:2560
    ds_read_b64_tr_b16 v[80:81], v213 offset:2048
    ds_read_b64_tr_b16 v[82:83], v213 offset:2560
    ds_read_b64_tr_b16 v[84:85], v214 offset:1024
    ds_read_b64_tr_b16 v[86:87], v214 offset:1280
    ds_read_b64_tr_b16 v[88:89], v212 offset:4096
    ds_read_b64_tr_b16 v[90:91], v212 offset:4608
    ds_read_b64_tr_b16 v[92:93], v213 offset:4096
    ds_read_b64_tr_b16 v[94:95], v213 offset:4608
    ds_read_b64_tr_b16 v[96:97], v214 offset:2048
    ds_read_b64_tr_b16 v[98:99], v214 offset:2304
    s_waitcnt lgkmcnt(12)
    v_mfma_f32_32x32x16_bf16 v[100:115], v[64:67], v[32:35], 0
    s_add_u32 m0, s37, 0
    s_nop 0
    buffer_load_dwordx4 v204, s[4:7], s28 offen offset:0 lds
    v_mfma_f32_32x32x16_bf16 v[116:131], v[68:71], v[32:35], 0
    buffer_load_dwordx4 v205, s[4:7], s29 offen offset:1024 lds
    v_mfma_f32_32x32x16_bf16 v[132:147], v[72:75], v[32:35], 0
    ds_read_b64_tr_b16 v[64:65], v212 offset:6144
    ds_read_b64_tr_b16 v[66:67], v212 offset:6656
    ds_read_b64_tr_b16 v[68:69], v213 offset:6144
    ds_read_b64_tr_b16 v[70:71], v213 offset:6656
    ds_read_b64_tr_b16 v[72:73], v214 offset:3072
    ds_read_b64_tr_b16 v[74:75], v214 offset:3328
    s_waitcnt lgkmcnt(12)
    v_mfma_f32_32x32x16_bf16 v[100:115], v[76:79], v[36:39], v[100:115]
    buffer_load_dwordx4 v204, s[4:7], s30 offen offset:2048 lds
    v_mfma_f32_32x32x16_bf16 v[116:131], v[80:83], v[36:39], v[116:131]
    buffer_load_dwordx4 v205, s[4:7], s31 offen offset:3072 lds
    s_add_u32 s4, s4, 128
    s_addc_u32 s5, s5, 0
    v_mfma_f32_32x32x16_bf16 v[132:147], v[84:87], v[36:39], v[132:147]
    s_waitcnt vmcnt(7)
    s_barrier
    ds_read_b64_tr_b16 v[76:77], v212 offset:8192
    ds_read_b64_tr_b16 v[78:79], v212 offset:8704
    ds_read_b64_tr_b16 v[80:81], v213 offset:8192
    ds_read_b64_tr_b16 v[82:83], v213 offset:8704
    ds_read_b64_tr_b16 v[84:85], v214 offset:4096
    ds_read_b64_tr_b16 v[86:87], v214 offset:4352
    ds_read_b128 v[48:51], v208 offset:4096
    ds_read_b128 v[52:55], v209 offset:4096
    s_waitcnt lgkmcnt(14)
    v_mfma_f32_32x32x16_bf16 v[100:115], v[88:91], v[40:43], v[100:115]
    s_add_u32 m0, s35, 24576
    s_nop 0
    buffer_load_dwordx4 v206, s[8:11], s33 offen lds
    v_mfma_f32_32x32x16_bf16 v[116:131], v[92:95], v[40:43], v[116:131]
    buffer_load_dwordx4 v206, s[8:11], s32 offen offset:1024 lds
    s_add_u32 s94, s59, 2
    s_and_b32 s94, s94, 3
    s_mul_i32 s94, s94, 262144
    s_add_u32 s8, s48, s94
    s_addc_u32 s9, s49, 0
    v_mfma_f32_32x32x16_bf16 v[132:147], v[96:99], v[40:43], v[132:147]
    ds_read_b64_tr_b16 v[88:89], v212 offset:10240
    ds_read_b64_tr_b16 v[90:91], v212 offset:10752
    ds_read_b64_tr_b16 v[92:93], v213 offset:10240
    ds_read_b64_tr_b16 v[94:95], v213 offset:10752
    ds_read_b64_tr_b16 v[96:97], v214 offset:5120
    ds_read_b64_tr_b16 v[98:99], v214 offset:5376
    ds_read_b128 v[56:59], v210 offset:4096
    ds_read_b128 v[60:63], v211 offset:4096
    s_waitcnt lgkmcnt(15)
    v_mfma_f32_32x32x16_bf16 v[100:115], v[64:67], v[44:47], v[100:115]
    s_add_u32 m0, s36, 12288
    s_nop 0
    buffer_load_dwordx4 v207, s[12:15], s34 offen lds
    s_add_u32 s94, s59, 2
    s_and_b32 s94, s94, 3
    s_mul_i32 s94, s94, 8192
    s_add_u32 s12, s50, s94
    s_addc_u32 s13, s51, 0
    v_mfma_f32_32x32x16_bf16 v[116:131], v[68:71], v[44:47], v[116:131]
    v_mfma_f32_32x32x16_bf16 v[132:147], v[72:75], v[44:47], v[132:147]
    ds_read_b64_tr_b16 v[64:65], v212 offset:12288
    ds_read_b64_tr_b16 v[66:67], v212 offset:12800
    ds_read_b64_tr_b16 v[68:69], v213 offset:12288
    ds_read_b64_tr_b16 v[70:71], v213 offset:12800
    ds_read_b64_tr_b16 v[72:73], v214 offset:6144
    ds_read_b64_tr_b16 v[74:75], v214 offset:6400
    s_waitcnt lgkmcnt(15)
    s_waitcnt lgkmcnt(6)
    v_mfma_f32_32x32x16_bf16 v[100:115], v[76:79], v[48:51], v[100:115]
    s_add_u32 m0, s37, 4096
    s_nop 0
    buffer_load_dwordx4 v204, s[4:7], s28 offen offset:0 lds
    v_mfma_f32_32x32x16_bf16 v[116:131], v[80:83], v[48:51], v[116:131]
    buffer_load_dwordx4 v205, s[4:7], s29 offen offset:1024 lds
    v_mfma_f32_32x32x16_bf16 v[132:147], v[84:87], v[48:51], v[132:147]
    ds_read_b64_tr_b16 v[76:77], v212 offset:14336
    ds_read_b64_tr_b16 v[78:79], v212 offset:14848
    ds_read_b64_tr_b16 v[80:81], v213 offset:14336
    ds_read_b64_tr_b16 v[82:83], v213 offset:14848
    ds_read_b64_tr_b16 v[84:85], v214 offset:7168
    ds_read_b64_tr_b16 v[86:87], v214 offset:7424
    v_mfma_f32_32x32x16_bf16 v[100:115], v[88:91], v[52:55], v[100:115]
    buffer_load_dwordx4 v204, s[4:7], s30 offen offset:2048 lds
    v_mfma_f32_32x32x16_bf16 v[116:131], v[92:95], v[52:55], v[116:131]
    buffer_load_dwordx4 v205, s[4:7], s31 offen offset:3072 lds
    s_add_u32 s94, s59, 2
    s_and_b32 s94, s94, 3
    s_mul_i32 s94, s94, 256
    s_add_u32 s4, s60, s94
    s_addc_u32 s5, s61, 0
    v_mfma_f32_32x32x16_bf16 v[132:147], v[96:99], v[52:55], v[132:147]
    s_waitcnt vmcnt(11)
    s_barrier
    ds_read_b64_tr_b16 v[88:89], v212 offset:16384
    ds_read_b64_tr_b16 v[90:91], v212 offset:16896
    ds_read_b64_tr_b16 v[92:93], v213 offset:16384
    ds_read_b64_tr_b16 v[94:95], v213 offset:16896
    ds_read_b64_tr_b16 v[96:97], v214 offset:8192
    ds_read_b64_tr_b16 v[98:99], v214 offset:8448
    s_waitcnt vmcnt(7)
    ds_read_b128 v[32:35], v208 offset:0
    ds_read_b128 v[36:39], v209 offset:0
    s_waitcnt lgkmcnt(14)
    v_mfma_f32_32x32x16_bf16 v[100:115], v[64:67], v[56:59], v[100:115]
    s_add_u32 m0, s35, 0
    s_nop 0
    buffer_load_dwordx4 v206, s[8:11], s33 offen lds
    v_mfma_f32_32x32x16_bf16 v[116:131], v[68:71], v[56:59], v[116:131]
    buffer_load_dwordx4 v206, s[8:11], s32 offen offset:1024 lds
    s_add_u32 s8, s8, 131072
    s_addc_u32 s9, s9, 0
    v_mfma_f32_32x32x16_bf16 v[132:147], v[72:75], v[56:59], v[132:147]
    ds_read_b64_tr_b16 v[64:65], v212 offset:18432
    ds_read_b64_tr_b16 v[66:67], v212 offset:18944
    ds_read_b64_tr_b16 v[68:69], v213 offset:18432
    ds_read_b64_tr_b16 v[70:71], v213 offset:18944
    ds_read_b64_tr_b16 v[72:73], v214 offset:9216
    ds_read_b64_tr_b16 v[74:75], v214 offset:9472
    ds_read_b128 v[40:43], v210 offset:0
    ds_read_b128 v[44:47], v211 offset:0
    s_waitcnt lgkmcnt(15)
    v_mfma_f32_32x32x16_bf16 v[100:115], v[76:79], v[60:63], v[100:115]
    s_add_u32 m0, s36, 0
    s_nop 0
    buffer_load_dwordx4 v207, s[12:15], s34 offen lds
    s_add_u32 s12, s12, 4096
    s_addc_u32 s13, s13, 0
    v_mfma_f32_32x32x16_bf16 v[116:131], v[80:83], v[60:63], v[116:131]
    v_mfma_f32_32x32x16_bf16 v[132:147], v[84:87], v[60:63], v[132:147]
    ds_read_b64_tr_b16 v[76:77], v212 offset:20480
    ds_read_b64_tr_b16 v[78:79], v212 offset:20992
    ds_read_b64_tr_b16 v[80:81], v213 offset:20480
    ds_read_b64_tr_b16 v[82:83], v213 offset:20992
    ds_read_b64_tr_b16 v[84:85], v214 offset:10240
    ds_read_b64_tr_b16 v[86:87], v214 offset:10496
    s_waitcnt lgkmcnt(15)
    s_waitcnt lgkmcnt(6)
    v_mfma_f32_32x32x16_bf16 v[100:115], v[88:91], v[32:35], v[100:115]
    s_add_u32 m0, s37, 0
    s_nop 0
    buffer_load_dwordx4 v204, s[4:7], s28 offen offset:0 lds
    v_mfma_f32_32x32x16_bf16 v[116:131], v[92:95], v[32:35], v[116:131]
    buffer_load_dwordx4 v205, s[4:7], s29 offen offset:1024 lds
    v_mfma_f32_32x32x16_bf16 v[132:147], v[96:99], v[32:35], v[132:147]
    ds_read_b64_tr_b16 v[88:89], v212 offset:22528
    ds_read_b64_tr_b16 v[90:91], v212 offset:23040
    ds_read_b64_tr_b16 v[92:93], v213 offset:22528
    ds_read_b64_tr_b16 v[94:95], v213 offset:23040
    ds_read_b64_tr_b16 v[96:97], v214 offset:11264
    ds_read_b64_tr_b16 v[98:99], v214 offset:11520
    v_mfma_f32_32x32x16_bf16 v[100:115], v[64:67], v[36:39], v[100:115]
    buffer_load_dwordx4 v204, s[4:7], s30 offen offset:2048 lds
    v_mfma_f32_32x32x16_bf16 v[116:131], v[68:71], v[36:39], v[116:131]
    buffer_load_dwordx4 v205, s[4:7], s31 offen offset:3072 lds
    s_add_u32 s4, s4, 128
    s_addc_u32 s5, s5, 0
    v_mfma_f32_32x32x16_bf16 v[132:147], v[72:75], v[36:39], v[132:147]
    s_waitcnt vmcnt(11)
    s_barrier
    ds_read_b64_tr_b16 v[64:65], v212 offset:24576
    ds_read_b64_tr_b16 v[66:67], v212 offset:25088
    ds_read_b64_tr_b16 v[68:69], v213 offset:24576
    ds_read_b64_tr_b16 v[70:71], v213 offset:25088
    ds_read_b64_tr_b16 v[72:73], v214 offset:12288
    ds_read_b64_tr_b16 v[74:75], v214 offset:12544
    s_waitcnt vmcnt(7)
    ds_read_b128 v[48:51], v208 offset:4096
    ds_read_b128 v[52:55], v209 offset:4096
    s_waitcnt lgkmcnt(14)
    v_mfma_f32_32x32x16_bf16 v[100:115], v[76:79], v[40:43], v[100:115]
    s_add_u32 m0, s35, 8192
    s_nop 0
    buffer_load_dwordx4 v206, s[8:11], s33 offen lds
    v_mfma_f32_32x32x16_bf16 v[116:131], v[80:83], v[40:43], v[116:131]
    buffer_load_dwordx4 v206, s[8:11], s32 offen offset:1024 lds
    s_add_u32 s94, s59, 3
    s_and_b32 s94, s94, 3
    s_mul_i32 s94, s94, 262144
    s_add_u32 s8, s48, s94
    s_addc_u32 s9, s49, 0
    v_mfma_f32_32x32x16_bf16 v[132:147], v[84:87], v[40:43], v[132:147]
    ds_read_b64_tr_b16 v[76:77], v212 offset:26624
    ds_read_b64_tr_b16 v[78:79], v212 offset:27136
    ds_read_b64_tr_b16 v[80:81], v213 offset:26624
    ds_read_b64_tr_b16 v[82:83], v213 offset:27136
    ds_read_b64_tr_b16 v[84:85], v214 offset:13312
    ds_read_b64_tr_b16 v[86:87], v214 offset:13568
    ds_read_b128 v[56:59], v210 offset:4096
    ds_read_b128 v[60:63], v211 offset:4096
    s_waitcnt lgkmcnt(15)
    v_mfma_f32_32x32x16_bf16 v[100:115], v[88:91], v[44:47], v[100:115]
    s_add_u32 m0, s36, 4096
    s_nop 0
    buffer_load_dwordx4 v207, s[12:15], s34 offen lds
    s_add_u32 s94, s59, 3
    s_and_b32 s94, s94, 3
    s_mul_i32 s94, s94, 8192
    s_add_u32 s12, s50, s94
    s_addc_u32 s13, s51, 0
    v_mfma_f32_32x32x16_bf16 v[116:131], v[92:95], v[44:47], v[116:131]
    v_mfma_f32_32x32x16_bf16 v[132:147], v[96:99], v[44:47], v[132:147]
    ds_read_b64_tr_b16 v[88:89], v212 offset:28672
    ds_read_b64_tr_b16 v[90:91], v212 offset:29184
    ds_read_b64_tr_b16 v[92:93], v213 offset:28672
    ds_read_b64_tr_b16 v[94:95], v213 offset:29184
    ds_read_b64_tr_b16 v[96:97], v214 offset:14336
    ds_read_b64_tr_b16 v[98:99], v214 offset:14592
    s_waitcnt lgkmcnt(15)
    s_waitcnt lgkmcnt(6)
    v_mfma_f32_32x32x16_bf16 v[100:115], v[64:67], v[48:51], v[100:115]
    s_add_u32 m0, s37, 4096
    s_nop 0
    buffer_load_dwordx4 v204, s[4:7], s28 offen offset:0 lds
    v_mfma_f32_32x32x16_bf16 v[116:131], v[68:71], v[48:51], v[116:131]
    buffer_load_dwordx4 v205, s[4:7], s29 offen offset:1024 lds
    v_mfma_f32_32x32x16_bf16 v[132:147], v[72:75], v[48:51], v[132:147]
    ds_read_b64_tr_b16 v[64:65], v212 offset:30720
    ds_read_b64_tr_b16 v[66:67], v212 offset:31232
    ds_read_b64_tr_b16 v[68:69], v213 offset:30720
    ds_read_b64_tr_b16 v[70:71], v213 offset:31232
    ds_read_b64_tr_b16 v[72:73], v214 offset:15360
    ds_read_b64_tr_b16 v[74:75], v214 offset:15616
    v_mfma_f32_32x32x16_bf16 v[100:115], v[76:79], v[52:55], v[100:115]
    buffer_load_dwordx4 v204, s[4:7], s30 offen offset:2048 lds
    v_mfma_f32_32x32x16_bf16 v[116:131], v[80:83], v[52:55], v[116:131]
    buffer_load_dwordx4 v205, s[4:7], s31 offen offset:3072 lds
    s_add_u32 s94, s59, 3
    s_and_b32 s94, s94, 3
    s_mul_i32 s94, s94, 256
    s_add_u32 s4, s60, s94
    s_addc_u32 s5, s61, 0
    v_mfma_f32_32x32x16_bf16 v[132:147], v[84:87], v[52:55], v[132:147]
    s_waitcnt vmcnt(11)
    s_barrier
    ds_read_b64_tr_b16 v[76:77], v212 offset:0
    ds_read_b64_tr_b16 v[78:79], v212 offset:512
    ds_read_b64_tr_b16 v[80:81], v213 offset:0
    ds_read_b64_tr_b16 v[82:83], v213 offset:512
    ds_read_b64_tr_b16 v[84:85], v214 offset:0
    ds_read_b64_tr_b16 v[86:87], v214 offset:256
    s_waitcnt vmcnt(7)
    ds_read_b128 v[32:35], v208 offset:0
    ds_read_b128 v[36:39], v209 offset:0
    s_waitcnt lgkmcnt(14)
    v_mfma_f32_32x32x16_bf16 v[100:115], v[88:91], v[56:59], v[100:115]
    s_add_u32 m0, s35, 16384
    s_nop 0
    buffer_load_dwordx4 v206, s[8:11], s33 offen lds
    v_mfma_f32_32x32x16_bf16 v[116:131], v[92:95], v[56:59], v[116:131]
    buffer_load_dwordx4 v206, s[8:11], s32 offen offset:1024 lds
    s_add_u32 s8, s8, 131072
    s_addc_u32 s9, s9, 0
    v_mfma_f32_32x32x16_bf16 v[132:147], v[96:99], v[56:59], v[132:147]
    ds_read_b64_tr_b16 v[88:89], v212 offset:2048
    ds_read_b64_tr_b16 v[90:91], v212 offset:2560
    ds_read_b64_tr_b16 v[92:93], v213 offset:2048
    ds_read_b64_tr_b16 v[94:95], v213 offset:2560
    ds_read_b64_tr_b16 v[96:97], v214 offset:1024
    ds_read_b64_tr_b16 v[98:99], v214 offset:1280
    ds_read_b128 v[40:43], v210 offset:0
    ds_read_b128 v[44:47], v211 offset:0
    s_waitcnt lgkmcnt(15)
    v_mfma_f32_32x32x16_bf16 v[100:115], v[64:67], v[60:63], v[100:115]
    s_add_u32 m0, s36, 8192
    s_nop 0
    buffer_load_dwordx4 v207, s[12:15], s34 offen lds
    s_add_u32 s12, s12, 4096
    s_addc_u32 s13, s13, 0
    v_mfma_f32_32x32x16_bf16 v[116:131], v[68:71], v[60:63], v[116:131]
    v_mfma_f32_32x32x16_bf16 v[132:147], v[72:75], v[60:63], v[132:147]
    ds_read_b64_tr_b16 v[64:65], v212 offset:4096
    ds_read_b64_tr_b16 v[66:67], v212 offset:4608
    ds_read_b64_tr_b16 v[68:69], v213 offset:4096
    ds_read_b64_tr_b16 v[70:71], v213 offset:4608
    ds_read_b64_tr_b16 v[72:73], v214 offset:2048
    ds_read_b64_tr_b16 v[74:75], v214 offset:2304
    s_waitcnt lgkmcnt(15)
    s_waitcnt lgkmcnt(6)
    v_mfma_f32_32x32x16_bf16 v[100:115], v[76:79], v[32:35], v[100:115]
    s_add_u32 m0, s37, 0
    s_nop 0
    buffer_load_dwordx4 v204, s[4:7], s28 offen offset:0 lds
    v_mfma_f32_32x32x16_bf16 v[116:131], v[80:83], v[32:35], v[116:131]
    buffer_load_dwordx4 v205, s[4:7], s29 offen offset:1024 lds
    v_mfma_f32_32x32x16_bf16 v[132:147], v[84:87], v[32:35], v[132:147]
    ds_read_b64_tr_b16 v[76:77], v212 offset:6144
    ds_read_b64_tr_b16 v[78:79], v212 offset:6656
    ds_read_b64_tr_b16 v[80:81], v213 offset:6144
    ds_read_b64_tr_b16 v[82:83], v213 offset:6656
    ds_read_b64_tr_b16 v[84:85], v214 offset:3072
    ds_read_b64_tr_b16 v[86:87], v214 offset:3328
    v_mfma_f32_32x32x16_bf16 v[100:115], v[88:91], v[36:39], v[100:115]
    buffer_load_dwordx4 v204, s[4:7], s30 offen offset:2048 lds
    v_mfma_f32_32x32x16_bf16 v[116:131], v[92:95], v[36:39], v[116:131]
    buffer_load_dwordx4 v205, s[4:7], s31 offen offset:3072 lds
    s_add_u32 s4, s4, 128
    s_addc_u32 s5, s5, 0
    v_mfma_f32_32x32x16_bf16 v[132:147], v[96:99], v[36:39], v[132:147]
    s_waitcnt vmcnt(11)
    s_barrier
    ds_read_b64_tr_b16 v[88:89], v212 offset:8192
    ds_read_b64_tr_b16 v[90:91], v212 offset:8704
    ds_read_b64_tr_b16 v[92:93], v213 offset:8192
    ds_read_b64_tr_b16 v[94:95], v213 offset:8704
    ds_read_b64_tr_b16 v[96:97], v214 offset:4096
    ds_read_b64_tr_b16 v[98:99], v214 offset:4352
    s_waitcnt vmcnt(7)
    ds_read_b128 v[48:51], v208 offset:4096
    ds_read_b128 v[52:55], v209 offset:4096
    s_waitcnt lgkmcnt(14)
    v_mfma_f32_32x32x16_bf16 v[100:115], v[64:67], v[40:43], v[100:115]
    s_add_u32 m0, s35, 24576
    s_nop 0
    buffer_load_dwordx4 v206, s[8:11], s33 offen lds
    v_mfma_f32_32x32x16_bf16 v[116:131], v[68:71], v[40:43], v[116:131]
    buffer_load_dwordx4 v206, s[8:11], s32 offen offset:1024 lds
    s_add_u32 s94, s59, 0
    s_and_b32 s94, s94, 3
    s_add_u32 s94, s94, 4
    s_mul_i32 s94, s94, 262144
    s_add_u32 s8, s48, s94
    s_addc_u32 s9, s49, 0
    v_mfma_f32_32x32x16_bf16 v[132:147], v[72:75], v[40:43], v[132:147]
    ds_read_b64_tr_b16 v[64:65], v212 offset:10240
    ds_read_b64_tr_b16 v[66:67], v212 offset:10752
    ds_read_b64_tr_b16 v[68:69], v213 offset:10240
    ds_read_b64_tr_b16 v[70:71], v213 offset:10752
    ds_read_b64_tr_b16 v[72:73], v214 offset:5120
    ds_read_b64_tr_b16 v[74:75], v214 offset:5376
    ds_read_b128 v[56:59], v210 offset:4096
    ds_read_b128 v[60:63], v211 offset:4096
    s_waitcnt lgkmcnt(15)
    v_mfma_f32_32x32x16_bf16 v[100:115], v[76:79], v[44:47], v[100:115]
    s_add_u32 m0, s36, 12288
    s_nop 0
    buffer_load_dwordx4 v207, s[12:15], s34 offen lds
    s_add_u32 s94, s59, 0
    s_and_b32 s94, s94, 3
    s_add_u32 s94, s94, 4
    s_mul_i32 s94, s94, 8192
    s_add_u32 s12, s50, s94
    s_addc_u32 s13, s51, 0
    v_mfma_f32_32x32x16_bf16 v[116:131], v[80:83], v[44:47], v[116:131]
    v_mfma_f32_32x32x16_bf16 v[132:147], v[84:87], v[44:47], v[132:147]
    ds_read_b64_tr_b16 v[76:77], v212 offset:12288
    ds_read_b64_tr_b16 v[78:79], v212 offset:12800
    ds_read_b64_tr_b16 v[80:81], v213 offset:12288
    ds_read_b64_tr_b16 v[82:83], v213 offset:12800
    ds_read_b64_tr_b16 v[84:85], v214 offset:6144
    ds_read_b64_tr_b16 v[86:87], v214 offset:6400
    s_waitcnt lgkmcnt(15)
    s_waitcnt lgkmcnt(6)
    v_mfma_f32_32x32x16_bf16 v[100:115], v[88:91], v[48:51], v[100:115]
    s_add_u32 m0, s37, 4096
    s_nop 0
    buffer_load_dwordx4 v204, s[4:7], s28 offen offset:0 lds
    v_mfma_f32_32x32x16_bf16 v[116:131], v[92:95], v[48:51], v[116:131]
    buffer_load_dwordx4 v205, s[4:7], s29 offen offset:1024 lds
    v_mfma_f32_32x32x16_bf16 v[132:147], v[96:99], v[48:51], v[132:147]
    ds_read_b64_tr_b16 v[88:89], v212 offset:14336
    ds_read_b64_tr_b16 v[90:91], v212 offset:14848
    ds_read_b64_tr_b16 v[92:93], v213 offset:14336
    ds_read_b64_tr_b16 v[94:95], v213 offset:14848
    ds_read_b64_tr_b16 v[96:97], v214 offset:7168
    ds_read_b64_tr_b16 v[98:99], v214 offset:7424
    v_mfma_f32_32x32x16_bf16 v[100:115], v[64:67], v[52:55], v[100:115]
    buffer_load_dwordx4 v204, s[4:7], s30 offen offset:2048 lds
    v_mfma_f32_32x32x16_bf16 v[116:131], v[68:71], v[52:55], v[116:131]
    buffer_load_dwordx4 v205, s[4:7], s31 offen offset:3072 lds
    s_add_u32 s94, s59, 0
    s_and_b32 s94, s94, 3
    s_add_u32 s94, s94, 4
    s_mul_i32 s94, s94, 256
    s_add_u32 s4, s60, s94
    s_addc_u32 s5, s61, 0
    v_mfma_f32_32x32x16_bf16 v[132:147], v[72:75], v[52:55], v[132:147]
    s_waitcnt vmcnt(11)
    s_barrier
    ds_read_b64_tr_b16 v[64:65], v212 offset:16384
    ds_read_b64_tr_b16 v[66:67], v212 offset:16896
    ds_read_b64_tr_b16 v[68:69], v213 offset:16384
    ds_read_b64_tr_b16 v[70:71], v213 offset:16896
    ds_read_b64_tr_b16 v[72:73], v214 offset:8192
    ds_read_b64_tr_b16 v[74:75], v214 offset:8448
    s_waitcnt vmcnt(7)
    ds_read_b128 v[32:35], v208 offset:0
    ds_read_b128 v[36:39], v209 offset:0
    s_waitcnt lgkmcnt(14)
    v_mfma_f32_32x32x16_bf16 v[100:115], v[76:79], v[56:59], v[100:115]
    s_add_u32 m0, s35, 0
    s_nop 0
    buffer_load_dwordx4 v206, s[8:11], s33 offen lds
    v_mfma_f32_32x32x16_bf16 v[116:131], v[80:83], v[56:59], v[116:131]
    buffer_load_dwordx4 v206, s[8:11], s32 offen offset:1024 lds
    s_add_u32 s8, s8, 131072
    s_addc_u32 s9, s9, 0
    v_mfma_f32_32x32x16_bf16 v[132:147], v[84:87], v[56:59], v[132:147]
    ds_read_b64_tr_b16 v[76:77], v212 offset:18432
    ds_read_b64_tr_b16 v[78:79], v212 offset:18944
    ds_read_b64_tr_b16 v[80:81], v213 offset:18432
    ds_read_b64_tr_b16 v[82:83], v213 offset:18944
    ds_read_b64_tr_b16 v[84:85], v214 offset:9216
    ds_read_b64_tr_b16 v[86:87], v214 offset:9472
    ds_read_b128 v[40:43], v210 offset:0
    ds_read_b128 v[44:47], v211 offset:0
    s_waitcnt lgkmcnt(15)
    v_mfma_f32_32x32x16_bf16 v[100:115], v[88:91], v[60:63], v[100:115]
    s_add_u32 m0, s36, 0
    s_nop 0
    buffer_load_dwordx4 v207, s[12:15], s34 offen lds
    s_add_u32 s12, s12, 4096
    s_addc_u32 s13, s13, 0
    v_mfma_f32_32x32x16_bf16 v[116:131], v[92:95], v[60:63], v[116:131]
    v_mfma_f32_32x32x16_bf16 v[132:147], v[96:99], v[60:63], v[132:147]
    ds_read_b64_tr_b16 v[88:89], v212 offset:20480
    ds_read_b64_tr_b16 v[90:91], v212 offset:20992
    ds_read_b64_tr_b16 v[92:93], v213 offset:20480
    ds_read_b64_tr_b16 v[94:95], v213 offset:20992
    ds_read_b64_tr_b16 v[96:97], v214 offset:10240
    ds_read_b64_tr_b16 v[98:99], v214 offset:10496
    s_waitcnt lgkmcnt(15)
    s_waitcnt lgkmcnt(6)
    v_mfma_f32_32x32x16_bf16 v[100:115], v[64:67], v[32:35], v[100:115]
    s_add_u32 m0, s37, 0
    s_nop 0
    buffer_load_dwordx4 v204, s[4:7], s28 offen offset:0 lds
    v_mfma_f32_32x32x16_bf16 v[116:131], v[68:71], v[32:35], v[116:131]
    buffer_load_dwordx4 v205, s[4:7], s29 offen offset:1024 lds
    v_mfma_f32_32x32x16_bf16 v[132:147], v[72:75], v[32:35], v[132:147]
    ds_read_b64_tr_b16 v[64:65], v212 offset:22528
    ds_read_b64_tr_b16 v[66:67], v212 offset:23040
    ds_read_b64_tr_b16 v[68:69], v213 offset:22528
    ds_read_b64_tr_b16 v[70:71], v213 offset:23040
    ds_read_b64_tr_b16 v[72:73], v214 offset:11264
    ds_read_b64_tr_b16 v[74:75], v214 offset:11520
    v_mfma_f32_32x32x16_bf16 v[100:115], v[76:79], v[36:39], v[100:115]
    buffer_load_dwordx4 v204, s[4:7], s30 offen offset:2048 lds
    v_mfma_f32_32x32x16_bf16 v[116:131], v[80:83], v[36:39], v[116:131]
    buffer_load_dwordx4 v205, s[4:7], s31 offen offset:3072 lds
    s_add_u32 s4, s4, 128
    s_addc_u32 s5, s5, 0
    v_mfma_f32_32x32x16_bf16 v[132:147], v[84:87], v[36:39], v[132:147]
    s_waitcnt vmcnt(11)
    s_barrier
    ds_read_b64_tr_b16 v[76:77], v212 offset:24576
    ds_read_b64_tr_b16 v[78:79], v212 offset:25088
    ds_read_b64_tr_b16 v[80:81], v213 offset:24576
    ds_read_b64_tr_b16 v[82:83], v213 offset:25088
    ds_read_b64_tr_b16 v[84:85], v214 offset:12288
    ds_read_b64_tr_b16 v[86:87], v214 offset:12544
    s_waitcnt vmcnt(7)
    ds_read_b128 v[48:51], v208 offset:4096
    ds_read_b128 v[52:55], v209 offset:4096
    s_waitcnt lgkmcnt(14)
    v_mfma_f32_32x32x16_bf16 v[100:115], v[88:91], v[40:43], v[100:115]
    s_add_u32 m0, s35, 8192
    s_nop 0
    buffer_load_dwordx4 v206, s[8:11], s33 offen lds
    v_mfma_f32_32x32x16_bf16 v[116:131], v[92:95], v[40:43], v[116:131]
    buffer_load_dwordx4 v206, s[8:11], s32 offen offset:1024 lds
    s_add_u32 s94, s59, 1
    s_and_b32 s94, s94, 3
    s_add_u32 s94, s94, 4
    s_mul_i32 s94, s94, 262144
    s_add_u32 s8, s48, s94
    s_addc_u32 s9, s49, 0
    v_mfma_f32_32x32x16_bf16 v[132:147], v[96:99], v[40:43], v[132:147]
    ds_read_b64_tr_b16 v[88:89], v212 offset:26624
    ds_read_b64_tr_b16 v[90:91], v212 offset:27136
    ds_read_b64_tr_b16 v[92:93], v213 offset:26624
    ds_read_b64_tr_b16 v[94:95], v213 offset:27136
    ds_read_b64_tr_b16 v[96:97], v214 offset:13312
    ds_read_b64_tr_b16 v[98:99], v214 offset:13568
    ds_read_b128 v[56:59], v210 offset:4096
    ds_read_b128 v[60:63], v211 offset:4096
    s_waitcnt lgkmcnt(15)
    v_mfma_f32_32x32x16_bf16 v[100:115], v[64:67], v[44:47], v[100:115]
    s_add_u32 m0, s36, 4096
    s_nop 0
    buffer_load_dwordx4 v207, s[12:15], s34 offen lds
    s_add_u32 s94, s59, 1
    s_and_b32 s94, s94, 3
    s_add_u32 s94, s94, 4
    s_mul_i32 s94, s94, 8192
    s_add_u32 s12, s50, s94
    s_addc_u32 s13, s51, 0
    v_mfma_f32_32x32x16_bf16 v[116:131], v[68:71], v[44:47], v[116:131]
    v_mfma_f32_32x32x16_bf16 v[132:147], v[72:75], v[44:47], v[132:147]
    ds_read_b64_tr_b16 v[64:65], v212 offset:28672
    ds_read_b64_tr_b16 v[66:67], v212 offset:29184
    ds_read_b64_tr_b16 v[68:69], v213 offset:28672
    ds_read_b64_tr_b16 v[70:71], v213 offset:29184
    ds_read_b64_tr_b16 v[72:73], v214 offset:14336
    ds_read_b64_tr_b16 v[74:75], v214 offset:14592
    s_waitcnt lgkmcnt(15)
    s_waitcnt lgkmcnt(6)
    v_mfma_f32_32x32x16_bf16 v[100:115], v[76:79], v[48:51], v[100:115]
    s_add_u32 m0, s37, 4096
    s_nop 0
    buffer_load_dwordx4 v204, s[4:7], s28 offen offset:0 lds
    v_mfma_f32_32x32x16_bf16 v[116:131], v[80:83], v[48:51], v[116:131]
    buffer_load_dwordx4 v205, s[4:7], s29 offen offset:1024 lds
    v_mfma_f32_32x32x16_bf16 v[132:147], v[84:87], v[48:51], v[132:147]
    ds_read_b64_tr_b16 v[76:77], v212 offset:30720
    ds_read_b64_tr_b16 v[78:79], v212 offset:31232
    ds_read_b64_tr_b16 v[80:81], v213 offset:30720
    ds_read_b64_tr_b16 v[82:83], v213 offset:31232
    ds_read_b64_tr_b16 v[84:85], v214 offset:15360
    ds_read_b64_tr_b16 v[86:87], v214 offset:15616
    v_mfma_f32_32x32x16_bf16 v[100:115], v[88:91], v[52:55], v[100:115]
    buffer_load_dwordx4 v204, s[4:7], s30 offen offset:2048 lds
    v_mfma_f32_32x32x16_bf16 v[116:131], v[92:95], v[52:55], v[116:131]
    buffer_load_dwordx4 v205, s[4:7], s31 offen offset:3072 lds
    s_add_u32 s94, s59, 1
    s_and_b32 s94, s94, 3
    s_add_u32 s94, s94, 4
    s_mul_i32 s94, s94, 256
    s_add_u32 s4, s60, s94
    s_addc_u32 s5, s61, 0
    v_mfma_f32_32x32x16_bf16 v[132:147], v[96:99], v[52:55], v[132:147]
    s_waitcnt vmcnt(11)
    s_barrier
    ds_read_b64_tr_b16 v[88:89], v212 offset:0
    ds_read_b64_tr_b16 v[90:91], v212 offset:512
    ds_read_b64_tr_b16 v[92:93], v213 offset:0
    ds_read_b64_tr_b16 v[94:95], v213 offset:512
    ds_read_b64_tr_b16 v[96:97], v214 offset:0
    ds_read_b64_tr_b16 v[98:99], v214 offset:256
    s_waitcnt vmcnt(7)
    ds_read_b128 v[32:35], v208 offset:0
    ds_read_b128 v[36:39], v209 offset:0
    s_waitcnt lgkmcnt(14)
    v_mfma_f32_32x32x16_bf16 v[100:115], v[64:67], v[56:59], v[100:115]
    s_add_u32 m0, s35, 16384
    s_nop 0
    buffer_load_dwordx4 v206, s[8:11], s33 offen lds
    v_mfma_f32_32x32x16_bf16 v[116:131], v[68:71], v[56:59], v[116:131]
    buffer_load_dwordx4 v206, s[8:11], s32 offen offset:1024 lds
    s_add_u32 s8, s8, 131072
    s_addc_u32 s9, s9, 0
    v_mfma_f32_32x32x16_bf16 v[132:147], v[72:75], v[56:59], v[132:147]
    ds_read_b64_tr_b16 v[64:65], v212 offset:2048
    ds_read_b64_tr_b16 v[66:67], v212 offset:2560
    ds_read_b64_tr_b16 v[68:69], v213 offset:2048
    ds_read_b64_tr_b16 v[70:71], v213 offset:2560
    ds_read_b64_tr_b16 v[72:73], v214 offset:1024
    ds_read_b64_tr_b16 v[74:75], v214 offset:1280
    ds_read_b128 v[40:43], v210 offset:0
    ds_read_b128 v[44:47], v211 offset:0
    s_waitcnt lgkmcnt(15)
    v_mfma_f32_32x32x16_bf16 v[100:115], v[76:79], v[60:63], v[100:115]
    s_add_u32 m0, s36, 8192
    s_nop 0
    buffer_load_dwordx4 v207, s[12:15], s34 offen lds
    s_add_u32 s12, s12, 4096
    s_addc_u32 s13, s13, 0
    v_mfma_f32_32x32x16_bf16 v[116:131], v[80:83], v[60:63], v[116:131]
    v_mfma_f32_32x32x16_bf16 v[132:147], v[84:87], v[60:63], v[132:147]
    ds_read_b64_tr_b16 v[76:77], v212 offset:4096
    ds_read_b64_tr_b16 v[78:79], v212 offset:4608
    ds_read_b64_tr_b16 v[80:81], v213 offset:4096
    ds_read_b64_tr_b16 v[82:83], v213 offset:4608
    ds_read_b64_tr_b16 v[84:85], v214 offset:2048
    ds_read_b64_tr_b16 v[86:87], v214 offset:2304
    s_waitcnt lgkmcnt(15)
    s_waitcnt lgkmcnt(6)
    v_mfma_f32_32x32x16_bf16 v[100:115], v[88:91], v[32:35], v[100:115]
    s_add_u32 m0, s37, 0
    s_nop 0
    buffer_load_dwordx4 v204, s[4:7], s28 offen offset:0 lds
    v_mfma_f32_32x32x16_bf16 v[116:131], v[92:95], v[32:35], v[116:131]
    buffer_load_dwordx4 v205, s[4:7], s29 offen offset:1024 lds
    v_mfma_f32_32x32x16_bf16 v[132:147], v[96:99], v[32:35], v[132:147]
    ds_read_b64_tr_b16 v[88:89], v212 offset:6144
    ds_read_b64_tr_b16 v[90:91], v212 offset:6656
    ds_read_b64_tr_b16 v[92:93], v213 offset:6144
    ds_read_b64_tr_b16 v[94:95], v213 offset:6656
    ds_read_b64_tr_b16 v[96:97], v214 offset:3072
    ds_read_b64_tr_b16 v[98:99], v214 offset:3328
    v_mfma_f32_32x32x16_bf16 v[100:115], v[64:67], v[36:39], v[100:115]
    buffer_load_dwordx4 v204, s[4:7], s30 offen offset:2048 lds
    v_mfma_f32_32x32x16_bf16 v[116:131], v[68:71], v[36:39], v[116:131]
    buffer_load_dwordx4 v205, s[4:7], s31 offen offset:3072 lds
    s_add_u32 s4, s4, 128
    s_addc_u32 s5, s5, 0
    v_mfma_f32_32x32x16_bf16 v[132:147], v[72:75], v[36:39], v[132:147]
    s_waitcnt vmcnt(11)
    s_barrier
    ds_read_b64_tr_b16 v[64:65], v212 offset:8192
    ds_read_b64_tr_b16 v[66:67], v212 offset:8704
    ds_read_b64_tr_b16 v[68:69], v213 offset:8192
    ds_read_b64_tr_b16 v[70:71], v213 offset:8704
    ds_read_b64_tr_b16 v[72:73], v214 offset:4096
    ds_read_b64_tr_b16 v[74:75], v214 offset:4352
    s_waitcnt vmcnt(7)
    ds_read_b128 v[48:51], v208 offset:4096
    ds_read_b128 v[52:55], v209 offset:4096
    s_waitcnt lgkmcnt(14)
    v_mfma_f32_32x32x16_bf16 v[100:115], v[76:79], v[40:43], v[100:115]
    s_add_u32 m0, s35, 24576
    s_nop 0
    buffer_load_dwordx4 v206, s[8:11], s33 offen lds
    v_mfma_f32_32x32x16_bf16 v[116:131], v[80:83], v[40:43], v[116:131]
    buffer_load_dwordx4 v206, s[8:11], s32 offen offset:1024 lds
    s_add_u32 s94, s59, 2
    s_and_b32 s94, s94, 3
    s_add_u32 s94, s94, 4
    s_mul_i32 s94, s94, 262144
    s_add_u32 s8, s48, s94
    s_addc_u32 s9, s49, 0
    v_mfma_f32_32x32x16_bf16 v[132:147], v[84:87], v[40:43], v[132:147]
    ds_read_b64_tr_b16 v[76:77], v212 offset:10240
    ds_read_b64_tr_b16 v[78:79], v212 offset:10752
    ds_read_b64_tr_b16 v[80:81], v213 offset:10240
    ds_read_b64_tr_b16 v[82:83], v213 offset:10752
    ds_read_b64_tr_b16 v[84:85], v214 offset:5120
    ds_read_b64_tr_b16 v[86:87], v214 offset:5376
    ds_read_b128 v[56:59], v210 offset:4096
    ds_read_b128 v[60:63], v211 offset:4096
    s_waitcnt lgkmcnt(15)
    v_mfma_f32_32x32x16_bf16 v[100:115], v[88:91], v[44:47], v[100:115]
    s_add_u32 m0, s36, 12288
    s_nop 0
    buffer_load_dwordx4 v207, s[12:15], s34 offen lds
    s_add_u32 s94, s59, 2
    s_and_b32 s94, s94, 3
    s_add_u32 s94, s94, 4
    s_mul_i32 s94, s94, 8192
    s_add_u32 s12, s50, s94
    s_addc_u32 s13, s51, 0
    v_mfma_f32_32x32x16_bf16 v[116:131], v[92:95], v[44:47], v[116:131]
    v_mfma_f32_32x32x16_bf16 v[132:147], v[96:99], v[44:47], v[132:147]
    ds_read_b64_tr_b16 v[88:89], v212 offset:12288
    ds_read_b64_tr_b16 v[90:91], v212 offset:12800
    ds_read_b64_tr_b16 v[92:93], v213 offset:12288
    ds_read_b64_tr_b16 v[94:95], v213 offset:12800
    ds_read_b64_tr_b16 v[96:97], v214 offset:6144
    ds_read_b64_tr_b16 v[98:99], v214 offset:6400
    s_waitcnt lgkmcnt(15)
    s_waitcnt lgkmcnt(6)
    v_mfma_f32_32x32x16_bf16 v[100:115], v[64:67], v[48:51], v[100:115]
    s_add_u32 m0, s37, 4096
    s_nop 0
    buffer_load_dwordx4 v204, s[4:7], s28 offen offset:0 lds
    v_mfma_f32_32x32x16_bf16 v[116:131], v[68:71], v[48:51], v[116:131]
    buffer_load_dwordx4 v205, s[4:7], s29 offen offset:1024 lds
    v_mfma_f32_32x32x16_bf16 v[132:147], v[72:75], v[48:51], v[132:147]
    ds_read_b64_tr_b16 v[64:65], v212 offset:14336
    ds_read_b64_tr_b16 v[66:67], v212 offset:14848
    ds_read_b64_tr_b16 v[68:69], v213 offset:14336
    ds_read_b64_tr_b16 v[70:71], v213 offset:14848
    ds_read_b64_tr_b16 v[72:73], v214 offset:7168
    ds_read_b64_tr_b16 v[74:75], v214 offset:7424
    v_mfma_f32_32x32x16_bf16 v[100:115], v[76:79], v[52:55], v[100:115]
    buffer_load_dwordx4 v204, s[4:7], s30 offen offset:2048 lds
    v_mfma_f32_32x32x16_bf16 v[116:131], v[80:83], v[52:55], v[116:131]
    buffer_load_dwordx4 v205, s[4:7], s31 offen offset:3072 lds
    s_add_u32 s94, s59, 2
    s_and_b32 s94, s94, 3
    s_add_u32 s94, s94, 4
    s_mul_i32 s94, s94, 256
    s_add_u32 s4, s60, s94
    s_addc_u32 s5, s61, 0
    v_mfma_f32_32x32x16_bf16 v[132:147], v[84:87], v[52:55], v[132:147]
    s_waitcnt vmcnt(11)
    s_barrier
    ds_read_b64_tr_b16 v[76:77], v212 offset:16384
    ds_read_b64_tr_b16 v[78:79], v212 offset:16896
    ds_read_b64_tr_b16 v[80:81], v213 offset:16384
    ds_read_b64_tr_b16 v[82:83], v213 offset:16896
    ds_read_b64_tr_b16 v[84:85], v214 offset:8192
    ds_read_b64_tr_b16 v[86:87], v214 offset:8448
    s_waitcnt vmcnt(7)
    ds_read_b128 v[32:35], v208 offset:0
    ds_read_b128 v[36:39], v209 offset:0
    s_waitcnt lgkmcnt(14)
    v_mfma_f32_32x32x16_bf16 v[100:115], v[88:91], v[56:59], v[100:115]
    s_add_u32 m0, s35, 0
    s_nop 0
    buffer_load_dwordx4 v206, s[8:11], s33 offen lds
    v_mfma_f32_32x32x16_bf16 v[116:131], v[92:95], v[56:59], v[116:131]
    buffer_load_dwordx4 v206, s[8:11], s32 offen offset:1024 lds
    s_add_u32 s8, s8, 131072
    s_addc_u32 s9, s9, 0
    v_mfma_f32_32x32x16_bf16 v[132:147], v[96:99], v[56:59], v[132:147]
    ds_read_b64_tr_b16 v[88:89], v212 offset:18432
    ds_read_b64_tr_b16 v[90:91], v212 offset:18944
    ds_read_b64_tr_b16 v[92:93], v213 offset:18432
    ds_read_b64_tr_b16 v[94:95], v213 offset:18944
    ds_read_b64_tr_b16 v[96:97], v214 offset:9216
    ds_read_b64_tr_b16 v[98:99], v214 offset:9472
    ds_read_b128 v[40:43], v210 offset:0
    ds_read_b128 v[44:47], v211 offset:0
    s_waitcnt lgkmcnt(15)
    v_mfma_f32_32x32x16_bf16 v[100:115], v[64:67], v[60:63], v[100:115]
    s_add_u32 m0, s36, 0
    s_nop 0
    buffer_load_dwordx4 v207, s[12:15], s34 offen lds
    s_add_u32 s12, s12, 4096
    s_addc_u32 s13, s13, 0
    v_mfma_f32_32x32x16_bf16 v[116:131], v[68:71], v[60:63], v[116:131]
    v_mfma_f32_32x32x16_bf16 v[132:147], v[72:75], v[60:63], v[132:147]
    s_cmp_lg_u32 s86, 0
    s_cbranch_scc1 gated_mix__grouped_kv_mqa__dense_activation_mish__prompt_kernel_k_ec
    s_mov_b32 s52, s82
    s_mov_b32 s53, s83
    s_mov_b32 s54, 0x100
    s_mov_b32 s55, 0x00020000
    s_and_b32 s97, s2, 1
    s_lshl_b32 s97, s97, 7
    v_mov_b32 v4, s97
    buffer_load_dword v253, v4, s[52:55], 0 offen sc1
gated_mix__grouped_kv_mqa__dense_activation_mish__prompt_kernel_k_ec:
    ds_read_b64_tr_b16 v[64:65], v212 offset:20480
    ds_read_b64_tr_b16 v[66:67], v212 offset:20992
    ds_read_b64_tr_b16 v[68:69], v213 offset:20480
    ds_read_b64_tr_b16 v[70:71], v213 offset:20992
    ds_read_b64_tr_b16 v[72:73], v214 offset:10240
    ds_read_b64_tr_b16 v[74:75], v214 offset:10496
    s_waitcnt lgkmcnt(15)
    s_waitcnt lgkmcnt(6)
    v_mfma_f32_32x32x16_bf16 v[100:115], v[76:79], v[32:35], v[100:115]
    s_add_u32 m0, s37, 0
    s_nop 0
    buffer_load_dwordx4 v204, s[4:7], s28 offen offset:0 lds
    v_mfma_f32_32x32x16_bf16 v[116:131], v[80:83], v[32:35], v[116:131]
    buffer_load_dwordx4 v205, s[4:7], s29 offen offset:1024 lds
    v_mfma_f32_32x32x16_bf16 v[132:147], v[84:87], v[32:35], v[132:147]
    ds_read_b64_tr_b16 v[76:77], v212 offset:22528
    ds_read_b64_tr_b16 v[78:79], v212 offset:23040
    ds_read_b64_tr_b16 v[80:81], v213 offset:22528
    ds_read_b64_tr_b16 v[82:83], v213 offset:23040
    ds_read_b64_tr_b16 v[84:85], v214 offset:11264
    ds_read_b64_tr_b16 v[86:87], v214 offset:11520
    v_mfma_f32_32x32x16_bf16 v[100:115], v[88:91], v[36:39], v[100:115]
    buffer_load_dwordx4 v204, s[4:7], s30 offen offset:2048 lds
    v_mfma_f32_32x32x16_bf16 v[116:131], v[92:95], v[36:39], v[116:131]
    buffer_load_dwordx4 v205, s[4:7], s31 offen offset:3072 lds
    s_add_u32 s4, s4, 128
    s_addc_u32 s5, s5, 0
    v_mfma_f32_32x32x16_bf16 v[132:147], v[96:99], v[36:39], v[132:147]
    s_waitcnt vmcnt(11)
    s_barrier
    ds_read_b64_tr_b16 v[88:89], v212 offset:24576
    ds_read_b64_tr_b16 v[90:91], v212 offset:25088
    ds_read_b64_tr_b16 v[92:93], v213 offset:24576
    ds_read_b64_tr_b16 v[94:95], v213 offset:25088
    ds_read_b64_tr_b16 v[96:97], v214 offset:12288
    ds_read_b64_tr_b16 v[98:99], v214 offset:12544
    s_waitcnt vmcnt(7)
    ds_read_b128 v[48:51], v208 offset:4096
    ds_read_b128 v[52:55], v209 offset:4096
    s_waitcnt lgkmcnt(14)
    v_mfma_f32_32x32x16_bf16 v[100:115], v[64:67], v[40:43], v[100:115]
    s_add_u32 m0, s35, 8192
    s_nop 0
    buffer_load_dwordx4 v206, s[8:11], s33 offen lds
    v_mfma_f32_32x32x16_bf16 v[116:131], v[68:71], v[40:43], v[116:131]
    buffer_load_dwordx4 v206, s[8:11], s32 offen offset:1024 lds
    s_add_u32 s94, s59, 3
    s_and_b32 s94, s94, 3
    s_add_u32 s94, s94, 4
    s_mul_i32 s94, s94, 262144
    s_add_u32 s8, s48, s94
    s_addc_u32 s9, s49, 0
    v_mfma_f32_32x32x16_bf16 v[132:147], v[72:75], v[40:43], v[132:147]
    ds_read_b64_tr_b16 v[64:65], v212 offset:26624
    ds_read_b64_tr_b16 v[66:67], v212 offset:27136
    ds_read_b64_tr_b16 v[68:69], v213 offset:26624
    ds_read_b64_tr_b16 v[70:71], v213 offset:27136
    ds_read_b64_tr_b16 v[72:73], v214 offset:13312
    ds_read_b64_tr_b16 v[74:75], v214 offset:13568
    ds_read_b128 v[56:59], v210 offset:4096
    ds_read_b128 v[60:63], v211 offset:4096
    s_waitcnt lgkmcnt(15)
    v_mfma_f32_32x32x16_bf16 v[100:115], v[76:79], v[44:47], v[100:115]
    s_add_u32 m0, s36, 4096
    s_nop 0
    buffer_load_dwordx4 v207, s[12:15], s34 offen lds
    s_add_u32 s94, s59, 3
    s_and_b32 s94, s94, 3
    s_add_u32 s94, s94, 4
    s_mul_i32 s94, s94, 8192
    s_add_u32 s12, s50, s94
    s_addc_u32 s13, s51, 0
    v_mfma_f32_32x32x16_bf16 v[116:131], v[80:83], v[44:47], v[116:131]
    v_mfma_f32_32x32x16_bf16 v[132:147], v[84:87], v[44:47], v[132:147]
    ds_read_b64_tr_b16 v[76:77], v212 offset:28672
    ds_read_b64_tr_b16 v[78:79], v212 offset:29184
    ds_read_b64_tr_b16 v[80:81], v213 offset:28672
    ds_read_b64_tr_b16 v[82:83], v213 offset:29184
    ds_read_b64_tr_b16 v[84:85], v214 offset:14336
    ds_read_b64_tr_b16 v[86:87], v214 offset:14592
    s_waitcnt lgkmcnt(15)
    s_waitcnt lgkmcnt(6)
    v_mfma_f32_32x32x16_bf16 v[100:115], v[88:91], v[48:51], v[100:115]
    s_add_u32 m0, s37, 4096
    s_nop 0
    buffer_load_dwordx4 v204, s[4:7], s28 offen offset:0 lds
    v_mfma_f32_32x32x16_bf16 v[116:131], v[92:95], v[48:51], v[116:131]
    buffer_load_dwordx4 v205, s[4:7], s29 offen offset:1024 lds
    v_mfma_f32_32x32x16_bf16 v[132:147], v[96:99], v[48:51], v[132:147]
    ds_read_b64_tr_b16 v[88:89], v212 offset:30720
    ds_read_b64_tr_b16 v[90:91], v212 offset:31232
    ds_read_b64_tr_b16 v[92:93], v213 offset:30720
    ds_read_b64_tr_b16 v[94:95], v213 offset:31232
    ds_read_b64_tr_b16 v[96:97], v214 offset:15360
    ds_read_b64_tr_b16 v[98:99], v214 offset:15616
    v_mfma_f32_32x32x16_bf16 v[100:115], v[64:67], v[52:55], v[100:115]
    buffer_load_dwordx4 v204, s[4:7], s30 offen offset:2048 lds
    v_mfma_f32_32x32x16_bf16 v[116:131], v[68:71], v[52:55], v[116:131]
    buffer_load_dwordx4 v205, s[4:7], s31 offen offset:3072 lds
    s_add_u32 s94, s59, 3
    s_and_b32 s94, s94, 3
    s_add_u32 s94, s94, 4
    s_mul_i32 s94, s94, 256
    s_add_u32 s4, s60, s94
    s_addc_u32 s5, s61, 0
    v_mfma_f32_32x32x16_bf16 v[132:147], v[72:75], v[52:55], v[132:147]
    s_waitcnt vmcnt(11)
    s_barrier
    ds_read_b64_tr_b16 v[64:65], v212 offset:0
    ds_read_b64_tr_b16 v[66:67], v212 offset:512
    ds_read_b64_tr_b16 v[68:69], v213 offset:0
    ds_read_b64_tr_b16 v[70:71], v213 offset:512
    ds_read_b64_tr_b16 v[72:73], v214 offset:0
    ds_read_b64_tr_b16 v[74:75], v214 offset:256
    s_waitcnt vmcnt(7)
    ds_read_b128 v[32:35], v208 offset:0
    ds_read_b128 v[36:39], v209 offset:0
    s_waitcnt lgkmcnt(14)
    v_mfma_f32_32x32x16_bf16 v[100:115], v[76:79], v[56:59], v[100:115]
    s_add_u32 m0, s35, 16384
    s_nop 0
    buffer_load_dwordx4 v206, s[8:11], s33 offen lds
    v_mfma_f32_32x32x16_bf16 v[116:131], v[80:83], v[56:59], v[116:131]
    buffer_load_dwordx4 v206, s[8:11], s32 offen offset:1024 lds
    s_add_u32 s8, s8, 131072
    s_addc_u32 s9, s9, 0
    v_mfma_f32_32x32x16_bf16 v[132:147], v[84:87], v[56:59], v[132:147]
    ds_read_b64_tr_b16 v[76:77], v212 offset:2048
    ds_read_b64_tr_b16 v[78:79], v212 offset:2560
    ds_read_b64_tr_b16 v[80:81], v213 offset:2048
    ds_read_b64_tr_b16 v[82:83], v213 offset:2560
    ds_read_b64_tr_b16 v[84:85], v214 offset:1024
    ds_read_b64_tr_b16 v[86:87], v214 offset:1280
    ds_read_b128 v[40:43], v210 offset:0
    ds_read_b128 v[44:47], v211 offset:0
    s_waitcnt lgkmcnt(15)
    v_mfma_f32_32x32x16_bf16 v[100:115], v[88:91], v[60:63], v[100:115]
    s_add_u32 m0, s36, 8192
    s_nop 0
    buffer_load_dwordx4 v207, s[12:15], s34 offen lds
    s_add_u32 s12, s12, 4096
    s_addc_u32 s13, s13, 0
    v_mfma_f32_32x32x16_bf16 v[116:131], v[92:95], v[60:63], v[116:131]
    v_mfma_f32_32x32x16_bf16 v[132:147], v[96:99], v[60:63], v[132:147]
    ds_read_b64_tr_b16 v[88:89], v212 offset:4096
    ds_read_b64_tr_b16 v[90:91], v212 offset:4608
    ds_read_b64_tr_b16 v[92:93], v213 offset:4096
    ds_read_b64_tr_b16 v[94:95], v213 offset:4608
    ds_read_b64_tr_b16 v[96:97], v214 offset:2048
    ds_read_b64_tr_b16 v[98:99], v214 offset:2304
    s_waitcnt lgkmcnt(15)
    s_waitcnt lgkmcnt(6)
    v_mfma_f32_32x32x16_bf16 v[100:115], v[64:67], v[32:35], v[100:115]
    s_add_u32 m0, s37, 0
    s_nop 0
    buffer_load_dwordx4 v204, s[4:7], s28 offen offset:0 lds
    v_mfma_f32_32x32x16_bf16 v[116:131], v[68:71], v[32:35], v[116:131]
    buffer_load_dwordx4 v205, s[4:7], s29 offen offset:1024 lds
    v_mfma_f32_32x32x16_bf16 v[132:147], v[72:75], v[32:35], v[132:147]
    ds_read_b64_tr_b16 v[64:65], v212 offset:6144
    ds_read_b64_tr_b16 v[66:67], v212 offset:6656
    ds_read_b64_tr_b16 v[68:69], v213 offset:6144
    ds_read_b64_tr_b16 v[70:71], v213 offset:6656
    ds_read_b64_tr_b16 v[72:73], v214 offset:3072
    ds_read_b64_tr_b16 v[74:75], v214 offset:3328
    v_mfma_f32_32x32x16_bf16 v[100:115], v[76:79], v[36:39], v[100:115]
    buffer_load_dwordx4 v204, s[4:7], s30 offen offset:2048 lds
    v_mfma_f32_32x32x16_bf16 v[116:131], v[80:83], v[36:39], v[116:131]
    buffer_load_dwordx4 v205, s[4:7], s31 offen offset:3072 lds
    s_add_u32 s4, s4, 128
    s_addc_u32 s5, s5, 0
    v_mfma_f32_32x32x16_bf16 v[132:147], v[84:87], v[36:39], v[132:147]
    s_waitcnt vmcnt(11)
    s_barrier
    ds_read_b64_tr_b16 v[76:77], v212 offset:8192
    ds_read_b64_tr_b16 v[78:79], v212 offset:8704
    ds_read_b64_tr_b16 v[80:81], v213 offset:8192
    ds_read_b64_tr_b16 v[82:83], v213 offset:8704
    ds_read_b64_tr_b16 v[84:85], v214 offset:4096
    ds_read_b64_tr_b16 v[86:87], v214 offset:4352
    s_waitcnt vmcnt(7)
    ds_read_b128 v[48:51], v208 offset:4096
    ds_read_b128 v[52:55], v209 offset:4096
    s_waitcnt lgkmcnt(14)
    v_mfma_f32_32x32x16_bf16 v[100:115], v[88:91], v[40:43], v[100:115]
    s_add_u32 m0, s35, 24576
    s_nop 0
    buffer_load_dwordx4 v206, s[8:11], s33 offen lds
    v_mfma_f32_32x32x16_bf16 v[116:131], v[92:95], v[40:43], v[116:131]
    buffer_load_dwordx4 v206, s[8:11], s32 offen offset:1024 lds
    v_mfma_f32_32x32x16_bf16 v[132:147], v[96:99], v[40:43], v[132:147]
    ds_read_b64_tr_b16 v[88:89], v212 offset:10240
    ds_read_b64_tr_b16 v[90:91], v212 offset:10752
    ds_read_b64_tr_b16 v[92:93], v213 offset:10240
    ds_read_b64_tr_b16 v[94:95], v213 offset:10752
    ds_read_b64_tr_b16 v[96:97], v214 offset:5120
    ds_read_b64_tr_b16 v[98:99], v214 offset:5376
    ds_read_b128 v[56:59], v210 offset:4096
    ds_read_b128 v[60:63], v211 offset:4096
    s_waitcnt lgkmcnt(15)
    v_mfma_f32_32x32x16_bf16 v[100:115], v[64:67], v[44:47], v[100:115]
    s_add_u32 m0, s36, 12288
    s_nop 0
    buffer_load_dwordx4 v207, s[12:15], s34 offen lds
    v_mfma_f32_32x32x16_bf16 v[116:131], v[68:71], v[44:47], v[116:131]
    v_mfma_f32_32x32x16_bf16 v[132:147], v[72:75], v[44:47], v[132:147]
    ds_read_b64_tr_b16 v[64:65], v212 offset:12288
    ds_read_b64_tr_b16 v[66:67], v212 offset:12800
    ds_read_b64_tr_b16 v[68:69], v213 offset:12288
    ds_read_b64_tr_b16 v[70:71], v213 offset:12800
    ds_read_b64_tr_b16 v[72:73], v214 offset:6144
    ds_read_b64_tr_b16 v[74:75], v214 offset:6400
    s_waitcnt lgkmcnt(15)
    s_waitcnt lgkmcnt(6)
    v_mfma_f32_32x32x16_bf16 v[100:115], v[76:79], v[48:51], v[100:115]
    s_add_u32 m0, s37, 4096
    s_nop 0
    buffer_load_dwordx4 v204, s[4:7], s28 offen offset:0 lds
    v_mfma_f32_32x32x16_bf16 v[116:131], v[80:83], v[48:51], v[116:131]
    buffer_load_dwordx4 v205, s[4:7], s29 offen offset:1024 lds
    v_mfma_f32_32x32x16_bf16 v[132:147], v[84:87], v[48:51], v[132:147]
    ds_read_b64_tr_b16 v[76:77], v212 offset:14336
    ds_read_b64_tr_b16 v[78:79], v212 offset:14848
    ds_read_b64_tr_b16 v[80:81], v213 offset:14336
    ds_read_b64_tr_b16 v[82:83], v213 offset:14848
    ds_read_b64_tr_b16 v[84:85], v214 offset:7168
    ds_read_b64_tr_b16 v[86:87], v214 offset:7424
    v_mfma_f32_32x32x16_bf16 v[100:115], v[88:91], v[52:55], v[100:115]
    buffer_load_dwordx4 v204, s[4:7], s30 offen offset:2048 lds
    v_mfma_f32_32x32x16_bf16 v[116:131], v[92:95], v[52:55], v[116:131]
    buffer_load_dwordx4 v205, s[4:7], s31 offen offset:3072 lds
    v_mfma_f32_32x32x16_bf16 v[132:147], v[96:99], v[52:55], v[132:147]
    s_waitcnt vmcnt(11)
    s_barrier
    ds_read_b64_tr_b16 v[88:89], v212 offset:16384
    ds_read_b64_tr_b16 v[90:91], v212 offset:16896
    ds_read_b64_tr_b16 v[92:93], v213 offset:16384
    ds_read_b64_tr_b16 v[94:95], v213 offset:16896
    ds_read_b64_tr_b16 v[96:97], v214 offset:8192
    ds_read_b64_tr_b16 v[98:99], v214 offset:8448
    s_waitcnt vmcnt(7)
    ds_read_b128 v[32:35], v208 offset:0
    ds_read_b128 v[36:39], v209 offset:0
    s_waitcnt lgkmcnt(14)
    v_mfma_f32_32x32x16_bf16 v[100:115], v[64:67], v[56:59], v[100:115]
    v_mfma_f32_32x32x16_bf16 v[116:131], v[68:71], v[56:59], v[116:131]
    v_mfma_f32_32x32x16_bf16 v[132:147], v[72:75], v[56:59], v[132:147]
    ds_read_b64_tr_b16 v[64:65], v212 offset:18432
    ds_read_b64_tr_b16 v[66:67], v212 offset:18944
    ds_read_b64_tr_b16 v[68:69], v213 offset:18432
    ds_read_b64_tr_b16 v[70:71], v213 offset:18944
    ds_read_b64_tr_b16 v[72:73], v214 offset:9216
    ds_read_b64_tr_b16 v[74:75], v214 offset:9472
    ds_read_b128 v[40:43], v210 offset:0
    ds_read_b128 v[44:47], v211 offset:0
    s_waitcnt lgkmcnt(15)
    v_mfma_f32_32x32x16_bf16 v[100:115], v[76:79], v[60:63], v[100:115]
    v_mfma_f32_32x32x16_bf16 v[116:131], v[80:83], v[60:63], v[116:131]
    v_mfma_f32_32x32x16_bf16 v[132:147], v[84:87], v[60:63], v[132:147]
    ds_read_b64_tr_b16 v[76:77], v212 offset:20480
    ds_read_b64_tr_b16 v[78:79], v212 offset:20992
    ds_read_b64_tr_b16 v[80:81], v213 offset:20480
    ds_read_b64_tr_b16 v[82:83], v213 offset:20992
    ds_read_b64_tr_b16 v[84:85], v214 offset:10240
    ds_read_b64_tr_b16 v[86:87], v214 offset:10496
    s_waitcnt lgkmcnt(15)
    v_mfma_f32_32x32x16_bf16 v[100:115], v[88:91], v[32:35], v[100:115]
    v_mfma_f32_32x32x16_bf16 v[116:131], v[92:95], v[32:35], v[116:131]
    v_mfma_f32_32x32x16_bf16 v[132:147], v[96:99], v[32:35], v[132:147]
    ds_read_b64_tr_b16 v[88:89], v212 offset:22528
    ds_read_b64_tr_b16 v[90:91], v212 offset:23040
    ds_read_b64_tr_b16 v[92:93], v213 offset:22528
    ds_read_b64_tr_b16 v[94:95], v213 offset:23040
    ds_read_b64_tr_b16 v[96:97], v214 offset:11264
    ds_read_b64_tr_b16 v[98:99], v214 offset:11520
    s_waitcnt lgkmcnt(14)
    v_mfma_f32_32x32x16_bf16 v[100:115], v[64:67], v[36:39], v[100:115]
    v_mfma_f32_32x32x16_bf16 v[116:131], v[68:71], v[36:39], v[116:131]
    v_mfma_f32_32x32x16_bf16 v[132:147], v[72:75], v[36:39], v[132:147]
    s_waitcnt vmcnt(4)
    s_barrier
    ds_read_b64_tr_b16 v[64:65], v212 offset:24576
    ds_read_b64_tr_b16 v[66:67], v212 offset:25088
    ds_read_b64_tr_b16 v[68:69], v213 offset:24576
    ds_read_b64_tr_b16 v[70:71], v213 offset:25088
    ds_read_b64_tr_b16 v[72:73], v214 offset:12288
    ds_read_b64_tr_b16 v[74:75], v214 offset:12544
    s_waitcnt vmcnt(0)
    ds_read_b128 v[48:51], v208 offset:4096
    ds_read_b128 v[52:55], v209 offset:4096
    s_waitcnt lgkmcnt(14)
    v_mfma_f32_32x32x16_bf16 v[100:115], v[76:79], v[40:43], v[100:115]
    v_mfma_f32_32x32x16_bf16 v[116:131], v[80:83], v[40:43], v[116:131]
    v_mfma_f32_32x32x16_bf16 v[132:147], v[84:87], v[40:43], v[132:147]
    ds_read_b64_tr_b16 v[76:77], v212 offset:26624
    ds_read_b64_tr_b16 v[78:79], v212 offset:27136
    ds_read_b64_tr_b16 v[80:81], v213 offset:26624
    ds_read_b64_tr_b16 v[82:83], v213 offset:27136
    ds_read_b64_tr_b16 v[84:85], v214 offset:13312
    ds_read_b64_tr_b16 v[86:87], v214 offset:13568
    ds_read_b128 v[56:59], v210 offset:4096
    ds_read_b128 v[60:63], v211 offset:4096
    s_waitcnt lgkmcnt(15)
    v_mfma_f32_32x32x16_bf16 v[100:115], v[88:91], v[44:47], v[100:115]
    v_mfma_f32_32x32x16_bf16 v[116:131], v[92:95], v[44:47], v[116:131]
    v_mfma_f32_32x32x16_bf16 v[132:147], v[96:99], v[44:47], v[132:147]
    ds_read_b64_tr_b16 v[88:89], v212 offset:28672
    ds_read_b64_tr_b16 v[90:91], v212 offset:29184
    ds_read_b64_tr_b16 v[92:93], v213 offset:28672
    ds_read_b64_tr_b16 v[94:95], v213 offset:29184
    ds_read_b64_tr_b16 v[96:97], v214 offset:14336
    ds_read_b64_tr_b16 v[98:99], v214 offset:14592
    s_waitcnt lgkmcnt(15)
    v_mfma_f32_32x32x16_bf16 v[100:115], v[64:67], v[48:51], v[100:115]
    v_mfma_f32_32x32x16_bf16 v[116:131], v[68:71], v[48:51], v[116:131]
    v_mfma_f32_32x32x16_bf16 v[132:147], v[72:75], v[48:51], v[132:147]
    ds_read_b64_tr_b16 v[64:65], v212 offset:30720
    ds_read_b64_tr_b16 v[66:67], v212 offset:31232
    ds_read_b64_tr_b16 v[68:69], v213 offset:30720
    ds_read_b64_tr_b16 v[70:71], v213 offset:31232
    ds_read_b64_tr_b16 v[72:73], v214 offset:15360
    ds_read_b64_tr_b16 v[74:75], v214 offset:15616
    s_waitcnt lgkmcnt(14)
    v_mfma_f32_32x32x16_bf16 v[100:115], v[76:79], v[52:55], v[100:115]
    v_mfma_f32_32x32x16_bf16 v[116:131], v[80:83], v[52:55], v[116:131]
    v_mfma_f32_32x32x16_bf16 v[132:147], v[84:87], v[52:55], v[132:147]
    s_waitcnt lgkmcnt(6)
    v_mfma_f32_32x32x16_bf16 v[100:115], v[88:91], v[56:59], v[100:115]
    v_mfma_f32_32x32x16_bf16 v[116:131], v[92:95], v[56:59], v[116:131]
    v_mfma_f32_32x32x16_bf16 v[132:147], v[96:99], v[56:59], v[132:147]
    s_waitcnt lgkmcnt(0)
    v_mfma_f32_32x32x16_bf16 v[100:115], v[64:67], v[60:63], v[100:115]
    v_mfma_f32_32x32x16_bf16 v[116:131], v[68:71], v[60:63], v[116:131]
    v_mfma_f32_32x32x16_bf16 v[132:147], v[72:75], v[60:63], v[132:147]
    s_nop 15
    v_pk_mul_f32 v[100:101], v[100:101], s[44:45]
    v_pk_mul_f32 v[102:103], v[102:103], s[44:45]
    v_pk_mul_f32 v[104:105], v[104:105], s[44:45]
    v_pk_mul_f32 v[106:107], v[106:107], s[44:45]
    v_pk_mul_f32 v[108:109], v[108:109], s[44:45]
    v_pk_mul_f32 v[110:111], v[110:111], s[44:45]
    v_pk_mul_f32 v[112:113], v[112:113], s[44:45]
    v_pk_mul_f32 v[114:115], v[114:115], s[44:45]
    v_cvt_pk_bf16_f32 v8, v100, v101
    v_cvt_pk_bf16_f32 v9, v102, v103
    v_cvt_pk_bf16_f32 v10, v104, v105
    v_cvt_pk_bf16_f32 v11, v106, v107
    v_cvt_pk_bf16_f32 v12, v108, v109
    v_cvt_pk_bf16_f32 v13, v110, v111
    v_cvt_pk_bf16_f32 v14, v112, v113
    v_cvt_pk_bf16_f32 v15, v114, v115
    v_pk_mul_f32 v[116:117], v[116:117], s[44:45]
    v_pk_mul_f32 v[118:119], v[118:119], s[44:45]
    v_pk_mul_f32 v[120:121], v[120:121], s[44:45]
    v_pk_mul_f32 v[122:123], v[122:123], s[44:45]
    v_pk_mul_f32 v[124:125], v[124:125], s[44:45]
    v_pk_mul_f32 v[126:127], v[126:127], s[44:45]
    v_pk_mul_f32 v[128:129], v[128:129], s[44:45]
    v_pk_mul_f32 v[130:131], v[130:131], s[44:45]
    v_cvt_pk_bf16_f32 v16, v116, v117
    v_cvt_pk_bf16_f32 v17, v118, v119
    v_cvt_pk_bf16_f32 v18, v120, v121
    v_cvt_pk_bf16_f32 v19, v122, v123
    v_cvt_pk_bf16_f32 v20, v124, v125
    v_cvt_pk_bf16_f32 v21, v126, v127
    v_cvt_pk_bf16_f32 v22, v128, v129
    v_cvt_pk_bf16_f32 v23, v130, v131
    v_cvt_pk_bf16_f32 v32, v132, v133
    v_cvt_pk_bf16_f32 v33, v134, v135
    v_cvt_pk_bf16_f32 v34, v136, v137
    v_cvt_pk_bf16_f32 v35, v138, v139
    v_cvt_pk_bf16_f32 v36, v140, v141
    v_cvt_pk_bf16_f32 v37, v142, v143
    v_cvt_pk_bf16_f32 v38, v144, v145
    v_cvt_pk_bf16_f32 v39, v146, v147
    s_add_u32 s92, s84, 0x1400000
    s_addc_u32 s93, s85, 0
    s_mov_b32 s8, s92
    s_mov_b32 s9, s93
    s_mov_b32 s10, 0x40000
    s_mov_b32 s11, 0x00020000
    s_lshl_b32 s91, s87, 2
    s_add_u32 s91, s91, s86
    s_lshl_b32 s91, s91, 12
    buffer_store_dwordx4 v[32:35], v2, s[8:11], s91 offen offset:0 sc1
    buffer_store_dwordx4 v[36:39], v2, s[8:11], s91 offen offset:1024 sc1
    s_waitcnt vmcnt(0) lgkmcnt(0)
    s_barrier
    s_branch gated_mix__grouped_kv_mqa__dense_activation_mish__prompt_kernel_attn
gated_mix__grouped_kv_mqa__dense_activation_mish__prompt_kernel_aV:
    s_mov_b32 s12, s66
    s_mov_b32 s13, s67
    s_mov_b32 s14, 0x10000
    s_mov_b32 s15, 0x00020000
    s_mov_b32 s50, s12
    s_mov_b32 s51, s13
    s_add_u32 s94, s59, 0
    s_and_b32 s94, s94, 3
    s_mul_i32 s94, s94, 8192
    s_add_u32 s12, s50, s94
    s_addc_u32 s13, s51, 0
    s_add_u32 m0, s35, 0
    s_nop 0
    buffer_load_dwordx4 v206, s[8:11], s33 offen lds
    buffer_load_dwordx4 v206, s[8:11], s32 offen offset:1024 lds
    s_add_u32 s8, s8, 131072
    s_addc_u32 s9, s9, 0
    s_add_u32 m0, s36, 0
    s_nop 0
    buffer_load_dwordx4 v207, s[12:15], s34 offen lds
    s_add_u32 s12, s12, 4096
    s_addc_u32 s13, s13, 0
    s_add_u32 m0, s37, 0
    s_nop 0
    buffer_load_dwordx4 v204, s[4:7], s28 offen offset:0 lds
    buffer_load_dwordx4 v205, s[4:7], s29 offen offset:1024 lds
    buffer_load_dwordx4 v204, s[4:7], s30 offen offset:2048 lds
    buffer_load_dwordx4 v205, s[4:7], s31 offen offset:3072 lds
    s_add_u32 s4, s4, 128
    s_addc_u32 s5, s5, 0
    s_add_u32 m0, s37, 4096
    s_nop 0
    buffer_load_dwordx4 v204, s[4:7], s28 offen offset:0 lds
    buffer_load_dwordx4 v205, s[4:7], s29 offen offset:1024 lds
    buffer_load_dwordx4 v204, s[4:7], s30 offen offset:2048 lds
    buffer_load_dwordx4 v205, s[4:7], s31 offen offset:3072 lds
    s_add_u32 s94, s59, 1
    s_and_b32 s94, s94, 3
    s_mul_i32 s94, s94, 256
    s_add_u32 s4, s60, s94
    s_addc_u32 s5, s61, 0
    s_add_u32 m0, s35, 8192
    s_nop 0
    buffer_load_dwordx4 v206, s[8:11], s33 offen lds
    buffer_load_dwordx4 v206, s[8:11], s32 offen offset:1024 lds
    s_add_u32 s94, s59, 1
    s_and_b32 s94, s94, 3
    s_mul_i32 s94, s94, 262144
    s_add_u32 s8, s48, s94
    s_addc_u32 s9, s49, 0
    s_add_u32 m0, s36, 4096
    s_nop 0
    buffer_load_dwordx4 v207, s[12:15], s34 offen lds
    s_add_u32 s94, s59, 1
    s_and_b32 s94, s94, 3
    s_mul_i32 s94, s94, 8192
    s_add_u32 s12, s50, s94
    s_addc_u32 s13, s51, 0
    v_and_b32 v3, 31, v1
    v_lshrrev_b32 v4, 5, v1
    v_bfe_u32 v5, v3, 1, 3
    v_xor_b32 v5, v5, v4
    v_lshlrev_b32 v5, 4, v5
    v_lshl_add_u32 v5, v3, 7, v5
    v_add_u32 v5, s37, v5
    v_xor_b32 v208, 0, v5
    v_xor_b32 v209, 32, v5
    v_xor_b32 v210, 64, v5
    v_xor_b32 v211, 96, v5
    v_bfe_u32 v6, v1, 2, 2
    v_bfe_u32 v5, v1, 4, 1
    v_and_b32 v7, 3, v1
    v_lshlrev_b32 v3, 5, v5
    v_lshl_add_u32 v3, v7, 3, v3
    v_lshl_add_u32 v4, v4, 3, v6
    v_lshrrev_b32 v5, 1, v6
    v_lshl_add_u32 v5, v5, 6, v3
    v_lshl_add_u32 v212, v4, 7, v5
    v_xor_b32 v213, 64, v212
    v_lshl_add_u32 v214, v4, 6, v3
    v_add_u32 v214, 32768, v214
    s_waitcnt vmcnt(7)
    s_cmp_lg_u32 s2, 0
    s_cbranch_scc1 gated_mix__grouped_kv_mqa__dense_activation_mish__prompt_kernel_v_clrw
    s_waitcnt vmcnt(0)
gated_mix__grouped_kv_mqa__dense_activation_mish__prompt_kernel_v_clrw:
    s_barrier
    s_add_u32 m0, s35, 16384
    s_nop 0
    buffer_load_dwordx4 v206, s[8:11], s33 offen lds
    buffer_load_dwordx4 v206, s[8:11], s32 offen offset:1024 lds
    s_add_u32 s8, s8, 131072
    s_addc_u32 s9, s9, 0
    s_add_u32 m0, s36, 8192
    s_nop 0
    buffer_load_dwordx4 v207, s[12:15], s34 offen lds
    s_add_u32 s12, s12, 4096
    s_addc_u32 s13, s13, 0
    s_cmp_lg_u32 s2, 0
    s_cbranch_scc1 gated_mix__grouped_kv_mqa__dense_activation_mish__prompt_kernel_v_nopub
    s_cmp_lg_u32 s86, 0
    s_cbranch_scc1 gated_mix__grouped_kv_mqa__dense_activation_mish__prompt_kernel_v_nopub
    s_mov_b32 s52, s82
    s_mov_b32 s53, s83
    s_mov_b32 s54, 0x100
    s_mov_b32 s55, 0x00020000
    v_lshlrev_b32 v6, 7, v1
    v_mov_b32 v4, 1
    v_cmp_gt_u32 vcc, 2, v1
    s_nop 1
    s_and_saveexec_b64 s[90:91], vcc
    buffer_store_dword v4, v6, s[52:55], 0 offen sc1
    s_mov_b64 exec, s[90:91]
gated_mix__grouped_kv_mqa__dense_activation_mish__prompt_kernel_v_nopub:
    ds_read_b128 v[32:35], v208 offset:0
    ds_read_b128 v[36:39], v209 offset:0
    ds_read_b128 v[40:43], v210 offset:0
    ds_read_b128 v[44:47], v211 offset:0
    ds_read_b64_tr_b16 v[64:65], v212 offset:0
    ds_read_b64_tr_b16 v[66:67], v212 offset:512
    ds_read_b64_tr_b16 v[68:69], v213 offset:0
    ds_read_b64_tr_b16 v[70:71], v213 offset:512
    ds_read_b64_tr_b16 v[72:73], v214 offset:0
    ds_read_b64_tr_b16 v[74:75], v214 offset:256
    ds_read_b64_tr_b16 v[76:77], v212 offset:2048
    ds_read_b64_tr_b16 v[78:79], v212 offset:2560
    ds_read_b64_tr_b16 v[80:81], v213 offset:2048
    ds_read_b64_tr_b16 v[82:83], v213 offset:2560
    ds_read_b64_tr_b16 v[84:85], v214 offset:1024
    ds_read_b64_tr_b16 v[86:87], v214 offset:1280
    ds_read_b64_tr_b16 v[88:89], v212 offset:4096
    ds_read_b64_tr_b16 v[90:91], v212 offset:4608
    ds_read_b64_tr_b16 v[92:93], v213 offset:4096
    ds_read_b64_tr_b16 v[94:95], v213 offset:4608
    ds_read_b64_tr_b16 v[96:97], v214 offset:2048
    ds_read_b64_tr_b16 v[98:99], v214 offset:2304
    s_waitcnt lgkmcnt(12)
    v_mfma_f32_32x32x16_bf16 v[100:115], v[64:67], v[32:35], 0
    s_add_u32 m0, s37, 0
    s_nop 0
    buffer_load_dwordx4 v204, s[4:7], s28 offen offset:0 lds
    v_mfma_f32_32x32x16_bf16 v[116:131], v[68:71], v[32:35], 0
    buffer_load_dwordx4 v205, s[4:7], s29 offen offset:1024 lds
    v_mfma_f32_32x32x16_bf16 v[132:147], v[32:35], v[72:75], 0
    ds_read_b64_tr_b16 v[64:65], v212 offset:6144
    ds_read_b64_tr_b16 v[66:67], v212 offset:6656
    ds_read_b64_tr_b16 v[68:69], v213 offset:6144
    ds_read_b64_tr_b16 v[70:71], v213 offset:6656
    ds_read_b64_tr_b16 v[72:73], v214 offset:3072
    ds_read_b64_tr_b16 v[74:75], v214 offset:3328
    s_waitcnt lgkmcnt(12)
    v_mfma_f32_32x32x16_bf16 v[100:115], v[76:79], v[36:39], v[100:115]
    buffer_load_dwordx4 v204, s[4:7], s30 offen offset:2048 lds
    v_mfma_f32_32x32x16_bf16 v[116:131], v[80:83], v[36:39], v[116:131]
    buffer_load_dwordx4 v205, s[4:7], s31 offen offset:3072 lds
    s_add_u32 s4, s4, 128
    s_addc_u32 s5, s5, 0
    v_mfma_f32_32x32x16_bf16 v[132:147], v[36:39], v[84:87], v[132:147]
    s_waitcnt vmcnt(7)
    s_barrier
    ds_read_b64_tr_b16 v[76:77], v212 offset:8192
    ds_read_b64_tr_b16 v[78:79], v212 offset:8704
    ds_read_b64_tr_b16 v[80:81], v213 offset:8192
    ds_read_b64_tr_b16 v[82:83], v213 offset:8704
    ds_read_b64_tr_b16 v[84:85], v214 offset:4096
    ds_read_b64_tr_b16 v[86:87], v214 offset:4352
    ds_read_b128 v[48:51], v208 offset:4096
    ds_read_b128 v[52:55], v209 offset:4096
    s_waitcnt lgkmcnt(14)
    v_mfma_f32_32x32x16_bf16 v[100:115], v[88:91], v[40:43], v[100:115]
    s_add_u32 m0, s35, 24576
    s_nop 0
    buffer_load_dwordx4 v206, s[8:11], s33 offen lds
    v_mfma_f32_32x32x16_bf16 v[116:131], v[92:95], v[40:43], v[116:131]
    buffer_load_dwordx4 v206, s[8:11], s32 offen offset:1024 lds
    s_add_u32 s94, s59, 2
    s_and_b32 s94, s94, 3
    s_mul_i32 s94, s94, 262144
    s_add_u32 s8, s48, s94
    s_addc_u32 s9, s49, 0
    v_mfma_f32_32x32x16_bf16 v[132:147], v[40:43], v[96:99], v[132:147]
    ds_read_b64_tr_b16 v[88:89], v212 offset:10240
    ds_read_b64_tr_b16 v[90:91], v212 offset:10752
    ds_read_b64_tr_b16 v[92:93], v213 offset:10240
    ds_read_b64_tr_b16 v[94:95], v213 offset:10752
    ds_read_b64_tr_b16 v[96:97], v214 offset:5120
    ds_read_b64_tr_b16 v[98:99], v214 offset:5376
    ds_read_b128 v[56:59], v210 offset:4096
    ds_read_b128 v[60:63], v211 offset:4096
    s_waitcnt lgkmcnt(15)
    v_mfma_f32_32x32x16_bf16 v[100:115], v[64:67], v[44:47], v[100:115]
    s_add_u32 m0, s36, 12288
    s_nop 0
    buffer_load_dwordx4 v207, s[12:15], s34 offen lds
    s_add_u32 s94, s59, 2
    s_and_b32 s94, s94, 3
    s_mul_i32 s94, s94, 8192
    s_add_u32 s12, s50, s94
    s_addc_u32 s13, s51, 0
    v_mfma_f32_32x32x16_bf16 v[116:131], v[68:71], v[44:47], v[116:131]
    v_mfma_f32_32x32x16_bf16 v[132:147], v[44:47], v[72:75], v[132:147]
    ds_read_b64_tr_b16 v[64:65], v212 offset:12288
    ds_read_b64_tr_b16 v[66:67], v212 offset:12800
    ds_read_b64_tr_b16 v[68:69], v213 offset:12288
    ds_read_b64_tr_b16 v[70:71], v213 offset:12800
    ds_read_b64_tr_b16 v[72:73], v214 offset:6144
    ds_read_b64_tr_b16 v[74:75], v214 offset:6400
    s_waitcnt lgkmcnt(15)
    s_waitcnt lgkmcnt(6)
    v_mfma_f32_32x32x16_bf16 v[100:115], v[76:79], v[48:51], v[100:115]
    s_add_u32 m0, s37, 4096
    s_nop 0
    buffer_load_dwordx4 v204, s[4:7], s28 offen offset:0 lds
    v_mfma_f32_32x32x16_bf16 v[116:131], v[80:83], v[48:51], v[116:131]
    buffer_load_dwordx4 v205, s[4:7], s29 offen offset:1024 lds
    v_mfma_f32_32x32x16_bf16 v[132:147], v[48:51], v[84:87], v[132:147]
    ds_read_b64_tr_b16 v[76:77], v212 offset:14336
    ds_read_b64_tr_b16 v[78:79], v212 offset:14848
    ds_read_b64_tr_b16 v[80:81], v213 offset:14336
    ds_read_b64_tr_b16 v[82:83], v213 offset:14848
    ds_read_b64_tr_b16 v[84:85], v214 offset:7168
    ds_read_b64_tr_b16 v[86:87], v214 offset:7424
    v_mfma_f32_32x32x16_bf16 v[100:115], v[88:91], v[52:55], v[100:115]
    buffer_load_dwordx4 v204, s[4:7], s30 offen offset:2048 lds
    v_mfma_f32_32x32x16_bf16 v[116:131], v[92:95], v[52:55], v[116:131]
    buffer_load_dwordx4 v205, s[4:7], s31 offen offset:3072 lds
    s_add_u32 s94, s59, 2
    s_and_b32 s94, s94, 3
    s_mul_i32 s94, s94, 256
    s_add_u32 s4, s60, s94
    s_addc_u32 s5, s61, 0
    v_mfma_f32_32x32x16_bf16 v[132:147], v[52:55], v[96:99], v[132:147]
    s_waitcnt vmcnt(11)
    s_barrier
    ds_read_b64_tr_b16 v[88:89], v212 offset:16384
    ds_read_b64_tr_b16 v[90:91], v212 offset:16896
    ds_read_b64_tr_b16 v[92:93], v213 offset:16384
    ds_read_b64_tr_b16 v[94:95], v213 offset:16896
    ds_read_b64_tr_b16 v[96:97], v214 offset:8192
    ds_read_b64_tr_b16 v[98:99], v214 offset:8448
    s_waitcnt vmcnt(7)
    ds_read_b128 v[32:35], v208 offset:0
    ds_read_b128 v[36:39], v209 offset:0
    s_waitcnt lgkmcnt(14)
    v_mfma_f32_32x32x16_bf16 v[100:115], v[64:67], v[56:59], v[100:115]
    s_add_u32 m0, s35, 0
    s_nop 0
    buffer_load_dwordx4 v206, s[8:11], s33 offen lds
    v_mfma_f32_32x32x16_bf16 v[116:131], v[68:71], v[56:59], v[116:131]
    buffer_load_dwordx4 v206, s[8:11], s32 offen offset:1024 lds
    s_add_u32 s8, s8, 131072
    s_addc_u32 s9, s9, 0
    v_mfma_f32_32x32x16_bf16 v[132:147], v[56:59], v[72:75], v[132:147]
    ds_read_b64_tr_b16 v[64:65], v212 offset:18432
    ds_read_b64_tr_b16 v[66:67], v212 offset:18944
    ds_read_b64_tr_b16 v[68:69], v213 offset:18432
    ds_read_b64_tr_b16 v[70:71], v213 offset:18944
    ds_read_b64_tr_b16 v[72:73], v214 offset:9216
    ds_read_b64_tr_b16 v[74:75], v214 offset:9472
    ds_read_b128 v[40:43], v210 offset:0
    ds_read_b128 v[44:47], v211 offset:0
    s_waitcnt lgkmcnt(15)
    v_mfma_f32_32x32x16_bf16 v[100:115], v[76:79], v[60:63], v[100:115]
    s_add_u32 m0, s36, 0
    s_nop 0
    buffer_load_dwordx4 v207, s[12:15], s34 offen lds
    s_add_u32 s12, s12, 4096
    s_addc_u32 s13, s13, 0
    v_mfma_f32_32x32x16_bf16 v[116:131], v[80:83], v[60:63], v[116:131]
    v_mfma_f32_32x32x16_bf16 v[132:147], v[60:63], v[84:87], v[132:147]
    ds_read_b64_tr_b16 v[76:77], v212 offset:20480
    ds_read_b64_tr_b16 v[78:79], v212 offset:20992
    ds_read_b64_tr_b16 v[80:81], v213 offset:20480
    ds_read_b64_tr_b16 v[82:83], v213 offset:20992
    ds_read_b64_tr_b16 v[84:85], v214 offset:10240
    ds_read_b64_tr_b16 v[86:87], v214 offset:10496
    s_waitcnt lgkmcnt(15)
    s_waitcnt lgkmcnt(6)
    v_mfma_f32_32x32x16_bf16 v[100:115], v[88:91], v[32:35], v[100:115]
    s_add_u32 m0, s37, 0
    s_nop 0
    buffer_load_dwordx4 v204, s[4:7], s28 offen offset:0 lds
    v_mfma_f32_32x32x16_bf16 v[116:131], v[92:95], v[32:35], v[116:131]
    buffer_load_dwordx4 v205, s[4:7], s29 offen offset:1024 lds
    v_mfma_f32_32x32x16_bf16 v[132:147], v[32:35], v[96:99], v[132:147]
    ds_read_b64_tr_b16 v[88:89], v212 offset:22528
    ds_read_b64_tr_b16 v[90:91], v212 offset:23040
    ds_read_b64_tr_b16 v[92:93], v213 offset:22528
    ds_read_b64_tr_b16 v[94:95], v213 offset:23040
    ds_read_b64_tr_b16 v[96:97], v214 offset:11264
    ds_read_b64_tr_b16 v[98:99], v214 offset:11520
    v_mfma_f32_32x32x16_bf16 v[100:115], v[64:67], v[36:39], v[100:115]
    buffer_load_dwordx4 v204, s[4:7], s30 offen offset:2048 lds
    v_mfma_f32_32x32x16_bf16 v[116:131], v[68:71], v[36:39], v[116:131]
    buffer_load_dwordx4 v205, s[4:7], s31 offen offset:3072 lds
    s_add_u32 s4, s4, 128
    s_addc_u32 s5, s5, 0
    v_mfma_f32_32x32x16_bf16 v[132:147], v[36:39], v[72:75], v[132:147]
    s_waitcnt vmcnt(11)
    s_barrier
    ds_read_b64_tr_b16 v[64:65], v212 offset:24576
    ds_read_b64_tr_b16 v[66:67], v212 offset:25088
    ds_read_b64_tr_b16 v[68:69], v213 offset:24576
    ds_read_b64_tr_b16 v[70:71], v213 offset:25088
    ds_read_b64_tr_b16 v[72:73], v214 offset:12288
    ds_read_b64_tr_b16 v[74:75], v214 offset:12544
    s_waitcnt vmcnt(7)
    ds_read_b128 v[48:51], v208 offset:4096
    ds_read_b128 v[52:55], v209 offset:4096
    s_waitcnt lgkmcnt(14)
    v_mfma_f32_32x32x16_bf16 v[100:115], v[76:79], v[40:43], v[100:115]
    s_add_u32 m0, s35, 8192
    s_nop 0
    buffer_load_dwordx4 v206, s[8:11], s33 offen lds
    v_mfma_f32_32x32x16_bf16 v[116:131], v[80:83], v[40:43], v[116:131]
    buffer_load_dwordx4 v206, s[8:11], s32 offen offset:1024 lds
    s_add_u32 s94, s59, 3
    s_and_b32 s94, s94, 3
    s_mul_i32 s94, s94, 262144
    s_add_u32 s8, s48, s94
    s_addc_u32 s9, s49, 0
    v_mfma_f32_32x32x16_bf16 v[132:147], v[40:43], v[84:87], v[132:147]
    ds_read_b64_tr_b16 v[76:77], v212 offset:26624
    ds_read_b64_tr_b16 v[78:79], v212 offset:27136
    ds_read_b64_tr_b16 v[80:81], v213 offset:26624
    ds_read_b64_tr_b16 v[82:83], v213 offset:27136
    ds_read_b64_tr_b16 v[84:85], v214 offset:13312
    ds_read_b64_tr_b16 v[86:87], v214 offset:13568
    ds_read_b128 v[56:59], v210 offset:4096
    ds_read_b128 v[60:63], v211 offset:4096
    s_waitcnt lgkmcnt(15)
    v_mfma_f32_32x32x16_bf16 v[100:115], v[88:91], v[44:47], v[100:115]
    s_add_u32 m0, s36, 4096
    s_nop 0
    buffer_load_dwordx4 v207, s[12:15], s34 offen lds
    s_add_u32 s94, s59, 3
    s_and_b32 s94, s94, 3
    s_mul_i32 s94, s94, 8192
    s_add_u32 s12, s50, s94
    s_addc_u32 s13, s51, 0
    v_mfma_f32_32x32x16_bf16 v[116:131], v[92:95], v[44:47], v[116:131]
    v_mfma_f32_32x32x16_bf16 v[132:147], v[44:47], v[96:99], v[132:147]
    ds_read_b64_tr_b16 v[88:89], v212 offset:28672
    ds_read_b64_tr_b16 v[90:91], v212 offset:29184
    ds_read_b64_tr_b16 v[92:93], v213 offset:28672
    ds_read_b64_tr_b16 v[94:95], v213 offset:29184
    ds_read_b64_tr_b16 v[96:97], v214 offset:14336
    ds_read_b64_tr_b16 v[98:99], v214 offset:14592
    s_waitcnt lgkmcnt(15)
    s_waitcnt lgkmcnt(6)
    v_mfma_f32_32x32x16_bf16 v[100:115], v[64:67], v[48:51], v[100:115]
    s_add_u32 m0, s37, 4096
    s_nop 0
    buffer_load_dwordx4 v204, s[4:7], s28 offen offset:0 lds
    v_mfma_f32_32x32x16_bf16 v[116:131], v[68:71], v[48:51], v[116:131]
    buffer_load_dwordx4 v205, s[4:7], s29 offen offset:1024 lds
    v_mfma_f32_32x32x16_bf16 v[132:147], v[48:51], v[72:75], v[132:147]
    ds_read_b64_tr_b16 v[64:65], v212 offset:30720
    ds_read_b64_tr_b16 v[66:67], v212 offset:31232
    ds_read_b64_tr_b16 v[68:69], v213 offset:30720
    ds_read_b64_tr_b16 v[70:71], v213 offset:31232
    ds_read_b64_tr_b16 v[72:73], v214 offset:15360
    ds_read_b64_tr_b16 v[74:75], v214 offset:15616
    v_mfma_f32_32x32x16_bf16 v[100:115], v[76:79], v[52:55], v[100:115]
    buffer_load_dwordx4 v204, s[4:7], s30 offen offset:2048 lds
    v_mfma_f32_32x32x16_bf16 v[116:131], v[80:83], v[52:55], v[116:131]
    buffer_load_dwordx4 v205, s[4:7], s31 offen offset:3072 lds
    s_add_u32 s94, s59, 3
    s_and_b32 s94, s94, 3
    s_mul_i32 s94, s94, 256
    s_add_u32 s4, s60, s94
    s_addc_u32 s5, s61, 0
    v_mfma_f32_32x32x16_bf16 v[132:147], v[52:55], v[84:87], v[132:147]
    s_waitcnt vmcnt(11)
    s_barrier
    ds_read_b64_tr_b16 v[76:77], v212 offset:0
    ds_read_b64_tr_b16 v[78:79], v212 offset:512
    ds_read_b64_tr_b16 v[80:81], v213 offset:0
    ds_read_b64_tr_b16 v[82:83], v213 offset:512
    ds_read_b64_tr_b16 v[84:85], v214 offset:0
    ds_read_b64_tr_b16 v[86:87], v214 offset:256
    s_waitcnt vmcnt(7)
    ds_read_b128 v[32:35], v208 offset:0
    ds_read_b128 v[36:39], v209 offset:0
    s_waitcnt lgkmcnt(14)
    v_mfma_f32_32x32x16_bf16 v[100:115], v[88:91], v[56:59], v[100:115]
    s_add_u32 m0, s35, 16384
    s_nop 0
    buffer_load_dwordx4 v206, s[8:11], s33 offen lds
    v_mfma_f32_32x32x16_bf16 v[116:131], v[92:95], v[56:59], v[116:131]
    buffer_load_dwordx4 v206, s[8:11], s32 offen offset:1024 lds
    s_add_u32 s8, s8, 131072
    s_addc_u32 s9, s9, 0
    v_mfma_f32_32x32x16_bf16 v[132:147], v[56:59], v[96:99], v[132:147]
    ds_read_b64_tr_b16 v[88:89], v212 offset:2048
    ds_read_b64_tr_b16 v[90:91], v212 offset:2560
    ds_read_b64_tr_b16 v[92:93], v213 offset:2048
    ds_read_b64_tr_b16 v[94:95], v213 offset:2560
    ds_read_b64_tr_b16 v[96:97], v214 offset:1024
    ds_read_b64_tr_b16 v[98:99], v214 offset:1280
    ds_read_b128 v[40:43], v210 offset:0
    ds_read_b128 v[44:47], v211 offset:0
    s_waitcnt lgkmcnt(15)
    v_mfma_f32_32x32x16_bf16 v[100:115], v[64:67], v[60:63], v[100:115]
    s_add_u32 m0, s36, 8192
    s_nop 0
    buffer_load_dwordx4 v207, s[12:15], s34 offen lds
    s_add_u32 s12, s12, 4096
    s_addc_u32 s13, s13, 0
    v_mfma_f32_32x32x16_bf16 v[116:131], v[68:71], v[60:63], v[116:131]
    v_mfma_f32_32x32x16_bf16 v[132:147], v[60:63], v[72:75], v[132:147]
    ds_read_b64_tr_b16 v[64:65], v212 offset:4096
    ds_read_b64_tr_b16 v[66:67], v212 offset:4608
    ds_read_b64_tr_b16 v[68:69], v213 offset:4096
    ds_read_b64_tr_b16 v[70:71], v213 offset:4608
    ds_read_b64_tr_b16 v[72:73], v214 offset:2048
    ds_read_b64_tr_b16 v[74:75], v214 offset:2304
    s_waitcnt lgkmcnt(15)
    s_waitcnt lgkmcnt(6)
    v_mfma_f32_32x32x16_bf16 v[100:115], v[76:79], v[32:35], v[100:115]
    s_add_u32 m0, s37, 0
    s_nop 0
    buffer_load_dwordx4 v204, s[4:7], s28 offen offset:0 lds
    v_mfma_f32_32x32x16_bf16 v[116:131], v[80:83], v[32:35], v[116:131]
    buffer_load_dwordx4 v205, s[4:7], s29 offen offset:1024 lds
    v_mfma_f32_32x32x16_bf16 v[132:147], v[32:35], v[84:87], v[132:147]
    ds_read_b64_tr_b16 v[76:77], v212 offset:6144
    ds_read_b64_tr_b16 v[78:79], v212 offset:6656
    ds_read_b64_tr_b16 v[80:81], v213 offset:6144
    ds_read_b64_tr_b16 v[82:83], v213 offset:6656
    ds_read_b64_tr_b16 v[84:85], v214 offset:3072
    ds_read_b64_tr_b16 v[86:87], v214 offset:3328
    v_mfma_f32_32x32x16_bf16 v[100:115], v[88:91], v[36:39], v[100:115]
    buffer_load_dwordx4 v204, s[4:7], s30 offen offset:2048 lds
    v_mfma_f32_32x32x16_bf16 v[116:131], v[92:95], v[36:39], v[116:131]
    buffer_load_dwordx4 v205, s[4:7], s31 offen offset:3072 lds
    s_add_u32 s4, s4, 128
    s_addc_u32 s5, s5, 0
    v_mfma_f32_32x32x16_bf16 v[132:147], v[36:39], v[96:99], v[132:147]
    s_waitcnt vmcnt(11)
    s_barrier
    ds_read_b64_tr_b16 v[88:89], v212 offset:8192
    ds_read_b64_tr_b16 v[90:91], v212 offset:8704
    ds_read_b64_tr_b16 v[92:93], v213 offset:8192
    ds_read_b64_tr_b16 v[94:95], v213 offset:8704
    ds_read_b64_tr_b16 v[96:97], v214 offset:4096
    ds_read_b64_tr_b16 v[98:99], v214 offset:4352
    s_waitcnt vmcnt(7)
    ds_read_b128 v[48:51], v208 offset:4096
    ds_read_b128 v[52:55], v209 offset:4096
    s_waitcnt lgkmcnt(14)
    v_mfma_f32_32x32x16_bf16 v[100:115], v[64:67], v[40:43], v[100:115]
    s_add_u32 m0, s35, 24576
    s_nop 0
    buffer_load_dwordx4 v206, s[8:11], s33 offen lds
    v_mfma_f32_32x32x16_bf16 v[116:131], v[68:71], v[40:43], v[116:131]
    buffer_load_dwordx4 v206, s[8:11], s32 offen offset:1024 lds
    s_add_u32 s94, s59, 0
    s_and_b32 s94, s94, 3
    s_add_u32 s94, s94, 4
    s_mul_i32 s94, s94, 262144
    s_add_u32 s8, s48, s94
    s_addc_u32 s9, s49, 0
    v_mfma_f32_32x32x16_bf16 v[132:147], v[40:43], v[72:75], v[132:147]
    ds_read_b64_tr_b16 v[64:65], v212 offset:10240
    ds_read_b64_tr_b16 v[66:67], v212 offset:10752
    ds_read_b64_tr_b16 v[68:69], v213 offset:10240
    ds_read_b64_tr_b16 v[70:71], v213 offset:10752
    ds_read_b64_tr_b16 v[72:73], v214 offset:5120
    ds_read_b64_tr_b16 v[74:75], v214 offset:5376
    ds_read_b128 v[56:59], v210 offset:4096
    ds_read_b128 v[60:63], v211 offset:4096
    s_waitcnt lgkmcnt(15)
    v_mfma_f32_32x32x16_bf16 v[100:115], v[76:79], v[44:47], v[100:115]
    s_add_u32 m0, s36, 12288
    s_nop 0
    buffer_load_dwordx4 v207, s[12:15], s34 offen lds
    s_add_u32 s94, s59, 0
    s_and_b32 s94, s94, 3
    s_add_u32 s94, s94, 4
    s_mul_i32 s94, s94, 8192
    s_add_u32 s12, s50, s94
    s_addc_u32 s13, s51, 0
    v_mfma_f32_32x32x16_bf16 v[116:131], v[80:83], v[44:47], v[116:131]
    v_mfma_f32_32x32x16_bf16 v[132:147], v[44:47], v[84:87], v[132:147]
    ds_read_b64_tr_b16 v[76:77], v212 offset:12288
    ds_read_b64_tr_b16 v[78:79], v212 offset:12800
    ds_read_b64_tr_b16 v[80:81], v213 offset:12288
    ds_read_b64_tr_b16 v[82:83], v213 offset:12800
    ds_read_b64_tr_b16 v[84:85], v214 offset:6144
    ds_read_b64_tr_b16 v[86:87], v214 offset:6400
    s_waitcnt lgkmcnt(15)
    s_waitcnt lgkmcnt(6)
    v_mfma_f32_32x32x16_bf16 v[100:115], v[88:91], v[48:51], v[100:115]
    s_add_u32 m0, s37, 4096
    s_nop 0
    buffer_load_dwordx4 v204, s[4:7], s28 offen offset:0 lds
    v_mfma_f32_32x32x16_bf16 v[116:131], v[92:95], v[48:51], v[116:131]
    buffer_load_dwordx4 v205, s[4:7], s29 offen offset:1024 lds
    v_mfma_f32_32x32x16_bf16 v[132:147], v[48:51], v[96:99], v[132:147]
    ds_read_b64_tr_b16 v[88:89], v212 offset:14336
    ds_read_b64_tr_b16 v[90:91], v212 offset:14848
    ds_read_b64_tr_b16 v[92:93], v213 offset:14336
    ds_read_b64_tr_b16 v[94:95], v213 offset:14848
    ds_read_b64_tr_b16 v[96:97], v214 offset:7168
    ds_read_b64_tr_b16 v[98:99], v214 offset:7424
    v_mfma_f32_32x32x16_bf16 v[100:115], v[64:67], v[52:55], v[100:115]
    buffer_load_dwordx4 v204, s[4:7], s30 offen offset:2048 lds
    v_mfma_f32_32x32x16_bf16 v[116:131], v[68:71], v[52:55], v[116:131]
    buffer_load_dwordx4 v205, s[4:7], s31 offen offset:3072 lds
    s_add_u32 s94, s59, 0
    s_and_b32 s94, s94, 3
    s_add_u32 s94, s94, 4
    s_mul_i32 s94, s94, 256
    s_add_u32 s4, s60, s94
    s_addc_u32 s5, s61, 0
    v_mfma_f32_32x32x16_bf16 v[132:147], v[52:55], v[72:75], v[132:147]
    s_waitcnt vmcnt(11)
    s_barrier
    ds_read_b64_tr_b16 v[64:65], v212 offset:16384
    ds_read_b64_tr_b16 v[66:67], v212 offset:16896
    ds_read_b64_tr_b16 v[68:69], v213 offset:16384
    ds_read_b64_tr_b16 v[70:71], v213 offset:16896
    ds_read_b64_tr_b16 v[72:73], v214 offset:8192
    ds_read_b64_tr_b16 v[74:75], v214 offset:8448
    s_waitcnt vmcnt(7)
    ds_read_b128 v[32:35], v208 offset:0
    ds_read_b128 v[36:39], v209 offset:0
    s_waitcnt lgkmcnt(14)
    v_mfma_f32_32x32x16_bf16 v[100:115], v[76:79], v[56:59], v[100:115]
    s_add_u32 m0, s35, 0
    s_nop 0
    buffer_load_dwordx4 v206, s[8:11], s33 offen lds
    v_mfma_f32_32x32x16_bf16 v[116:131], v[80:83], v[56:59], v[116:131]
    buffer_load_dwordx4 v206, s[8:11], s32 offen offset:1024 lds
    s_add_u32 s8, s8, 131072
    s_addc_u32 s9, s9, 0
    v_mfma_f32_32x32x16_bf16 v[132:147], v[56:59], v[84:87], v[132:147]
    ds_read_b64_tr_b16 v[76:77], v212 offset:18432
    ds_read_b64_tr_b16 v[78:79], v212 offset:18944
    ds_read_b64_tr_b16 v[80:81], v213 offset:18432
    ds_read_b64_tr_b16 v[82:83], v213 offset:18944
    ds_read_b64_tr_b16 v[84:85], v214 offset:9216
    ds_read_b64_tr_b16 v[86:87], v214 offset:9472
    ds_read_b128 v[40:43], v210 offset:0
    ds_read_b128 v[44:47], v211 offset:0
    s_waitcnt lgkmcnt(15)
    v_mfma_f32_32x32x16_bf16 v[100:115], v[88:91], v[60:63], v[100:115]
    s_add_u32 m0, s36, 0
    s_nop 0
    buffer_load_dwordx4 v207, s[12:15], s34 offen lds
    s_add_u32 s12, s12, 4096
    s_addc_u32 s13, s13, 0
    v_mfma_f32_32x32x16_bf16 v[116:131], v[92:95], v[60:63], v[116:131]
    v_mfma_f32_32x32x16_bf16 v[132:147], v[60:63], v[96:99], v[132:147]
    ds_read_b64_tr_b16 v[88:89], v212 offset:20480
    ds_read_b64_tr_b16 v[90:91], v212 offset:20992
    ds_read_b64_tr_b16 v[92:93], v213 offset:20480
    ds_read_b64_tr_b16 v[94:95], v213 offset:20992
    ds_read_b64_tr_b16 v[96:97], v214 offset:10240
    ds_read_b64_tr_b16 v[98:99], v214 offset:10496
    s_waitcnt lgkmcnt(15)
    s_waitcnt lgkmcnt(6)
    v_mfma_f32_32x32x16_bf16 v[100:115], v[64:67], v[32:35], v[100:115]
    s_add_u32 m0, s37, 0
    s_nop 0
    buffer_load_dwordx4 v204, s[4:7], s28 offen offset:0 lds
    v_mfma_f32_32x32x16_bf16 v[116:131], v[68:71], v[32:35], v[116:131]
    buffer_load_dwordx4 v205, s[4:7], s29 offen offset:1024 lds
    v_mfma_f32_32x32x16_bf16 v[132:147], v[32:35], v[72:75], v[132:147]
    ds_read_b64_tr_b16 v[64:65], v212 offset:22528
    ds_read_b64_tr_b16 v[66:67], v212 offset:23040
    ds_read_b64_tr_b16 v[68:69], v213 offset:22528
    ds_read_b64_tr_b16 v[70:71], v213 offset:23040
    ds_read_b64_tr_b16 v[72:73], v214 offset:11264
    ds_read_b64_tr_b16 v[74:75], v214 offset:11520
    v_mfma_f32_32x32x16_bf16 v[100:115], v[76:79], v[36:39], v[100:115]
    buffer_load_dwordx4 v204, s[4:7], s30 offen offset:2048 lds
    v_mfma_f32_32x32x16_bf16 v[116:131], v[80:83], v[36:39], v[116:131]
    buffer_load_dwordx4 v205, s[4:7], s31 offen offset:3072 lds
    s_add_u32 s4, s4, 128
    s_addc_u32 s5, s5, 0
    v_mfma_f32_32x32x16_bf16 v[132:147], v[36:39], v[84:87], v[132:147]
    s_waitcnt vmcnt(11)
    s_barrier
    ds_read_b64_tr_b16 v[76:77], v212 offset:24576
    ds_read_b64_tr_b16 v[78:79], v212 offset:25088
    ds_read_b64_tr_b16 v[80:81], v213 offset:24576
    ds_read_b64_tr_b16 v[82:83], v213 offset:25088
    ds_read_b64_tr_b16 v[84:85], v214 offset:12288
    ds_read_b64_tr_b16 v[86:87], v214 offset:12544
    s_waitcnt vmcnt(7)
    ds_read_b128 v[48:51], v208 offset:4096
    ds_read_b128 v[52:55], v209 offset:4096
    s_waitcnt lgkmcnt(14)
    v_mfma_f32_32x32x16_bf16 v[100:115], v[88:91], v[40:43], v[100:115]
    s_add_u32 m0, s35, 8192
    s_nop 0
    buffer_load_dwordx4 v206, s[8:11], s33 offen lds
    v_mfma_f32_32x32x16_bf16 v[116:131], v[92:95], v[40:43], v[116:131]
    buffer_load_dwordx4 v206, s[8:11], s32 offen offset:1024 lds
    s_add_u32 s94, s59, 1
    s_and_b32 s94, s94, 3
    s_add_u32 s94, s94, 4
    s_mul_i32 s94, s94, 262144
    s_add_u32 s8, s48, s94
    s_addc_u32 s9, s49, 0
    v_mfma_f32_32x32x16_bf16 v[132:147], v[40:43], v[96:99], v[132:147]
    ds_read_b64_tr_b16 v[88:89], v212 offset:26624
    ds_read_b64_tr_b16 v[90:91], v212 offset:27136
    ds_read_b64_tr_b16 v[92:93], v213 offset:26624
    ds_read_b64_tr_b16 v[94:95], v213 offset:27136
    ds_read_b64_tr_b16 v[96:97], v214 offset:13312
    ds_read_b64_tr_b16 v[98:99], v214 offset:13568
    ds_read_b128 v[56:59], v210 offset:4096
    ds_read_b128 v[60:63], v211 offset:4096
    s_waitcnt lgkmcnt(15)
    v_mfma_f32_32x32x16_bf16 v[100:115], v[64:67], v[44:47], v[100:115]
    s_add_u32 m0, s36, 4096
    s_nop 0
    buffer_load_dwordx4 v207, s[12:15], s34 offen lds
    s_add_u32 s94, s59, 1
    s_and_b32 s94, s94, 3
    s_add_u32 s94, s94, 4
    s_mul_i32 s94, s94, 8192
    s_add_u32 s12, s50, s94
    s_addc_u32 s13, s51, 0
    v_mfma_f32_32x32x16_bf16 v[116:131], v[68:71], v[44:47], v[116:131]
    v_mfma_f32_32x32x16_bf16 v[132:147], v[44:47], v[72:75], v[132:147]
    ds_read_b64_tr_b16 v[64:65], v212 offset:28672
    ds_read_b64_tr_b16 v[66:67], v212 offset:29184
    ds_read_b64_tr_b16 v[68:69], v213 offset:28672
    ds_read_b64_tr_b16 v[70:71], v213 offset:29184
    ds_read_b64_tr_b16 v[72:73], v214 offset:14336
    ds_read_b64_tr_b16 v[74:75], v214 offset:14592
    s_waitcnt lgkmcnt(15)
    s_waitcnt lgkmcnt(6)
    v_mfma_f32_32x32x16_bf16 v[100:115], v[76:79], v[48:51], v[100:115]
    s_add_u32 m0, s37, 4096
    s_nop 0
    buffer_load_dwordx4 v204, s[4:7], s28 offen offset:0 lds
    v_mfma_f32_32x32x16_bf16 v[116:131], v[80:83], v[48:51], v[116:131]
    buffer_load_dwordx4 v205, s[4:7], s29 offen offset:1024 lds
    v_mfma_f32_32x32x16_bf16 v[132:147], v[48:51], v[84:87], v[132:147]
    ds_read_b64_tr_b16 v[76:77], v212 offset:30720
    ds_read_b64_tr_b16 v[78:79], v212 offset:31232
    ds_read_b64_tr_b16 v[80:81], v213 offset:30720
    ds_read_b64_tr_b16 v[82:83], v213 offset:31232
    ds_read_b64_tr_b16 v[84:85], v214 offset:15360
    ds_read_b64_tr_b16 v[86:87], v214 offset:15616
    v_mfma_f32_32x32x16_bf16 v[100:115], v[88:91], v[52:55], v[100:115]
    buffer_load_dwordx4 v204, s[4:7], s30 offen offset:2048 lds
    v_mfma_f32_32x32x16_bf16 v[116:131], v[92:95], v[52:55], v[116:131]
    buffer_load_dwordx4 v205, s[4:7], s31 offen offset:3072 lds
    s_add_u32 s94, s59, 1
    s_and_b32 s94, s94, 3
    s_add_u32 s94, s94, 4
    s_mul_i32 s94, s94, 256
    s_add_u32 s4, s60, s94
    s_addc_u32 s5, s61, 0
    v_mfma_f32_32x32x16_bf16 v[132:147], v[52:55], v[96:99], v[132:147]
    s_waitcnt vmcnt(11)
    s_barrier
    ds_read_b64_tr_b16 v[88:89], v212 offset:0
    ds_read_b64_tr_b16 v[90:91], v212 offset:512
    ds_read_b64_tr_b16 v[92:93], v213 offset:0
    ds_read_b64_tr_b16 v[94:95], v213 offset:512
    ds_read_b64_tr_b16 v[96:97], v214 offset:0
    ds_read_b64_tr_b16 v[98:99], v214 offset:256
    s_waitcnt vmcnt(7)
    ds_read_b128 v[32:35], v208 offset:0
    ds_read_b128 v[36:39], v209 offset:0
    s_waitcnt lgkmcnt(14)
    v_mfma_f32_32x32x16_bf16 v[100:115], v[64:67], v[56:59], v[100:115]
    s_add_u32 m0, s35, 16384
    s_nop 0
    buffer_load_dwordx4 v206, s[8:11], s33 offen lds
    v_mfma_f32_32x32x16_bf16 v[116:131], v[68:71], v[56:59], v[116:131]
    buffer_load_dwordx4 v206, s[8:11], s32 offen offset:1024 lds
    s_add_u32 s8, s8, 131072
    s_addc_u32 s9, s9, 0
    v_mfma_f32_32x32x16_bf16 v[132:147], v[56:59], v[72:75], v[132:147]
    ds_read_b64_tr_b16 v[64:65], v212 offset:2048
    ds_read_b64_tr_b16 v[66:67], v212 offset:2560
    ds_read_b64_tr_b16 v[68:69], v213 offset:2048
    ds_read_b64_tr_b16 v[70:71], v213 offset:2560
    ds_read_b64_tr_b16 v[72:73], v214 offset:1024
    ds_read_b64_tr_b16 v[74:75], v214 offset:1280
    ds_read_b128 v[40:43], v210 offset:0
    ds_read_b128 v[44:47], v211 offset:0
    s_waitcnt lgkmcnt(15)
    v_mfma_f32_32x32x16_bf16 v[100:115], v[76:79], v[60:63], v[100:115]
    s_add_u32 m0, s36, 8192
    s_nop 0
    buffer_load_dwordx4 v207, s[12:15], s34 offen lds
    s_add_u32 s12, s12, 4096
    s_addc_u32 s13, s13, 0
    v_mfma_f32_32x32x16_bf16 v[116:131], v[80:83], v[60:63], v[116:131]
    v_mfma_f32_32x32x16_bf16 v[132:147], v[60:63], v[84:87], v[132:147]
    ds_read_b64_tr_b16 v[76:77], v212 offset:4096
    ds_read_b64_tr_b16 v[78:79], v212 offset:4608
    ds_read_b64_tr_b16 v[80:81], v213 offset:4096
    ds_read_b64_tr_b16 v[82:83], v213 offset:4608
    ds_read_b64_tr_b16 v[84:85], v214 offset:2048
    ds_read_b64_tr_b16 v[86:87], v214 offset:2304
    s_waitcnt lgkmcnt(15)
    s_waitcnt lgkmcnt(6)
    v_mfma_f32_32x32x16_bf16 v[100:115], v[88:91], v[32:35], v[100:115]
    s_add_u32 m0, s37, 0
    s_nop 0
    buffer_load_dwordx4 v204, s[4:7], s28 offen offset:0 lds
    v_mfma_f32_32x32x16_bf16 v[116:131], v[92:95], v[32:35], v[116:131]
    buffer_load_dwordx4 v205, s[4:7], s29 offen offset:1024 lds
    v_mfma_f32_32x32x16_bf16 v[132:147], v[32:35], v[96:99], v[132:147]
    ds_read_b64_tr_b16 v[88:89], v212 offset:6144
    ds_read_b64_tr_b16 v[90:91], v212 offset:6656
    ds_read_b64_tr_b16 v[92:93], v213 offset:6144
    ds_read_b64_tr_b16 v[94:95], v213 offset:6656
    ds_read_b64_tr_b16 v[96:97], v214 offset:3072
    ds_read_b64_tr_b16 v[98:99], v214 offset:3328
    v_mfma_f32_32x32x16_bf16 v[100:115], v[64:67], v[36:39], v[100:115]
    buffer_load_dwordx4 v204, s[4:7], s30 offen offset:2048 lds
    v_mfma_f32_32x32x16_bf16 v[116:131], v[68:71], v[36:39], v[116:131]
    buffer_load_dwordx4 v205, s[4:7], s31 offen offset:3072 lds
    s_add_u32 s4, s4, 128
    s_addc_u32 s5, s5, 0
    v_mfma_f32_32x32x16_bf16 v[132:147], v[36:39], v[72:75], v[132:147]
    s_waitcnt vmcnt(11)
    s_barrier
    ds_read_b64_tr_b16 v[64:65], v212 offset:8192
    ds_read_b64_tr_b16 v[66:67], v212 offset:8704
    ds_read_b64_tr_b16 v[68:69], v213 offset:8192
    ds_read_b64_tr_b16 v[70:71], v213 offset:8704
    ds_read_b64_tr_b16 v[72:73], v214 offset:4096
    ds_read_b64_tr_b16 v[74:75], v214 offset:4352
    s_waitcnt vmcnt(7)
    ds_read_b128 v[48:51], v208 offset:4096
    ds_read_b128 v[52:55], v209 offset:4096
    s_waitcnt lgkmcnt(14)
    v_mfma_f32_32x32x16_bf16 v[100:115], v[76:79], v[40:43], v[100:115]
    s_add_u32 m0, s35, 24576
    s_nop 0
    buffer_load_dwordx4 v206, s[8:11], s33 offen lds
    v_mfma_f32_32x32x16_bf16 v[116:131], v[80:83], v[40:43], v[116:131]
    buffer_load_dwordx4 v206, s[8:11], s32 offen offset:1024 lds
    s_add_u32 s94, s59, 2
    s_and_b32 s94, s94, 3
    s_add_u32 s94, s94, 4
    s_mul_i32 s94, s94, 262144
    s_add_u32 s8, s48, s94
    s_addc_u32 s9, s49, 0
    v_mfma_f32_32x32x16_bf16 v[132:147], v[40:43], v[84:87], v[132:147]
    ds_read_b64_tr_b16 v[76:77], v212 offset:10240
    ds_read_b64_tr_b16 v[78:79], v212 offset:10752
    ds_read_b64_tr_b16 v[80:81], v213 offset:10240
    ds_read_b64_tr_b16 v[82:83], v213 offset:10752
    ds_read_b64_tr_b16 v[84:85], v214 offset:5120
    ds_read_b64_tr_b16 v[86:87], v214 offset:5376
    ds_read_b128 v[56:59], v210 offset:4096
    ds_read_b128 v[60:63], v211 offset:4096
    s_waitcnt lgkmcnt(15)
    v_mfma_f32_32x32x16_bf16 v[100:115], v[88:91], v[44:47], v[100:115]
    s_add_u32 m0, s36, 12288
    s_nop 0
    buffer_load_dwordx4 v207, s[12:15], s34 offen lds
    s_add_u32 s94, s59, 2
    s_and_b32 s94, s94, 3
    s_add_u32 s94, s94, 4
    s_mul_i32 s94, s94, 8192
    s_add_u32 s12, s50, s94
    s_addc_u32 s13, s51, 0
    v_mfma_f32_32x32x16_bf16 v[116:131], v[92:95], v[44:47], v[116:131]
    v_mfma_f32_32x32x16_bf16 v[132:147], v[44:47], v[96:99], v[132:147]
    ds_read_b64_tr_b16 v[88:89], v212 offset:12288
    ds_read_b64_tr_b16 v[90:91], v212 offset:12800
    ds_read_b64_tr_b16 v[92:93], v213 offset:12288
    ds_read_b64_tr_b16 v[94:95], v213 offset:12800
    ds_read_b64_tr_b16 v[96:97], v214 offset:6144
    ds_read_b64_tr_b16 v[98:99], v214 offset:6400
    s_waitcnt lgkmcnt(15)
    s_waitcnt lgkmcnt(6)
    v_mfma_f32_32x32x16_bf16 v[100:115], v[64:67], v[48:51], v[100:115]
    s_add_u32 m0, s37, 4096
    s_nop 0
    buffer_load_dwordx4 v204, s[4:7], s28 offen offset:0 lds
    v_mfma_f32_32x32x16_bf16 v[116:131], v[68:71], v[48:51], v[116:131]
    buffer_load_dwordx4 v205, s[4:7], s29 offen offset:1024 lds
    v_mfma_f32_32x32x16_bf16 v[132:147], v[48:51], v[72:75], v[132:147]
    ds_read_b64_tr_b16 v[64:65], v212 offset:14336
    ds_read_b64_tr_b16 v[66:67], v212 offset:14848
    ds_read_b64_tr_b16 v[68:69], v213 offset:14336
    ds_read_b64_tr_b16 v[70:71], v213 offset:14848
    ds_read_b64_tr_b16 v[72:73], v214 offset:7168
    ds_read_b64_tr_b16 v[74:75], v214 offset:7424
    v_mfma_f32_32x32x16_bf16 v[100:115], v[76:79], v[52:55], v[100:115]
    buffer_load_dwordx4 v204, s[4:7], s30 offen offset:2048 lds
    v_mfma_f32_32x32x16_bf16 v[116:131], v[80:83], v[52:55], v[116:131]
    buffer_load_dwordx4 v205, s[4:7], s31 offen offset:3072 lds
    s_add_u32 s94, s59, 2
    s_and_b32 s94, s94, 3
    s_add_u32 s94, s94, 4
    s_mul_i32 s94, s94, 256
    s_add_u32 s4, s60, s94
    s_addc_u32 s5, s61, 0
    v_mfma_f32_32x32x16_bf16 v[132:147], v[52:55], v[84:87], v[132:147]
    s_waitcnt vmcnt(11)
    s_barrier
    ds_read_b64_tr_b16 v[76:77], v212 offset:16384
    ds_read_b64_tr_b16 v[78:79], v212 offset:16896
    ds_read_b64_tr_b16 v[80:81], v213 offset:16384
    ds_read_b64_tr_b16 v[82:83], v213 offset:16896
    ds_read_b64_tr_b16 v[84:85], v214 offset:8192
    ds_read_b64_tr_b16 v[86:87], v214 offset:8448
    s_waitcnt vmcnt(7)
    ds_read_b128 v[32:35], v208 offset:0
    ds_read_b128 v[36:39], v209 offset:0
    s_waitcnt lgkmcnt(14)
    v_mfma_f32_32x32x16_bf16 v[100:115], v[88:91], v[56:59], v[100:115]
    s_add_u32 m0, s35, 0
    s_nop 0
    buffer_load_dwordx4 v206, s[8:11], s33 offen lds
    v_mfma_f32_32x32x16_bf16 v[116:131], v[92:95], v[56:59], v[116:131]
    buffer_load_dwordx4 v206, s[8:11], s32 offen offset:1024 lds
    s_add_u32 s8, s8, 131072
    s_addc_u32 s9, s9, 0
    v_mfma_f32_32x32x16_bf16 v[132:147], v[56:59], v[96:99], v[132:147]
    ds_read_b64_tr_b16 v[88:89], v212 offset:18432
    ds_read_b64_tr_b16 v[90:91], v212 offset:18944
    ds_read_b64_tr_b16 v[92:93], v213 offset:18432
    ds_read_b64_tr_b16 v[94:95], v213 offset:18944
    ds_read_b64_tr_b16 v[96:97], v214 offset:9216
    ds_read_b64_tr_b16 v[98:99], v214 offset:9472
    ds_read_b128 v[40:43], v210 offset:0
    ds_read_b128 v[44:47], v211 offset:0
    s_waitcnt lgkmcnt(15)
    v_mfma_f32_32x32x16_bf16 v[100:115], v[64:67], v[60:63], v[100:115]
    s_add_u32 m0, s36, 0
    s_nop 0
    buffer_load_dwordx4 v207, s[12:15], s34 offen lds
    s_add_u32 s12, s12, 4096
    s_addc_u32 s13, s13, 0
    v_mfma_f32_32x32x16_bf16 v[116:131], v[68:71], v[60:63], v[116:131]
    v_mfma_f32_32x32x16_bf16 v[132:147], v[60:63], v[72:75], v[132:147]
    s_cmp_lg_u32 s86, 0
    s_cbranch_scc1 gated_mix__grouped_kv_mqa__dense_activation_mish__prompt_kernel_v_ec
    s_mov_b32 s52, s82
    s_mov_b32 s53, s83
    s_mov_b32 s54, 0x100
    s_mov_b32 s55, 0x00020000
    s_and_b32 s97, s2, 1
    s_lshl_b32 s97, s97, 7
    v_mov_b32 v4, s97
    buffer_load_dword v253, v4, s[52:55], 0 offen sc1
gated_mix__grouped_kv_mqa__dense_activation_mish__prompt_kernel_v_ec:
    ds_read_b64_tr_b16 v[64:65], v212 offset:20480
    ds_read_b64_tr_b16 v[66:67], v212 offset:20992
    ds_read_b64_tr_b16 v[68:69], v213 offset:20480
    ds_read_b64_tr_b16 v[70:71], v213 offset:20992
    ds_read_b64_tr_b16 v[72:73], v214 offset:10240
    ds_read_b64_tr_b16 v[74:75], v214 offset:10496
    s_waitcnt lgkmcnt(15)
    s_waitcnt lgkmcnt(6)
    v_mfma_f32_32x32x16_bf16 v[100:115], v[76:79], v[32:35], v[100:115]
    s_add_u32 m0, s37, 0
    s_nop 0
    buffer_load_dwordx4 v204, s[4:7], s28 offen offset:0 lds
    v_mfma_f32_32x32x16_bf16 v[116:131], v[80:83], v[32:35], v[116:131]
    buffer_load_dwordx4 v205, s[4:7], s29 offen offset:1024 lds
    v_mfma_f32_32x32x16_bf16 v[132:147], v[32:35], v[84:87], v[132:147]
    ds_read_b64_tr_b16 v[76:77], v212 offset:22528
    ds_read_b64_tr_b16 v[78:79], v212 offset:23040
    ds_read_b64_tr_b16 v[80:81], v213 offset:22528
    ds_read_b64_tr_b16 v[82:83], v213 offset:23040
    ds_read_b64_tr_b16 v[84:85], v214 offset:11264
    ds_read_b64_tr_b16 v[86:87], v214 offset:11520
    v_mfma_f32_32x32x16_bf16 v[100:115], v[88:91], v[36:39], v[100:115]
    buffer_load_dwordx4 v204, s[4:7], s30 offen offset:2048 lds
    v_mfma_f32_32x32x16_bf16 v[116:131], v[92:95], v[36:39], v[116:131]
    buffer_load_dwordx4 v205, s[4:7], s31 offen offset:3072 lds
    s_add_u32 s4, s4, 128
    s_addc_u32 s5, s5, 0
    v_mfma_f32_32x32x16_bf16 v[132:147], v[36:39], v[96:99], v[132:147]
    s_waitcnt vmcnt(11)
    s_barrier
    ds_read_b64_tr_b16 v[88:89], v212 offset:24576
    ds_read_b64_tr_b16 v[90:91], v212 offset:25088
    ds_read_b64_tr_b16 v[92:93], v213 offset:24576
    ds_read_b64_tr_b16 v[94:95], v213 offset:25088
    ds_read_b64_tr_b16 v[96:97], v214 offset:12288
    ds_read_b64_tr_b16 v[98:99], v214 offset:12544
    s_waitcnt vmcnt(7)
    ds_read_b128 v[48:51], v208 offset:4096
    ds_read_b128 v[52:55], v209 offset:4096
    s_waitcnt lgkmcnt(14)
    v_mfma_f32_32x32x16_bf16 v[100:115], v[64:67], v[40:43], v[100:115]
    s_add_u32 m0, s35, 8192
    s_nop 0
    buffer_load_dwordx4 v206, s[8:11], s33 offen lds
    v_mfma_f32_32x32x16_bf16 v[116:131], v[68:71], v[40:43], v[116:131]
    buffer_load_dwordx4 v206, s[8:11], s32 offen offset:1024 lds
    s_add_u32 s94, s59, 3
    s_and_b32 s94, s94, 3
    s_add_u32 s94, s94, 4
    s_mul_i32 s94, s94, 262144
    s_add_u32 s8, s48, s94
    s_addc_u32 s9, s49, 0
    v_mfma_f32_32x32x16_bf16 v[132:147], v[40:43], v[72:75], v[132:147]
    ds_read_b64_tr_b16 v[64:65], v212 offset:26624
    ds_read_b64_tr_b16 v[66:67], v212 offset:27136
    ds_read_b64_tr_b16 v[68:69], v213 offset:26624
    ds_read_b64_tr_b16 v[70:71], v213 offset:27136
    ds_read_b64_tr_b16 v[72:73], v214 offset:13312
    ds_read_b64_tr_b16 v[74:75], v214 offset:13568
    ds_read_b128 v[56:59], v210 offset:4096
    ds_read_b128 v[60:63], v211 offset:4096
    s_waitcnt lgkmcnt(15)
    v_mfma_f32_32x32x16_bf16 v[100:115], v[76:79], v[44:47], v[100:115]
    s_add_u32 m0, s36, 4096
    s_nop 0
    buffer_load_dwordx4 v207, s[12:15], s34 offen lds
    s_add_u32 s94, s59, 3
    s_and_b32 s94, s94, 3
    s_add_u32 s94, s94, 4
    s_mul_i32 s94, s94, 8192
    s_add_u32 s12, s50, s94
    s_addc_u32 s13, s51, 0
    v_mfma_f32_32x32x16_bf16 v[116:131], v[80:83], v[44:47], v[116:131]
    v_mfma_f32_32x32x16_bf16 v[132:147], v[44:47], v[84:87], v[132:147]
    ds_read_b64_tr_b16 v[76:77], v212 offset:28672
    ds_read_b64_tr_b16 v[78:79], v212 offset:29184
    ds_read_b64_tr_b16 v[80:81], v213 offset:28672
    ds_read_b64_tr_b16 v[82:83], v213 offset:29184
    ds_read_b64_tr_b16 v[84:85], v214 offset:14336
    ds_read_b64_tr_b16 v[86:87], v214 offset:14592
    s_waitcnt lgkmcnt(15)
    s_waitcnt lgkmcnt(6)
    v_mfma_f32_32x32x16_bf16 v[100:115], v[88:91], v[48:51], v[100:115]
    s_add_u32 m0, s37, 4096
    s_nop 0
    buffer_load_dwordx4 v204, s[4:7], s28 offen offset:0 lds
    v_mfma_f32_32x32x16_bf16 v[116:131], v[92:95], v[48:51], v[116:131]
    buffer_load_dwordx4 v205, s[4:7], s29 offen offset:1024 lds
    v_mfma_f32_32x32x16_bf16 v[132:147], v[48:51], v[96:99], v[132:147]
    ds_read_b64_tr_b16 v[88:89], v212 offset:30720
    ds_read_b64_tr_b16 v[90:91], v212 offset:31232
    ds_read_b64_tr_b16 v[92:93], v213 offset:30720
    ds_read_b64_tr_b16 v[94:95], v213 offset:31232
    ds_read_b64_tr_b16 v[96:97], v214 offset:15360
    ds_read_b64_tr_b16 v[98:99], v214 offset:15616
    v_mfma_f32_32x32x16_bf16 v[100:115], v[64:67], v[52:55], v[100:115]
    buffer_load_dwordx4 v204, s[4:7], s30 offen offset:2048 lds
    v_mfma_f32_32x32x16_bf16 v[116:131], v[68:71], v[52:55], v[116:131]
    buffer_load_dwordx4 v205, s[4:7], s31 offen offset:3072 lds
    s_add_u32 s94, s59, 3
    s_and_b32 s94, s94, 3
    s_add_u32 s94, s94, 4
    s_mul_i32 s94, s94, 256
    s_add_u32 s4, s60, s94
    s_addc_u32 s5, s61, 0
    v_mfma_f32_32x32x16_bf16 v[132:147], v[52:55], v[72:75], v[132:147]
    s_waitcnt vmcnt(11)
    s_barrier
    ds_read_b64_tr_b16 v[64:65], v212 offset:0
    ds_read_b64_tr_b16 v[66:67], v212 offset:512
    ds_read_b64_tr_b16 v[68:69], v213 offset:0
    ds_read_b64_tr_b16 v[70:71], v213 offset:512
    ds_read_b64_tr_b16 v[72:73], v214 offset:0
    ds_read_b64_tr_b16 v[74:75], v214 offset:256
    s_waitcnt vmcnt(7)
    ds_read_b128 v[32:35], v208 offset:0
    ds_read_b128 v[36:39], v209 offset:0
    s_waitcnt lgkmcnt(14)
    v_mfma_f32_32x32x16_bf16 v[100:115], v[76:79], v[56:59], v[100:115]
    s_add_u32 m0, s35, 16384
    s_nop 0
    buffer_load_dwordx4 v206, s[8:11], s33 offen lds
    v_mfma_f32_32x32x16_bf16 v[116:131], v[80:83], v[56:59], v[116:131]
    buffer_load_dwordx4 v206, s[8:11], s32 offen offset:1024 lds
    s_add_u32 s8, s8, 131072
    s_addc_u32 s9, s9, 0
    v_mfma_f32_32x32x16_bf16 v[132:147], v[56:59], v[84:87], v[132:147]
    ds_read_b64_tr_b16 v[76:77], v212 offset:2048
    ds_read_b64_tr_b16 v[78:79], v212 offset:2560
    ds_read_b64_tr_b16 v[80:81], v213 offset:2048
    ds_read_b64_tr_b16 v[82:83], v213 offset:2560
    ds_read_b64_tr_b16 v[84:85], v214 offset:1024
    ds_read_b64_tr_b16 v[86:87], v214 offset:1280
    ds_read_b128 v[40:43], v210 offset:0
    ds_read_b128 v[44:47], v211 offset:0
    s_waitcnt lgkmcnt(15)
    v_mfma_f32_32x32x16_bf16 v[100:115], v[88:91], v[60:63], v[100:115]
    s_add_u32 m0, s36, 8192
    s_nop 0
    buffer_load_dwordx4 v207, s[12:15], s34 offen lds
    s_add_u32 s12, s12, 4096
    s_addc_u32 s13, s13, 0
    v_mfma_f32_32x32x16_bf16 v[116:131], v[92:95], v[60:63], v[116:131]
    v_mfma_f32_32x32x16_bf16 v[132:147], v[60:63], v[96:99], v[132:147]
    ds_read_b64_tr_b16 v[88:89], v212 offset:4096
    ds_read_b64_tr_b16 v[90:91], v212 offset:4608
    ds_read_b64_tr_b16 v[92:93], v213 offset:4096
    ds_read_b64_tr_b16 v[94:95], v213 offset:4608
    ds_read_b64_tr_b16 v[96:97], v214 offset:2048
    ds_read_b64_tr_b16 v[98:99], v214 offset:2304
    s_waitcnt lgkmcnt(15)
    s_waitcnt lgkmcnt(6)
    v_mfma_f32_32x32x16_bf16 v[100:115], v[64:67], v[32:35], v[100:115]
    s_add_u32 m0, s37, 0
    s_nop 0
    buffer_load_dwordx4 v204, s[4:7], s28 offen offset:0 lds
    v_mfma_f32_32x32x16_bf16 v[116:131], v[68:71], v[32:35], v[116:131]
    buffer_load_dwordx4 v205, s[4:7], s29 offen offset:1024 lds
    v_mfma_f32_32x32x16_bf16 v[132:147], v[32:35], v[72:75], v[132:147]
    ds_read_b64_tr_b16 v[64:65], v212 offset:6144
    ds_read_b64_tr_b16 v[66:67], v212 offset:6656
    ds_read_b64_tr_b16 v[68:69], v213 offset:6144
    ds_read_b64_tr_b16 v[70:71], v213 offset:6656
    ds_read_b64_tr_b16 v[72:73], v214 offset:3072
    ds_read_b64_tr_b16 v[74:75], v214 offset:3328
    v_mfma_f32_32x32x16_bf16 v[100:115], v[76:79], v[36:39], v[100:115]
    buffer_load_dwordx4 v204, s[4:7], s30 offen offset:2048 lds
    v_mfma_f32_32x32x16_bf16 v[116:131], v[80:83], v[36:39], v[116:131]
    buffer_load_dwordx4 v205, s[4:7], s31 offen offset:3072 lds
    s_add_u32 s4, s4, 128
    s_addc_u32 s5, s5, 0
    v_mfma_f32_32x32x16_bf16 v[132:147], v[36:39], v[84:87], v[132:147]
    s_waitcnt vmcnt(11)
    s_barrier
    ds_read_b64_tr_b16 v[76:77], v212 offset:8192
    ds_read_b64_tr_b16 v[78:79], v212 offset:8704
    ds_read_b64_tr_b16 v[80:81], v213 offset:8192
    ds_read_b64_tr_b16 v[82:83], v213 offset:8704
    ds_read_b64_tr_b16 v[84:85], v214 offset:4096
    ds_read_b64_tr_b16 v[86:87], v214 offset:4352
    s_waitcnt vmcnt(7)
    ds_read_b128 v[48:51], v208 offset:4096
    ds_read_b128 v[52:55], v209 offset:4096
    s_waitcnt lgkmcnt(14)
    v_mfma_f32_32x32x16_bf16 v[100:115], v[88:91], v[40:43], v[100:115]
    s_add_u32 m0, s35, 24576
    s_nop 0
    buffer_load_dwordx4 v206, s[8:11], s33 offen lds
    v_mfma_f32_32x32x16_bf16 v[116:131], v[92:95], v[40:43], v[116:131]
    buffer_load_dwordx4 v206, s[8:11], s32 offen offset:1024 lds
    v_mfma_f32_32x32x16_bf16 v[132:147], v[40:43], v[96:99], v[132:147]
    ds_read_b64_tr_b16 v[88:89], v212 offset:10240
    ds_read_b64_tr_b16 v[90:91], v212 offset:10752
    ds_read_b64_tr_b16 v[92:93], v213 offset:10240
    ds_read_b64_tr_b16 v[94:95], v213 offset:10752
    ds_read_b64_tr_b16 v[96:97], v214 offset:5120
    ds_read_b64_tr_b16 v[98:99], v214 offset:5376
    ds_read_b128 v[56:59], v210 offset:4096
    ds_read_b128 v[60:63], v211 offset:4096
    s_waitcnt lgkmcnt(15)
    v_mfma_f32_32x32x16_bf16 v[100:115], v[64:67], v[44:47], v[100:115]
    s_add_u32 m0, s36, 12288
    s_nop 0
    buffer_load_dwordx4 v207, s[12:15], s34 offen lds
    v_mfma_f32_32x32x16_bf16 v[116:131], v[68:71], v[44:47], v[116:131]
    v_mfma_f32_32x32x16_bf16 v[132:147], v[44:47], v[72:75], v[132:147]
    ds_read_b64_tr_b16 v[64:65], v212 offset:12288
    ds_read_b64_tr_b16 v[66:67], v212 offset:12800
    ds_read_b64_tr_b16 v[68:69], v213 offset:12288
    ds_read_b64_tr_b16 v[70:71], v213 offset:12800
    ds_read_b64_tr_b16 v[72:73], v214 offset:6144
    ds_read_b64_tr_b16 v[74:75], v214 offset:6400
    s_waitcnt lgkmcnt(15)
    s_waitcnt lgkmcnt(6)
    v_mfma_f32_32x32x16_bf16 v[100:115], v[76:79], v[48:51], v[100:115]
    s_add_u32 m0, s37, 4096
    s_nop 0
    buffer_load_dwordx4 v204, s[4:7], s28 offen offset:0 lds
    v_mfma_f32_32x32x16_bf16 v[116:131], v[80:83], v[48:51], v[116:131]
    buffer_load_dwordx4 v205, s[4:7], s29 offen offset:1024 lds
    v_mfma_f32_32x32x16_bf16 v[132:147], v[48:51], v[84:87], v[132:147]
    ds_read_b64_tr_b16 v[76:77], v212 offset:14336
    ds_read_b64_tr_b16 v[78:79], v212 offset:14848
    ds_read_b64_tr_b16 v[80:81], v213 offset:14336
    ds_read_b64_tr_b16 v[82:83], v213 offset:14848
    ds_read_b64_tr_b16 v[84:85], v214 offset:7168
    ds_read_b64_tr_b16 v[86:87], v214 offset:7424
    v_mfma_f32_32x32x16_bf16 v[100:115], v[88:91], v[52:55], v[100:115]
    buffer_load_dwordx4 v204, s[4:7], s30 offen offset:2048 lds
    v_mfma_f32_32x32x16_bf16 v[116:131], v[92:95], v[52:55], v[116:131]
    buffer_load_dwordx4 v205, s[4:7], s31 offen offset:3072 lds
    v_mfma_f32_32x32x16_bf16 v[132:147], v[52:55], v[96:99], v[132:147]
    s_waitcnt vmcnt(11)
    s_barrier
    ds_read_b64_tr_b16 v[88:89], v212 offset:16384
    ds_read_b64_tr_b16 v[90:91], v212 offset:16896
    ds_read_b64_tr_b16 v[92:93], v213 offset:16384
    ds_read_b64_tr_b16 v[94:95], v213 offset:16896
    ds_read_b64_tr_b16 v[96:97], v214 offset:8192
    ds_read_b64_tr_b16 v[98:99], v214 offset:8448
    s_waitcnt vmcnt(7)
    ds_read_b128 v[32:35], v208 offset:0
    ds_read_b128 v[36:39], v209 offset:0
    s_waitcnt lgkmcnt(14)
    v_mfma_f32_32x32x16_bf16 v[100:115], v[64:67], v[56:59], v[100:115]
    v_mfma_f32_32x32x16_bf16 v[116:131], v[68:71], v[56:59], v[116:131]
    v_mfma_f32_32x32x16_bf16 v[132:147], v[56:59], v[72:75], v[132:147]
    ds_read_b64_tr_b16 v[64:65], v212 offset:18432
    ds_read_b64_tr_b16 v[66:67], v212 offset:18944
    ds_read_b64_tr_b16 v[68:69], v213 offset:18432
    ds_read_b64_tr_b16 v[70:71], v213 offset:18944
    ds_read_b64_tr_b16 v[72:73], v214 offset:9216
    ds_read_b64_tr_b16 v[74:75], v214 offset:9472
    ds_read_b128 v[40:43], v210 offset:0
    ds_read_b128 v[44:47], v211 offset:0
    s_waitcnt lgkmcnt(15)
    v_mfma_f32_32x32x16_bf16 v[100:115], v[76:79], v[60:63], v[100:115]
    v_mfma_f32_32x32x16_bf16 v[116:131], v[80:83], v[60:63], v[116:131]
    v_mfma_f32_32x32x16_bf16 v[132:147], v[60:63], v[84:87], v[132:147]
    ds_read_b64_tr_b16 v[76:77], v212 offset:20480
    ds_read_b64_tr_b16 v[78:79], v212 offset:20992
    ds_read_b64_tr_b16 v[80:81], v213 offset:20480
    ds_read_b64_tr_b16 v[82:83], v213 offset:20992
    ds_read_b64_tr_b16 v[84:85], v214 offset:10240
    ds_read_b64_tr_b16 v[86:87], v214 offset:10496
    s_waitcnt lgkmcnt(15)
    v_mfma_f32_32x32x16_bf16 v[100:115], v[88:91], v[32:35], v[100:115]
    v_mfma_f32_32x32x16_bf16 v[116:131], v[92:95], v[32:35], v[116:131]
    v_mfma_f32_32x32x16_bf16 v[132:147], v[32:35], v[96:99], v[132:147]
    ds_read_b64_tr_b16 v[88:89], v212 offset:22528
    ds_read_b64_tr_b16 v[90:91], v212 offset:23040
    ds_read_b64_tr_b16 v[92:93], v213 offset:22528
    ds_read_b64_tr_b16 v[94:95], v213 offset:23040
    ds_read_b64_tr_b16 v[96:97], v214 offset:11264
    ds_read_b64_tr_b16 v[98:99], v214 offset:11520
    s_waitcnt lgkmcnt(14)
    v_mfma_f32_32x32x16_bf16 v[100:115], v[64:67], v[36:39], v[100:115]
    v_mfma_f32_32x32x16_bf16 v[116:131], v[68:71], v[36:39], v[116:131]
    v_mfma_f32_32x32x16_bf16 v[132:147], v[36:39], v[72:75], v[132:147]
    s_waitcnt vmcnt(4)
    s_barrier
    ds_read_b64_tr_b16 v[64:65], v212 offset:24576
    ds_read_b64_tr_b16 v[66:67], v212 offset:25088
    ds_read_b64_tr_b16 v[68:69], v213 offset:24576
    ds_read_b64_tr_b16 v[70:71], v213 offset:25088
    ds_read_b64_tr_b16 v[72:73], v214 offset:12288
    ds_read_b64_tr_b16 v[74:75], v214 offset:12544
    s_waitcnt vmcnt(0)
    ds_read_b128 v[48:51], v208 offset:4096
    ds_read_b128 v[52:55], v209 offset:4096
    s_waitcnt lgkmcnt(14)
    v_mfma_f32_32x32x16_bf16 v[100:115], v[76:79], v[40:43], v[100:115]
    v_mfma_f32_32x32x16_bf16 v[116:131], v[80:83], v[40:43], v[116:131]
    v_mfma_f32_32x32x16_bf16 v[132:147], v[40:43], v[84:87], v[132:147]
    ds_read_b64_tr_b16 v[76:77], v212 offset:26624
    ds_read_b64_tr_b16 v[78:79], v212 offset:27136
    ds_read_b64_tr_b16 v[80:81], v213 offset:26624
    ds_read_b64_tr_b16 v[82:83], v213 offset:27136
    ds_read_b64_tr_b16 v[84:85], v214 offset:13312
    ds_read_b64_tr_b16 v[86:87], v214 offset:13568
    ds_read_b128 v[56:59], v210 offset:4096
    ds_read_b128 v[60:63], v211 offset:4096
    s_waitcnt lgkmcnt(15)
    v_mfma_f32_32x32x16_bf16 v[100:115], v[88:91], v[44:47], v[100:115]
    v_mfma_f32_32x32x16_bf16 v[116:131], v[92:95], v[44:47], v[116:131]
    v_mfma_f32_32x32x16_bf16 v[132:147], v[44:47], v[96:99], v[132:147]
    ds_read_b64_tr_b16 v[88:89], v212 offset:28672
    ds_read_b64_tr_b16 v[90:91], v212 offset:29184
    ds_read_b64_tr_b16 v[92:93], v213 offset:28672
    ds_read_b64_tr_b16 v[94:95], v213 offset:29184
    ds_read_b64_tr_b16 v[96:97], v214 offset:14336
    ds_read_b64_tr_b16 v[98:99], v214 offset:14592
    s_waitcnt lgkmcnt(15)
    v_mfma_f32_32x32x16_bf16 v[100:115], v[64:67], v[48:51], v[100:115]
    v_mfma_f32_32x32x16_bf16 v[116:131], v[68:71], v[48:51], v[116:131]
    v_mfma_f32_32x32x16_bf16 v[132:147], v[48:51], v[72:75], v[132:147]
    ds_read_b64_tr_b16 v[64:65], v212 offset:30720
    ds_read_b64_tr_b16 v[66:67], v212 offset:31232
    ds_read_b64_tr_b16 v[68:69], v213 offset:30720
    ds_read_b64_tr_b16 v[70:71], v213 offset:31232
    ds_read_b64_tr_b16 v[72:73], v214 offset:15360
    ds_read_b64_tr_b16 v[74:75], v214 offset:15616
    s_waitcnt lgkmcnt(14)
    v_mfma_f32_32x32x16_bf16 v[100:115], v[76:79], v[52:55], v[100:115]
    v_mfma_f32_32x32x16_bf16 v[116:131], v[80:83], v[52:55], v[116:131]
    v_mfma_f32_32x32x16_bf16 v[132:147], v[52:55], v[84:87], v[132:147]
    s_waitcnt lgkmcnt(6)
    v_mfma_f32_32x32x16_bf16 v[100:115], v[88:91], v[56:59], v[100:115]
    v_mfma_f32_32x32x16_bf16 v[116:131], v[92:95], v[56:59], v[116:131]
    v_mfma_f32_32x32x16_bf16 v[132:147], v[56:59], v[96:99], v[132:147]
    s_waitcnt lgkmcnt(0)
    v_mfma_f32_32x32x16_bf16 v[100:115], v[64:67], v[60:63], v[100:115]
    v_mfma_f32_32x32x16_bf16 v[116:131], v[68:71], v[60:63], v[116:131]
    v_mfma_f32_32x32x16_bf16 v[132:147], v[60:63], v[72:75], v[132:147]
    s_nop 15
    v_pk_mul_f32 v[100:101], v[100:101], s[44:45]
    v_pk_mul_f32 v[102:103], v[102:103], s[44:45]
    v_pk_mul_f32 v[104:105], v[104:105], s[44:45]
    v_pk_mul_f32 v[106:107], v[106:107], s[44:45]
    v_pk_mul_f32 v[108:109], v[108:109], s[44:45]
    v_pk_mul_f32 v[110:111], v[110:111], s[44:45]
    v_pk_mul_f32 v[112:113], v[112:113], s[44:45]
    v_pk_mul_f32 v[114:115], v[114:115], s[44:45]
    v_cvt_pk_bf16_f32 v8, v100, v101
    v_cvt_pk_bf16_f32 v9, v102, v103
    v_cvt_pk_bf16_f32 v10, v104, v105
    v_cvt_pk_bf16_f32 v11, v106, v107
    v_cvt_pk_bf16_f32 v12, v108, v109
    v_cvt_pk_bf16_f32 v13, v110, v111
    v_cvt_pk_bf16_f32 v14, v112, v113
    v_cvt_pk_bf16_f32 v15, v114, v115
    v_pk_mul_f32 v[116:117], v[116:117], s[44:45]
    v_pk_mul_f32 v[118:119], v[118:119], s[44:45]
    v_pk_mul_f32 v[120:121], v[120:121], s[44:45]
    v_pk_mul_f32 v[122:123], v[122:123], s[44:45]
    v_pk_mul_f32 v[124:125], v[124:125], s[44:45]
    v_pk_mul_f32 v[126:127], v[126:127], s[44:45]
    v_pk_mul_f32 v[128:129], v[128:129], s[44:45]
    v_pk_mul_f32 v[130:131], v[130:131], s[44:45]
    v_cvt_pk_bf16_f32 v16, v116, v117
    v_cvt_pk_bf16_f32 v17, v118, v119
    v_cvt_pk_bf16_f32 v18, v120, v121
    v_cvt_pk_bf16_f32 v19, v122, v123
    v_cvt_pk_bf16_f32 v20, v124, v125
    v_cvt_pk_bf16_f32 v21, v126, v127
    v_cvt_pk_bf16_f32 v22, v128, v129
    v_cvt_pk_bf16_f32 v23, v130, v131
    v_cvt_pk_bf16_f32 v32, v132, v133
    v_cvt_pk_bf16_f32 v33, v134, v135
    v_cvt_pk_bf16_f32 v34, v136, v137
    v_cvt_pk_bf16_f32 v35, v138, v139
    v_cvt_pk_bf16_f32 v36, v140, v141
    v_cvt_pk_bf16_f32 v37, v142, v143
    v_cvt_pk_bf16_f32 v38, v144, v145
    v_cvt_pk_bf16_f32 v39, v146, v147
    s_add_u32 s92, s84, 0x1400000
    s_addc_u32 s93, s85, 0
    s_mov_b32 s8, s92
    s_mov_b32 s9, s93
    s_mov_b32 s10, 0x40000
    s_mov_b32 s11, 0x00020000
    s_lshl_b32 s91, s87, 2
    s_add_u32 s91, s91, s86
    s_lshl_b32 s91, s91, 12
    buffer_store_dwordx4 v[32:35], v2, s[8:11], s91 offen offset:2048 sc1
    buffer_store_dwordx4 v[36:39], v2, s[8:11], s91 offen offset:3072 sc1
    s_waitcnt vmcnt(0) lgkmcnt(0)
    s_barrier
gated_mix__grouped_kv_mqa__dense_activation_mish__prompt_kernel_attn:
    s_cmp_lg_u32 s86, 0
    s_cbranch_scc1 gated_mix__grouped_kv_mqa__dense_activation_mish__prompt_kernel_kvw
    v_readfirstlane_b32 s97, v253
    s_nop 3
    s_cmp_eq_u32 s97, 1
    s_cbranch_scc1 gated_mix__grouped_kv_mqa__dense_activation_mish__prompt_kernel_clr_ok
    s_mov_b32 s52, s82
    s_mov_b32 s53, s83
    s_mov_b32 s54, 0x100
    s_mov_b32 s55, 0x00020000
    s_and_b32 s97, s2, 1
    s_lshl_b32 s97, s97, 7
    v_mov_b32 v4, s97
    s_mov_b32 s96, 0x40000
gated_mix__grouped_kv_mqa__dense_activation_mish__prompt_kernel_clr:
    buffer_load_dword v5, v4, s[52:55], 0 offen sc1
    s_waitcnt vmcnt(0)
    v_cmp_eq_u32 vcc, 1, v5
    s_nop 3
    s_cmp_eq_u64 vcc, exec
    s_cbranch_scc1 gated_mix__grouped_kv_mqa__dense_activation_mish__prompt_kernel_clr_ok
    s_sleep 6
    s_sub_u32 s96, s96, 1
    s_cmp_lg_u32 s96, 0
    s_cbranch_scc1 gated_mix__grouped_kv_mqa__dense_activation_mish__prompt_kernel_clr
gated_mix__grouped_kv_mqa__dense_activation_mish__prompt_kernel_clr_ok:
    s_cmp_ge_u32 s88, 2
    s_cbranch_scc1 gated_mix__grouped_kv_mqa__dense_activation_mish__prompt_kernel_nokvsig
    s_lshl_b32 s28, s87, 1
    s_add_u32 s28, s28, s88
    s_lshl_b32 s28, s28, 2
    s_add_u32 s28, s28, 0
    s_add_u32 s92, s84, 0x1b00000
    s_addc_u32 s93, s85, 0
    s_mov_b32 s52, s92
    s_mov_b32 s53, s93
    s_mov_b32 s54, 0x4000
    s_mov_b32 s55, 0x00020000
    v_lshlrev_b32 v6, 8, v1
    v_add_u32 v6, s28, v6
    v_mov_b32 v4, 1
    v_cmp_gt_u32 vcc, 32, v1
    s_nop 1
    s_and_saveexec_b64 s[90:91], vcc
    buffer_store_dword v4, v6, s[52:55], 0 offen sc1
    s_mov_b64 exec, s[90:91]
gated_mix__grouped_kv_mqa__dense_activation_mish__prompt_kernel_nokvsig:
    s_and_b32 s28, s2, 31
    s_lshl_b32 s28, s28, 8
    s_add_u32 s28, s28, 0
    s_add_u32 s92, s84, 0x1b00000
    s_addc_u32 s93, s85, 0
    s_mov_b32 s52, s92
    s_mov_b32 s53, s93
    s_mov_b32 s54, 0x4000
    s_mov_b32 s55, 0x00020000
    v_and_b32 v4, 31, v1
    v_lshlrev_b32 v4, 2, v4
    s_mov_b32 s96, 0x40000
gated_mix__grouped_kv_mqa__dense_activation_mish__prompt_kernel_kvp:
    buffer_load_dword v5, v4, s[52:55], s28 offen sc1
    s_waitcnt vmcnt(0)
    v_cmp_eq_u32 vcc, 1, v5
    s_nop 3
    s_cmp_eq_u64 vcc, exec
    s_cbranch_scc1 gated_mix__grouped_kv_mqa__dense_activation_mish__prompt_kernel_kvp_ok
    s_sleep 6
    s_sub_u32 s96, s96, 1
    s_cmp_lg_u32 s96, 0
    s_cbranch_scc1 gated_mix__grouped_kv_mqa__dense_activation_mish__prompt_kernel_kvp
gated_mix__grouped_kv_mqa__dense_activation_mish__prompt_kernel_kvp_ok:
gated_mix__grouped_kv_mqa__dense_activation_mish__prompt_kernel_kvw:
    s_barrier
    s_setprio 0
    s_lshl_b32 s38, s87, 2
    s_add_u32 s38, s38, s86
    s_lshl_b32 s38, s38, 6
    s_lshl_b32 s91, s88, 2
    s_add_u32 s38, s38, s91
    s_lshl_b32 s38, s38, 10
    s_lshl_b32 s30, s86, 12
    s_mov_b32 s39, 0
    s_add_u32 s92, s84, 0x1400000
    s_addc_u32 s93, s85, 0
    s_mov_b32 s8, s92
    s_mov_b32 s9, s93
    s_mov_b32 s10, 0x40000
    s_mov_b32 s11, 0x00020000
    s_add_u32 s92, s84, 0x1500000
    s_addc_u32 s93, s85, 0
    s_mov_b32 s12, s92
    s_mov_b32 s13, s93
    s_mov_b32 s14, 0x400000
    s_mov_b32 s15, 0x00020000
gated_mix__grouped_kv_mqa__dense_activation_mish__prompt_kernel_pass:
    s_sub_u32 s31, s30, 16384
    s_add_u32 m0, s30, 0
    s_add_u32 s31, s31, 16384
    buffer_load_dwordx4 v2, s[8:11], s31 offen offset:0 sc1 lds
    buffer_load_dwordx4 v2, s[8:11], s31 offen offset:1024 sc1 lds
    buffer_load_dwordx4 v2, s[8:11], s31 offen offset:2048 sc1 lds
    buffer_load_dwordx4 v2, s[8:11], s31 offen offset:3072 sc1 lds
    v_mov_b32 v4, 0x10000
    v_mov_b32 v5, 0
    ds_write_b32 v4, v5
    v_bfe_u32 v4, v1, 2, 1
    v_cmp_eq_u32 vcc, 0, v4
    v_mov_b32 v6, 0x3f803f80
    v_mov_b32 v7, 0
    v_cndmask_b32 v128, v7, v6, vcc
    v_cndmask_b32 v129, v7, v6, vcc
    v_cndmask_b32 v130, v6, v7, vcc
    v_cndmask_b32 v131, v6, v7, vcc
    v_and_b32 v4, 1, v1
    v_cmp_eq_u32 vcc, 0, v4
    v_mov_b32 v6, 0x44444444
    v_mov_b32 v7, 0xeeeeeeee
    v_cndmask_b32 v222, v7, v6, vcc
    v_mov_b32 v80, 0
    v_mov_b32 v81, 0
    v_mov_b32 v82, 0
    v_mov_b32 v83, 0
    v_mov_b32 v88, 0
    v_mov_b32 v89, 0
    v_mov_b32 v90, 0
    v_mov_b32 v91, 0
    v_mov_b32 v92, 0
    v_mov_b32 v93, 0
    v_mov_b32 v94, 0
    v_mov_b32 v95, 0
    v_mov_b32 v96, 0
    v_mov_b32 v97, 0
    v_mov_b32 v98, 0
    v_mov_b32 v99, 0
    v_mov_b32 v100, 0
    v_mov_b32 v101, 0
    v_mov_b32 v102, 0
    v_mov_b32 v103, 0
    v_mov_b32 v120, 0
    v_mov_b32 v121, 0
    v_mov_b32 v122, 0
    v_mov_b32 v123, 0
    v_mov_b32 v104, 0
    v_mov_b32 v105, 0
    v_mov_b32 v106, 0
    v_mov_b32 v107, 0
    v_mov_b32 v108, 0
    v_mov_b32 v109, 0
    v_mov_b32 v110, 0
    v_mov_b32 v111, 0
    v_mov_b32 v112, 0
    v_mov_b32 v113, 0
    v_mov_b32 v114, 0
    v_mov_b32 v115, 0
    v_mov_b32 v116, 0
    v_mov_b32 v117, 0
    v_mov_b32 v118, 0
    v_mov_b32 v119, 0
    v_mov_b32 v124, 0
    v_mov_b32 v125, 0
    v_mov_b32 v126, 0
    v_mov_b32 v127, 0
    v_mov_b32 v84, 0
    v_mov_b32 v85, 0
    v_mov_b32 v86, 0
    v_mov_b32 v87, 0
    v_mov_b32 v36, 0
    v_mov_b32 v37, 0
    v_mov_b32 v38, 0
    v_mov_b32 v39, 0
    s_waitcnt vmcnt(0) lgkmcnt(0)
    s_barrier
    ds_read_b128 v[24:27], v2 offset:0
    ds_read_b128 v[28:31], v2 offset:1024
    s_add_u32 m0, s30, 16384
    s_add_u32 s31, s31, 16384
    buffer_load_dwordx4 v2, s[8:11], s31 offen offset:0 sc1 lds
    buffer_load_dwordx4 v2, s[8:11], s31 offen offset:1024 sc1 lds
    buffer_load_dwordx4 v2, s[8:11], s31 offen offset:2048 sc1 lds
    buffer_load_dwordx4 v2, s[8:11], s31 offen offset:3072 sc1 lds
    s_add_u32 m0, s30, 32768
    s_add_u32 s31, s31, 16384
    buffer_load_dwordx4 v2, s[8:11], s31 offen offset:0 sc1 lds
    buffer_load_dwordx4 v2, s[8:11], s31 offen offset:1024 sc1 lds
    buffer_load_dwordx4 v2, s[8:11], s31 offen offset:2048 sc1 lds
    buffer_load_dwordx4 v2, s[8:11], s31 offen offset:3072 sc1 lds
    s_cmp_lg_u32 s39, 0
    s_cbranch_scc1 gated_mix__grouped_kv_mqa__dense_activation_mish__prompt_kernel_havemax
    s_mov_b32 s20, s60
    s_mov_b32 s21, s61
    s_mov_b32 s22, 0x400000
    s_mov_b32 s23, 0x00020000
    s_mov_b32 s24, s78
    s_mov_b32 s25, s79
    s_mov_b32 s26, 0x800
    s_mov_b32 s27, 0x00020000
    s_lshl_b32 s91, s87, 4
    s_add_u32 s91, s91, s88
    s_lshl_b32 s91, s91, 2
    s_add_u32 s91, s91, s86
    s_lshl_b32 s28, s91, 12
    v_lshlrev_b32 v3, 5, v1
    buffer_load_dwordx4 v[180:183], v3, s[24:27], 0 offen
    buffer_load_dwordx4 v[184:187], v3, s[24:27], 0 offen offset:16
    buffer_load_dwordx4 v[188:191], v3, s[20:23], s28 offen
    buffer_load_dwordx4 v[192:195], v3, s[20:23], s28 offen offset:16
    buffer_load_dwordx4 v[196:199], v3, s[20:23], s28 offen offset:2048
    buffer_load_dwordx4 v[200:203], v3, s[20:23], s28 offen offset:2064
    s_waitcnt lgkmcnt(0)
    v_mfma_f32_32x32x16_bf16 v[40:55], v[24:27], v[8:11], 0
    v_mfma_f32_32x32x16_bf16 v[40:55], v[28:31], v[12:15], v[40:55]
    v_mfma_f32_32x32x16_bf16 v[56:71], v[24:27], v[16:19], 0
    v_mfma_f32_32x32x16_bf16 v[56:71], v[28:31], v[20:23], v[56:71]
    s_nop 15
    v_max3_f32 v4, v40, v41, v42
    v_max3_f32 v4, v4, v43, v44
    v_max3_f32 v4, v4, v45, v46
    v_max3_f32 v4, v4, v47, v48
    v_max3_f32 v4, v4, v49, v50
    v_max3_f32 v4, v4, v51, v52
    v_max3_f32 v4, v4, v53, v54
    v_max_f32 v4, v4, v55
    v_mov_b32 v5, v4
    v_mov_b32 v6, v4
    s_nop 1
    v_permlane32_swap_b32 v5, v6
    s_nop 1
    v_max_f32 v5, v5, v6
    v_sub_f32 v5, 0, v5
    v_mov_b32 v132, v5
    v_mov_b32 v133, v5
    v_mov_b32 v134, v5
    v_mov_b32 v135, v5
    v_mov_b32 v136, v5
    v_mov_b32 v137, v5
    v_mov_b32 v138, v5
    v_mov_b32 v139, v5
    v_mov_b32 v140, v5
    v_mov_b32 v141, v5
    v_mov_b32 v142, v5
    v_mov_b32 v143, v5
    v_mov_b32 v144, v5
    v_mov_b32 v145, v5
    v_mov_b32 v146, v5
    v_mov_b32 v147, v5
    v_max3_f32 v4, v56, v57, v58
    v_max3_f32 v4, v4, v59, v60
    v_max3_f32 v4, v4, v61, v62
    v_max3_f32 v4, v4, v63, v64
    v_max3_f32 v4, v4, v65, v66
    v_max3_f32 v4, v4, v67, v68
    v_max3_f32 v4, v4, v69, v70
    v_max_f32 v4, v4, v71
    v_mov_b32 v5, v4
    v_mov_b32 v6, v4
    s_nop 1
    v_permlane32_swap_b32 v5, v6
    s_nop 1
    v_max_f32 v5, v5, v6
    v_sub_f32 v5, 0, v5
    v_mov_b32 v148, v5
    v_mov_b32 v149, v5
    v_mov_b32 v150, v5
    v_mov_b32 v151, v5
    v_mov_b32 v152, v5
    v_mov_b32 v153, v5
    v_mov_b32 v154, v5
    v_mov_b32 v155, v5
    v_mov_b32 v156, v5
    v_mov_b32 v157, v5
    v_mov_b32 v158, v5
    v_mov_b32 v159, v5
    v_mov_b32 v160, v5
    v_mov_b32 v161, v5
    v_mov_b32 v162, v5
    v_mov_b32 v163, v5
gated_mix__grouped_kv_mqa__dense_activation_mish__prompt_kernel_havemax:
    s_waitcnt lgkmcnt(0)
    s_nop 0
    v_mfma_f32_32x32x16_bf16 v[40:55], v[24:27], v[8:11], v[132:147]
    v_mfma_f32_32x32x16_bf16 v[40:55], v[28:31], v[12:15], v[40:55]
    ds_read_b128 v[32:35], v2 offset:2048
    s_nop 15
    s_lshl_b32 s91, s88, 7
    s_add_u32 s92, s76, s91
    s_addc_u32 s93, s77, 0
    s_mov_b32 s16, s92
    s_mov_b32 s17, s93
    s_mov_b32 s18, 0x700000
    s_mov_b32 s19, 0x00020000
    s_add_u32 s92, s68, s91
    s_addc_u32 s93, s69, 0
    s_mov_b32 s40, s92
    s_mov_b32 s41, s93
    s_mov_b32 s42, 0x200000
    s_mov_b32 s43, 0x00020000
    s_and_b32 s91, s87, 3
    s_lshl_b32 s91, s91, 4
    v_lshrrev_b32 v3, 4, v1
    v_lshlrev_b32 v3, 6, v3
    v_and_b32 v4, 15, v1
    v_add_u32 v3, v3, v4
    v_add_u32 v3, s91, v3
    v_lshlrev_b32 v215, 11, v3
    s_mov_b32 s29, 0
    s_mov_b32 s32, 0
    s_mov_b32 s33, 4
gated_mix__grouped_kv_mqa__dense_activation_mish__prompt_kernel_loop:
    v_mfma_f32_32x32x16_bf16 v[56:71], v[24:27], v[16:19], v[148:163]
    v_exp_f32 v40, v40
    v_exp_f32 v41, v41
    v_exp_f32 v42, v42
    v_mfma_f32_32x32x16_bf16 v[104:119], v[36:39], v[84:87], v[104:119]
    ds_read_b128 v[36:39], v2 offset:3072
    v_exp_f32 v43, v43
    v_exp_f32 v44, v44
    v_exp_f32 v45, v45
    v_mfma_f32_32x32x16_bf16 v[56:71], v[28:31], v[20:23], v[56:71]
    ds_read_b128 v[24:27], v2 offset:4096
    ds_read_b128 v[28:31], v2 offset:5120
    v_exp_f32 v46, v46
    v_exp_f32 v47, v47
    v_exp_f32 v48, v48
    v_smfmac_f32_16x16x64_bf16 v[124:127], v[128:131], v[80:87], v222
    v_cvt_pk_bf16_f32 v72, v40, v41
    v_cvt_pk_bf16_f32 v73, v42, v43
    v_exp_f32 v49, v49
    v_cvt_pk_bf16_f32 v74, v44, v45
    v_cvt_pk_bf16_f32 v75, v46, v47
    v_exp_f32 v50, v50
    v_exp_f32 v51, v51
    s_waitcnt lgkmcnt(3)
    v_mfma_f32_32x32x16_bf16 v[88:103], v[32:35], v[72:75], v[88:103]
    v_exp_f32 v52, v52
    v_exp_f32 v53, v53
    v_exp_f32 v54, v54
    v_exp_f32 v55, v55
    v_cvt_pk_bf16_f32 v76, v48, v49
    v_cvt_pk_bf16_f32 v77, v50, v51
    v_cvt_pk_bf16_f32 v78, v52, v53
    v_cvt_pk_bf16_f32 v79, v54, v55
    s_cmp_lg_u32 s86, 0
    s_cbranch_scc1 gated_mix__grouped_kv_mqa__dense_activation_mish__prompt_kernel_pf2_0
    buffer_load_dword v216, v215, s[16:19], s29 offen
    s_cmp_lg_u32 s33, 1
    s_cbranch_scc1 gated_mix__grouped_kv_mqa__dense_activation_mish__prompt_kernel_pf2_0
    buffer_load_dword v217, v215, s[40:43], s32 offen
gated_mix__grouped_kv_mqa__dense_activation_mish__prompt_kernel_pf2_0:
    s_add_u32 s29, s29, 524288
    s_cmp_lg_u32 s33, 1
    s_cbranch_scc1 gated_mix__grouped_kv_mqa__dense_activation_mish__prompt_kernel_pf2_0_n
    s_add_u32 s32, s32, 524288
gated_mix__grouped_kv_mqa__dense_activation_mish__prompt_kernel_pf2_0_n:
    s_waitcnt lgkmcnt(0)
    v_mfma_f32_32x32x16_bf16 v[40:55], v[24:27], v[8:11], v[132:147]
    v_exp_f32 v56, v56
    v_exp_f32 v57, v57
    v_exp_f32 v58, v58
    v_mfma_f32_32x32x16_bf16 v[88:103], v[36:39], v[76:79], v[88:103]
    v_exp_f32 v59, v59
    v_exp_f32 v60, v60
    v_exp_f32 v61, v61
    v_mfma_f32_32x32x16_bf16 v[40:55], v[28:31], v[12:15], v[40:55]
    v_exp_f32 v62, v62
    v_exp_f32 v63, v63
    v_exp_f32 v64, v64
    v_smfmac_f32_16x16x64_bf16 v[120:123], v[128:131], v[72:79], v222
    v_cvt_pk_bf16_f32 v80, v56, v57
    v_cvt_pk_bf16_f32 v81, v58, v59
    v_exp_f32 v65, v65
    v_cvt_pk_bf16_f32 v82, v60, v61
    v_cvt_pk_bf16_f32 v83, v62, v63
    v_exp_f32 v66, v66
    v_exp_f32 v67, v67
    v_mfma_f32_32x32x16_bf16 v[104:119], v[32:35], v[80:83], v[104:119]
    ds_read_b128 v[32:35], v2 offset:6144
    v_exp_f32 v68, v68
    v_exp_f32 v69, v69
    v_exp_f32 v70, v70
    v_exp_f32 v71, v71
    v_cvt_pk_bf16_f32 v84, v64, v65
    v_cvt_pk_bf16_f32 v85, v66, v67
    v_cvt_pk_bf16_f32 v86, v68, v69
    v_cvt_pk_bf16_f32 v87, v70, v71
    v_mfma_f32_32x32x16_bf16 v[56:71], v[24:27], v[16:19], v[148:163]
    v_exp_f32 v40, v40
    v_exp_f32 v41, v41
    v_exp_f32 v42, v42
    v_mfma_f32_32x32x16_bf16 v[104:119], v[36:39], v[84:87], v[104:119]
    ds_read_b128 v[36:39], v2 offset:7168
    v_exp_f32 v43, v43
    v_exp_f32 v44, v44
    v_exp_f32 v45, v45
    v_mfma_f32_32x32x16_bf16 v[56:71], v[28:31], v[20:23], v[56:71]
    ds_read_b128 v[24:27], v2 offset:8192
    ds_read_b128 v[28:31], v2 offset:9216
    v_exp_f32 v46, v46
    v_exp_f32 v47, v47
    v_exp_f32 v48, v48
    v_smfmac_f32_16x16x64_bf16 v[124:127], v[128:131], v[80:87], v222
    v_cvt_pk_bf16_f32 v72, v40, v41
    v_cvt_pk_bf16_f32 v73, v42, v43
    v_exp_f32 v49, v49
    v_cvt_pk_bf16_f32 v74, v44, v45
    v_cvt_pk_bf16_f32 v75, v46, v47
    v_exp_f32 v50, v50
    v_exp_f32 v51, v51
    s_waitcnt lgkmcnt(3)
    v_mfma_f32_32x32x16_bf16 v[88:103], v[32:35], v[72:75], v[88:103]
    v_exp_f32 v52, v52
    v_exp_f32 v53, v53
    v_exp_f32 v54, v54
    v_exp_f32 v55, v55
    v_cvt_pk_bf16_f32 v76, v48, v49
    v_cvt_pk_bf16_f32 v77, v50, v51
    v_cvt_pk_bf16_f32 v78, v52, v53
    v_cvt_pk_bf16_f32 v79, v54, v55
    s_waitcnt lgkmcnt(0)
    v_mfma_f32_32x32x16_bf16 v[40:55], v[24:27], v[8:11], v[132:147]
    v_exp_f32 v56, v56
    v_exp_f32 v57, v57
    v_exp_f32 v58, v58
    v_mfma_f32_32x32x16_bf16 v[88:103], v[36:39], v[76:79], v[88:103]
    v_exp_f32 v59, v59
    v_exp_f32 v60, v60
    v_exp_f32 v61, v61
    v_mfma_f32_32x32x16_bf16 v[40:55], v[28:31], v[12:15], v[40:55]
    v_exp_f32 v62, v62
    v_exp_f32 v63, v63
    v_exp_f32 v64, v64
    v_smfmac_f32_16x16x64_bf16 v[120:123], v[128:131], v[72:79], v222
    v_cvt_pk_bf16_f32 v80, v56, v57
    v_cvt_pk_bf16_f32 v81, v58, v59
    v_exp_f32 v65, v65
    v_cvt_pk_bf16_f32 v82, v60, v61
    v_cvt_pk_bf16_f32 v83, v62, v63
    v_exp_f32 v66, v66
    v_exp_f32 v67, v67
    v_mfma_f32_32x32x16_bf16 v[104:119], v[32:35], v[80:83], v[104:119]
    ds_read_b128 v[32:35], v2 offset:10240
    v_exp_f32 v68, v68
    v_exp_f32 v69, v69
    v_exp_f32 v70, v70
    v_exp_f32 v71, v71
    v_cvt_pk_bf16_f32 v84, v64, v65
    v_cvt_pk_bf16_f32 v85, v66, v67
    v_cvt_pk_bf16_f32 v86, v68, v69
    v_cvt_pk_bf16_f32 v87, v70, v71
    v_mfma_f32_32x32x16_bf16 v[56:71], v[24:27], v[16:19], v[148:163]
    v_exp_f32 v40, v40
    v_exp_f32 v41, v41
    v_exp_f32 v42, v42
    v_mfma_f32_32x32x16_bf16 v[104:119], v[36:39], v[84:87], v[104:119]
    ds_read_b128 v[36:39], v2 offset:11264
    v_exp_f32 v43, v43
    v_exp_f32 v44, v44
    v_exp_f32 v45, v45
    v_mfma_f32_32x32x16_bf16 v[56:71], v[28:31], v[20:23], v[56:71]
    ds_read_b128 v[24:27], v2 offset:12288
    ds_read_b128 v[28:31], v2 offset:13312
    v_exp_f32 v46, v46
    v_exp_f32 v47, v47
    v_exp_f32 v48, v48
    v_smfmac_f32_16x16x64_bf16 v[124:127], v[128:131], v[80:87], v222
    v_cvt_pk_bf16_f32 v72, v40, v41
    v_cvt_pk_bf16_f32 v73, v42, v43
    v_exp_f32 v49, v49
    v_cvt_pk_bf16_f32 v74, v44, v45
    v_cvt_pk_bf16_f32 v75, v46, v47
    v_exp_f32 v50, v50
    v_exp_f32 v51, v51
    s_waitcnt lgkmcnt(3)
    v_mfma_f32_32x32x16_bf16 v[88:103], v[32:35], v[72:75], v[88:103]
    v_exp_f32 v52, v52
    v_exp_f32 v53, v53
    v_exp_f32 v54, v54
    v_exp_f32 v55, v55
    v_cvt_pk_bf16_f32 v76, v48, v49
    v_cvt_pk_bf16_f32 v77, v50, v51
    v_cvt_pk_bf16_f32 v78, v52, v53
    v_cvt_pk_bf16_f32 v79, v54, v55
    s_waitcnt lgkmcnt(0)
    v_mfma_f32_32x32x16_bf16 v[40:55], v[24:27], v[8:11], v[132:147]
    v_exp_f32 v56, v56
    v_exp_f32 v57, v57
    v_exp_f32 v58, v58
    v_mfma_f32_32x32x16_bf16 v[88:103], v[36:39], v[76:79], v[88:103]
    v_exp_f32 v59, v59
    v_exp_f32 v60, v60
    v_exp_f32 v61, v61
    v_mfma_f32_32x32x16_bf16 v[40:55], v[28:31], v[12:15], v[40:55]
    v_exp_f32 v62, v62
    v_exp_f32 v63, v63
    v_exp_f32 v64, v64
    v_smfmac_f32_16x16x64_bf16 v[120:123], v[128:131], v[72:79], v222
    v_cvt_pk_bf16_f32 v80, v56, v57
    v_cvt_pk_bf16_f32 v81, v58, v59
    v_exp_f32 v65, v65
    v_cvt_pk_bf16_f32 v82, v60, v61
    v_cvt_pk_bf16_f32 v83, v62, v63
    v_exp_f32 v66, v66
    v_exp_f32 v67, v67
    v_mfma_f32_32x32x16_bf16 v[104:119], v[32:35], v[80:83], v[104:119]
    ds_read_b128 v[32:35], v2 offset:14336
    v_exp_f32 v68, v68
    v_exp_f32 v69, v69
    v_exp_f32 v70, v70
    v_exp_f32 v71, v71
    v_cvt_pk_bf16_f32 v84, v64, v65
    v_cvt_pk_bf16_f32 v85, v66, v67
    v_cvt_pk_bf16_f32 v86, v68, v69
    v_cvt_pk_bf16_f32 v87, v70, v71
    s_waitcnt vmcnt(4)
    s_barrier
    v_mfma_f32_32x32x16_bf16 v[56:71], v[24:27], v[16:19], v[148:163]
    v_exp_f32 v40, v40
    v_exp_f32 v41, v41
    s_add_u32 m0, s30, 49152
    s_add_u32 s31, s31, 16384
    buffer_load_dwordx4 v2, s[8:11], s31 offen sc1 lds
    v_exp_f32 v42, v42
    v_mfma_f32_32x32x16_bf16 v[104:119], v[36:39], v[84:87], v[104:119]
    ds_read_b128 v[36:39], v2 offset:15360
    v_exp_f32 v43, v43
    v_exp_f32 v44, v44
    buffer_load_dwordx4 v2, s[8:11], s31 offen offset:1024 sc1 lds
    v_exp_f32 v45, v45
    v_mfma_f32_32x32x16_bf16 v[56:71], v[28:31], v[20:23], v[56:71]
    ds_read_b128 v[24:27], v2 offset:16384
    ds_read_b128 v[28:31], v2 offset:17408
    v_exp_f32 v46, v46
    v_exp_f32 v47, v47
    buffer_load_dwordx4 v2, s[8:11], s31 offen offset:2048 sc1 lds
    v_exp_f32 v48, v48
    v_smfmac_f32_16x16x64_bf16 v[124:127], v[128:131], v[80:87], v222
    v_cvt_pk_bf16_f32 v72, v40, v41
    v_cvt_pk_bf16_f32 v73, v42, v43
    v_exp_f32 v49, v49
    v_cvt_pk_bf16_f32 v74, v44, v45
    v_cvt_pk_bf16_f32 v75, v46, v47
    v_exp_f32 v50, v50
    buffer_load_dwordx4 v2, s[8:11], s31 offen offset:3072 sc1 lds
    v_exp_f32 v51, v51
    s_waitcnt lgkmcnt(3)
    v_mfma_f32_32x32x16_bf16 v[88:103], v[32:35], v[72:75], v[88:103]
    v_exp_f32 v52, v52
    v_exp_f32 v53, v53
    v_exp_f32 v54, v54
    v_exp_f32 v55, v55
    v_cvt_pk_bf16_f32 v76, v48, v49
    v_cvt_pk_bf16_f32 v77, v50, v51
    v_cvt_pk_bf16_f32 v78, v52, v53
    v_cvt_pk_bf16_f32 v79, v54, v55
    s_waitcnt lgkmcnt(0)
    v_mfma_f32_32x32x16_bf16 v[40:55], v[24:27], v[8:11], v[132:147]
    v_exp_f32 v56, v56
    v_exp_f32 v57, v57
    v_exp_f32 v58, v58
    v_mfma_f32_32x32x16_bf16 v[88:103], v[36:39], v[76:79], v[88:103]
    v_exp_f32 v59, v59
    v_exp_f32 v60, v60
    v_exp_f32 v61, v61
    v_mfma_f32_32x32x16_bf16 v[40:55], v[28:31], v[12:15], v[40:55]
    v_exp_f32 v62, v62
    v_exp_f32 v63, v63
    v_exp_f32 v64, v64
    v_smfmac_f32_16x16x64_bf16 v[120:123], v[128:131], v[72:79], v222
    v_cvt_pk_bf16_f32 v80, v56, v57
    v_cvt_pk_bf16_f32 v81, v58, v59
    v_exp_f32 v65, v65
    v_cvt_pk_bf16_f32 v82, v60, v61
    v_cvt_pk_bf16_f32 v83, v62, v63
    v_exp_f32 v66, v66
    v_exp_f32 v67, v67
    v_mfma_f32_32x32x16_bf16 v[104:119], v[32:35], v[80:83], v[104:119]
    ds_read_b128 v[32:35], v2 offset:18432
    v_exp_f32 v68, v68
    v_exp_f32 v69, v69
    v_exp_f32 v70, v70
    v_exp_f32 v71, v71
    v_cvt_pk_bf16_f32 v84, v64, v65
    v_cvt_pk_bf16_f32 v85, v66, v67
    v_cvt_pk_bf16_f32 v86, v68, v69
    v_cvt_pk_bf16_f32 v87, v70, v71
    v_mfma_f32_32x32x16_bf16 v[56:71], v[24:27], v[16:19], v[148:163]
    v_exp_f32 v40, v40
    v_exp_f32 v41, v41
    v_exp_f32 v42, v42
    v_mfma_f32_32x32x16_bf16 v[104:119], v[36:39], v[84:87], v[104:119]
    ds_read_b128 v[36:39], v2 offset:19456
    v_exp_f32 v43, v43
    v_exp_f32 v44, v44
    v_exp_f32 v45, v45
    v_mfma_f32_32x32x16_bf16 v[56:71], v[28:31], v[20:23], v[56:71]
    ds_read_b128 v[24:27], v2 offset:20480
    ds_read_b128 v[28:31], v2 offset:21504
    v_exp_f32 v46, v46
    v_exp_f32 v47, v47
    v_exp_f32 v48, v48
    v_smfmac_f32_16x16x64_bf16 v[124:127], v[128:131], v[80:87], v222
    v_cvt_pk_bf16_f32 v72, v40, v41
    v_cvt_pk_bf16_f32 v73, v42, v43
    v_exp_f32 v49, v49
    v_cvt_pk_bf16_f32 v74, v44, v45
    v_cvt_pk_bf16_f32 v75, v46, v47
    v_exp_f32 v50, v50
    v_exp_f32 v51, v51
    s_waitcnt lgkmcnt(3)
    v_mfma_f32_32x32x16_bf16 v[88:103], v[32:35], v[72:75], v[88:103]
    v_exp_f32 v52, v52
    v_exp_f32 v53, v53
    v_exp_f32 v54, v54
    v_exp_f32 v55, v55
    v_cvt_pk_bf16_f32 v76, v48, v49
    v_cvt_pk_bf16_f32 v77, v50, v51
    v_cvt_pk_bf16_f32 v78, v52, v53
    v_cvt_pk_bf16_f32 v79, v54, v55
    s_cmp_lg_u32 s86, 1
    s_cbranch_scc1 gated_mix__grouped_kv_mqa__dense_activation_mish__prompt_kernel_pf2_4
    buffer_load_dword v216, v215, s[16:19], s29 offen
    s_cmp_lg_u32 s33, 1
    s_cbranch_scc1 gated_mix__grouped_kv_mqa__dense_activation_mish__prompt_kernel_pf2_4
    buffer_load_dword v217, v215, s[40:43], s32 offen
gated_mix__grouped_kv_mqa__dense_activation_mish__prompt_kernel_pf2_4:
    s_add_u32 s29, s29, 524288
    s_cmp_lg_u32 s33, 1
    s_cbranch_scc1 gated_mix__grouped_kv_mqa__dense_activation_mish__prompt_kernel_pf2_4_n
    s_add_u32 s32, s32, 524288
gated_mix__grouped_kv_mqa__dense_activation_mish__prompt_kernel_pf2_4_n:
    s_waitcnt lgkmcnt(0)
    v_mfma_f32_32x32x16_bf16 v[40:55], v[24:27], v[8:11], v[132:147]
    v_exp_f32 v56, v56
    v_exp_f32 v57, v57
    v_exp_f32 v58, v58
    v_mfma_f32_32x32x16_bf16 v[88:103], v[36:39], v[76:79], v[88:103]
    v_exp_f32 v59, v59
    v_exp_f32 v60, v60
    v_exp_f32 v61, v61
    v_mfma_f32_32x32x16_bf16 v[40:55], v[28:31], v[12:15], v[40:55]
    v_exp_f32 v62, v62
    v_exp_f32 v63, v63
    v_exp_f32 v64, v64
    v_smfmac_f32_16x16x64_bf16 v[120:123], v[128:131], v[72:79], v222
    v_cvt_pk_bf16_f32 v80, v56, v57
    v_cvt_pk_bf16_f32 v81, v58, v59
    v_exp_f32 v65, v65
    v_cvt_pk_bf16_f32 v82, v60, v61
    v_cvt_pk_bf16_f32 v83, v62, v63
    v_exp_f32 v66, v66
    v_exp_f32 v67, v67
    v_mfma_f32_32x32x16_bf16 v[104:119], v[32:35], v[80:83], v[104:119]
    ds_read_b128 v[32:35], v2 offset:22528
    v_exp_f32 v68, v68
    v_exp_f32 v69, v69
    v_exp_f32 v70, v70
    v_exp_f32 v71, v71
    v_cvt_pk_bf16_f32 v84, v64, v65
    v_cvt_pk_bf16_f32 v85, v66, v67
    v_cvt_pk_bf16_f32 v86, v68, v69
    v_cvt_pk_bf16_f32 v87, v70, v71
    v_mfma_f32_32x32x16_bf16 v[56:71], v[24:27], v[16:19], v[148:163]
    v_exp_f32 v40, v40
    v_exp_f32 v41, v41
    v_exp_f32 v42, v42
    v_mfma_f32_32x32x16_bf16 v[104:119], v[36:39], v[84:87], v[104:119]
    ds_read_b128 v[36:39], v2 offset:23552
    v_exp_f32 v43, v43
    v_exp_f32 v44, v44
    v_exp_f32 v45, v45
    v_mfma_f32_32x32x16_bf16 v[56:71], v[28:31], v[20:23], v[56:71]
    ds_read_b128 v[24:27], v2 offset:24576
    ds_read_b128 v[28:31], v2 offset:25600
    v_exp_f32 v46, v46
    v_exp_f32 v47, v47
    v_exp_f32 v48, v48
    v_smfmac_f32_16x16x64_bf16 v[124:127], v[128:131], v[80:87], v222
    v_cvt_pk_bf16_f32 v72, v40, v41
    v_cvt_pk_bf16_f32 v73, v42, v43
    v_exp_f32 v49, v49
    v_cvt_pk_bf16_f32 v74, v44, v45
    v_cvt_pk_bf16_f32 v75, v46, v47
    v_exp_f32 v50, v50
    v_exp_f32 v51, v51
    s_waitcnt lgkmcnt(3)
    v_mfma_f32_32x32x16_bf16 v[88:103], v[32:35], v[72:75], v[88:103]
    v_exp_f32 v52, v52
    v_exp_f32 v53, v53
    v_exp_f32 v54, v54
    v_exp_f32 v55, v55
    v_cvt_pk_bf16_f32 v76, v48, v49
    v_cvt_pk_bf16_f32 v77, v50, v51
    v_cvt_pk_bf16_f32 v78, v52, v53
    v_cvt_pk_bf16_f32 v79, v54, v55
    s_waitcnt lgkmcnt(0)
    v_mfma_f32_32x32x16_bf16 v[40:55], v[24:27], v[8:11], v[132:147]
    v_exp_f32 v56, v56
    v_exp_f32 v57, v57
    v_exp_f32 v58, v58
    v_mfma_f32_32x32x16_bf16 v[88:103], v[36:39], v[76:79], v[88:103]
    v_exp_f32 v59, v59
    v_exp_f32 v60, v60
    v_exp_f32 v61, v61
    v_mfma_f32_32x32x16_bf16 v[40:55], v[28:31], v[12:15], v[40:55]
    v_exp_f32 v62, v62
    v_exp_f32 v63, v63
    v_exp_f32 v64, v64
    v_smfmac_f32_16x16x64_bf16 v[120:123], v[128:131], v[72:79], v222
    v_cvt_pk_bf16_f32 v80, v56, v57
    v_cvt_pk_bf16_f32 v81, v58, v59
    v_exp_f32 v65, v65
    v_cvt_pk_bf16_f32 v82, v60, v61
    v_cvt_pk_bf16_f32 v83, v62, v63
    v_exp_f32 v66, v66
    v_exp_f32 v67, v67
    v_mfma_f32_32x32x16_bf16 v[104:119], v[32:35], v[80:83], v[104:119]
    ds_read_b128 v[32:35], v2 offset:26624
    v_exp_f32 v68, v68
    v_exp_f32 v69, v69
    v_exp_f32 v70, v70
    v_exp_f32 v71, v71
    v_cvt_pk_bf16_f32 v84, v64, v65
    v_cvt_pk_bf16_f32 v85, v66, v67
    v_cvt_pk_bf16_f32 v86, v68, v69
    v_cvt_pk_bf16_f32 v87, v70, v71
    v_mfma_f32_32x32x16_bf16 v[56:71], v[24:27], v[16:19], v[148:163]
    v_exp_f32 v40, v40
    v_exp_f32 v41, v41
    v_exp_f32 v42, v42
    v_mfma_f32_32x32x16_bf16 v[104:119], v[36:39], v[84:87], v[104:119]
    ds_read_b128 v[36:39], v2 offset:27648
    v_exp_f32 v43, v43
    v_exp_f32 v44, v44
    v_exp_f32 v45, v45
    v_mfma_f32_32x32x16_bf16 v[56:71], v[28:31], v[20:23], v[56:71]
    ds_read_b128 v[24:27], v2 offset:28672
    ds_read_b128 v[28:31], v2 offset:29696
    v_exp_f32 v46, v46
    v_exp_f32 v47, v47
    v_exp_f32 v48, v48
    v_smfmac_f32_16x16x64_bf16 v[124:127], v[128:131], v[80:87], v222
    v_cvt_pk_bf16_f32 v72, v40, v41
    v_cvt_pk_bf16_f32 v73, v42, v43
    v_exp_f32 v49, v49
    v_cvt_pk_bf16_f32 v74, v44, v45
    v_cvt_pk_bf16_f32 v75, v46, v47
    v_exp_f32 v50, v50
    v_exp_f32 v51, v51
    s_waitcnt lgkmcnt(3)
    v_mfma_f32_32x32x16_bf16 v[88:103], v[32:35], v[72:75], v[88:103]
    v_exp_f32 v52, v52
    v_exp_f32 v53, v53
    v_exp_f32 v54, v54
    v_exp_f32 v55, v55
    v_cvt_pk_bf16_f32 v76, v48, v49
    v_cvt_pk_bf16_f32 v77, v50, v51
    v_cvt_pk_bf16_f32 v78, v52, v53
    v_cvt_pk_bf16_f32 v79, v54, v55
    s_waitcnt lgkmcnt(0)
    v_mfma_f32_32x32x16_bf16 v[40:55], v[24:27], v[8:11], v[132:147]
    v_exp_f32 v56, v56
    v_exp_f32 v57, v57
    v_exp_f32 v58, v58
    v_mfma_f32_32x32x16_bf16 v[88:103], v[36:39], v[76:79], v[88:103]
    v_exp_f32 v59, v59
    v_exp_f32 v60, v60
    v_exp_f32 v61, v61
    v_mfma_f32_32x32x16_bf16 v[40:55], v[28:31], v[12:15], v[40:55]
    v_exp_f32 v62, v62
    v_exp_f32 v63, v63
    v_exp_f32 v64, v64
    v_smfmac_f32_16x16x64_bf16 v[120:123], v[128:131], v[72:79], v222
    v_cvt_pk_bf16_f32 v80, v56, v57
    v_cvt_pk_bf16_f32 v81, v58, v59
    v_exp_f32 v65, v65
    v_cvt_pk_bf16_f32 v82, v60, v61
    v_cvt_pk_bf16_f32 v83, v62, v63
    v_exp_f32 v66, v66
    v_exp_f32 v67, v67
    v_mfma_f32_32x32x16_bf16 v[104:119], v[32:35], v[80:83], v[104:119]
    ds_read_b128 v[32:35], v2 offset:30720
    v_exp_f32 v68, v68
    v_exp_f32 v69, v69
    v_exp_f32 v70, v70
    v_exp_f32 v71, v71
    v_cvt_pk_bf16_f32 v84, v64, v65
    v_cvt_pk_bf16_f32 v85, v66, v67
    v_cvt_pk_bf16_f32 v86, v68, v69
    v_cvt_pk_bf16_f32 v87, v70, v71
    s_waitcnt vmcnt(4)
    s_barrier
    v_mfma_f32_32x32x16_bf16 v[56:71], v[24:27], v[16:19], v[148:163]
    v_exp_f32 v40, v40
    v_exp_f32 v41, v41
    s_add_u32 m0, s30, 0
    s_add_u32 s31, s31, 16384
    buffer_load_dwordx4 v2, s[8:11], s31 offen sc1 lds
    v_exp_f32 v42, v42
    v_mfma_f32_32x32x16_bf16 v[104:119], v[36:39], v[84:87], v[104:119]
    ds_read_b128 v[36:39], v2 offset:31744
    v_exp_f32 v43, v43
    v_exp_f32 v44, v44
    buffer_load_dwordx4 v2, s[8:11], s31 offen offset:1024 sc1 lds
    v_exp_f32 v45, v45
    v_mfma_f32_32x32x16_bf16 v[56:71], v[28:31], v[20:23], v[56:71]
    ds_read_b128 v[24:27], v2 offset:32768
    ds_read_b128 v[28:31], v2 offset:33792
    v_exp_f32 v46, v46
    v_exp_f32 v47, v47
    buffer_load_dwordx4 v2, s[8:11], s31 offen offset:2048 sc1 lds
    v_exp_f32 v48, v48
    v_smfmac_f32_16x16x64_bf16 v[124:127], v[128:131], v[80:87], v222
    v_cvt_pk_bf16_f32 v72, v40, v41
    v_cvt_pk_bf16_f32 v73, v42, v43
    v_exp_f32 v49, v49
    v_cvt_pk_bf16_f32 v74, v44, v45
    v_cvt_pk_bf16_f32 v75, v46, v47
    v_exp_f32 v50, v50
    buffer_load_dwordx4 v2, s[8:11], s31 offen offset:3072 sc1 lds
    v_exp_f32 v51, v51
    s_waitcnt lgkmcnt(3)
    v_mfma_f32_32x32x16_bf16 v[88:103], v[32:35], v[72:75], v[88:103]
    v_exp_f32 v52, v52
    v_exp_f32 v53, v53
    v_exp_f32 v54, v54
    v_exp_f32 v55, v55
    v_cvt_pk_bf16_f32 v76, v48, v49
    v_cvt_pk_bf16_f32 v77, v50, v51
    v_cvt_pk_bf16_f32 v78, v52, v53
    v_cvt_pk_bf16_f32 v79, v54, v55
    s_waitcnt lgkmcnt(0)
    v_mfma_f32_32x32x16_bf16 v[40:55], v[24:27], v[8:11], v[132:147]
    v_exp_f32 v56, v56
    v_exp_f32 v57, v57
    v_exp_f32 v58, v58
    v_mfma_f32_32x32x16_bf16 v[88:103], v[36:39], v[76:79], v[88:103]
    v_exp_f32 v59, v59
    v_exp_f32 v60, v60
    v_exp_f32 v61, v61
    v_mfma_f32_32x32x16_bf16 v[40:55], v[28:31], v[12:15], v[40:55]
    v_exp_f32 v62, v62
    v_exp_f32 v63, v63
    v_exp_f32 v64, v64
    v_smfmac_f32_16x16x64_bf16 v[120:123], v[128:131], v[72:79], v222
    v_cvt_pk_bf16_f32 v80, v56, v57
    v_cvt_pk_bf16_f32 v81, v58, v59
    v_exp_f32 v65, v65
    v_cvt_pk_bf16_f32 v82, v60, v61
    v_cvt_pk_bf16_f32 v83, v62, v63
    v_exp_f32 v66, v66
    v_exp_f32 v67, v67
    v_mfma_f32_32x32x16_bf16 v[104:119], v[32:35], v[80:83], v[104:119]
    ds_read_b128 v[32:35], v2 offset:34816
    v_exp_f32 v68, v68
    v_exp_f32 v69, v69
    v_exp_f32 v70, v70
    v_exp_f32 v71, v71
    v_cvt_pk_bf16_f32 v84, v64, v65
    v_cvt_pk_bf16_f32 v85, v66, v67
    v_cvt_pk_bf16_f32 v86, v68, v69
    v_cvt_pk_bf16_f32 v87, v70, v71
    v_mfma_f32_32x32x16_bf16 v[56:71], v[24:27], v[16:19], v[148:163]
    v_exp_f32 v40, v40
    v_exp_f32 v41, v41
    v_exp_f32 v42, v42
    v_mfma_f32_32x32x16_bf16 v[104:119], v[36:39], v[84:87], v[104:119]
    ds_read_b128 v[36:39], v2 offset:35840
    v_exp_f32 v43, v43
    v_exp_f32 v44, v44
    v_exp_f32 v45, v45
    v_mfma_f32_32x32x16_bf16 v[56:71], v[28:31], v[20:23], v[56:71]
    ds_read_b128 v[24:27], v2 offset:36864
    ds_read_b128 v[28:31], v2 offset:37888
    v_exp_f32 v46, v46
    v_exp_f32 v47, v47
    v_exp_f32 v48, v48
    v_smfmac_f32_16x16x64_bf16 v[124:127], v[128:131], v[80:87], v222
    v_cvt_pk_bf16_f32 v72, v40, v41
    v_cvt_pk_bf16_f32 v73, v42, v43
    v_exp_f32 v49, v49
    v_cvt_pk_bf16_f32 v74, v44, v45
    v_cvt_pk_bf16_f32 v75, v46, v47
    v_exp_f32 v50, v50
    v_exp_f32 v51, v51
    s_waitcnt lgkmcnt(3)
    v_mfma_f32_32x32x16_bf16 v[88:103], v[32:35], v[72:75], v[88:103]
    v_exp_f32 v52, v52
    v_exp_f32 v53, v53
    v_exp_f32 v54, v54
    v_exp_f32 v55, v55
    v_cvt_pk_bf16_f32 v76, v48, v49
    v_cvt_pk_bf16_f32 v77, v50, v51
    v_cvt_pk_bf16_f32 v78, v52, v53
    v_cvt_pk_bf16_f32 v79, v54, v55
    s_cmp_lg_u32 s86, 2
    s_cbranch_scc1 gated_mix__grouped_kv_mqa__dense_activation_mish__prompt_kernel_pf2_8
    buffer_load_dword v216, v215, s[16:19], s29 offen
    s_cmp_lg_u32 s33, 1
    s_cbranch_scc1 gated_mix__grouped_kv_mqa__dense_activation_mish__prompt_kernel_pf2_8
    buffer_load_dword v217, v215, s[40:43], s32 offen
gated_mix__grouped_kv_mqa__dense_activation_mish__prompt_kernel_pf2_8:
    s_add_u32 s29, s29, 524288
    s_cmp_lg_u32 s33, 1
    s_cbranch_scc1 gated_mix__grouped_kv_mqa__dense_activation_mish__prompt_kernel_pf2_8_n
    s_add_u32 s32, s32, 524288
gated_mix__grouped_kv_mqa__dense_activation_mish__prompt_kernel_pf2_8_n:
    s_waitcnt lgkmcnt(0)
    v_mfma_f32_32x32x16_bf16 v[40:55], v[24:27], v[8:11], v[132:147]
    v_exp_f32 v56, v56
    v_exp_f32 v57, v57
    v_exp_f32 v58, v58
    v_mfma_f32_32x32x16_bf16 v[88:103], v[36:39], v[76:79], v[88:103]
    v_exp_f32 v59, v59
    v_exp_f32 v60, v60
    v_exp_f32 v61, v61
    v_mfma_f32_32x32x16_bf16 v[40:55], v[28:31], v[12:15], v[40:55]
    v_exp_f32 v62, v62
    v_exp_f32 v63, v63
    v_exp_f32 v64, v64
    v_smfmac_f32_16x16x64_bf16 v[120:123], v[128:131], v[72:79], v222
    v_cvt_pk_bf16_f32 v80, v56, v57
    v_cvt_pk_bf16_f32 v81, v58, v59
    v_exp_f32 v65, v65
    v_cvt_pk_bf16_f32 v82, v60, v61
    v_cvt_pk_bf16_f32 v83, v62, v63
    v_exp_f32 v66, v66
    v_exp_f32 v67, v67
    v_mfma_f32_32x32x16_bf16 v[104:119], v[32:35], v[80:83], v[104:119]
    ds_read_b128 v[32:35], v2 offset:38912
    v_exp_f32 v68, v68
    v_exp_f32 v69, v69
    v_exp_f32 v70, v70
    v_exp_f32 v71, v71
    v_cvt_pk_bf16_f32 v84, v64, v65
    v_cvt_pk_bf16_f32 v85, v66, v67
    v_cvt_pk_bf16_f32 v86, v68, v69
    v_cvt_pk_bf16_f32 v87, v70, v71
    v_mfma_f32_32x32x16_bf16 v[56:71], v[24:27], v[16:19], v[148:163]
    v_exp_f32 v40, v40
    v_exp_f32 v41, v41
    v_exp_f32 v42, v42
    v_mfma_f32_32x32x16_bf16 v[104:119], v[36:39], v[84:87], v[104:119]
    ds_read_b128 v[36:39], v2 offset:39936
    v_exp_f32 v43, v43
    v_exp_f32 v44, v44
    v_exp_f32 v45, v45
    v_mfma_f32_32x32x16_bf16 v[56:71], v[28:31], v[20:23], v[56:71]
    ds_read_b128 v[24:27], v2 offset:40960
    ds_read_b128 v[28:31], v2 offset:41984
    v_exp_f32 v46, v46
    v_exp_f32 v47, v47
    v_exp_f32 v48, v48
    v_smfmac_f32_16x16x64_bf16 v[124:127], v[128:131], v[80:87], v222
    v_cvt_pk_bf16_f32 v72, v40, v41
    v_cvt_pk_bf16_f32 v73, v42, v43
    v_exp_f32 v49, v49
    v_cvt_pk_bf16_f32 v74, v44, v45
    v_cvt_pk_bf16_f32 v75, v46, v47
    v_exp_f32 v50, v50
    v_exp_f32 v51, v51
    s_waitcnt lgkmcnt(3)
    v_mfma_f32_32x32x16_bf16 v[88:103], v[32:35], v[72:75], v[88:103]
    v_exp_f32 v52, v52
    v_exp_f32 v53, v53
    v_exp_f32 v54, v54
    v_exp_f32 v55, v55
    v_cvt_pk_bf16_f32 v76, v48, v49
    v_cvt_pk_bf16_f32 v77, v50, v51
    v_cvt_pk_bf16_f32 v78, v52, v53
    v_cvt_pk_bf16_f32 v79, v54, v55
    s_waitcnt lgkmcnt(0)
    v_mfma_f32_32x32x16_bf16 v[40:55], v[24:27], v[8:11], v[132:147]
    v_exp_f32 v56, v56
    v_exp_f32 v57, v57
    v_exp_f32 v58, v58
    v_mfma_f32_32x32x16_bf16 v[88:103], v[36:39], v[76:79], v[88:103]
    v_exp_f32 v59, v59
    v_exp_f32 v60, v60
    v_exp_f32 v61, v61
    v_mfma_f32_32x32x16_bf16 v[40:55], v[28:31], v[12:15], v[40:55]
    v_exp_f32 v62, v62
    v_exp_f32 v63, v63
    v_exp_f32 v64, v64
    v_smfmac_f32_16x16x64_bf16 v[120:123], v[128:131], v[72:79], v222
    v_cvt_pk_bf16_f32 v80, v56, v57
    v_cvt_pk_bf16_f32 v81, v58, v59
    v_exp_f32 v65, v65
    v_cvt_pk_bf16_f32 v82, v60, v61
    v_cvt_pk_bf16_f32 v83, v62, v63
    v_exp_f32 v66, v66
    v_exp_f32 v67, v67
    v_mfma_f32_32x32x16_bf16 v[104:119], v[32:35], v[80:83], v[104:119]
    ds_read_b128 v[32:35], v2 offset:43008
    v_exp_f32 v68, v68
    v_exp_f32 v69, v69
    v_exp_f32 v70, v70
    v_exp_f32 v71, v71
    v_cvt_pk_bf16_f32 v84, v64, v65
    v_cvt_pk_bf16_f32 v85, v66, v67
    v_cvt_pk_bf16_f32 v86, v68, v69
    v_cvt_pk_bf16_f32 v87, v70, v71
    v_mfma_f32_32x32x16_bf16 v[56:71], v[24:27], v[16:19], v[148:163]
    v_exp_f32 v40, v40
    v_exp_f32 v41, v41
    v_exp_f32 v42, v42
    v_mfma_f32_32x32x16_bf16 v[104:119], v[36:39], v[84:87], v[104:119]
    ds_read_b128 v[36:39], v2 offset:44032
    v_exp_f32 v43, v43
    v_exp_f32 v44, v44
    v_exp_f32 v45, v45
    v_mfma_f32_32x32x16_bf16 v[56:71], v[28:31], v[20:23], v[56:71]
    ds_read_b128 v[24:27], v2 offset:45056
    ds_read_b128 v[28:31], v2 offset:46080
    v_exp_f32 v46, v46
    v_exp_f32 v47, v47
    v_exp_f32 v48, v48
    v_smfmac_f32_16x16x64_bf16 v[124:127], v[128:131], v[80:87], v222
    v_cvt_pk_bf16_f32 v72, v40, v41
    v_cvt_pk_bf16_f32 v73, v42, v43
    v_exp_f32 v49, v49
    v_cvt_pk_bf16_f32 v74, v44, v45
    v_cvt_pk_bf16_f32 v75, v46, v47
    v_exp_f32 v50, v50
    v_exp_f32 v51, v51
    s_waitcnt lgkmcnt(3)
    v_mfma_f32_32x32x16_bf16 v[88:103], v[32:35], v[72:75], v[88:103]
    v_exp_f32 v52, v52
    v_exp_f32 v53, v53
    v_exp_f32 v54, v54
    v_exp_f32 v55, v55
    v_cvt_pk_bf16_f32 v76, v48, v49
    v_cvt_pk_bf16_f32 v77, v50, v51
    v_cvt_pk_bf16_f32 v78, v52, v53
    v_cvt_pk_bf16_f32 v79, v54, v55
    s_waitcnt lgkmcnt(0)
    v_mfma_f32_32x32x16_bf16 v[40:55], v[24:27], v[8:11], v[132:147]
    v_exp_f32 v56, v56
    v_exp_f32 v57, v57
    v_exp_f32 v58, v58
    v_mfma_f32_32x32x16_bf16 v[88:103], v[36:39], v[76:79], v[88:103]
    v_exp_f32 v59, v59
    v_exp_f32 v60, v60
    v_exp_f32 v61, v61
    v_mfma_f32_32x32x16_bf16 v[40:55], v[28:31], v[12:15], v[40:55]
    v_exp_f32 v62, v62
    v_exp_f32 v63, v63
    v_exp_f32 v64, v64
    v_smfmac_f32_16x16x64_bf16 v[120:123], v[128:131], v[72:79], v222
    v_cvt_pk_bf16_f32 v80, v56, v57
    v_cvt_pk_bf16_f32 v81, v58, v59
    v_exp_f32 v65, v65
    v_cvt_pk_bf16_f32 v82, v60, v61
    v_cvt_pk_bf16_f32 v83, v62, v63
    v_exp_f32 v66, v66
    v_exp_f32 v67, v67
    v_mfma_f32_32x32x16_bf16 v[104:119], v[32:35], v[80:83], v[104:119]
    ds_read_b128 v[32:35], v2 offset:47104
    v_exp_f32 v68, v68
    v_exp_f32 v69, v69
    v_exp_f32 v70, v70
    v_exp_f32 v71, v71
    v_cvt_pk_bf16_f32 v84, v64, v65
    v_cvt_pk_bf16_f32 v85, v66, v67
    v_cvt_pk_bf16_f32 v86, v68, v69
    v_cvt_pk_bf16_f32 v87, v70, v71
    s_waitcnt vmcnt(4)
    s_barrier
    v_mfma_f32_32x32x16_bf16 v[56:71], v[24:27], v[16:19], v[148:163]
    v_exp_f32 v40, v40
    v_exp_f32 v41, v41
    s_add_u32 m0, s30, 16384
    s_add_u32 s31, s31, 16384
    buffer_load_dwordx4 v2, s[8:11], s31 offen sc1 lds
    v_exp_f32 v42, v42
    v_mfma_f32_32x32x16_bf16 v[104:119], v[36:39], v[84:87], v[104:119]
    ds_read_b128 v[36:39], v2 offset:48128
    v_exp_f32 v43, v43
    v_exp_f32 v44, v44
    buffer_load_dwordx4 v2, s[8:11], s31 offen offset:1024 sc1 lds
    v_exp_f32 v45, v45
    v_mfma_f32_32x32x16_bf16 v[56:71], v[28:31], v[20:23], v[56:71]
    ds_read_b128 v[24:27], v2 offset:49152
    ds_read_b128 v[28:31], v2 offset:50176
    v_exp_f32 v46, v46
    v_exp_f32 v47, v47
    buffer_load_dwordx4 v2, s[8:11], s31 offen offset:2048 sc1 lds
    v_exp_f32 v48, v48
    v_smfmac_f32_16x16x64_bf16 v[124:127], v[128:131], v[80:87], v222
    v_cvt_pk_bf16_f32 v72, v40, v41
    v_cvt_pk_bf16_f32 v73, v42, v43
    v_exp_f32 v49, v49
    v_cvt_pk_bf16_f32 v74, v44, v45
    v_cvt_pk_bf16_f32 v75, v46, v47
    v_exp_f32 v50, v50
    buffer_load_dwordx4 v2, s[8:11], s31 offen offset:3072 sc1 lds
    v_exp_f32 v51, v51
    s_waitcnt lgkmcnt(3)
    v_mfma_f32_32x32x16_bf16 v[88:103], v[32:35], v[72:75], v[88:103]
    v_exp_f32 v52, v52
    v_exp_f32 v53, v53
    v_exp_f32 v54, v54
    v_exp_f32 v55, v55
    v_cvt_pk_bf16_f32 v76, v48, v49
    v_cvt_pk_bf16_f32 v77, v50, v51
    v_cvt_pk_bf16_f32 v78, v52, v53
    v_cvt_pk_bf16_f32 v79, v54, v55
    s_waitcnt lgkmcnt(0)
    v_mfma_f32_32x32x16_bf16 v[40:55], v[24:27], v[8:11], v[132:147]
    v_exp_f32 v56, v56
    v_exp_f32 v57, v57
    v_exp_f32 v58, v58
    v_mfma_f32_32x32x16_bf16 v[88:103], v[36:39], v[76:79], v[88:103]
    v_exp_f32 v59, v59
    v_exp_f32 v60, v60
    v_exp_f32 v61, v61
    v_mfma_f32_32x32x16_bf16 v[40:55], v[28:31], v[12:15], v[40:55]
    v_exp_f32 v62, v62
    v_exp_f32 v63, v63
    v_exp_f32 v64, v64
    v_smfmac_f32_16x16x64_bf16 v[120:123], v[128:131], v[72:79], v222
    v_cvt_pk_bf16_f32 v80, v56, v57
    v_cvt_pk_bf16_f32 v81, v58, v59
    v_exp_f32 v65, v65
    v_cvt_pk_bf16_f32 v82, v60, v61
    v_cvt_pk_bf16_f32 v83, v62, v63
    v_exp_f32 v66, v66
    v_exp_f32 v67, v67
    v_mfma_f32_32x32x16_bf16 v[104:119], v[32:35], v[80:83], v[104:119]
    ds_read_b128 v[32:35], v2 offset:51200
    v_exp_f32 v68, v68
    v_exp_f32 v69, v69
    v_exp_f32 v70, v70
    v_exp_f32 v71, v71
    v_cvt_pk_bf16_f32 v84, v64, v65
    v_cvt_pk_bf16_f32 v85, v66, v67
    v_cvt_pk_bf16_f32 v86, v68, v69
    v_cvt_pk_bf16_f32 v87, v70, v71
    v_mfma_f32_32x32x16_bf16 v[56:71], v[24:27], v[16:19], v[148:163]
    v_exp_f32 v40, v40
    v_exp_f32 v41, v41
    v_exp_f32 v42, v42
    v_mfma_f32_32x32x16_bf16 v[104:119], v[36:39], v[84:87], v[104:119]
    ds_read_b128 v[36:39], v2 offset:52224
    v_exp_f32 v43, v43
    v_exp_f32 v44, v44
    v_exp_f32 v45, v45
    v_mfma_f32_32x32x16_bf16 v[56:71], v[28:31], v[20:23], v[56:71]
    ds_read_b128 v[24:27], v2 offset:53248
    ds_read_b128 v[28:31], v2 offset:54272
    v_exp_f32 v46, v46
    v_exp_f32 v47, v47
    v_exp_f32 v48, v48
    v_smfmac_f32_16x16x64_bf16 v[124:127], v[128:131], v[80:87], v222
    v_cvt_pk_bf16_f32 v72, v40, v41
    v_cvt_pk_bf16_f32 v73, v42, v43
    v_exp_f32 v49, v49
    v_cvt_pk_bf16_f32 v74, v44, v45
    v_cvt_pk_bf16_f32 v75, v46, v47
    v_exp_f32 v50, v50
    v_exp_f32 v51, v51
    s_waitcnt lgkmcnt(3)
    v_mfma_f32_32x32x16_bf16 v[88:103], v[32:35], v[72:75], v[88:103]
    v_exp_f32 v52, v52
    v_exp_f32 v53, v53
    v_exp_f32 v54, v54
    v_exp_f32 v55, v55
    v_cvt_pk_bf16_f32 v76, v48, v49
    v_cvt_pk_bf16_f32 v77, v50, v51
    v_cvt_pk_bf16_f32 v78, v52, v53
    v_cvt_pk_bf16_f32 v79, v54, v55
    s_cmp_lg_u32 s86, 3
    s_cbranch_scc1 gated_mix__grouped_kv_mqa__dense_activation_mish__prompt_kernel_pf2_12
    buffer_load_dword v216, v215, s[16:19], s29 offen
    s_cmp_lg_u32 s33, 1
    s_cbranch_scc1 gated_mix__grouped_kv_mqa__dense_activation_mish__prompt_kernel_pf2_12
    buffer_load_dword v217, v215, s[40:43], s32 offen
gated_mix__grouped_kv_mqa__dense_activation_mish__prompt_kernel_pf2_12:
    s_add_u32 s29, s29, 524288
    s_cmp_lg_u32 s33, 1
    s_cbranch_scc1 gated_mix__grouped_kv_mqa__dense_activation_mish__prompt_kernel_pf2_12_n
    s_add_u32 s32, s32, 524288
gated_mix__grouped_kv_mqa__dense_activation_mish__prompt_kernel_pf2_12_n:
    s_waitcnt lgkmcnt(0)
    v_mfma_f32_32x32x16_bf16 v[40:55], v[24:27], v[8:11], v[132:147]
    v_exp_f32 v56, v56
    v_exp_f32 v57, v57
    v_exp_f32 v58, v58
    v_mfma_f32_32x32x16_bf16 v[88:103], v[36:39], v[76:79], v[88:103]
    v_exp_f32 v59, v59
    v_exp_f32 v60, v60
    v_exp_f32 v61, v61
    v_mfma_f32_32x32x16_bf16 v[40:55], v[28:31], v[12:15], v[40:55]
    v_exp_f32 v62, v62
    v_exp_f32 v63, v63
    v_exp_f32 v64, v64
    v_smfmac_f32_16x16x64_bf16 v[120:123], v[128:131], v[72:79], v222
    v_cvt_pk_bf16_f32 v80, v56, v57
    v_cvt_pk_bf16_f32 v81, v58, v59
    v_exp_f32 v65, v65
    v_cvt_pk_bf16_f32 v82, v60, v61
    v_cvt_pk_bf16_f32 v83, v62, v63
    v_exp_f32 v66, v66
    v_exp_f32 v67, v67
    v_mfma_f32_32x32x16_bf16 v[104:119], v[32:35], v[80:83], v[104:119]
    ds_read_b128 v[32:35], v2 offset:55296
    v_exp_f32 v68, v68
    v_exp_f32 v69, v69
    v_exp_f32 v70, v70
    v_exp_f32 v71, v71
    v_cvt_pk_bf16_f32 v84, v64, v65
    v_cvt_pk_bf16_f32 v85, v66, v67
    v_cvt_pk_bf16_f32 v86, v68, v69
    v_cvt_pk_bf16_f32 v87, v70, v71
    v_mfma_f32_32x32x16_bf16 v[56:71], v[24:27], v[16:19], v[148:163]
    v_exp_f32 v40, v40
    v_exp_f32 v41, v41
    v_exp_f32 v42, v42
    v_mfma_f32_32x32x16_bf16 v[104:119], v[36:39], v[84:87], v[104:119]
    ds_read_b128 v[36:39], v2 offset:56320
    v_exp_f32 v43, v43
    v_exp_f32 v44, v44
    v_exp_f32 v45, v45
    v_mfma_f32_32x32x16_bf16 v[56:71], v[28:31], v[20:23], v[56:71]
    ds_read_b128 v[24:27], v2 offset:57344
    ds_read_b128 v[28:31], v2 offset:58368
    v_exp_f32 v46, v46
    v_exp_f32 v47, v47
    v_exp_f32 v48, v48
    v_smfmac_f32_16x16x64_bf16 v[124:127], v[128:131], v[80:87], v222
    v_cvt_pk_bf16_f32 v72, v40, v41
    v_cvt_pk_bf16_f32 v73, v42, v43
    v_exp_f32 v49, v49
    v_cvt_pk_bf16_f32 v74, v44, v45
    v_cvt_pk_bf16_f32 v75, v46, v47
    v_exp_f32 v50, v50
    v_exp_f32 v51, v51
    s_waitcnt lgkmcnt(3)
    v_mfma_f32_32x32x16_bf16 v[88:103], v[32:35], v[72:75], v[88:103]
    v_exp_f32 v52, v52
    v_exp_f32 v53, v53
    v_exp_f32 v54, v54
    v_exp_f32 v55, v55
    v_cvt_pk_bf16_f32 v76, v48, v49
    v_cvt_pk_bf16_f32 v77, v50, v51
    v_cvt_pk_bf16_f32 v78, v52, v53
    v_cvt_pk_bf16_f32 v79, v54, v55
    s_waitcnt lgkmcnt(0)
    v_mfma_f32_32x32x16_bf16 v[40:55], v[24:27], v[8:11], v[132:147]
    v_exp_f32 v56, v56
    v_exp_f32 v57, v57
    v_exp_f32 v58, v58
    v_mfma_f32_32x32x16_bf16 v[88:103], v[36:39], v[76:79], v[88:103]
    v_exp_f32 v59, v59
    v_exp_f32 v60, v60
    v_exp_f32 v61, v61
    v_mfma_f32_32x32x16_bf16 v[40:55], v[28:31], v[12:15], v[40:55]
    v_exp_f32 v62, v62
    v_exp_f32 v63, v63
    v_exp_f32 v64, v64
    v_smfmac_f32_16x16x64_bf16 v[120:123], v[128:131], v[72:79], v222
    v_cvt_pk_bf16_f32 v80, v56, v57
    v_cvt_pk_bf16_f32 v81, v58, v59
    v_exp_f32 v65, v65
    v_cvt_pk_bf16_f32 v82, v60, v61
    v_cvt_pk_bf16_f32 v83, v62, v63
    v_exp_f32 v66, v66
    v_exp_f32 v67, v67
    v_mfma_f32_32x32x16_bf16 v[104:119], v[32:35], v[80:83], v[104:119]
    ds_read_b128 v[32:35], v2 offset:59392
    v_exp_f32 v68, v68
    v_exp_f32 v69, v69
    v_exp_f32 v70, v70
    v_exp_f32 v71, v71
    v_cvt_pk_bf16_f32 v84, v64, v65
    v_cvt_pk_bf16_f32 v85, v66, v67
    v_cvt_pk_bf16_f32 v86, v68, v69
    v_cvt_pk_bf16_f32 v87, v70, v71
    v_mfma_f32_32x32x16_bf16 v[56:71], v[24:27], v[16:19], v[148:163]
    v_exp_f32 v40, v40
    v_exp_f32 v41, v41
    v_exp_f32 v42, v42
    v_mfma_f32_32x32x16_bf16 v[104:119], v[36:39], v[84:87], v[104:119]
    ds_read_b128 v[36:39], v2 offset:60416
    v_exp_f32 v43, v43
    v_exp_f32 v44, v44
    v_exp_f32 v45, v45
    v_mfma_f32_32x32x16_bf16 v[56:71], v[28:31], v[20:23], v[56:71]
    ds_read_b128 v[24:27], v2 offset:61440
    ds_read_b128 v[28:31], v2 offset:62464
    v_exp_f32 v46, v46
    v_exp_f32 v47, v47
    v_exp_f32 v48, v48
    v_smfmac_f32_16x16x64_bf16 v[124:127], v[128:131], v[80:87], v222
    v_cvt_pk_bf16_f32 v72, v40, v41
    v_cvt_pk_bf16_f32 v73, v42, v43
    v_exp_f32 v49, v49
    v_cvt_pk_bf16_f32 v74, v44, v45
    v_cvt_pk_bf16_f32 v75, v46, v47
    v_exp_f32 v50, v50
    v_exp_f32 v51, v51
    s_waitcnt lgkmcnt(3)
    v_mfma_f32_32x32x16_bf16 v[88:103], v[32:35], v[72:75], v[88:103]
    v_exp_f32 v52, v52
    v_exp_f32 v53, v53
    v_exp_f32 v54, v54
    v_exp_f32 v55, v55
    v_cvt_pk_bf16_f32 v76, v48, v49
    v_cvt_pk_bf16_f32 v77, v50, v51
    v_cvt_pk_bf16_f32 v78, v52, v53
    v_cvt_pk_bf16_f32 v79, v54, v55
    s_waitcnt lgkmcnt(0)
    v_mfma_f32_32x32x16_bf16 v[40:55], v[24:27], v[8:11], v[132:147]
    v_exp_f32 v56, v56
    v_exp_f32 v57, v57
    v_exp_f32 v58, v58
    v_mfma_f32_32x32x16_bf16 v[88:103], v[36:39], v[76:79], v[88:103]
    v_exp_f32 v59, v59
    v_exp_f32 v60, v60
    v_exp_f32 v61, v61
    v_mfma_f32_32x32x16_bf16 v[40:55], v[28:31], v[12:15], v[40:55]
    v_exp_f32 v62, v62
    v_exp_f32 v63, v63
    v_exp_f32 v64, v64
    v_smfmac_f32_16x16x64_bf16 v[120:123], v[128:131], v[72:79], v222
    v_cvt_pk_bf16_f32 v80, v56, v57
    v_cvt_pk_bf16_f32 v81, v58, v59
    v_exp_f32 v65, v65
    v_cvt_pk_bf16_f32 v82, v60, v61
    v_cvt_pk_bf16_f32 v83, v62, v63
    v_exp_f32 v66, v66
    v_exp_f32 v67, v67
    v_mfma_f32_32x32x16_bf16 v[104:119], v[32:35], v[80:83], v[104:119]
    ds_read_b128 v[32:35], v2 offset:63488
    v_exp_f32 v68, v68
    v_exp_f32 v69, v69
    v_exp_f32 v70, v70
    v_exp_f32 v71, v71
    v_cvt_pk_bf16_f32 v84, v64, v65
    v_cvt_pk_bf16_f32 v85, v66, v67
    v_cvt_pk_bf16_f32 v86, v68, v69
    v_cvt_pk_bf16_f32 v87, v70, v71
    s_waitcnt vmcnt(4)
    s_barrier
    v_mfma_f32_32x32x16_bf16 v[56:71], v[24:27], v[16:19], v[148:163]
    v_exp_f32 v40, v40
    v_exp_f32 v41, v41
    s_add_u32 m0, s30, 32768
    s_add_u32 s31, s31, 16384
    buffer_load_dwordx4 v2, s[8:11], s31 offen sc1 lds
    v_exp_f32 v42, v42
    v_mfma_f32_32x32x16_bf16 v[104:119], v[36:39], v[84:87], v[104:119]
    ds_read_b128 v[36:39], v2 offset:64512
    v_exp_f32 v43, v43
    v_exp_f32 v44, v44
    buffer_load_dwordx4 v2, s[8:11], s31 offen offset:1024 sc1 lds
    v_exp_f32 v45, v45
    v_mfma_f32_32x32x16_bf16 v[56:71], v[28:31], v[20:23], v[56:71]
    ds_read_b128 v[24:27], v2 offset:0
    ds_read_b128 v[28:31], v2 offset:1024
    v_exp_f32 v46, v46
    v_exp_f32 v47, v47
    buffer_load_dwordx4 v2, s[8:11], s31 offen offset:2048 sc1 lds
    v_exp_f32 v48, v48
    v_smfmac_f32_16x16x64_bf16 v[124:127], v[128:131], v[80:87], v222
    v_cvt_pk_bf16_f32 v72, v40, v41
    v_cvt_pk_bf16_f32 v73, v42, v43
    v_exp_f32 v49, v49
    v_cvt_pk_bf16_f32 v74, v44, v45
    v_cvt_pk_bf16_f32 v75, v46, v47
    v_exp_f32 v50, v50
    buffer_load_dwordx4 v2, s[8:11], s31 offen offset:3072 sc1 lds
    v_exp_f32 v51, v51
    s_waitcnt lgkmcnt(3)
    v_mfma_f32_32x32x16_bf16 v[88:103], v[32:35], v[72:75], v[88:103]
    v_exp_f32 v52, v52
    v_exp_f32 v53, v53
    v_exp_f32 v54, v54
    v_exp_f32 v55, v55
    v_cvt_pk_bf16_f32 v76, v48, v49
    v_cvt_pk_bf16_f32 v77, v50, v51
    v_cvt_pk_bf16_f32 v78, v52, v53
    v_cvt_pk_bf16_f32 v79, v54, v55
    s_waitcnt lgkmcnt(0)
    v_mfma_f32_32x32x16_bf16 v[40:55], v[24:27], v[8:11], v[132:147]
    v_exp_f32 v56, v56
    v_exp_f32 v57, v57
    v_exp_f32 v58, v58
    v_mfma_f32_32x32x16_bf16 v[88:103], v[36:39], v[76:79], v[88:103]
    v_exp_f32 v59, v59
    v_exp_f32 v60, v60
    v_exp_f32 v61, v61
    v_mfma_f32_32x32x16_bf16 v[40:55], v[28:31], v[12:15], v[40:55]
    v_exp_f32 v62, v62
    v_exp_f32 v63, v63
    v_exp_f32 v64, v64
    v_smfmac_f32_16x16x64_bf16 v[120:123], v[128:131], v[72:79], v222
    v_cvt_pk_bf16_f32 v80, v56, v57
    v_cvt_pk_bf16_f32 v81, v58, v59
    v_exp_f32 v65, v65
    v_cvt_pk_bf16_f32 v82, v60, v61
    v_cvt_pk_bf16_f32 v83, v62, v63
    v_exp_f32 v66, v66
    v_exp_f32 v67, v67
    v_mfma_f32_32x32x16_bf16 v[104:119], v[32:35], v[80:83], v[104:119]
    ds_read_b128 v[32:35], v2 offset:2048
    v_exp_f32 v68, v68
    v_exp_f32 v69, v69
    v_exp_f32 v70, v70
    v_exp_f32 v71, v71
    v_cvt_pk_bf16_f32 v84, v64, v65
    v_cvt_pk_bf16_f32 v85, v66, v67
    v_cvt_pk_bf16_f32 v86, v68, v69
    v_cvt_pk_bf16_f32 v87, v70, v71
    s_cmp_lg_u32 s33, 4
    s_cbranch_scc1 gated_mix__grouped_kv_mqa__dense_activation_mish__prompt_kernel_nog2
    s_cmp_lg_u32 s39, 0
    s_cbranch_scc1 gated_mix__grouped_kv_mqa__dense_activation_mish__prompt_kernel_nog2
    v_mov_b32 v4, 0
    v_mov_b32 v5, 0
    s_nop 0
    v_dot2c_f32_bf16 v4, v188, v180
    v_dot2c_f32_bf16 v5, v196, v180
    v_dot2c_f32_bf16 v4, v189, v181
    v_dot2c_f32_bf16 v5, v197, v181
    v_dot2c_f32_bf16 v4, v190, v182
    v_dot2c_f32_bf16 v5, v198, v182
    v_dot2c_f32_bf16 v4, v191, v183
    v_dot2c_f32_bf16 v5, v199, v183
    v_dot2c_f32_bf16 v4, v192, v184
    v_dot2c_f32_bf16 v5, v200, v184
    v_dot2c_f32_bf16 v4, v193, v185
    v_dot2c_f32_bf16 v5, v201, v185
    v_dot2c_f32_bf16 v4, v194, v186
    v_dot2c_f32_bf16 v5, v202, v186
    v_dot2c_f32_bf16 v4, v195, v187
    v_dot2c_f32_bf16 v5, v203, v187
    s_nop 2
    v_add_f32_dpp v4, v4, v4 row_shr:1 row_mask:0xf bank_mask:0xf bound_ctrl:0
    v_add_f32_dpp v5, v5, v5 row_shr:1 row_mask:0xf bank_mask:0xf bound_ctrl:0
    s_nop 0
    v_add_f32_dpp v4, v4, v4 row_shr:2 row_mask:0xf bank_mask:0xf bound_ctrl:0
    v_add_f32_dpp v5, v5, v5 row_shr:2 row_mask:0xf bank_mask:0xf bound_ctrl:0
    s_nop 0
    v_add_f32_dpp v4, v4, v4 row_shr:4 row_mask:0xf bank_mask:0xf bound_ctrl:0
    v_add_f32_dpp v5, v5, v5 row_shr:4 row_mask:0xf bank_mask:0xf bound_ctrl:0
    s_nop 0
    v_add_f32_dpp v4, v4, v4 row_shr:8 row_mask:0xf bank_mask:0xf bound_ctrl:0
    v_add_f32_dpp v5, v5, v5 row_shr:8 row_mask:0xf bank_mask:0xf bound_ctrl:0
    s_nop 0
    v_add_f32_dpp v4, v4, v4 row_bcast:15 row_mask:0xa bank_mask:0xf
    v_add_f32_dpp v5, v5, v5 row_bcast:15 row_mask:0xa bank_mask:0xf
    s_nop 0
    v_add_f32_dpp v4, v4, v4 row_bcast:31 row_mask:0xc bank_mask:0xf
    v_add_f32_dpp v5, v5, v5 row_bcast:31 row_mask:0xc bank_mask:0xf
    s_nop 0
    v_mul_f32 v4, 0xbfb8aa3b, v4
    v_mul_f32 v5, 0xbfb8aa3b, v5
    v_exp_f32 v4, v4
    v_exp_f32 v5, v5
    s_nop 0
    v_add_f32 v4, 1.0, v4
    v_add_f32 v5, 1.0, v5
    v_rcp_f32 v4, v4
    v_rcp_f32 v5, v5
    s_add_u32 s92, s84, 0x1900000
    s_addc_u32 s93, s85, 0
    s_mov_b32 s24, s92
    s_mov_b32 s25, s93
    s_mov_b32 s26, 0x8000
    s_mov_b32 s27, 0x00020000
    s_lshl_b32 s91, s87, 4
    s_add_u32 s91, s91, s88
    s_lshl_b32 s91, s91, 7
    s_lshl_b32 s94, s86, 3
    s_add_u32 s91, s91, s94
    v_mov_b32 v6, s91
    v_cmp_eq_u32 vcc, 63, v1
    s_nop 1
    s_and_saveexec_b64 s[90:91], vcc
    buffer_store_dwordx2 v[4:5], v6, s[24:27], 0 offen sc1
    s_mov_b64 exec, s[90:91]
gated_mix__grouped_kv_mqa__dense_activation_mish__prompt_kernel_nog2:
    s_sub_u32 s33, s33, 1
    s_cmp_lg_u32 s33, 0
    s_cbranch_scc1 gated_mix__grouped_kv_mqa__dense_activation_mish__prompt_kernel_loop
    s_waitcnt vmcnt(0) lgkmcnt(0)
    v_mfma_f32_32x32x16_bf16 v[104:119], v[36:39], v[84:87], v[104:119]
    v_smfmac_f32_16x16x64_bf16 v[124:127], v[128:131], v[80:87], v222
    s_nop 15
    v_mov_b32 v5, 0x4e800000
    v_mov_b32 v7, 0
    s_mov_b64 s[34:35], 0
    v_add_f32 v120, v120, v121
    v_add_f32 v124, v124, v125
    v_rcp_f32 v4, v120
    v_cmp_nle_f32 vcc, v120, v5
    s_or_b64 s[34:35], s[34:35], vcc
    v_mul_f32 v88, v88, v4
    v_mul_f32 v89, v89, v4
    v_mul_f32 v90, v90, v4
    v_mul_f32 v91, v91, v4
    v_mul_f32 v92, v92, v4
    v_mul_f32 v93, v93, v4
    v_mul_f32 v94, v94, v4
    v_mul_f32 v95, v95, v4
    v_mul_f32 v96, v96, v4
    v_mul_f32 v97, v97, v4
    v_mul_f32 v98, v98, v4
    v_mul_f32 v99, v99, v4
    v_mul_f32 v100, v100, v4
    v_mul_f32 v101, v101, v4
    v_mul_f32 v102, v102, v4
    v_mul_f32 v103, v103, v4
    v_fma_f32 v7, v88, 0, v7
    v_fma_f32 v7, v89, 0, v7
    v_fma_f32 v7, v90, 0, v7
    v_fma_f32 v7, v91, 0, v7
    v_fma_f32 v7, v92, 0, v7
    v_fma_f32 v7, v93, 0, v7
    v_fma_f32 v7, v94, 0, v7
    v_fma_f32 v7, v95, 0, v7
    v_fma_f32 v7, v96, 0, v7
    v_fma_f32 v7, v97, 0, v7
    v_fma_f32 v7, v98, 0, v7
    v_fma_f32 v7, v99, 0, v7
    v_fma_f32 v7, v100, 0, v7
    v_fma_f32 v7, v101, 0, v7
    v_fma_f32 v7, v102, 0, v7
    v_fma_f32 v7, v103, 0, v7
    v_rcp_f32 v4, v124
    v_cmp_nle_f32 vcc, v124, v5
    s_or_b64 s[34:35], s[34:35], vcc
    v_mul_f32 v104, v104, v4
    v_mul_f32 v105, v105, v4
    v_mul_f32 v106, v106, v4
    v_mul_f32 v107, v107, v4
    v_mul_f32 v108, v108, v4
    v_mul_f32 v109, v109, v4
    v_mul_f32 v110, v110, v4
    v_mul_f32 v111, v111, v4
    v_mul_f32 v112, v112, v4
    v_mul_f32 v113, v113, v4
    v_mul_f32 v114, v114, v4
    v_mul_f32 v115, v115, v4
    v_mul_f32 v116, v116, v4
    v_mul_f32 v117, v117, v4
    v_mul_f32 v118, v118, v4
    v_mul_f32 v119, v119, v4
    v_fma_f32 v7, v104, 0, v7
    v_fma_f32 v7, v105, 0, v7
    v_fma_f32 v7, v106, 0, v7
    v_fma_f32 v7, v107, 0, v7
    v_fma_f32 v7, v108, 0, v7
    v_fma_f32 v7, v109, 0, v7
    v_fma_f32 v7, v110, 0, v7
    v_fma_f32 v7, v111, 0, v7
    v_fma_f32 v7, v112, 0, v7
    v_fma_f32 v7, v113, 0, v7
    v_fma_f32 v7, v114, 0, v7
    v_fma_f32 v7, v115, 0, v7
    v_fma_f32 v7, v116, 0, v7
    v_fma_f32 v7, v117, 0, v7
    v_fma_f32 v7, v118, 0, v7
    v_fma_f32 v7, v119, 0, v7
    v_cmp_u_f32 vcc, v7, v7
    s_or_b64 s[34:35], s[34:35], vcc
    v_cvt_pk_bf16_f32 v164, v88, v89
    v_cvt_pk_bf16_f32 v165, v90, v91
    v_cvt_pk_bf16_f32 v166, v92, v93
    v_cvt_pk_bf16_f32 v167, v94, v95
    v_cvt_pk_bf16_f32 v168, v96, v97
    v_cvt_pk_bf16_f32 v169, v98, v99
    v_cvt_pk_bf16_f32 v170, v100, v101
    v_cvt_pk_bf16_f32 v171, v102, v103
    v_cvt_pk_bf16_f32 v172, v104, v105
    v_cvt_pk_bf16_f32 v173, v106, v107
    v_cvt_pk_bf16_f32 v174, v108, v109
    v_cvt_pk_bf16_f32 v175, v110, v111
    v_cvt_pk_bf16_f32 v176, v112, v113
    v_cvt_pk_bf16_f32 v177, v114, v115
    v_cvt_pk_bf16_f32 v178, v116, v117
    v_cvt_pk_bf16_f32 v179, v118, v119
    buffer_store_dwordx4 v[164:167], v2, s[12:15], s38 offen offset:0 sc1
    buffer_store_dwordx4 v[168:171], v2, s[12:15], s38 offen offset:1024 sc1
    buffer_store_dwordx4 v[172:175], v2, s[12:15], s38 offen offset:2048 sc1
    buffer_store_dwordx4 v[176:179], v2, s[12:15], s38 offen offset:3072 sc1
    s_cmp_lg_u32 s39, 0
    s_cbranch_scc1 gated_mix__grouped_kv_mqa__dense_activation_mish__prompt_kernel_ok
    s_cmp_eq_u64 s[34:35], 0
    s_cbranch_scc1 gated_mix__grouped_kv_mqa__dense_activation_mish__prompt_kernel_ok
    v_mov_b32 v4, 0x10000
    v_mov_b32 v5, 1
    ds_write_b32 v4, v5
gated_mix__grouped_kv_mqa__dense_activation_mish__prompt_kernel_ok:
    s_waitcnt vmcnt(0) lgkmcnt(0)
    s_barrier
    v_mov_b32 v4, 0x10000
    ds_read_b32 v5, v4
    s_waitcnt lgkmcnt(0)
    v_readfirstlane_b32 s36, v5
    s_nop 3
    s_cmp_eq_u32 s36, 0
    s_cbranch_scc1 gated_mix__grouped_kv_mqa__dense_activation_mish__prompt_kernel_store
    s_cmp_lg_u32 s39, 0
    s_cbranch_scc1 gated_mix__grouped_kv_mqa__dense_activation_mish__prompt_kernel_store
    s_barrier
    s_mov_b32 s39, 1
    v_mov_b32 v164, 0xff800000
    v_mov_b32 v165, 0xff800000
    s_mov_b32 s37, 0
gated_mix__grouped_kv_mqa__dense_activation_mish__prompt_kernel_mx:
    buffer_load_dwordx4 v[24:27], v2, s[8:11], s37 offen sc1
    buffer_load_dwordx4 v[28:31], v2, s[8:11], s37 offen offset:1024 sc1
    s_waitcnt vmcnt(0)
    v_mfma_f32_32x32x16_bf16 v[40:55], v[24:27], v[8:11], 0
    v_mfma_f32_32x32x16_bf16 v[40:55], v[28:31], v[12:15], v[40:55]
    v_mfma_f32_32x32x16_bf16 v[56:71], v[24:27], v[16:19], 0
    v_mfma_f32_32x32x16_bf16 v[56:71], v[28:31], v[20:23], v[56:71]
    s_nop 15
    v_max3_f32 v164, v164, v40, v41
    v_max3_f32 v164, v164, v42, v43
    v_max3_f32 v164, v164, v44, v45
    v_max3_f32 v164, v164, v46, v47
    v_max3_f32 v164, v164, v48, v49
    v_max3_f32 v164, v164, v50, v51
    v_max3_f32 v164, v164, v52, v53
    v_max3_f32 v164, v164, v54, v55
    v_max3_f32 v165, v165, v56, v57
    v_max3_f32 v165, v165, v58, v59
    v_max3_f32 v165, v165, v60, v61
    v_max3_f32 v165, v165, v62, v63
    v_max3_f32 v165, v165, v64, v65
    v_max3_f32 v165, v165, v66, v67
    v_max3_f32 v165, v165, v68, v69
    v_max3_f32 v165, v165, v70, v71
    s_add_u32 s37, s37, 4096
    s_cmp_lt_u32 s37, 262144
    s_cbranch_scc1 gated_mix__grouped_kv_mqa__dense_activation_mish__prompt_kernel_mx
    v_mov_b32 v5, v164
    v_mov_b32 v6, v164
    s_nop 1
    v_permlane32_swap_b32 v5, v6
    s_nop 1
    v_max_f32 v5, v5, v6
    v_sub_f32 v5, 0, v5
    v_mov_b32 v132, v5
    v_mov_b32 v133, v5
    v_mov_b32 v134, v5
    v_mov_b32 v135, v5
    v_mov_b32 v136, v5
    v_mov_b32 v137, v5
    v_mov_b32 v138, v5
    v_mov_b32 v139, v5
    v_mov_b32 v140, v5
    v_mov_b32 v141, v5
    v_mov_b32 v142, v5
    v_mov_b32 v143, v5
    v_mov_b32 v144, v5
    v_mov_b32 v145, v5
    v_mov_b32 v146, v5
    v_mov_b32 v147, v5
    v_mov_b32 v5, v165
    v_mov_b32 v6, v165
    s_nop 1
    v_permlane32_swap_b32 v5, v6
    s_nop 1
    v_max_f32 v5, v5, v6
    v_sub_f32 v5, 0, v5
    v_mov_b32 v148, v5
    v_mov_b32 v149, v5
    v_mov_b32 v150, v5
    v_mov_b32 v151, v5
    v_mov_b32 v152, v5
    v_mov_b32 v153, v5
    v_mov_b32 v154, v5
    v_mov_b32 v155, v5
    v_mov_b32 v156, v5
    v_mov_b32 v157, v5
    v_mov_b32 v158, v5
    v_mov_b32 v159, v5
    v_mov_b32 v160, v5
    v_mov_b32 v161, v5
    v_mov_b32 v162, v5
    v_mov_b32 v163, v5
    s_branch gated_mix__grouped_kv_mqa__dense_activation_mish__prompt_kernel_pass
gated_mix__grouped_kv_mqa__dense_activation_mish__prompt_kernel_store:
    s_cmp_lg_u32 s86, 0
    s_cbranch_scc1 gated_mix__grouped_kv_mqa__dense_activation_mish__prompt_kernel_nosig
    s_lshl_b32 s28, s87, 8
    s_lshl_b32 s91, s88, 2
    s_add_u32 s28, s28, s91
    s_add_u32 s28, s28, 12288
    s_add_u32 s92, s84, 0x1b00000
    s_addc_u32 s93, s85, 0
    s_mov_b32 s52, s92
    s_mov_b32 s53, s93
    s_mov_b32 s54, 0x4000
    s_mov_b32 s55, 0x00020000
    v_lshlrev_b32 v6, 8, v1
    v_add_u32 v6, s28, v6
    v_mov_b32 v4, 1
    v_cmp_gt_u32 vcc, 1, v1
    s_nop 1
    s_and_saveexec_b64 s[90:91], vcc
    buffer_store_dword v4, v6, s[52:55], 0 offen sc1
    s_mov_b64 exec, s[90:91]
gated_mix__grouped_kv_mqa__dense_activation_mish__prompt_kernel_nosig:
    s_endpgm
gated_mix__grouped_kv_mqa__dense_activation_mish__prompt_kernel_roleb:
    s_setprio 2
    v_lshrrev_b32 v3, 3, v1
    v_and_b32 v4, 6, v3
    v_and_b32 v5, 7, v1
    v_xor_b32 v4, v4, v5
    v_lshlrev_b32 v4, 4, v4
    v_lshl_add_u32 v240, v3, 11, v4
    s_lshl_b32 s91, s87, 7
    s_lshl_b32 s92, s86, 5
    s_add_u32 s91, s91, s92
    s_lshl_b32 s91, s91, 11
    s_add_u32 s28, s91, 0
    s_add_u32 s29, s91, 15360
    s_add_u32 s30, s91, 30720
    s_add_u32 s31, s91, 46080
    s_lshl_b32 s35, s86, 12
    s_add_u32 s36, s35, 32768
    s_add_u32 s35, s35, 0
    s_waitcnt lgkmcnt(0)
    s_mov_b32 s4, s60
    s_mov_b32 s5, s61
    s_mov_b32 s6, 0x400000
    s_mov_b32 s7, 0x00020000
    s_mul_i32 s94, s87, 1
    s_add_u32 s59, s94, s88
    s_and_b32 s59, s59, 3
    s_add_u32 s94, s59, 0
    s_and_b32 s94, s94, 3
    s_mul_i32 s94, s94, 256
    s_add_u32 s4, s60, s94
    s_addc_u32 s5, s61, 0
    s_add_u32 m0, s35, 0
    s_nop 0
    buffer_load_dwordx4 v240, s[4:7], s28 offen offset:0 lds
    buffer_load_dwordx4 v240, s[4:7], s29 offen offset:1024 lds
    buffer_load_dwordx4 v240, s[4:7], s30 offen offset:2048 lds
    buffer_load_dwordx4 v240, s[4:7], s31 offen offset:3072 lds
    s_add_u32 s4, s4, 128
    s_addc_u32 s5, s5, 0
    v_lshrrev_b32 v3, 5, v1
    v_bfe_u32 v4, v1, 1, 4
    v_and_b32 v9, 1, v1
    v_lshlrev_b32 v9, 4, v9
    s_and_b32 s91, s86, 1
    s_lshl_b32 s91, s91, 2
    v_or_b32 v5, s91, v3
    v_mul_u32_u24 v8, 7168, v3
    v_add_u32 v8, v8, v9
    v_mov_b32 v10, 0x40000000
    v_xor_b32 v6, 0, v5
    v_xor_b32 v6, v6, v4
    v_lshl_add_u32 v7, v6, 5, v8
    v_cmp_le_u32 vcc, 14, v6
    s_nop 1
    v_cndmask_b32 v241, v7, v10, vcc
    v_xor_b32 v6, 2, v5
    v_xor_b32 v6, v6, v4
    v_lshl_add_u32 v7, v6, 5, v8
    v_cmp_le_u32 vcc, 14, v6
    s_nop 1
    v_cndmask_b32 v242, v7, v10, vcc
    s_mul_i32 s94, s88, 448
    s_add_u32 s92, s72, s94
    s_addc_u32 s93, s73, 0
    s_mov_b32 s8, s92
    s_mov_b32 s9, s93
    s_mov_b32 s10, 0x700000
    s_mov_b32 s11, 0x00020000
    s_mov_b32 s12, s92
    s_mov_b32 s13, s93
    s_add_u32 s94, s59, 0
    s_and_b32 s94, s94, 3
    s_mul_i32 s94, s94, 917504
    s_add_u32 s8, s12, s94
    s_addc_u32 s9, s13, 0
    s_mul_i32 s91, s86, 57344
    s_add_u32 s48, s91, 0
    s_add_u32 s49, s91, 13312
    s_add_u32 s50, s91, 26624
    s_add_u32 s51, s91, 39936
    s_add_u32 m0, s36, 0
    s_nop 0
    buffer_load_dwordx4 v241, s[8:11], s48 offen offset:0 lds
    buffer_load_dwordx4 v242, s[8:11], s49 offen offset:1024 lds
    buffer_load_dwordx4 v241, s[8:11], s50 offen offset:2048 lds
    buffer_load_dwordx4 v242, s[8:11], s51 offen offset:3072 lds
    s_add_u32 s8, s8, 229376
    s_addc_u32 s9, s9, 0
    s_add_u32 m0, s36, 16384
    s_nop 0
    buffer_load_dwordx4 v241, s[8:11], s48 offen offset:0 lds
    buffer_load_dwordx4 v242, s[8:11], s49 offen offset:1024 lds
    buffer_load_dwordx4 v241, s[8:11], s50 offen offset:2048 lds
    buffer_load_dwordx4 v242, s[8:11], s51 offen offset:3072 lds
    s_add_u32 s8, s8, 229376
    s_addc_u32 s9, s9, 0
    v_and_b32 v5, 15, v1
    v_lshrrev_b32 v6, 4, v1
    v_bfe_u32 v7, v1, 2, 2
    v_and_b32 v8, 3, v1
    s_and_b32 s37, s86, 1
    s_lshr_b32 s38, s86, 1
    v_and_b32 v3, 6, v5
    v_xor_b32 v3, v3, v6
    v_lshlrev_b32 v4, 4, v3
    v_lshl_add_u32 v4, v5, 7, v4
    s_lshl_b32 s91, s37, 13
    v_add_u32 v243, s91, v4
    v_xor_b32 v244, 64, v243
    v_and_b32 v3, 1, v6
    v_lshl_or_b32 v3, v3, 2, v7
    v_lshl_add_u32 v4, v6, 3, v7
    v_lshlrev_b32 v4, 9, v4
    v_lshl_add_u32 v4, v8, 3, v4
    v_add_u32 v4, 32768, v4
    s_mul_i32 s91, s38, 7
    s_add_u32 s94, s91, 0
    v_xor_b32 v9, s94, v3
    v_lshl_add_u32 v246, v9, 5, v4
    s_add_u32 s94, s91, 1
    v_xor_b32 v9, s94, v3
    v_lshl_add_u32 v247, v9, 5, v4
    s_add_u32 s94, s91, 2
    v_xor_b32 v9, s94, v3
    v_lshl_add_u32 v248, v9, 5, v4
    s_add_u32 s94, s91, 3
    v_xor_b32 v9, s94, v3
    v_lshl_add_u32 v249, v9, 5, v4
    s_add_u32 s94, s91, 4
    v_xor_b32 v9, s94, v3
    v_lshl_add_u32 v250, v9, 5, v4
    s_add_u32 s94, s91, 5
    v_xor_b32 v9, s94, v3
    v_lshl_add_u32 v251, v9, 5, v4
    s_add_u32 s94, s91, 6
    v_xor_b32 v9, s94, v3
    v_lshl_add_u32 v252, v9, 5, v4
    v_lshlrev_b32 v245, 3, v6
    s_mul_i32 s39, s88, 448
    s_mul_i32 s91, s38, 224
    s_add_u32 s39, s39, s91
    s_mov_b32 s24, s74
    s_mov_b32 s25, s75
    s_mov_b32 s26, 0x1c00
    s_mov_b32 s27, 0x00020000
    buffer_load_dwordx2 v[212:213], v245, s[24:27], s39 offen offset:0
    buffer_load_dwordx2 v[216:217], v245, s[24:27], s39 offen offset:32
    buffer_load_dwordx2 v[220:221], v245, s[24:27], s39 offen offset:64
    buffer_load_dwordx2 v[224:225], v245, s[24:27], s39 offen offset:96
    buffer_load_dwordx2 v[228:229], v245, s[24:27], s39 offen offset:128
    buffer_load_dwordx2 v[232:233], v245, s[24:27], s39 offen offset:160
    buffer_load_dwordx2 v[236:237], v245, s[24:27], s39 offen offset:192
    s_waitcnt vmcnt(11)
    s_barrier
    s_add_u32 m0, s36, 32768
    s_nop 0
    buffer_load_dwordx4 v241, s[8:11], s48 offen offset:0 lds
    buffer_load_dwordx4 v242, s[8:11], s49 offen offset:1024 lds
    buffer_load_dwordx4 v241, s[8:11], s50 offen offset:2048 lds
    buffer_load_dwordx4 v242, s[8:11], s51 offen offset:3072 lds
    s_add_u32 s8, s8, 229376
    s_addc_u32 s9, s9, 0
    s_add_u32 m0, s35, 16384
    s_nop 0
    buffer_load_dwordx4 v240, s[4:7], s28 offen offset:0 lds
    buffer_load_dwordx4 v240, s[4:7], s29 offen offset:1024 lds
    buffer_load_dwordx4 v240, s[4:7], s30 offen offset:2048 lds
    buffer_load_dwordx4 v240, s[4:7], s31 offen offset:3072 lds
    s_add_u32 s94, s59, 1
    s_and_b32 s94, s94, 3
    s_mul_i32 s94, s94, 256
    s_add_u32 s4, s60, s94
    s_addc_u32 s5, s61, 0
    ds_read_b128 v[64:67], v243 offset:0
    ds_read_b128 v[68:71], v243 offset:2048
    ds_read_b128 v[72:75], v243 offset:4096
    ds_read_b128 v[76:79], v243 offset:6144
    ds_read_b64_tr_b16 v[8:9], v246 offset:0
    ds_read_b64_tr_b16 v[10:11], v246 offset:2048
    ds_read_b64_tr_b16 v[12:13], v247 offset:0
    ds_read_b64_tr_b16 v[14:15], v247 offset:2048
    ds_read_b64_tr_b16 v[16:17], v248 offset:0
    ds_read_b64_tr_b16 v[18:19], v248 offset:2048
    ds_read_b64_tr_b16 v[20:21], v249 offset:0
    ds_read_b64_tr_b16 v[22:23], v249 offset:2048
    ds_read_b64_tr_b16 v[24:25], v250 offset:0
    ds_read_b64_tr_b16 v[26:27], v250 offset:2048
    ds_read_b64_tr_b16 v[28:29], v251 offset:0
    ds_read_b64_tr_b16 v[30:31], v251 offset:2048
    ds_read_b64_tr_b16 v[32:33], v252 offset:0
    ds_read_b64_tr_b16 v[34:35], v252 offset:2048
    s_waitcnt vmcnt(8)
    v_and_b32 v215, 0xffff0000, v213
    v_lshlrev_b32 v214, 16, v213
    v_and_b32 v213, 0xffff0000, v212
    v_lshlrev_b32 v212, 16, v212
    v_and_b32 v219, 0xffff0000, v217
    v_lshlrev_b32 v218, 16, v217
    v_and_b32 v217, 0xffff0000, v216
    v_lshlrev_b32 v216, 16, v216
    v_and_b32 v223, 0xffff0000, v221
    v_lshlrev_b32 v222, 16, v221
    v_and_b32 v221, 0xffff0000, v220
    v_lshlrev_b32 v220, 16, v220
    v_and_b32 v227, 0xffff0000, v225
    v_lshlrev_b32 v226, 16, v225
    v_and_b32 v225, 0xffff0000, v224
    v_lshlrev_b32 v224, 16, v224
    v_and_b32 v231, 0xffff0000, v229
    v_lshlrev_b32 v230, 16, v229
    v_and_b32 v229, 0xffff0000, v228
    v_lshlrev_b32 v228, 16, v228
    v_and_b32 v235, 0xffff0000, v233
    v_lshlrev_b32 v234, 16, v233
    v_and_b32 v233, 0xffff0000, v232
    v_lshlrev_b32 v232, 16, v232
    v_and_b32 v239, 0xffff0000, v237
    v_lshlrev_b32 v238, 16, v237
    v_and_b32 v237, 0xffff0000, v236
    v_lshlrev_b32 v236, 16, v236
    s_waitcnt lgkmcnt(0)
    s_barrier
    v_mfma_f32_16x16x32_bf16 v[100:103], v[8:11], v[64:67], v[212:215]
    ds_read_b128 v[80:83], v244 offset:0
    v_mfma_f32_16x16x32_bf16 v[104:107], v[8:11], v[68:71], v[212:215]
    ds_read_b128 v[84:87], v244 offset:2048
    v_mfma_f32_16x16x32_bf16 v[108:111], v[8:11], v[72:75], v[212:215]
    ds_read_b128 v[88:91], v244 offset:4096
    v_mfma_f32_16x16x32_bf16 v[112:115], v[8:11], v[76:79], v[212:215]
    s_add_u32 m0, s36, 0
    s_nop 0
    buffer_load_dwordx4 v241, s[8:11], s48 offen offset:0 lds
    v_mfma_f32_16x16x32_bf16 v[116:119], v[12:15], v[64:67], v[216:219]
    ds_read_b128 v[92:95], v244 offset:6144
    v_mfma_f32_16x16x32_bf16 v[120:123], v[12:15], v[68:71], v[216:219]
    ds_read_b64_tr_b16 v[36:37], v246 offset:16384
    v_mfma_f32_16x16x32_bf16 v[124:127], v[12:15], v[72:75], v[216:219]
    ds_read_b64_tr_b16 v[38:39], v246 offset:18432
    v_mfma_f32_16x16x32_bf16 v[128:131], v[12:15], v[76:79], v[216:219]
    buffer_load_dwordx4 v242, s[8:11], s49 offen offset:1024 lds
    v_mfma_f32_16x16x32_bf16 v[132:135], v[16:19], v[64:67], v[220:223]
    ds_read_b64_tr_b16 v[40:41], v247 offset:16384
    v_mfma_f32_16x16x32_bf16 v[136:139], v[16:19], v[68:71], v[220:223]
    ds_read_b64_tr_b16 v[42:43], v247 offset:18432
    v_mfma_f32_16x16x32_bf16 v[140:143], v[16:19], v[72:75], v[220:223]
    ds_read_b64_tr_b16 v[44:45], v248 offset:16384
    v_mfma_f32_16x16x32_bf16 v[144:147], v[16:19], v[76:79], v[220:223]
    buffer_load_dwordx4 v241, s[8:11], s50 offen offset:2048 lds
    v_mfma_f32_16x16x32_bf16 v[148:151], v[20:23], v[64:67], v[224:227]
    ds_read_b64_tr_b16 v[46:47], v248 offset:18432
    v_mfma_f32_16x16x32_bf16 v[152:155], v[20:23], v[68:71], v[224:227]
    ds_read_b64_tr_b16 v[48:49], v249 offset:16384
    buffer_load_dwordx4 v242, s[8:11], s51 offen offset:3072 lds
    s_add_u32 s94, s59, 1
    s_and_b32 s94, s94, 3
    s_mul_i32 s94, s94, 917504
    s_add_u32 s8, s12, s94
    s_addc_u32 s9, s13, 0
    v_mfma_f32_16x16x32_bf16 v[156:159], v[20:23], v[72:75], v[224:227]
    ds_read_b64_tr_b16 v[50:51], v249 offset:18432
    v_mfma_f32_16x16x32_bf16 v[160:163], v[20:23], v[76:79], v[224:227]
    v_mfma_f32_16x16x32_bf16 v[164:167], v[24:27], v[64:67], v[228:231]
    ds_read_b64_tr_b16 v[52:53], v250 offset:16384
    v_mfma_f32_16x16x32_bf16 v[168:171], v[24:27], v[68:71], v[228:231]
    ds_read_b64_tr_b16 v[54:55], v250 offset:18432
    v_mfma_f32_16x16x32_bf16 v[172:175], v[24:27], v[72:75], v[228:231]
    ds_read_b64_tr_b16 v[56:57], v251 offset:16384
    v_mfma_f32_16x16x32_bf16 v[176:179], v[24:27], v[76:79], v[228:231]
    v_mfma_f32_16x16x32_bf16 v[180:183], v[28:31], v[64:67], v[232:235]
    ds_read_b64_tr_b16 v[58:59], v251 offset:18432
    v_mfma_f32_16x16x32_bf16 v[184:187], v[28:31], v[68:71], v[232:235]
    ds_read_b64_tr_b16 v[60:61], v252 offset:16384
    v_mfma_f32_16x16x32_bf16 v[188:191], v[28:31], v[72:75], v[232:235]
    ds_read_b64_tr_b16 v[62:63], v252 offset:18432
    v_mfma_f32_16x16x32_bf16 v[192:195], v[28:31], v[76:79], v[232:235]
    v_mfma_f32_16x16x32_bf16 v[196:199], v[32:35], v[64:67], v[236:239]
    v_mfma_f32_16x16x32_bf16 v[200:203], v[32:35], v[68:71], v[236:239]
    v_mfma_f32_16x16x32_bf16 v[204:207], v[32:35], v[72:75], v[236:239]
    v_mfma_f32_16x16x32_bf16 v[208:211], v[32:35], v[76:79], v[236:239]
    s_waitcnt vmcnt(4) lgkmcnt(0)
    s_barrier
    v_mfma_f32_16x16x32_bf16 v[100:103], v[36:39], v[80:83], v[100:103]
    ds_read_b128 v[64:67], v243 offset:16384
    v_mfma_f32_16x16x32_bf16 v[104:107], v[36:39], v[84:87], v[104:107]
    ds_read_b128 v[68:71], v243 offset:18432
    v_mfma_f32_16x16x32_bf16 v[108:111], v[36:39], v[88:91], v[108:111]
    ds_read_b128 v[72:75], v243 offset:20480
    v_mfma_f32_16x16x32_bf16 v[112:115], v[36:39], v[92:95], v[112:115]
    s_add_u32 m0, s36, 16384
    s_nop 0
    buffer_load_dwordx4 v241, s[8:11], s48 offen offset:0 lds
    v_mfma_f32_16x16x32_bf16 v[116:119], v[40:43], v[80:83], v[116:119]
    ds_read_b128 v[76:79], v243 offset:22528
    v_mfma_f32_16x16x32_bf16 v[120:123], v[40:43], v[84:87], v[120:123]
    ds_read_b64_tr_b16 v[8:9], v246 offset:32768
    v_mfma_f32_16x16x32_bf16 v[124:127], v[40:43], v[88:91], v[124:127]
    ds_read_b64_tr_b16 v[10:11], v246 offset:34816
    v_mfma_f32_16x16x32_bf16 v[128:131], v[40:43], v[92:95], v[128:131]
    buffer_load_dwordx4 v242, s[8:11], s49 offen offset:1024 lds
    v_mfma_f32_16x16x32_bf16 v[132:135], v[44:47], v[80:83], v[132:135]
    ds_read_b64_tr_b16 v[12:13], v247 offset:32768
    v_mfma_f32_16x16x32_bf16 v[136:139], v[44:47], v[84:87], v[136:139]
    ds_read_b64_tr_b16 v[14:15], v247 offset:34816
    v_mfma_f32_16x16x32_bf16 v[140:143], v[44:47], v[88:91], v[140:143]
    ds_read_b64_tr_b16 v[16:17], v248 offset:32768
    v_mfma_f32_16x16x32_bf16 v[144:147], v[44:47], v[92:95], v[144:147]
    buffer_load_dwordx4 v241, s[8:11], s50 offen offset:2048 lds
    v_mfma_f32_16x16x32_bf16 v[148:151], v[48:51], v[80:83], v[148:151]
    ds_read_b64_tr_b16 v[18:19], v248 offset:34816
    v_mfma_f32_16x16x32_bf16 v[152:155], v[48:51], v[84:87], v[152:155]
    ds_read_b64_tr_b16 v[20:21], v249 offset:32768
    buffer_load_dwordx4 v242, s[8:11], s51 offen offset:3072 lds
    s_add_u32 s8, s8, 229376
    s_addc_u32 s9, s9, 0
    v_mfma_f32_16x16x32_bf16 v[156:159], v[48:51], v[88:91], v[156:159]
    ds_read_b64_tr_b16 v[22:23], v249 offset:34816
    v_mfma_f32_16x16x32_bf16 v[160:163], v[48:51], v[92:95], v[160:163]
    s_add_u32 m0, s35, 0
    s_nop 0
    buffer_load_dwordx4 v240, s[4:7], s28 offen offset:0 lds
    v_mfma_f32_16x16x32_bf16 v[164:167], v[52:55], v[80:83], v[164:167]
    ds_read_b64_tr_b16 v[24:25], v250 offset:32768
    v_mfma_f32_16x16x32_bf16 v[168:171], v[52:55], v[84:87], v[168:171]
    ds_read_b64_tr_b16 v[26:27], v250 offset:34816
    v_mfma_f32_16x16x32_bf16 v[172:175], v[52:55], v[88:91], v[172:175]
    ds_read_b64_tr_b16 v[28:29], v251 offset:32768
    v_mfma_f32_16x16x32_bf16 v[176:179], v[52:55], v[92:95], v[176:179]
    buffer_load_dwordx4 v240, s[4:7], s29 offen offset:1024 lds
    v_mfma_f32_16x16x32_bf16 v[180:183], v[56:59], v[80:83], v[180:183]
    ds_read_b64_tr_b16 v[30:31], v251 offset:34816
    v_mfma_f32_16x16x32_bf16 v[184:187], v[56:59], v[84:87], v[184:187]
    ds_read_b64_tr_b16 v[32:33], v252 offset:32768
    v_mfma_f32_16x16x32_bf16 v[188:191], v[56:59], v[88:91], v[188:191]
    ds_read_b64_tr_b16 v[34:35], v252 offset:34816
    v_mfma_f32_16x16x32_bf16 v[192:195], v[56:59], v[92:95], v[192:195]
    buffer_load_dwordx4 v240, s[4:7], s30 offen offset:2048 lds
    v_mfma_f32_16x16x32_bf16 v[196:199], v[60:63], v[80:83], v[196:199]
    v_mfma_f32_16x16x32_bf16 v[200:203], v[60:63], v[84:87], v[200:203]
    v_mfma_f32_16x16x32_bf16 v[204:207], v[60:63], v[88:91], v[204:207]
    v_mfma_f32_16x16x32_bf16 v[208:211], v[60:63], v[92:95], v[208:211]
    buffer_load_dwordx4 v240, s[4:7], s31 offen offset:3072 lds
    s_add_u32 s4, s4, 128
    s_addc_u32 s5, s5, 0
    s_waitcnt vmcnt(8) lgkmcnt(0)
    s_barrier
    v_mfma_f32_16x16x32_bf16 v[100:103], v[8:11], v[64:67], v[100:103]
    ds_read_b128 v[80:83], v244 offset:16384
    v_mfma_f32_16x16x32_bf16 v[104:107], v[8:11], v[68:71], v[104:107]
    ds_read_b128 v[84:87], v244 offset:18432
    v_mfma_f32_16x16x32_bf16 v[108:111], v[8:11], v[72:75], v[108:111]
    ds_read_b128 v[88:91], v244 offset:20480
    v_mfma_f32_16x16x32_bf16 v[112:115], v[8:11], v[76:79], v[112:115]
    s_add_u32 m0, s36, 32768
    s_nop 0
    buffer_load_dwordx4 v241, s[8:11], s48 offen offset:0 lds
    v_mfma_f32_16x16x32_bf16 v[116:119], v[12:15], v[64:67], v[116:119]
    ds_read_b128 v[92:95], v244 offset:22528
    v_mfma_f32_16x16x32_bf16 v[120:123], v[12:15], v[68:71], v[120:123]
    ds_read_b64_tr_b16 v[36:37], v246 offset:0
    v_mfma_f32_16x16x32_bf16 v[124:127], v[12:15], v[72:75], v[124:127]
    ds_read_b64_tr_b16 v[38:39], v246 offset:2048
    v_mfma_f32_16x16x32_bf16 v[128:131], v[12:15], v[76:79], v[128:131]
    buffer_load_dwordx4 v242, s[8:11], s49 offen offset:1024 lds
    v_mfma_f32_16x16x32_bf16 v[132:135], v[16:19], v[64:67], v[132:135]
    ds_read_b64_tr_b16 v[40:41], v247 offset:0
    v_mfma_f32_16x16x32_bf16 v[136:139], v[16:19], v[68:71], v[136:139]
    ds_read_b64_tr_b16 v[42:43], v247 offset:2048
    v_mfma_f32_16x16x32_bf16 v[140:143], v[16:19], v[72:75], v[140:143]
    ds_read_b64_tr_b16 v[44:45], v248 offset:0
    v_mfma_f32_16x16x32_bf16 v[144:147], v[16:19], v[76:79], v[144:147]
    buffer_load_dwordx4 v241, s[8:11], s50 offen offset:2048 lds
    v_mfma_f32_16x16x32_bf16 v[148:151], v[20:23], v[64:67], v[148:151]
    ds_read_b64_tr_b16 v[46:47], v248 offset:2048
    v_mfma_f32_16x16x32_bf16 v[152:155], v[20:23], v[68:71], v[152:155]
    ds_read_b64_tr_b16 v[48:49], v249 offset:0
    buffer_load_dwordx4 v242, s[8:11], s51 offen offset:3072 lds
    s_add_u32 s8, s8, 229376
    s_addc_u32 s9, s9, 0
    v_mfma_f32_16x16x32_bf16 v[156:159], v[20:23], v[72:75], v[156:159]
    ds_read_b64_tr_b16 v[50:51], v249 offset:2048
    v_mfma_f32_16x16x32_bf16 v[160:163], v[20:23], v[76:79], v[160:163]
    v_mfma_f32_16x16x32_bf16 v[164:167], v[24:27], v[64:67], v[164:167]
    ds_read_b64_tr_b16 v[52:53], v250 offset:0
    v_mfma_f32_16x16x32_bf16 v[168:171], v[24:27], v[68:71], v[168:171]
    ds_read_b64_tr_b16 v[54:55], v250 offset:2048
    v_mfma_f32_16x16x32_bf16 v[172:175], v[24:27], v[72:75], v[172:175]
    ds_read_b64_tr_b16 v[56:57], v251 offset:0
    v_mfma_f32_16x16x32_bf16 v[176:179], v[24:27], v[76:79], v[176:179]
    v_mfma_f32_16x16x32_bf16 v[180:183], v[28:31], v[64:67], v[180:183]
    ds_read_b64_tr_b16 v[58:59], v251 offset:2048
    v_mfma_f32_16x16x32_bf16 v[184:187], v[28:31], v[68:71], v[184:187]
    ds_read_b64_tr_b16 v[60:61], v252 offset:0
    v_mfma_f32_16x16x32_bf16 v[188:191], v[28:31], v[72:75], v[188:191]
    ds_read_b64_tr_b16 v[62:63], v252 offset:2048
    v_mfma_f32_16x16x32_bf16 v[192:195], v[28:31], v[76:79], v[192:195]
    v_mfma_f32_16x16x32_bf16 v[196:199], v[32:35], v[64:67], v[196:199]
    v_mfma_f32_16x16x32_bf16 v[200:203], v[32:35], v[68:71], v[200:203]
    v_mfma_f32_16x16x32_bf16 v[204:207], v[32:35], v[72:75], v[204:207]
    v_mfma_f32_16x16x32_bf16 v[208:211], v[32:35], v[76:79], v[208:211]
    s_waitcnt vmcnt(4) lgkmcnt(0)
    s_barrier
    v_mfma_f32_16x16x32_bf16 v[100:103], v[36:39], v[80:83], v[100:103]
    ds_read_b128 v[64:67], v243 offset:0
    v_mfma_f32_16x16x32_bf16 v[104:107], v[36:39], v[84:87], v[104:107]
    ds_read_b128 v[68:71], v243 offset:2048
    v_mfma_f32_16x16x32_bf16 v[108:111], v[36:39], v[88:91], v[108:111]
    ds_read_b128 v[72:75], v243 offset:4096
    v_mfma_f32_16x16x32_bf16 v[112:115], v[36:39], v[92:95], v[112:115]
    s_add_u32 m0, s36, 0
    s_nop 0
    buffer_load_dwordx4 v241, s[8:11], s48 offen offset:0 lds
    v_mfma_f32_16x16x32_bf16 v[116:119], v[40:43], v[80:83], v[116:119]
    ds_read_b128 v[76:79], v243 offset:6144
    v_mfma_f32_16x16x32_bf16 v[120:123], v[40:43], v[84:87], v[120:123]
    ds_read_b64_tr_b16 v[8:9], v246 offset:16384
    v_mfma_f32_16x16x32_bf16 v[124:127], v[40:43], v[88:91], v[124:127]
    ds_read_b64_tr_b16 v[10:11], v246 offset:18432
    v_mfma_f32_16x16x32_bf16 v[128:131], v[40:43], v[92:95], v[128:131]
    buffer_load_dwordx4 v242, s[8:11], s49 offen offset:1024 lds
    v_mfma_f32_16x16x32_bf16 v[132:135], v[44:47], v[80:83], v[132:135]
    ds_read_b64_tr_b16 v[12:13], v247 offset:16384
    v_mfma_f32_16x16x32_bf16 v[136:139], v[44:47], v[84:87], v[136:139]
    ds_read_b64_tr_b16 v[14:15], v247 offset:18432
    v_mfma_f32_16x16x32_bf16 v[140:143], v[44:47], v[88:91], v[140:143]
    ds_read_b64_tr_b16 v[16:17], v248 offset:16384
    v_mfma_f32_16x16x32_bf16 v[144:147], v[44:47], v[92:95], v[144:147]
    buffer_load_dwordx4 v241, s[8:11], s50 offen offset:2048 lds
    v_mfma_f32_16x16x32_bf16 v[148:151], v[48:51], v[80:83], v[148:151]
    ds_read_b64_tr_b16 v[18:19], v248 offset:18432
    v_mfma_f32_16x16x32_bf16 v[152:155], v[48:51], v[84:87], v[152:155]
    ds_read_b64_tr_b16 v[20:21], v249 offset:16384
    buffer_load_dwordx4 v242, s[8:11], s51 offen offset:3072 lds
    s_add_u32 s8, s8, 229376
    s_addc_u32 s9, s9, 0
    v_mfma_f32_16x16x32_bf16 v[156:159], v[48:51], v[88:91], v[156:159]
    ds_read_b64_tr_b16 v[22:23], v249 offset:18432
    v_mfma_f32_16x16x32_bf16 v[160:163], v[48:51], v[92:95], v[160:163]
    s_add_u32 m0, s35, 16384
    s_nop 0
    buffer_load_dwordx4 v240, s[4:7], s28 offen offset:0 lds
    v_mfma_f32_16x16x32_bf16 v[164:167], v[52:55], v[80:83], v[164:167]
    ds_read_b64_tr_b16 v[24:25], v250 offset:16384
    v_mfma_f32_16x16x32_bf16 v[168:171], v[52:55], v[84:87], v[168:171]
    ds_read_b64_tr_b16 v[26:27], v250 offset:18432
    v_mfma_f32_16x16x32_bf16 v[172:175], v[52:55], v[88:91], v[172:175]
    ds_read_b64_tr_b16 v[28:29], v251 offset:16384
    v_mfma_f32_16x16x32_bf16 v[176:179], v[52:55], v[92:95], v[176:179]
    buffer_load_dwordx4 v240, s[4:7], s29 offen offset:1024 lds
    v_mfma_f32_16x16x32_bf16 v[180:183], v[56:59], v[80:83], v[180:183]
    ds_read_b64_tr_b16 v[30:31], v251 offset:18432
    v_mfma_f32_16x16x32_bf16 v[184:187], v[56:59], v[84:87], v[184:187]
    ds_read_b64_tr_b16 v[32:33], v252 offset:16384
    v_mfma_f32_16x16x32_bf16 v[188:191], v[56:59], v[88:91], v[188:191]
    ds_read_b64_tr_b16 v[34:35], v252 offset:18432
    v_mfma_f32_16x16x32_bf16 v[192:195], v[56:59], v[92:95], v[192:195]
    buffer_load_dwordx4 v240, s[4:7], s30 offen offset:2048 lds
    v_mfma_f32_16x16x32_bf16 v[196:199], v[60:63], v[80:83], v[196:199]
    v_mfma_f32_16x16x32_bf16 v[200:203], v[60:63], v[84:87], v[200:203]
    v_mfma_f32_16x16x32_bf16 v[204:207], v[60:63], v[88:91], v[204:207]
    v_mfma_f32_16x16x32_bf16 v[208:211], v[60:63], v[92:95], v[208:211]
    buffer_load_dwordx4 v240, s[4:7], s31 offen offset:3072 lds
    s_add_u32 s94, s59, 2
    s_and_b32 s94, s94, 3
    s_mul_i32 s94, s94, 256
    s_add_u32 s4, s60, s94
    s_addc_u32 s5, s61, 0
    s_waitcnt vmcnt(8) lgkmcnt(0)
    s_barrier
    v_mfma_f32_16x16x32_bf16 v[100:103], v[8:11], v[64:67], v[100:103]
    ds_read_b128 v[80:83], v244 offset:0
    v_mfma_f32_16x16x32_bf16 v[104:107], v[8:11], v[68:71], v[104:107]
    ds_read_b128 v[84:87], v244 offset:2048
    v_mfma_f32_16x16x32_bf16 v[108:111], v[8:11], v[72:75], v[108:111]
    ds_read_b128 v[88:91], v244 offset:4096
    v_mfma_f32_16x16x32_bf16 v[112:115], v[8:11], v[76:79], v[112:115]
    s_add_u32 m0, s36, 16384
    s_nop 0
    buffer_load_dwordx4 v241, s[8:11], s48 offen offset:0 lds
    v_mfma_f32_16x16x32_bf16 v[116:119], v[12:15], v[64:67], v[116:119]
    ds_read_b128 v[92:95], v244 offset:6144
    v_mfma_f32_16x16x32_bf16 v[120:123], v[12:15], v[68:71], v[120:123]
    ds_read_b64_tr_b16 v[36:37], v246 offset:32768
    v_mfma_f32_16x16x32_bf16 v[124:127], v[12:15], v[72:75], v[124:127]
    ds_read_b64_tr_b16 v[38:39], v246 offset:34816
    v_mfma_f32_16x16x32_bf16 v[128:131], v[12:15], v[76:79], v[128:131]
    buffer_load_dwordx4 v242, s[8:11], s49 offen offset:1024 lds
    v_mfma_f32_16x16x32_bf16 v[132:135], v[16:19], v[64:67], v[132:135]
    ds_read_b64_tr_b16 v[40:41], v247 offset:32768
    v_mfma_f32_16x16x32_bf16 v[136:139], v[16:19], v[68:71], v[136:139]
    ds_read_b64_tr_b16 v[42:43], v247 offset:34816
    v_mfma_f32_16x16x32_bf16 v[140:143], v[16:19], v[72:75], v[140:143]
    ds_read_b64_tr_b16 v[44:45], v248 offset:32768
    v_mfma_f32_16x16x32_bf16 v[144:147], v[16:19], v[76:79], v[144:147]
    buffer_load_dwordx4 v241, s[8:11], s50 offen offset:2048 lds
    v_mfma_f32_16x16x32_bf16 v[148:151], v[20:23], v[64:67], v[148:151]
    ds_read_b64_tr_b16 v[46:47], v248 offset:34816
    v_mfma_f32_16x16x32_bf16 v[152:155], v[20:23], v[68:71], v[152:155]
    ds_read_b64_tr_b16 v[48:49], v249 offset:32768
    buffer_load_dwordx4 v242, s[8:11], s51 offen offset:3072 lds
    s_add_u32 s94, s59, 2
    s_and_b32 s94, s94, 3
    s_mul_i32 s94, s94, 917504
    s_add_u32 s8, s12, s94
    s_addc_u32 s9, s13, 0
    v_mfma_f32_16x16x32_bf16 v[156:159], v[20:23], v[72:75], v[156:159]
    ds_read_b64_tr_b16 v[50:51], v249 offset:34816
    v_mfma_f32_16x16x32_bf16 v[160:163], v[20:23], v[76:79], v[160:163]
    v_mfma_f32_16x16x32_bf16 v[164:167], v[24:27], v[64:67], v[164:167]
    ds_read_b64_tr_b16 v[52:53], v250 offset:32768
    v_mfma_f32_16x16x32_bf16 v[168:171], v[24:27], v[68:71], v[168:171]
    ds_read_b64_tr_b16 v[54:55], v250 offset:34816
    v_mfma_f32_16x16x32_bf16 v[172:175], v[24:27], v[72:75], v[172:175]
    ds_read_b64_tr_b16 v[56:57], v251 offset:32768
    v_mfma_f32_16x16x32_bf16 v[176:179], v[24:27], v[76:79], v[176:179]
    v_mfma_f32_16x16x32_bf16 v[180:183], v[28:31], v[64:67], v[180:183]
    ds_read_b64_tr_b16 v[58:59], v251 offset:34816
    v_mfma_f32_16x16x32_bf16 v[184:187], v[28:31], v[68:71], v[184:187]
    ds_read_b64_tr_b16 v[60:61], v252 offset:32768
    v_mfma_f32_16x16x32_bf16 v[188:191], v[28:31], v[72:75], v[188:191]
    ds_read_b64_tr_b16 v[62:63], v252 offset:34816
    v_mfma_f32_16x16x32_bf16 v[192:195], v[28:31], v[76:79], v[192:195]
    v_mfma_f32_16x16x32_bf16 v[196:199], v[32:35], v[64:67], v[196:199]
    v_mfma_f32_16x16x32_bf16 v[200:203], v[32:35], v[68:71], v[200:203]
    v_mfma_f32_16x16x32_bf16 v[204:207], v[32:35], v[72:75], v[204:207]
    v_mfma_f32_16x16x32_bf16 v[208:211], v[32:35], v[76:79], v[208:211]
    s_waitcnt vmcnt(4) lgkmcnt(0)
    s_barrier
    v_mfma_f32_16x16x32_bf16 v[100:103], v[36:39], v[80:83], v[100:103]
    ds_read_b128 v[64:67], v243 offset:16384
    v_mfma_f32_16x16x32_bf16 v[104:107], v[36:39], v[84:87], v[104:107]
    ds_read_b128 v[68:71], v243 offset:18432
    v_mfma_f32_16x16x32_bf16 v[108:111], v[36:39], v[88:91], v[108:111]
    ds_read_b128 v[72:75], v243 offset:20480
    v_mfma_f32_16x16x32_bf16 v[112:115], v[36:39], v[92:95], v[112:115]
    s_add_u32 m0, s36, 32768
    s_nop 0
    buffer_load_dwordx4 v241, s[8:11], s48 offen offset:0 lds
    v_mfma_f32_16x16x32_bf16 v[116:119], v[40:43], v[80:83], v[116:119]
    ds_read_b128 v[76:79], v243 offset:22528
    v_mfma_f32_16x16x32_bf16 v[120:123], v[40:43], v[84:87], v[120:123]
    ds_read_b64_tr_b16 v[8:9], v246 offset:0
    v_mfma_f32_16x16x32_bf16 v[124:127], v[40:43], v[88:91], v[124:127]
    ds_read_b64_tr_b16 v[10:11], v246 offset:2048
    v_mfma_f32_16x16x32_bf16 v[128:131], v[40:43], v[92:95], v[128:131]
    buffer_load_dwordx4 v242, s[8:11], s49 offen offset:1024 lds
    v_mfma_f32_16x16x32_bf16 v[132:135], v[44:47], v[80:83], v[132:135]
    ds_read_b64_tr_b16 v[12:13], v247 offset:0
    v_mfma_f32_16x16x32_bf16 v[136:139], v[44:47], v[84:87], v[136:139]
    ds_read_b64_tr_b16 v[14:15], v247 offset:2048
    v_mfma_f32_16x16x32_bf16 v[140:143], v[44:47], v[88:91], v[140:143]
    ds_read_b64_tr_b16 v[16:17], v248 offset:0
    v_mfma_f32_16x16x32_bf16 v[144:147], v[44:47], v[92:95], v[144:147]
    buffer_load_dwordx4 v241, s[8:11], s50 offen offset:2048 lds
    v_mfma_f32_16x16x32_bf16 v[148:151], v[48:51], v[80:83], v[148:151]
    ds_read_b64_tr_b16 v[18:19], v248 offset:2048
    v_mfma_f32_16x16x32_bf16 v[152:155], v[48:51], v[84:87], v[152:155]
    ds_read_b64_tr_b16 v[20:21], v249 offset:0
    buffer_load_dwordx4 v242, s[8:11], s51 offen offset:3072 lds
    s_add_u32 s8, s8, 229376
    s_addc_u32 s9, s9, 0
    v_mfma_f32_16x16x32_bf16 v[156:159], v[48:51], v[88:91], v[156:159]
    ds_read_b64_tr_b16 v[22:23], v249 offset:2048
    v_mfma_f32_16x16x32_bf16 v[160:163], v[48:51], v[92:95], v[160:163]
    s_add_u32 m0, s35, 0
    s_nop 0
    buffer_load_dwordx4 v240, s[4:7], s28 offen offset:0 lds
    v_mfma_f32_16x16x32_bf16 v[164:167], v[52:55], v[80:83], v[164:167]
    ds_read_b64_tr_b16 v[24:25], v250 offset:0
    v_mfma_f32_16x16x32_bf16 v[168:171], v[52:55], v[84:87], v[168:171]
    ds_read_b64_tr_b16 v[26:27], v250 offset:2048
    v_mfma_f32_16x16x32_bf16 v[172:175], v[52:55], v[88:91], v[172:175]
    ds_read_b64_tr_b16 v[28:29], v251 offset:0
    v_mfma_f32_16x16x32_bf16 v[176:179], v[52:55], v[92:95], v[176:179]
    buffer_load_dwordx4 v240, s[4:7], s29 offen offset:1024 lds
    v_mfma_f32_16x16x32_bf16 v[180:183], v[56:59], v[80:83], v[180:183]
    ds_read_b64_tr_b16 v[30:31], v251 offset:2048
    v_mfma_f32_16x16x32_bf16 v[184:187], v[56:59], v[84:87], v[184:187]
    ds_read_b64_tr_b16 v[32:33], v252 offset:0
    v_mfma_f32_16x16x32_bf16 v[188:191], v[56:59], v[88:91], v[188:191]
    ds_read_b64_tr_b16 v[34:35], v252 offset:2048
    v_mfma_f32_16x16x32_bf16 v[192:195], v[56:59], v[92:95], v[192:195]
    buffer_load_dwordx4 v240, s[4:7], s30 offen offset:2048 lds
    v_mfma_f32_16x16x32_bf16 v[196:199], v[60:63], v[80:83], v[196:199]
    v_mfma_f32_16x16x32_bf16 v[200:203], v[60:63], v[84:87], v[200:203]
    v_mfma_f32_16x16x32_bf16 v[204:207], v[60:63], v[88:91], v[204:207]
    v_mfma_f32_16x16x32_bf16 v[208:211], v[60:63], v[92:95], v[208:211]
    buffer_load_dwordx4 v240, s[4:7], s31 offen offset:3072 lds
    s_add_u32 s4, s4, 128
    s_addc_u32 s5, s5, 0
    s_waitcnt vmcnt(8) lgkmcnt(0)
    s_barrier
    v_mfma_f32_16x16x32_bf16 v[100:103], v[8:11], v[64:67], v[100:103]
    ds_read_b128 v[80:83], v244 offset:16384
    v_mfma_f32_16x16x32_bf16 v[104:107], v[8:11], v[68:71], v[104:107]
    ds_read_b128 v[84:87], v244 offset:18432
    v_mfma_f32_16x16x32_bf16 v[108:111], v[8:11], v[72:75], v[108:111]
    ds_read_b128 v[88:91], v244 offset:20480
    v_mfma_f32_16x16x32_bf16 v[112:115], v[8:11], v[76:79], v[112:115]
    s_add_u32 m0, s36, 0
    s_nop 0
    buffer_load_dwordx4 v241, s[8:11], s48 offen offset:0 lds
    v_mfma_f32_16x16x32_bf16 v[116:119], v[12:15], v[64:67], v[116:119]
    ds_read_b128 v[92:95], v244 offset:22528
    v_mfma_f32_16x16x32_bf16 v[120:123], v[12:15], v[68:71], v[120:123]
    ds_read_b64_tr_b16 v[36:37], v246 offset:16384
    v_mfma_f32_16x16x32_bf16 v[124:127], v[12:15], v[72:75], v[124:127]
    ds_read_b64_tr_b16 v[38:39], v246 offset:18432
    v_mfma_f32_16x16x32_bf16 v[128:131], v[12:15], v[76:79], v[128:131]
    buffer_load_dwordx4 v242, s[8:11], s49 offen offset:1024 lds
    v_mfma_f32_16x16x32_bf16 v[132:135], v[16:19], v[64:67], v[132:135]
    ds_read_b64_tr_b16 v[40:41], v247 offset:16384
    v_mfma_f32_16x16x32_bf16 v[136:139], v[16:19], v[68:71], v[136:139]
    ds_read_b64_tr_b16 v[42:43], v247 offset:18432
    v_mfma_f32_16x16x32_bf16 v[140:143], v[16:19], v[72:75], v[140:143]
    ds_read_b64_tr_b16 v[44:45], v248 offset:16384
    v_mfma_f32_16x16x32_bf16 v[144:147], v[16:19], v[76:79], v[144:147]
    buffer_load_dwordx4 v241, s[8:11], s50 offen offset:2048 lds
    v_mfma_f32_16x16x32_bf16 v[148:151], v[20:23], v[64:67], v[148:151]
    ds_read_b64_tr_b16 v[46:47], v248 offset:18432
    v_mfma_f32_16x16x32_bf16 v[152:155], v[20:23], v[68:71], v[152:155]
    ds_read_b64_tr_b16 v[48:49], v249 offset:16384
    buffer_load_dwordx4 v242, s[8:11], s51 offen offset:3072 lds
    s_add_u32 s8, s8, 229376
    s_addc_u32 s9, s9, 0
    v_mfma_f32_16x16x32_bf16 v[156:159], v[20:23], v[72:75], v[156:159]
    ds_read_b64_tr_b16 v[50:51], v249 offset:18432
    v_mfma_f32_16x16x32_bf16 v[160:163], v[20:23], v[76:79], v[160:163]
    v_mfma_f32_16x16x32_bf16 v[164:167], v[24:27], v[64:67], v[164:167]
    ds_read_b64_tr_b16 v[52:53], v250 offset:16384
    v_mfma_f32_16x16x32_bf16 v[168:171], v[24:27], v[68:71], v[168:171]
    ds_read_b64_tr_b16 v[54:55], v250 offset:18432
    v_mfma_f32_16x16x32_bf16 v[172:175], v[24:27], v[72:75], v[172:175]
    ds_read_b64_tr_b16 v[56:57], v251 offset:16384
    v_mfma_f32_16x16x32_bf16 v[176:179], v[24:27], v[76:79], v[176:179]
    v_mfma_f32_16x16x32_bf16 v[180:183], v[28:31], v[64:67], v[180:183]
    ds_read_b64_tr_b16 v[58:59], v251 offset:18432
    v_mfma_f32_16x16x32_bf16 v[184:187], v[28:31], v[68:71], v[184:187]
    ds_read_b64_tr_b16 v[60:61], v252 offset:16384
    v_mfma_f32_16x16x32_bf16 v[188:191], v[28:31], v[72:75], v[188:191]
    ds_read_b64_tr_b16 v[62:63], v252 offset:18432
    v_mfma_f32_16x16x32_bf16 v[192:195], v[28:31], v[76:79], v[192:195]
    v_mfma_f32_16x16x32_bf16 v[196:199], v[32:35], v[64:67], v[196:199]
    v_mfma_f32_16x16x32_bf16 v[200:203], v[32:35], v[68:71], v[200:203]
    v_mfma_f32_16x16x32_bf16 v[204:207], v[32:35], v[72:75], v[204:207]
    v_mfma_f32_16x16x32_bf16 v[208:211], v[32:35], v[76:79], v[208:211]
    s_waitcnt vmcnt(4) lgkmcnt(0)
    s_barrier
    v_mfma_f32_16x16x32_bf16 v[100:103], v[36:39], v[80:83], v[100:103]
    ds_read_b128 v[64:67], v243 offset:0
    v_mfma_f32_16x16x32_bf16 v[104:107], v[36:39], v[84:87], v[104:107]
    ds_read_b128 v[68:71], v243 offset:2048
    v_mfma_f32_16x16x32_bf16 v[108:111], v[36:39], v[88:91], v[108:111]
    ds_read_b128 v[72:75], v243 offset:4096
    v_mfma_f32_16x16x32_bf16 v[112:115], v[36:39], v[92:95], v[112:115]
    s_add_u32 m0, s36, 16384
    s_nop 0
    buffer_load_dwordx4 v241, s[8:11], s48 offen offset:0 lds
    v_mfma_f32_16x16x32_bf16 v[116:119], v[40:43], v[80:83], v[116:119]
    ds_read_b128 v[76:79], v243 offset:6144
    v_mfma_f32_16x16x32_bf16 v[120:123], v[40:43], v[84:87], v[120:123]
    ds_read_b64_tr_b16 v[8:9], v246 offset:32768
    v_mfma_f32_16x16x32_bf16 v[124:127], v[40:43], v[88:91], v[124:127]
    ds_read_b64_tr_b16 v[10:11], v246 offset:34816
    v_mfma_f32_16x16x32_bf16 v[128:131], v[40:43], v[92:95], v[128:131]
    buffer_load_dwordx4 v242, s[8:11], s49 offen offset:1024 lds
    v_mfma_f32_16x16x32_bf16 v[132:135], v[44:47], v[80:83], v[132:135]
    ds_read_b64_tr_b16 v[12:13], v247 offset:32768
    v_mfma_f32_16x16x32_bf16 v[136:139], v[44:47], v[84:87], v[136:139]
    ds_read_b64_tr_b16 v[14:15], v247 offset:34816
    v_mfma_f32_16x16x32_bf16 v[140:143], v[44:47], v[88:91], v[140:143]
    ds_read_b64_tr_b16 v[16:17], v248 offset:32768
    v_mfma_f32_16x16x32_bf16 v[144:147], v[44:47], v[92:95], v[144:147]
    buffer_load_dwordx4 v241, s[8:11], s50 offen offset:2048 lds
    v_mfma_f32_16x16x32_bf16 v[148:151], v[48:51], v[80:83], v[148:151]
    ds_read_b64_tr_b16 v[18:19], v248 offset:34816
    v_mfma_f32_16x16x32_bf16 v[152:155], v[48:51], v[84:87], v[152:155]
    ds_read_b64_tr_b16 v[20:21], v249 offset:32768
    buffer_load_dwordx4 v242, s[8:11], s51 offen offset:3072 lds
    s_add_u32 s8, s8, 229376
    s_addc_u32 s9, s9, 0
    v_mfma_f32_16x16x32_bf16 v[156:159], v[48:51], v[88:91], v[156:159]
    ds_read_b64_tr_b16 v[22:23], v249 offset:34816
    v_mfma_f32_16x16x32_bf16 v[160:163], v[48:51], v[92:95], v[160:163]
    s_add_u32 m0, s35, 16384
    s_nop 0
    buffer_load_dwordx4 v240, s[4:7], s28 offen offset:0 lds
    v_mfma_f32_16x16x32_bf16 v[164:167], v[52:55], v[80:83], v[164:167]
    ds_read_b64_tr_b16 v[24:25], v250 offset:32768
    v_mfma_f32_16x16x32_bf16 v[168:171], v[52:55], v[84:87], v[168:171]
    ds_read_b64_tr_b16 v[26:27], v250 offset:34816
    v_mfma_f32_16x16x32_bf16 v[172:175], v[52:55], v[88:91], v[172:175]
    ds_read_b64_tr_b16 v[28:29], v251 offset:32768
    v_mfma_f32_16x16x32_bf16 v[176:179], v[52:55], v[92:95], v[176:179]
    buffer_load_dwordx4 v240, s[4:7], s29 offen offset:1024 lds
    v_mfma_f32_16x16x32_bf16 v[180:183], v[56:59], v[80:83], v[180:183]
    ds_read_b64_tr_b16 v[30:31], v251 offset:34816
    v_mfma_f32_16x16x32_bf16 v[184:187], v[56:59], v[84:87], v[184:187]
    ds_read_b64_tr_b16 v[32:33], v252 offset:32768
    v_mfma_f32_16x16x32_bf16 v[188:191], v[56:59], v[88:91], v[188:191]
    ds_read_b64_tr_b16 v[34:35], v252 offset:34816
    v_mfma_f32_16x16x32_bf16 v[192:195], v[56:59], v[92:95], v[192:195]
    buffer_load_dwordx4 v240, s[4:7], s30 offen offset:2048 lds
    v_mfma_f32_16x16x32_bf16 v[196:199], v[60:63], v[80:83], v[196:199]
    v_mfma_f32_16x16x32_bf16 v[200:203], v[60:63], v[84:87], v[200:203]
    v_mfma_f32_16x16x32_bf16 v[204:207], v[60:63], v[88:91], v[204:207]
    v_mfma_f32_16x16x32_bf16 v[208:211], v[60:63], v[92:95], v[208:211]
    buffer_load_dwordx4 v240, s[4:7], s31 offen offset:3072 lds
    s_add_u32 s94, s59, 3
    s_and_b32 s94, s94, 3
    s_mul_i32 s94, s94, 256
    s_add_u32 s4, s60, s94
    s_addc_u32 s5, s61, 0
    s_waitcnt vmcnt(8) lgkmcnt(0)
    s_barrier
    v_mfma_f32_16x16x32_bf16 v[100:103], v[8:11], v[64:67], v[100:103]
    ds_read_b128 v[80:83], v244 offset:0
    v_mfma_f32_16x16x32_bf16 v[104:107], v[8:11], v[68:71], v[104:107]
    ds_read_b128 v[84:87], v244 offset:2048
    v_mfma_f32_16x16x32_bf16 v[108:111], v[8:11], v[72:75], v[108:111]
    ds_read_b128 v[88:91], v244 offset:4096
    v_mfma_f32_16x16x32_bf16 v[112:115], v[8:11], v[76:79], v[112:115]
    s_add_u32 m0, s36, 32768
    s_nop 0
    buffer_load_dwordx4 v241, s[8:11], s48 offen offset:0 lds
    v_mfma_f32_16x16x32_bf16 v[116:119], v[12:15], v[64:67], v[116:119]
    ds_read_b128 v[92:95], v244 offset:6144
    v_mfma_f32_16x16x32_bf16 v[120:123], v[12:15], v[68:71], v[120:123]
    ds_read_b64_tr_b16 v[36:37], v246 offset:0
    v_mfma_f32_16x16x32_bf16 v[124:127], v[12:15], v[72:75], v[124:127]
    ds_read_b64_tr_b16 v[38:39], v246 offset:2048
    v_mfma_f32_16x16x32_bf16 v[128:131], v[12:15], v[76:79], v[128:131]
    buffer_load_dwordx4 v242, s[8:11], s49 offen offset:1024 lds
    v_mfma_f32_16x16x32_bf16 v[132:135], v[16:19], v[64:67], v[132:135]
    ds_read_b64_tr_b16 v[40:41], v247 offset:0
    v_mfma_f32_16x16x32_bf16 v[136:139], v[16:19], v[68:71], v[136:139]
    ds_read_b64_tr_b16 v[42:43], v247 offset:2048
    v_mfma_f32_16x16x32_bf16 v[140:143], v[16:19], v[72:75], v[140:143]
    ds_read_b64_tr_b16 v[44:45], v248 offset:0
    v_mfma_f32_16x16x32_bf16 v[144:147], v[16:19], v[76:79], v[144:147]
    buffer_load_dwordx4 v241, s[8:11], s50 offen offset:2048 lds
    v_mfma_f32_16x16x32_bf16 v[148:151], v[20:23], v[64:67], v[148:151]
    ds_read_b64_tr_b16 v[46:47], v248 offset:2048
    v_mfma_f32_16x16x32_bf16 v[152:155], v[20:23], v[68:71], v[152:155]
    ds_read_b64_tr_b16 v[48:49], v249 offset:0
    buffer_load_dwordx4 v242, s[8:11], s51 offen offset:3072 lds
    s_add_u32 s94, s59, 3
    s_and_b32 s94, s94, 3
    s_mul_i32 s94, s94, 917504
    s_add_u32 s8, s12, s94
    s_addc_u32 s9, s13, 0
    v_mfma_f32_16x16x32_bf16 v[156:159], v[20:23], v[72:75], v[156:159]
    ds_read_b64_tr_b16 v[50:51], v249 offset:2048
    v_mfma_f32_16x16x32_bf16 v[160:163], v[20:23], v[76:79], v[160:163]
    v_mfma_f32_16x16x32_bf16 v[164:167], v[24:27], v[64:67], v[164:167]
    ds_read_b64_tr_b16 v[52:53], v250 offset:0
    v_mfma_f32_16x16x32_bf16 v[168:171], v[24:27], v[68:71], v[168:171]
    ds_read_b64_tr_b16 v[54:55], v250 offset:2048
    v_mfma_f32_16x16x32_bf16 v[172:175], v[24:27], v[72:75], v[172:175]
    ds_read_b64_tr_b16 v[56:57], v251 offset:0
    v_mfma_f32_16x16x32_bf16 v[176:179], v[24:27], v[76:79], v[176:179]
    v_mfma_f32_16x16x32_bf16 v[180:183], v[28:31], v[64:67], v[180:183]
    ds_read_b64_tr_b16 v[58:59], v251 offset:2048
    v_mfma_f32_16x16x32_bf16 v[184:187], v[28:31], v[68:71], v[184:187]
    ds_read_b64_tr_b16 v[60:61], v252 offset:0
    v_mfma_f32_16x16x32_bf16 v[188:191], v[28:31], v[72:75], v[188:191]
    ds_read_b64_tr_b16 v[62:63], v252 offset:2048
    v_mfma_f32_16x16x32_bf16 v[192:195], v[28:31], v[76:79], v[192:195]
    v_mfma_f32_16x16x32_bf16 v[196:199], v[32:35], v[64:67], v[196:199]
    v_mfma_f32_16x16x32_bf16 v[200:203], v[32:35], v[68:71], v[200:203]
    v_mfma_f32_16x16x32_bf16 v[204:207], v[32:35], v[72:75], v[204:207]
    v_mfma_f32_16x16x32_bf16 v[208:211], v[32:35], v[76:79], v[208:211]
    s_waitcnt vmcnt(4) lgkmcnt(0)
    s_barrier
    v_mfma_f32_16x16x32_bf16 v[100:103], v[36:39], v[80:83], v[100:103]
    ds_read_b128 v[64:67], v243 offset:16384
    v_mfma_f32_16x16x32_bf16 v[104:107], v[36:39], v[84:87], v[104:107]
    ds_read_b128 v[68:71], v243 offset:18432
    v_mfma_f32_16x16x32_bf16 v[108:111], v[36:39], v[88:91], v[108:111]
    ds_read_b128 v[72:75], v243 offset:20480
    v_mfma_f32_16x16x32_bf16 v[112:115], v[36:39], v[92:95], v[112:115]
    s_add_u32 m0, s36, 0
    s_nop 0
    buffer_load_dwordx4 v241, s[8:11], s48 offen offset:0 lds
    v_mfma_f32_16x16x32_bf16 v[116:119], v[40:43], v[80:83], v[116:119]
    ds_read_b128 v[76:79], v243 offset:22528
    v_mfma_f32_16x16x32_bf16 v[120:123], v[40:43], v[84:87], v[120:123]
    ds_read_b64_tr_b16 v[8:9], v246 offset:16384
    v_mfma_f32_16x16x32_bf16 v[124:127], v[40:43], v[88:91], v[124:127]
    ds_read_b64_tr_b16 v[10:11], v246 offset:18432
    v_mfma_f32_16x16x32_bf16 v[128:131], v[40:43], v[92:95], v[128:131]
    buffer_load_dwordx4 v242, s[8:11], s49 offen offset:1024 lds
    v_mfma_f32_16x16x32_bf16 v[132:135], v[44:47], v[80:83], v[132:135]
    ds_read_b64_tr_b16 v[12:13], v247 offset:16384
    v_mfma_f32_16x16x32_bf16 v[136:139], v[44:47], v[84:87], v[136:139]
    ds_read_b64_tr_b16 v[14:15], v247 offset:18432
    v_mfma_f32_16x16x32_bf16 v[140:143], v[44:47], v[88:91], v[140:143]
    ds_read_b64_tr_b16 v[16:17], v248 offset:16384
    v_mfma_f32_16x16x32_bf16 v[144:147], v[44:47], v[92:95], v[144:147]
    buffer_load_dwordx4 v241, s[8:11], s50 offen offset:2048 lds
    v_mfma_f32_16x16x32_bf16 v[148:151], v[48:51], v[80:83], v[148:151]
    ds_read_b64_tr_b16 v[18:19], v248 offset:18432
    v_mfma_f32_16x16x32_bf16 v[152:155], v[48:51], v[84:87], v[152:155]
    ds_read_b64_tr_b16 v[20:21], v249 offset:16384
    buffer_load_dwordx4 v242, s[8:11], s51 offen offset:3072 lds
    s_add_u32 s8, s8, 229376
    s_addc_u32 s9, s9, 0
    v_mfma_f32_16x16x32_bf16 v[156:159], v[48:51], v[88:91], v[156:159]
    ds_read_b64_tr_b16 v[22:23], v249 offset:18432
    v_mfma_f32_16x16x32_bf16 v[160:163], v[48:51], v[92:95], v[160:163]
    s_add_u32 m0, s35, 0
    s_nop 0
    buffer_load_dwordx4 v240, s[4:7], s28 offen offset:0 lds
    v_mfma_f32_16x16x32_bf16 v[164:167], v[52:55], v[80:83], v[164:167]
    ds_read_b64_tr_b16 v[24:25], v250 offset:16384
    v_mfma_f32_16x16x32_bf16 v[168:171], v[52:55], v[84:87], v[168:171]
    ds_read_b64_tr_b16 v[26:27], v250 offset:18432
    v_mfma_f32_16x16x32_bf16 v[172:175], v[52:55], v[88:91], v[172:175]
    ds_read_b64_tr_b16 v[28:29], v251 offset:16384
    v_mfma_f32_16x16x32_bf16 v[176:179], v[52:55], v[92:95], v[176:179]
    buffer_load_dwordx4 v240, s[4:7], s29 offen offset:1024 lds
    v_mfma_f32_16x16x32_bf16 v[180:183], v[56:59], v[80:83], v[180:183]
    ds_read_b64_tr_b16 v[30:31], v251 offset:18432
    v_mfma_f32_16x16x32_bf16 v[184:187], v[56:59], v[84:87], v[184:187]
    ds_read_b64_tr_b16 v[32:33], v252 offset:16384
    v_mfma_f32_16x16x32_bf16 v[188:191], v[56:59], v[88:91], v[188:191]
    ds_read_b64_tr_b16 v[34:35], v252 offset:18432
    v_mfma_f32_16x16x32_bf16 v[192:195], v[56:59], v[92:95], v[192:195]
    buffer_load_dwordx4 v240, s[4:7], s30 offen offset:2048 lds
    v_mfma_f32_16x16x32_bf16 v[196:199], v[60:63], v[80:83], v[196:199]
    v_mfma_f32_16x16x32_bf16 v[200:203], v[60:63], v[84:87], v[200:203]
    v_mfma_f32_16x16x32_bf16 v[204:207], v[60:63], v[88:91], v[204:207]
    v_mfma_f32_16x16x32_bf16 v[208:211], v[60:63], v[92:95], v[208:211]
    buffer_load_dwordx4 v240, s[4:7], s31 offen offset:3072 lds
    s_add_u32 s4, s4, 128
    s_addc_u32 s5, s5, 0
    s_waitcnt vmcnt(8) lgkmcnt(0)
    s_barrier
    v_mfma_f32_16x16x32_bf16 v[100:103], v[8:11], v[64:67], v[100:103]
    ds_read_b128 v[80:83], v244 offset:16384
    v_mfma_f32_16x16x32_bf16 v[104:107], v[8:11], v[68:71], v[104:107]
    ds_read_b128 v[84:87], v244 offset:18432
    v_mfma_f32_16x16x32_bf16 v[108:111], v[8:11], v[72:75], v[108:111]
    ds_read_b128 v[88:91], v244 offset:20480
    v_mfma_f32_16x16x32_bf16 v[112:115], v[8:11], v[76:79], v[112:115]
    s_add_u32 m0, s36, 16384
    s_nop 0
    buffer_load_dwordx4 v241, s[8:11], s48 offen offset:0 lds
    v_mfma_f32_16x16x32_bf16 v[116:119], v[12:15], v[64:67], v[116:119]
    ds_read_b128 v[92:95], v244 offset:22528
    v_mfma_f32_16x16x32_bf16 v[120:123], v[12:15], v[68:71], v[120:123]
    ds_read_b64_tr_b16 v[36:37], v246 offset:32768
    v_mfma_f32_16x16x32_bf16 v[124:127], v[12:15], v[72:75], v[124:127]
    ds_read_b64_tr_b16 v[38:39], v246 offset:34816
    v_mfma_f32_16x16x32_bf16 v[128:131], v[12:15], v[76:79], v[128:131]
    buffer_load_dwordx4 v242, s[8:11], s49 offen offset:1024 lds
    v_mfma_f32_16x16x32_bf16 v[132:135], v[16:19], v[64:67], v[132:135]
    ds_read_b64_tr_b16 v[40:41], v247 offset:32768
    v_mfma_f32_16x16x32_bf16 v[136:139], v[16:19], v[68:71], v[136:139]
    ds_read_b64_tr_b16 v[42:43], v247 offset:34816
    v_mfma_f32_16x16x32_bf16 v[140:143], v[16:19], v[72:75], v[140:143]
    ds_read_b64_tr_b16 v[44:45], v248 offset:32768
    v_mfma_f32_16x16x32_bf16 v[144:147], v[16:19], v[76:79], v[144:147]
    buffer_load_dwordx4 v241, s[8:11], s50 offen offset:2048 lds
    v_mfma_f32_16x16x32_bf16 v[148:151], v[20:23], v[64:67], v[148:151]
    ds_read_b64_tr_b16 v[46:47], v248 offset:34816
    v_mfma_f32_16x16x32_bf16 v[152:155], v[20:23], v[68:71], v[152:155]
    ds_read_b64_tr_b16 v[48:49], v249 offset:32768
    buffer_load_dwordx4 v242, s[8:11], s51 offen offset:3072 lds
    s_add_u32 s8, s8, 229376
    s_addc_u32 s9, s9, 0
    v_mfma_f32_16x16x32_bf16 v[156:159], v[20:23], v[72:75], v[156:159]
    ds_read_b64_tr_b16 v[50:51], v249 offset:34816
    v_mfma_f32_16x16x32_bf16 v[160:163], v[20:23], v[76:79], v[160:163]
    v_mfma_f32_16x16x32_bf16 v[164:167], v[24:27], v[64:67], v[164:167]
    ds_read_b64_tr_b16 v[52:53], v250 offset:32768
    v_mfma_f32_16x16x32_bf16 v[168:171], v[24:27], v[68:71], v[168:171]
    ds_read_b64_tr_b16 v[54:55], v250 offset:34816
    v_mfma_f32_16x16x32_bf16 v[172:175], v[24:27], v[72:75], v[172:175]
    ds_read_b64_tr_b16 v[56:57], v251 offset:32768
    v_mfma_f32_16x16x32_bf16 v[176:179], v[24:27], v[76:79], v[176:179]
    v_mfma_f32_16x16x32_bf16 v[180:183], v[28:31], v[64:67], v[180:183]
    ds_read_b64_tr_b16 v[58:59], v251 offset:34816
    v_mfma_f32_16x16x32_bf16 v[184:187], v[28:31], v[68:71], v[184:187]
    ds_read_b64_tr_b16 v[60:61], v252 offset:32768
    v_mfma_f32_16x16x32_bf16 v[188:191], v[28:31], v[72:75], v[188:191]
    ds_read_b64_tr_b16 v[62:63], v252 offset:34816
    v_mfma_f32_16x16x32_bf16 v[192:195], v[28:31], v[76:79], v[192:195]
    v_mfma_f32_16x16x32_bf16 v[196:199], v[32:35], v[64:67], v[196:199]
    v_mfma_f32_16x16x32_bf16 v[200:203], v[32:35], v[68:71], v[200:203]
    v_mfma_f32_16x16x32_bf16 v[204:207], v[32:35], v[72:75], v[204:207]
    v_mfma_f32_16x16x32_bf16 v[208:211], v[32:35], v[76:79], v[208:211]
    s_waitcnt vmcnt(4) lgkmcnt(0)
    s_barrier
    v_mfma_f32_16x16x32_bf16 v[100:103], v[36:39], v[80:83], v[100:103]
    ds_read_b128 v[64:67], v243 offset:0
    v_mfma_f32_16x16x32_bf16 v[104:107], v[36:39], v[84:87], v[104:107]
    ds_read_b128 v[68:71], v243 offset:2048
    v_mfma_f32_16x16x32_bf16 v[108:111], v[36:39], v[88:91], v[108:111]
    ds_read_b128 v[72:75], v243 offset:4096
    v_mfma_f32_16x16x32_bf16 v[112:115], v[36:39], v[92:95], v[112:115]
    s_add_u32 m0, s36, 32768
    s_nop 0
    buffer_load_dwordx4 v241, s[8:11], s48 offen offset:0 lds
    v_mfma_f32_16x16x32_bf16 v[116:119], v[40:43], v[80:83], v[116:119]
    ds_read_b128 v[76:79], v243 offset:6144
    v_mfma_f32_16x16x32_bf16 v[120:123], v[40:43], v[84:87], v[120:123]
    ds_read_b64_tr_b16 v[8:9], v246 offset:0
    v_mfma_f32_16x16x32_bf16 v[124:127], v[40:43], v[88:91], v[124:127]
    ds_read_b64_tr_b16 v[10:11], v246 offset:2048
    v_mfma_f32_16x16x32_bf16 v[128:131], v[40:43], v[92:95], v[128:131]
    buffer_load_dwordx4 v242, s[8:11], s49 offen offset:1024 lds
    v_mfma_f32_16x16x32_bf16 v[132:135], v[44:47], v[80:83], v[132:135]
    ds_read_b64_tr_b16 v[12:13], v247 offset:0
    v_mfma_f32_16x16x32_bf16 v[136:139], v[44:47], v[84:87], v[136:139]
    ds_read_b64_tr_b16 v[14:15], v247 offset:2048
    v_mfma_f32_16x16x32_bf16 v[140:143], v[44:47], v[88:91], v[140:143]
    ds_read_b64_tr_b16 v[16:17], v248 offset:0
    v_mfma_f32_16x16x32_bf16 v[144:147], v[44:47], v[92:95], v[144:147]
    buffer_load_dwordx4 v241, s[8:11], s50 offen offset:2048 lds
    v_mfma_f32_16x16x32_bf16 v[148:151], v[48:51], v[80:83], v[148:151]
    ds_read_b64_tr_b16 v[18:19], v248 offset:2048
    v_mfma_f32_16x16x32_bf16 v[152:155], v[48:51], v[84:87], v[152:155]
    ds_read_b64_tr_b16 v[20:21], v249 offset:0
    buffer_load_dwordx4 v242, s[8:11], s51 offen offset:3072 lds
    s_add_u32 s8, s8, 229376
    s_addc_u32 s9, s9, 0
    v_mfma_f32_16x16x32_bf16 v[156:159], v[48:51], v[88:91], v[156:159]
    ds_read_b64_tr_b16 v[22:23], v249 offset:2048
    v_mfma_f32_16x16x32_bf16 v[160:163], v[48:51], v[92:95], v[160:163]
    s_add_u32 m0, s35, 16384
    s_nop 0
    buffer_load_dwordx4 v240, s[4:7], s28 offen offset:0 lds
    v_mfma_f32_16x16x32_bf16 v[164:167], v[52:55], v[80:83], v[164:167]
    ds_read_b64_tr_b16 v[24:25], v250 offset:0
    v_mfma_f32_16x16x32_bf16 v[168:171], v[52:55], v[84:87], v[168:171]
    ds_read_b64_tr_b16 v[26:27], v250 offset:2048
    v_mfma_f32_16x16x32_bf16 v[172:175], v[52:55], v[88:91], v[172:175]
    ds_read_b64_tr_b16 v[28:29], v251 offset:0
    v_mfma_f32_16x16x32_bf16 v[176:179], v[52:55], v[92:95], v[176:179]
    buffer_load_dwordx4 v240, s[4:7], s29 offen offset:1024 lds
    v_mfma_f32_16x16x32_bf16 v[180:183], v[56:59], v[80:83], v[180:183]
    ds_read_b64_tr_b16 v[30:31], v251 offset:2048
    v_mfma_f32_16x16x32_bf16 v[184:187], v[56:59], v[84:87], v[184:187]
    ds_read_b64_tr_b16 v[32:33], v252 offset:0
    v_mfma_f32_16x16x32_bf16 v[188:191], v[56:59], v[88:91], v[188:191]
    ds_read_b64_tr_b16 v[34:35], v252 offset:2048
    v_mfma_f32_16x16x32_bf16 v[192:195], v[56:59], v[92:95], v[192:195]
    buffer_load_dwordx4 v240, s[4:7], s30 offen offset:2048 lds
    v_mfma_f32_16x16x32_bf16 v[196:199], v[60:63], v[80:83], v[196:199]
    v_mfma_f32_16x16x32_bf16 v[200:203], v[60:63], v[84:87], v[200:203]
    v_mfma_f32_16x16x32_bf16 v[204:207], v[60:63], v[88:91], v[204:207]
    v_mfma_f32_16x16x32_bf16 v[208:211], v[60:63], v[92:95], v[208:211]
    buffer_load_dwordx4 v240, s[4:7], s31 offen offset:3072 lds
    s_add_u32 s94, s59, 0
    s_and_b32 s94, s94, 3
    s_add_u32 s94, s94, 4
    s_mul_i32 s94, s94, 256
    s_add_u32 s4, s60, s94
    s_addc_u32 s5, s61, 0
    s_waitcnt vmcnt(8) lgkmcnt(0)
    s_barrier
    v_mfma_f32_16x16x32_bf16 v[100:103], v[8:11], v[64:67], v[100:103]
    ds_read_b128 v[80:83], v244 offset:0
    v_mfma_f32_16x16x32_bf16 v[104:107], v[8:11], v[68:71], v[104:107]
    ds_read_b128 v[84:87], v244 offset:2048
    v_mfma_f32_16x16x32_bf16 v[108:111], v[8:11], v[72:75], v[108:111]
    ds_read_b128 v[88:91], v244 offset:4096
    v_mfma_f32_16x16x32_bf16 v[112:115], v[8:11], v[76:79], v[112:115]
    s_add_u32 m0, s36, 0
    s_nop 0
    buffer_load_dwordx4 v241, s[8:11], s48 offen offset:0 lds
    v_mfma_f32_16x16x32_bf16 v[116:119], v[12:15], v[64:67], v[116:119]
    ds_read_b128 v[92:95], v244 offset:6144
    v_mfma_f32_16x16x32_bf16 v[120:123], v[12:15], v[68:71], v[120:123]
    ds_read_b64_tr_b16 v[36:37], v246 offset:16384
    v_mfma_f32_16x16x32_bf16 v[124:127], v[12:15], v[72:75], v[124:127]
    ds_read_b64_tr_b16 v[38:39], v246 offset:18432
    v_mfma_f32_16x16x32_bf16 v[128:131], v[12:15], v[76:79], v[128:131]
    buffer_load_dwordx4 v242, s[8:11], s49 offen offset:1024 lds
    v_mfma_f32_16x16x32_bf16 v[132:135], v[16:19], v[64:67], v[132:135]
    ds_read_b64_tr_b16 v[40:41], v247 offset:16384
    v_mfma_f32_16x16x32_bf16 v[136:139], v[16:19], v[68:71], v[136:139]
    ds_read_b64_tr_b16 v[42:43], v247 offset:18432
    v_mfma_f32_16x16x32_bf16 v[140:143], v[16:19], v[72:75], v[140:143]
    ds_read_b64_tr_b16 v[44:45], v248 offset:16384
    v_mfma_f32_16x16x32_bf16 v[144:147], v[16:19], v[76:79], v[144:147]
    buffer_load_dwordx4 v241, s[8:11], s50 offen offset:2048 lds
    v_mfma_f32_16x16x32_bf16 v[148:151], v[20:23], v[64:67], v[148:151]
    ds_read_b64_tr_b16 v[46:47], v248 offset:18432
    v_mfma_f32_16x16x32_bf16 v[152:155], v[20:23], v[68:71], v[152:155]
    ds_read_b64_tr_b16 v[48:49], v249 offset:16384
    buffer_load_dwordx4 v242, s[8:11], s51 offen offset:3072 lds
    s_add_u32 s94, s59, 0
    s_and_b32 s94, s94, 3
    s_add_u32 s94, s94, 4
    s_mul_i32 s94, s94, 917504
    s_add_u32 s8, s12, s94
    s_addc_u32 s9, s13, 0
    v_mfma_f32_16x16x32_bf16 v[156:159], v[20:23], v[72:75], v[156:159]
    ds_read_b64_tr_b16 v[50:51], v249 offset:18432
    v_mfma_f32_16x16x32_bf16 v[160:163], v[20:23], v[76:79], v[160:163]
    v_mfma_f32_16x16x32_bf16 v[164:167], v[24:27], v[64:67], v[164:167]
    ds_read_b64_tr_b16 v[52:53], v250 offset:16384
    v_mfma_f32_16x16x32_bf16 v[168:171], v[24:27], v[68:71], v[168:171]
    ds_read_b64_tr_b16 v[54:55], v250 offset:18432
    v_mfma_f32_16x16x32_bf16 v[172:175], v[24:27], v[72:75], v[172:175]
    ds_read_b64_tr_b16 v[56:57], v251 offset:16384
    v_mfma_f32_16x16x32_bf16 v[176:179], v[24:27], v[76:79], v[176:179]
    v_mfma_f32_16x16x32_bf16 v[180:183], v[28:31], v[64:67], v[180:183]
    ds_read_b64_tr_b16 v[58:59], v251 offset:18432
    v_mfma_f32_16x16x32_bf16 v[184:187], v[28:31], v[68:71], v[184:187]
    ds_read_b64_tr_b16 v[60:61], v252 offset:16384
    v_mfma_f32_16x16x32_bf16 v[188:191], v[28:31], v[72:75], v[188:191]
    ds_read_b64_tr_b16 v[62:63], v252 offset:18432
    v_mfma_f32_16x16x32_bf16 v[192:195], v[28:31], v[76:79], v[192:195]
    v_mfma_f32_16x16x32_bf16 v[196:199], v[32:35], v[64:67], v[196:199]
    v_mfma_f32_16x16x32_bf16 v[200:203], v[32:35], v[68:71], v[200:203]
    v_mfma_f32_16x16x32_bf16 v[204:207], v[32:35], v[72:75], v[204:207]
    v_mfma_f32_16x16x32_bf16 v[208:211], v[32:35], v[76:79], v[208:211]
    s_waitcnt vmcnt(4) lgkmcnt(0)
    s_barrier
    v_mfma_f32_16x16x32_bf16 v[100:103], v[36:39], v[80:83], v[100:103]
    ds_read_b128 v[64:67], v243 offset:16384
    v_mfma_f32_16x16x32_bf16 v[104:107], v[36:39], v[84:87], v[104:107]
    ds_read_b128 v[68:71], v243 offset:18432
    v_mfma_f32_16x16x32_bf16 v[108:111], v[36:39], v[88:91], v[108:111]
    ds_read_b128 v[72:75], v243 offset:20480
    v_mfma_f32_16x16x32_bf16 v[112:115], v[36:39], v[92:95], v[112:115]
    s_add_u32 m0, s36, 16384
    s_nop 0
    buffer_load_dwordx4 v241, s[8:11], s48 offen offset:0 lds
    v_mfma_f32_16x16x32_bf16 v[116:119], v[40:43], v[80:83], v[116:119]
    ds_read_b128 v[76:79], v243 offset:22528
    v_mfma_f32_16x16x32_bf16 v[120:123], v[40:43], v[84:87], v[120:123]
    ds_read_b64_tr_b16 v[8:9], v246 offset:32768
    v_mfma_f32_16x16x32_bf16 v[124:127], v[40:43], v[88:91], v[124:127]
    ds_read_b64_tr_b16 v[10:11], v246 offset:34816
    v_mfma_f32_16x16x32_bf16 v[128:131], v[40:43], v[92:95], v[128:131]
    buffer_load_dwordx4 v242, s[8:11], s49 offen offset:1024 lds
    v_mfma_f32_16x16x32_bf16 v[132:135], v[44:47], v[80:83], v[132:135]
    ds_read_b64_tr_b16 v[12:13], v247 offset:32768
    v_mfma_f32_16x16x32_bf16 v[136:139], v[44:47], v[84:87], v[136:139]
    ds_read_b64_tr_b16 v[14:15], v247 offset:34816
    v_mfma_f32_16x16x32_bf16 v[140:143], v[44:47], v[88:91], v[140:143]
    ds_read_b64_tr_b16 v[16:17], v248 offset:32768
    v_mfma_f32_16x16x32_bf16 v[144:147], v[44:47], v[92:95], v[144:147]
    buffer_load_dwordx4 v241, s[8:11], s50 offen offset:2048 lds
    v_mfma_f32_16x16x32_bf16 v[148:151], v[48:51], v[80:83], v[148:151]
    ds_read_b64_tr_b16 v[18:19], v248 offset:34816
    v_mfma_f32_16x16x32_bf16 v[152:155], v[48:51], v[84:87], v[152:155]
    ds_read_b64_tr_b16 v[20:21], v249 offset:32768
    buffer_load_dwordx4 v242, s[8:11], s51 offen offset:3072 lds
    s_add_u32 s8, s8, 229376
    s_addc_u32 s9, s9, 0
    v_mfma_f32_16x16x32_bf16 v[156:159], v[48:51], v[88:91], v[156:159]
    ds_read_b64_tr_b16 v[22:23], v249 offset:34816
    v_mfma_f32_16x16x32_bf16 v[160:163], v[48:51], v[92:95], v[160:163]
    s_add_u32 m0, s35, 0
    s_nop 0
    buffer_load_dwordx4 v240, s[4:7], s28 offen offset:0 lds
    v_mfma_f32_16x16x32_bf16 v[164:167], v[52:55], v[80:83], v[164:167]
    ds_read_b64_tr_b16 v[24:25], v250 offset:32768
    v_mfma_f32_16x16x32_bf16 v[168:171], v[52:55], v[84:87], v[168:171]
    ds_read_b64_tr_b16 v[26:27], v250 offset:34816
    v_mfma_f32_16x16x32_bf16 v[172:175], v[52:55], v[88:91], v[172:175]
    ds_read_b64_tr_b16 v[28:29], v251 offset:32768
    v_mfma_f32_16x16x32_bf16 v[176:179], v[52:55], v[92:95], v[176:179]
    buffer_load_dwordx4 v240, s[4:7], s29 offen offset:1024 lds
    v_mfma_f32_16x16x32_bf16 v[180:183], v[56:59], v[80:83], v[180:183]
    ds_read_b64_tr_b16 v[30:31], v251 offset:34816
    v_mfma_f32_16x16x32_bf16 v[184:187], v[56:59], v[84:87], v[184:187]
    ds_read_b64_tr_b16 v[32:33], v252 offset:32768
    v_mfma_f32_16x16x32_bf16 v[188:191], v[56:59], v[88:91], v[188:191]
    ds_read_b64_tr_b16 v[34:35], v252 offset:34816
    v_mfma_f32_16x16x32_bf16 v[192:195], v[56:59], v[92:95], v[192:195]
    buffer_load_dwordx4 v240, s[4:7], s30 offen offset:2048 lds
    v_mfma_f32_16x16x32_bf16 v[196:199], v[60:63], v[80:83], v[196:199]
    v_mfma_f32_16x16x32_bf16 v[200:203], v[60:63], v[84:87], v[200:203]
    v_mfma_f32_16x16x32_bf16 v[204:207], v[60:63], v[88:91], v[204:207]
    v_mfma_f32_16x16x32_bf16 v[208:211], v[60:63], v[92:95], v[208:211]
    buffer_load_dwordx4 v240, s[4:7], s31 offen offset:3072 lds
    s_add_u32 s4, s4, 128
    s_addc_u32 s5, s5, 0
    s_waitcnt vmcnt(8) lgkmcnt(0)
    s_barrier
    v_mfma_f32_16x16x32_bf16 v[100:103], v[8:11], v[64:67], v[100:103]
    ds_read_b128 v[80:83], v244 offset:16384
    v_mfma_f32_16x16x32_bf16 v[104:107], v[8:11], v[68:71], v[104:107]
    ds_read_b128 v[84:87], v244 offset:18432
    v_mfma_f32_16x16x32_bf16 v[108:111], v[8:11], v[72:75], v[108:111]
    ds_read_b128 v[88:91], v244 offset:20480
    v_mfma_f32_16x16x32_bf16 v[112:115], v[8:11], v[76:79], v[112:115]
    s_add_u32 m0, s36, 32768
    s_nop 0
    buffer_load_dwordx4 v241, s[8:11], s48 offen offset:0 lds
    v_mfma_f32_16x16x32_bf16 v[116:119], v[12:15], v[64:67], v[116:119]
    ds_read_b128 v[92:95], v244 offset:22528
    v_mfma_f32_16x16x32_bf16 v[120:123], v[12:15], v[68:71], v[120:123]
    ds_read_b64_tr_b16 v[36:37], v246 offset:0
    v_mfma_f32_16x16x32_bf16 v[124:127], v[12:15], v[72:75], v[124:127]
    ds_read_b64_tr_b16 v[38:39], v246 offset:2048
    v_mfma_f32_16x16x32_bf16 v[128:131], v[12:15], v[76:79], v[128:131]
    buffer_load_dwordx4 v242, s[8:11], s49 offen offset:1024 lds
    v_mfma_f32_16x16x32_bf16 v[132:135], v[16:19], v[64:67], v[132:135]
    ds_read_b64_tr_b16 v[40:41], v247 offset:0
    v_mfma_f32_16x16x32_bf16 v[136:139], v[16:19], v[68:71], v[136:139]
    ds_read_b64_tr_b16 v[42:43], v247 offset:2048
    v_mfma_f32_16x16x32_bf16 v[140:143], v[16:19], v[72:75], v[140:143]
    ds_read_b64_tr_b16 v[44:45], v248 offset:0
    v_mfma_f32_16x16x32_bf16 v[144:147], v[16:19], v[76:79], v[144:147]
    buffer_load_dwordx4 v241, s[8:11], s50 offen offset:2048 lds
    v_mfma_f32_16x16x32_bf16 v[148:151], v[20:23], v[64:67], v[148:151]
    ds_read_b64_tr_b16 v[46:47], v248 offset:2048
    v_mfma_f32_16x16x32_bf16 v[152:155], v[20:23], v[68:71], v[152:155]
    ds_read_b64_tr_b16 v[48:49], v249 offset:0
    buffer_load_dwordx4 v242, s[8:11], s51 offen offset:3072 lds
    s_add_u32 s8, s8, 229376
    s_addc_u32 s9, s9, 0
    v_mfma_f32_16x16x32_bf16 v[156:159], v[20:23], v[72:75], v[156:159]
    ds_read_b64_tr_b16 v[50:51], v249 offset:2048
    v_mfma_f32_16x16x32_bf16 v[160:163], v[20:23], v[76:79], v[160:163]
    v_mfma_f32_16x16x32_bf16 v[164:167], v[24:27], v[64:67], v[164:167]
    ds_read_b64_tr_b16 v[52:53], v250 offset:0
    v_mfma_f32_16x16x32_bf16 v[168:171], v[24:27], v[68:71], v[168:171]
    ds_read_b64_tr_b16 v[54:55], v250 offset:2048
    v_mfma_f32_16x16x32_bf16 v[172:175], v[24:27], v[72:75], v[172:175]
    ds_read_b64_tr_b16 v[56:57], v251 offset:0
    v_mfma_f32_16x16x32_bf16 v[176:179], v[24:27], v[76:79], v[176:179]
    v_mfma_f32_16x16x32_bf16 v[180:183], v[28:31], v[64:67], v[180:183]
    ds_read_b64_tr_b16 v[58:59], v251 offset:2048
    v_mfma_f32_16x16x32_bf16 v[184:187], v[28:31], v[68:71], v[184:187]
    ds_read_b64_tr_b16 v[60:61], v252 offset:0
    v_mfma_f32_16x16x32_bf16 v[188:191], v[28:31], v[72:75], v[188:191]
    ds_read_b64_tr_b16 v[62:63], v252 offset:2048
    v_mfma_f32_16x16x32_bf16 v[192:195], v[28:31], v[76:79], v[192:195]
    v_mfma_f32_16x16x32_bf16 v[196:199], v[32:35], v[64:67], v[196:199]
    v_mfma_f32_16x16x32_bf16 v[200:203], v[32:35], v[68:71], v[200:203]
    v_mfma_f32_16x16x32_bf16 v[204:207], v[32:35], v[72:75], v[204:207]
    v_mfma_f32_16x16x32_bf16 v[208:211], v[32:35], v[76:79], v[208:211]
    s_waitcnt vmcnt(4) lgkmcnt(0)
    s_barrier
    v_mfma_f32_16x16x32_bf16 v[100:103], v[36:39], v[80:83], v[100:103]
    ds_read_b128 v[64:67], v243 offset:0
    v_mfma_f32_16x16x32_bf16 v[104:107], v[36:39], v[84:87], v[104:107]
    ds_read_b128 v[68:71], v243 offset:2048
    v_mfma_f32_16x16x32_bf16 v[108:111], v[36:39], v[88:91], v[108:111]
    ds_read_b128 v[72:75], v243 offset:4096
    v_mfma_f32_16x16x32_bf16 v[112:115], v[36:39], v[92:95], v[112:115]
    s_add_u32 m0, s36, 0
    s_nop 0
    buffer_load_dwordx4 v241, s[8:11], s48 offen offset:0 lds
    v_mfma_f32_16x16x32_bf16 v[116:119], v[40:43], v[80:83], v[116:119]
    ds_read_b128 v[76:79], v243 offset:6144
    v_mfma_f32_16x16x32_bf16 v[120:123], v[40:43], v[84:87], v[120:123]
    ds_read_b64_tr_b16 v[8:9], v246 offset:16384
    v_mfma_f32_16x16x32_bf16 v[124:127], v[40:43], v[88:91], v[124:127]
    ds_read_b64_tr_b16 v[10:11], v246 offset:18432
    v_mfma_f32_16x16x32_bf16 v[128:131], v[40:43], v[92:95], v[128:131]
    buffer_load_dwordx4 v242, s[8:11], s49 offen offset:1024 lds
    v_mfma_f32_16x16x32_bf16 v[132:135], v[44:47], v[80:83], v[132:135]
    ds_read_b64_tr_b16 v[12:13], v247 offset:16384
    v_mfma_f32_16x16x32_bf16 v[136:139], v[44:47], v[84:87], v[136:139]
    ds_read_b64_tr_b16 v[14:15], v247 offset:18432
    v_mfma_f32_16x16x32_bf16 v[140:143], v[44:47], v[88:91], v[140:143]
    ds_read_b64_tr_b16 v[16:17], v248 offset:16384
    v_mfma_f32_16x16x32_bf16 v[144:147], v[44:47], v[92:95], v[144:147]
    buffer_load_dwordx4 v241, s[8:11], s50 offen offset:2048 lds
    v_mfma_f32_16x16x32_bf16 v[148:151], v[48:51], v[80:83], v[148:151]
    ds_read_b64_tr_b16 v[18:19], v248 offset:18432
    v_mfma_f32_16x16x32_bf16 v[152:155], v[48:51], v[84:87], v[152:155]
    ds_read_b64_tr_b16 v[20:21], v249 offset:16384
    buffer_load_dwordx4 v242, s[8:11], s51 offen offset:3072 lds
    s_add_u32 s8, s8, 229376
    s_addc_u32 s9, s9, 0
    v_mfma_f32_16x16x32_bf16 v[156:159], v[48:51], v[88:91], v[156:159]
    ds_read_b64_tr_b16 v[22:23], v249 offset:18432
    v_mfma_f32_16x16x32_bf16 v[160:163], v[48:51], v[92:95], v[160:163]
    s_add_u32 m0, s35, 16384
    s_nop 0
    buffer_load_dwordx4 v240, s[4:7], s28 offen offset:0 lds
    v_mfma_f32_16x16x32_bf16 v[164:167], v[52:55], v[80:83], v[164:167]
    ds_read_b64_tr_b16 v[24:25], v250 offset:16384
    v_mfma_f32_16x16x32_bf16 v[168:171], v[52:55], v[84:87], v[168:171]
    ds_read_b64_tr_b16 v[26:27], v250 offset:18432
    v_mfma_f32_16x16x32_bf16 v[172:175], v[52:55], v[88:91], v[172:175]
    ds_read_b64_tr_b16 v[28:29], v251 offset:16384
    v_mfma_f32_16x16x32_bf16 v[176:179], v[52:55], v[92:95], v[176:179]
    buffer_load_dwordx4 v240, s[4:7], s29 offen offset:1024 lds
    v_mfma_f32_16x16x32_bf16 v[180:183], v[56:59], v[80:83], v[180:183]
    ds_read_b64_tr_b16 v[30:31], v251 offset:18432
    v_mfma_f32_16x16x32_bf16 v[184:187], v[56:59], v[84:87], v[184:187]
    ds_read_b64_tr_b16 v[32:33], v252 offset:16384
    v_mfma_f32_16x16x32_bf16 v[188:191], v[56:59], v[88:91], v[188:191]
    ds_read_b64_tr_b16 v[34:35], v252 offset:18432
    v_mfma_f32_16x16x32_bf16 v[192:195], v[56:59], v[92:95], v[192:195]
    buffer_load_dwordx4 v240, s[4:7], s30 offen offset:2048 lds
    v_mfma_f32_16x16x32_bf16 v[196:199], v[60:63], v[80:83], v[196:199]
    v_mfma_f32_16x16x32_bf16 v[200:203], v[60:63], v[84:87], v[200:203]
    v_mfma_f32_16x16x32_bf16 v[204:207], v[60:63], v[88:91], v[204:207]
    v_mfma_f32_16x16x32_bf16 v[208:211], v[60:63], v[92:95], v[208:211]
    buffer_load_dwordx4 v240, s[4:7], s31 offen offset:3072 lds
    s_add_u32 s94, s59, 1
    s_and_b32 s94, s94, 3
    s_add_u32 s94, s94, 4
    s_mul_i32 s94, s94, 256
    s_add_u32 s4, s60, s94
    s_addc_u32 s5, s61, 0
    s_waitcnt vmcnt(8) lgkmcnt(0)
    s_barrier
    s_cmp_lg_u32 s86, 0
    s_cbranch_scc1 gated_mix__grouped_kv_mqa__dense_activation_mish__prompt_kernel_b1_ec
    s_mov_b32 s52, s82
    s_mov_b32 s53, s83
    s_mov_b32 s54, 0x100
    s_mov_b32 s55, 0x00020000
    s_and_b32 s97, s2, 1
    s_lshl_b32 s97, s97, 7
    v_mov_b32 v4, s97
    buffer_load_dword v253, v4, s[52:55], 0 offen sc1
gated_mix__grouped_kv_mqa__dense_activation_mish__prompt_kernel_b1_ec:
    v_mfma_f32_16x16x32_bf16 v[100:103], v[8:11], v[64:67], v[100:103]
    ds_read_b128 v[80:83], v244 offset:0
    v_mfma_f32_16x16x32_bf16 v[104:107], v[8:11], v[68:71], v[104:107]
    ds_read_b128 v[84:87], v244 offset:2048
    v_mfma_f32_16x16x32_bf16 v[108:111], v[8:11], v[72:75], v[108:111]
    ds_read_b128 v[88:91], v244 offset:4096
    v_mfma_f32_16x16x32_bf16 v[112:115], v[8:11], v[76:79], v[112:115]
    s_add_u32 m0, s36, 16384
    s_nop 0
    buffer_load_dwordx4 v241, s[8:11], s48 offen offset:0 lds
    v_mfma_f32_16x16x32_bf16 v[116:119], v[12:15], v[64:67], v[116:119]
    ds_read_b128 v[92:95], v244 offset:6144
    v_mfma_f32_16x16x32_bf16 v[120:123], v[12:15], v[68:71], v[120:123]
    ds_read_b64_tr_b16 v[36:37], v246 offset:32768
    v_mfma_f32_16x16x32_bf16 v[124:127], v[12:15], v[72:75], v[124:127]
    ds_read_b64_tr_b16 v[38:39], v246 offset:34816
    v_mfma_f32_16x16x32_bf16 v[128:131], v[12:15], v[76:79], v[128:131]
    buffer_load_dwordx4 v242, s[8:11], s49 offen offset:1024 lds
    v_mfma_f32_16x16x32_bf16 v[132:135], v[16:19], v[64:67], v[132:135]
    ds_read_b64_tr_b16 v[40:41], v247 offset:32768
    v_mfma_f32_16x16x32_bf16 v[136:139], v[16:19], v[68:71], v[136:139]
    ds_read_b64_tr_b16 v[42:43], v247 offset:34816
    v_mfma_f32_16x16x32_bf16 v[140:143], v[16:19], v[72:75], v[140:143]
    ds_read_b64_tr_b16 v[44:45], v248 offset:32768
    v_mfma_f32_16x16x32_bf16 v[144:147], v[16:19], v[76:79], v[144:147]
    buffer_load_dwordx4 v241, s[8:11], s50 offen offset:2048 lds
    v_mfma_f32_16x16x32_bf16 v[148:151], v[20:23], v[64:67], v[148:151]
    ds_read_b64_tr_b16 v[46:47], v248 offset:34816
    v_mfma_f32_16x16x32_bf16 v[152:155], v[20:23], v[68:71], v[152:155]
    ds_read_b64_tr_b16 v[48:49], v249 offset:32768
    buffer_load_dwordx4 v242, s[8:11], s51 offen offset:3072 lds
    s_add_u32 s94, s59, 1
    s_and_b32 s94, s94, 3
    s_add_u32 s94, s94, 4
    s_mul_i32 s94, s94, 917504
    s_add_u32 s8, s12, s94
    s_addc_u32 s9, s13, 0
    v_mfma_f32_16x16x32_bf16 v[156:159], v[20:23], v[72:75], v[156:159]
    ds_read_b64_tr_b16 v[50:51], v249 offset:34816
    v_mfma_f32_16x16x32_bf16 v[160:163], v[20:23], v[76:79], v[160:163]
    v_mfma_f32_16x16x32_bf16 v[164:167], v[24:27], v[64:67], v[164:167]
    ds_read_b64_tr_b16 v[52:53], v250 offset:32768
    v_mfma_f32_16x16x32_bf16 v[168:171], v[24:27], v[68:71], v[168:171]
    ds_read_b64_tr_b16 v[54:55], v250 offset:34816
    v_mfma_f32_16x16x32_bf16 v[172:175], v[24:27], v[72:75], v[172:175]
    ds_read_b64_tr_b16 v[56:57], v251 offset:32768
    v_mfma_f32_16x16x32_bf16 v[176:179], v[24:27], v[76:79], v[176:179]
    v_mfma_f32_16x16x32_bf16 v[180:183], v[28:31], v[64:67], v[180:183]
    ds_read_b64_tr_b16 v[58:59], v251 offset:34816
    v_mfma_f32_16x16x32_bf16 v[184:187], v[28:31], v[68:71], v[184:187]
    ds_read_b64_tr_b16 v[60:61], v252 offset:32768
    v_mfma_f32_16x16x32_bf16 v[188:191], v[28:31], v[72:75], v[188:191]
    ds_read_b64_tr_b16 v[62:63], v252 offset:34816
    v_mfma_f32_16x16x32_bf16 v[192:195], v[28:31], v[76:79], v[192:195]
    v_mfma_f32_16x16x32_bf16 v[196:199], v[32:35], v[64:67], v[196:199]
    v_mfma_f32_16x16x32_bf16 v[200:203], v[32:35], v[68:71], v[200:203]
    v_mfma_f32_16x16x32_bf16 v[204:207], v[32:35], v[72:75], v[204:207]
    v_mfma_f32_16x16x32_bf16 v[208:211], v[32:35], v[76:79], v[208:211]
    s_waitcnt vmcnt(4) lgkmcnt(0)
    s_barrier
    v_mfma_f32_16x16x32_bf16 v[100:103], v[36:39], v[80:83], v[100:103]
    ds_read_b128 v[64:67], v243 offset:16384
    v_mfma_f32_16x16x32_bf16 v[104:107], v[36:39], v[84:87], v[104:107]
    ds_read_b128 v[68:71], v243 offset:18432
    v_mfma_f32_16x16x32_bf16 v[108:111], v[36:39], v[88:91], v[108:111]
    ds_read_b128 v[72:75], v243 offset:20480
    v_mfma_f32_16x16x32_bf16 v[112:115], v[36:39], v[92:95], v[112:115]
    s_add_u32 m0, s36, 32768
    s_nop 0
    buffer_load_dwordx4 v241, s[8:11], s48 offen offset:0 lds
    v_mfma_f32_16x16x32_bf16 v[116:119], v[40:43], v[80:83], v[116:119]
    ds_read_b128 v[76:79], v243 offset:22528
    v_mfma_f32_16x16x32_bf16 v[120:123], v[40:43], v[84:87], v[120:123]
    ds_read_b64_tr_b16 v[8:9], v246 offset:0
    v_mfma_f32_16x16x32_bf16 v[124:127], v[40:43], v[88:91], v[124:127]
    ds_read_b64_tr_b16 v[10:11], v246 offset:2048
    v_mfma_f32_16x16x32_bf16 v[128:131], v[40:43], v[92:95], v[128:131]
    buffer_load_dwordx4 v242, s[8:11], s49 offen offset:1024 lds
    v_mfma_f32_16x16x32_bf16 v[132:135], v[44:47], v[80:83], v[132:135]
    ds_read_b64_tr_b16 v[12:13], v247 offset:0
    v_mfma_f32_16x16x32_bf16 v[136:139], v[44:47], v[84:87], v[136:139]
    ds_read_b64_tr_b16 v[14:15], v247 offset:2048
    v_mfma_f32_16x16x32_bf16 v[140:143], v[44:47], v[88:91], v[140:143]
    ds_read_b64_tr_b16 v[16:17], v248 offset:0
    v_mfma_f32_16x16x32_bf16 v[144:147], v[44:47], v[92:95], v[144:147]
    buffer_load_dwordx4 v241, s[8:11], s50 offen offset:2048 lds
    v_mfma_f32_16x16x32_bf16 v[148:151], v[48:51], v[80:83], v[148:151]
    ds_read_b64_tr_b16 v[18:19], v248 offset:2048
    v_mfma_f32_16x16x32_bf16 v[152:155], v[48:51], v[84:87], v[152:155]
    ds_read_b64_tr_b16 v[20:21], v249 offset:0
    buffer_load_dwordx4 v242, s[8:11], s51 offen offset:3072 lds
    s_add_u32 s8, s8, 229376
    s_addc_u32 s9, s9, 0
    v_mfma_f32_16x16x32_bf16 v[156:159], v[48:51], v[88:91], v[156:159]
    ds_read_b64_tr_b16 v[22:23], v249 offset:2048
    v_mfma_f32_16x16x32_bf16 v[160:163], v[48:51], v[92:95], v[160:163]
    s_add_u32 m0, s35, 0
    s_nop 0
    buffer_load_dwordx4 v240, s[4:7], s28 offen offset:0 lds
    v_mfma_f32_16x16x32_bf16 v[164:167], v[52:55], v[80:83], v[164:167]
    ds_read_b64_tr_b16 v[24:25], v250 offset:0
    v_mfma_f32_16x16x32_bf16 v[168:171], v[52:55], v[84:87], v[168:171]
    ds_read_b64_tr_b16 v[26:27], v250 offset:2048
    v_mfma_f32_16x16x32_bf16 v[172:175], v[52:55], v[88:91], v[172:175]
    ds_read_b64_tr_b16 v[28:29], v251 offset:0
    v_mfma_f32_16x16x32_bf16 v[176:179], v[52:55], v[92:95], v[176:179]
    buffer_load_dwordx4 v240, s[4:7], s29 offen offset:1024 lds
    v_mfma_f32_16x16x32_bf16 v[180:183], v[56:59], v[80:83], v[180:183]
    ds_read_b64_tr_b16 v[30:31], v251 offset:2048
    v_mfma_f32_16x16x32_bf16 v[184:187], v[56:59], v[84:87], v[184:187]
    ds_read_b64_tr_b16 v[32:33], v252 offset:0
    v_mfma_f32_16x16x32_bf16 v[188:191], v[56:59], v[88:91], v[188:191]
    ds_read_b64_tr_b16 v[34:35], v252 offset:2048
    v_mfma_f32_16x16x32_bf16 v[192:195], v[56:59], v[92:95], v[192:195]
    buffer_load_dwordx4 v240, s[4:7], s30 offen offset:2048 lds
    v_mfma_f32_16x16x32_bf16 v[196:199], v[60:63], v[80:83], v[196:199]
    v_mfma_f32_16x16x32_bf16 v[200:203], v[60:63], v[84:87], v[200:203]
    v_mfma_f32_16x16x32_bf16 v[204:207], v[60:63], v[88:91], v[204:207]
    v_mfma_f32_16x16x32_bf16 v[208:211], v[60:63], v[92:95], v[208:211]
    buffer_load_dwordx4 v240, s[4:7], s31 offen offset:3072 lds
    s_add_u32 s4, s4, 128
    s_addc_u32 s5, s5, 0
    s_waitcnt vmcnt(8) lgkmcnt(0)
    s_barrier
    v_mfma_f32_16x16x32_bf16 v[100:103], v[8:11], v[64:67], v[100:103]
    ds_read_b128 v[80:83], v244 offset:16384
    v_mfma_f32_16x16x32_bf16 v[104:107], v[8:11], v[68:71], v[104:107]
    ds_read_b128 v[84:87], v244 offset:18432
    v_mfma_f32_16x16x32_bf16 v[108:111], v[8:11], v[72:75], v[108:111]
    ds_read_b128 v[88:91], v244 offset:20480
    v_mfma_f32_16x16x32_bf16 v[112:115], v[8:11], v[76:79], v[112:115]
    s_add_u32 m0, s36, 0
    s_nop 0
    buffer_load_dwordx4 v241, s[8:11], s48 offen offset:0 lds
    v_mfma_f32_16x16x32_bf16 v[116:119], v[12:15], v[64:67], v[116:119]
    ds_read_b128 v[92:95], v244 offset:22528
    v_mfma_f32_16x16x32_bf16 v[120:123], v[12:15], v[68:71], v[120:123]
    ds_read_b64_tr_b16 v[36:37], v246 offset:16384
    v_mfma_f32_16x16x32_bf16 v[124:127], v[12:15], v[72:75], v[124:127]
    ds_read_b64_tr_b16 v[38:39], v246 offset:18432
    v_mfma_f32_16x16x32_bf16 v[128:131], v[12:15], v[76:79], v[128:131]
    buffer_load_dwordx4 v242, s[8:11], s49 offen offset:1024 lds
    v_mfma_f32_16x16x32_bf16 v[132:135], v[16:19], v[64:67], v[132:135]
    ds_read_b64_tr_b16 v[40:41], v247 offset:16384
    v_mfma_f32_16x16x32_bf16 v[136:139], v[16:19], v[68:71], v[136:139]
    ds_read_b64_tr_b16 v[42:43], v247 offset:18432
    v_mfma_f32_16x16x32_bf16 v[140:143], v[16:19], v[72:75], v[140:143]
    ds_read_b64_tr_b16 v[44:45], v248 offset:16384
    v_mfma_f32_16x16x32_bf16 v[144:147], v[16:19], v[76:79], v[144:147]
    buffer_load_dwordx4 v241, s[8:11], s50 offen offset:2048 lds
    v_mfma_f32_16x16x32_bf16 v[148:151], v[20:23], v[64:67], v[148:151]
    ds_read_b64_tr_b16 v[46:47], v248 offset:18432
    v_mfma_f32_16x16x32_bf16 v[152:155], v[20:23], v[68:71], v[152:155]
    ds_read_b64_tr_b16 v[48:49], v249 offset:16384
    buffer_load_dwordx4 v242, s[8:11], s51 offen offset:3072 lds
    s_add_u32 s8, s8, 229376
    s_addc_u32 s9, s9, 0
    v_mfma_f32_16x16x32_bf16 v[156:159], v[20:23], v[72:75], v[156:159]
    ds_read_b64_tr_b16 v[50:51], v249 offset:18432
    v_mfma_f32_16x16x32_bf16 v[160:163], v[20:23], v[76:79], v[160:163]
    v_mfma_f32_16x16x32_bf16 v[164:167], v[24:27], v[64:67], v[164:167]
    ds_read_b64_tr_b16 v[52:53], v250 offset:16384
    v_mfma_f32_16x16x32_bf16 v[168:171], v[24:27], v[68:71], v[168:171]
    ds_read_b64_tr_b16 v[54:55], v250 offset:18432
    v_mfma_f32_16x16x32_bf16 v[172:175], v[24:27], v[72:75], v[172:175]
    ds_read_b64_tr_b16 v[56:57], v251 offset:16384
    v_mfma_f32_16x16x32_bf16 v[176:179], v[24:27], v[76:79], v[176:179]
    v_mfma_f32_16x16x32_bf16 v[180:183], v[28:31], v[64:67], v[180:183]
    ds_read_b64_tr_b16 v[58:59], v251 offset:18432
    v_mfma_f32_16x16x32_bf16 v[184:187], v[28:31], v[68:71], v[184:187]
    ds_read_b64_tr_b16 v[60:61], v252 offset:16384
    v_mfma_f32_16x16x32_bf16 v[188:191], v[28:31], v[72:75], v[188:191]
    ds_read_b64_tr_b16 v[62:63], v252 offset:18432
    v_mfma_f32_16x16x32_bf16 v[192:195], v[28:31], v[76:79], v[192:195]
    v_mfma_f32_16x16x32_bf16 v[196:199], v[32:35], v[64:67], v[196:199]
    v_mfma_f32_16x16x32_bf16 v[200:203], v[32:35], v[68:71], v[200:203]
    v_mfma_f32_16x16x32_bf16 v[204:207], v[32:35], v[72:75], v[204:207]
    v_mfma_f32_16x16x32_bf16 v[208:211], v[32:35], v[76:79], v[208:211]
    s_waitcnt vmcnt(4) lgkmcnt(0)
    s_barrier
    v_mfma_f32_16x16x32_bf16 v[100:103], v[36:39], v[80:83], v[100:103]
    ds_read_b128 v[64:67], v243 offset:0
    v_mfma_f32_16x16x32_bf16 v[104:107], v[36:39], v[84:87], v[104:107]
    ds_read_b128 v[68:71], v243 offset:2048
    v_mfma_f32_16x16x32_bf16 v[108:111], v[36:39], v[88:91], v[108:111]
    ds_read_b128 v[72:75], v243 offset:4096
    v_mfma_f32_16x16x32_bf16 v[112:115], v[36:39], v[92:95], v[112:115]
    s_add_u32 m0, s36, 16384
    s_nop 0
    buffer_load_dwordx4 v241, s[8:11], s48 offen offset:0 lds
    v_mfma_f32_16x16x32_bf16 v[116:119], v[40:43], v[80:83], v[116:119]
    ds_read_b128 v[76:79], v243 offset:6144
    v_mfma_f32_16x16x32_bf16 v[120:123], v[40:43], v[84:87], v[120:123]
    ds_read_b64_tr_b16 v[8:9], v246 offset:32768
    v_mfma_f32_16x16x32_bf16 v[124:127], v[40:43], v[88:91], v[124:127]
    ds_read_b64_tr_b16 v[10:11], v246 offset:34816
    v_mfma_f32_16x16x32_bf16 v[128:131], v[40:43], v[92:95], v[128:131]
    buffer_load_dwordx4 v242, s[8:11], s49 offen offset:1024 lds
    v_mfma_f32_16x16x32_bf16 v[132:135], v[44:47], v[80:83], v[132:135]
    ds_read_b64_tr_b16 v[12:13], v247 offset:32768
    v_mfma_f32_16x16x32_bf16 v[136:139], v[44:47], v[84:87], v[136:139]
    ds_read_b64_tr_b16 v[14:15], v247 offset:34816
    v_mfma_f32_16x16x32_bf16 v[140:143], v[44:47], v[88:91], v[140:143]
    ds_read_b64_tr_b16 v[16:17], v248 offset:32768
    v_mfma_f32_16x16x32_bf16 v[144:147], v[44:47], v[92:95], v[144:147]
    buffer_load_dwordx4 v241, s[8:11], s50 offen offset:2048 lds
    v_mfma_f32_16x16x32_bf16 v[148:151], v[48:51], v[80:83], v[148:151]
    ds_read_b64_tr_b16 v[18:19], v248 offset:34816
    v_mfma_f32_16x16x32_bf16 v[152:155], v[48:51], v[84:87], v[152:155]
    ds_read_b64_tr_b16 v[20:21], v249 offset:32768
    buffer_load_dwordx4 v242, s[8:11], s51 offen offset:3072 lds
    s_add_u32 s8, s8, 229376
    s_addc_u32 s9, s9, 0
    v_mfma_f32_16x16x32_bf16 v[156:159], v[48:51], v[88:91], v[156:159]
    ds_read_b64_tr_b16 v[22:23], v249 offset:34816
    v_mfma_f32_16x16x32_bf16 v[160:163], v[48:51], v[92:95], v[160:163]
    s_add_u32 m0, s35, 16384
    s_nop 0
    buffer_load_dwordx4 v240, s[4:7], s28 offen offset:0 lds
    v_mfma_f32_16x16x32_bf16 v[164:167], v[52:55], v[80:83], v[164:167]
    ds_read_b64_tr_b16 v[24:25], v250 offset:32768
    v_mfma_f32_16x16x32_bf16 v[168:171], v[52:55], v[84:87], v[168:171]
    ds_read_b64_tr_b16 v[26:27], v250 offset:34816
    v_mfma_f32_16x16x32_bf16 v[172:175], v[52:55], v[88:91], v[172:175]
    ds_read_b64_tr_b16 v[28:29], v251 offset:32768
    v_mfma_f32_16x16x32_bf16 v[176:179], v[52:55], v[92:95], v[176:179]
    buffer_load_dwordx4 v240, s[4:7], s29 offen offset:1024 lds
    v_mfma_f32_16x16x32_bf16 v[180:183], v[56:59], v[80:83], v[180:183]
    ds_read_b64_tr_b16 v[30:31], v251 offset:34816
    v_mfma_f32_16x16x32_bf16 v[184:187], v[56:59], v[84:87], v[184:187]
    ds_read_b64_tr_b16 v[32:33], v252 offset:32768
    v_mfma_f32_16x16x32_bf16 v[188:191], v[56:59], v[88:91], v[188:191]
    ds_read_b64_tr_b16 v[34:35], v252 offset:34816
    v_mfma_f32_16x16x32_bf16 v[192:195], v[56:59], v[92:95], v[192:195]
    buffer_load_dwordx4 v240, s[4:7], s30 offen offset:2048 lds
    v_mfma_f32_16x16x32_bf16 v[196:199], v[60:63], v[80:83], v[196:199]
    v_mfma_f32_16x16x32_bf16 v[200:203], v[60:63], v[84:87], v[200:203]
    v_mfma_f32_16x16x32_bf16 v[204:207], v[60:63], v[88:91], v[204:207]
    v_mfma_f32_16x16x32_bf16 v[208:211], v[60:63], v[92:95], v[208:211]
    buffer_load_dwordx4 v240, s[4:7], s31 offen offset:3072 lds
    s_add_u32 s94, s59, 2
    s_and_b32 s94, s94, 3
    s_add_u32 s94, s94, 4
    s_mul_i32 s94, s94, 256
    s_add_u32 s4, s60, s94
    s_addc_u32 s5, s61, 0
    s_waitcnt vmcnt(8) lgkmcnt(0)
    s_barrier
    v_mfma_f32_16x16x32_bf16 v[100:103], v[8:11], v[64:67], v[100:103]
    ds_read_b128 v[80:83], v244 offset:0
    v_mfma_f32_16x16x32_bf16 v[104:107], v[8:11], v[68:71], v[104:107]
    ds_read_b128 v[84:87], v244 offset:2048
    v_mfma_f32_16x16x32_bf16 v[108:111], v[8:11], v[72:75], v[108:111]
    ds_read_b128 v[88:91], v244 offset:4096
    v_mfma_f32_16x16x32_bf16 v[112:115], v[8:11], v[76:79], v[112:115]
    s_add_u32 m0, s36, 32768
    s_nop 0
    buffer_load_dwordx4 v241, s[8:11], s48 offen offset:0 lds
    v_mfma_f32_16x16x32_bf16 v[116:119], v[12:15], v[64:67], v[116:119]
    ds_read_b128 v[92:95], v244 offset:6144
    v_mfma_f32_16x16x32_bf16 v[120:123], v[12:15], v[68:71], v[120:123]
    ds_read_b64_tr_b16 v[36:37], v246 offset:0
    v_mfma_f32_16x16x32_bf16 v[124:127], v[12:15], v[72:75], v[124:127]
    ds_read_b64_tr_b16 v[38:39], v246 offset:2048
    v_mfma_f32_16x16x32_bf16 v[128:131], v[12:15], v[76:79], v[128:131]
    buffer_load_dwordx4 v242, s[8:11], s49 offen offset:1024 lds
    v_mfma_f32_16x16x32_bf16 v[132:135], v[16:19], v[64:67], v[132:135]
    ds_read_b64_tr_b16 v[40:41], v247 offset:0
    v_mfma_f32_16x16x32_bf16 v[136:139], v[16:19], v[68:71], v[136:139]
    ds_read_b64_tr_b16 v[42:43], v247 offset:2048
    v_mfma_f32_16x16x32_bf16 v[140:143], v[16:19], v[72:75], v[140:143]
    ds_read_b64_tr_b16 v[44:45], v248 offset:0
    v_mfma_f32_16x16x32_bf16 v[144:147], v[16:19], v[76:79], v[144:147]
    buffer_load_dwordx4 v241, s[8:11], s50 offen offset:2048 lds
    v_mfma_f32_16x16x32_bf16 v[148:151], v[20:23], v[64:67], v[148:151]
    ds_read_b64_tr_b16 v[46:47], v248 offset:2048
    v_mfma_f32_16x16x32_bf16 v[152:155], v[20:23], v[68:71], v[152:155]
    ds_read_b64_tr_b16 v[48:49], v249 offset:0
    buffer_load_dwordx4 v242, s[8:11], s51 offen offset:3072 lds
    s_add_u32 s94, s59, 2
    s_and_b32 s94, s94, 3
    s_add_u32 s94, s94, 4
    s_mul_i32 s94, s94, 917504
    s_add_u32 s8, s12, s94
    s_addc_u32 s9, s13, 0
    v_mfma_f32_16x16x32_bf16 v[156:159], v[20:23], v[72:75], v[156:159]
    ds_read_b64_tr_b16 v[50:51], v249 offset:2048
    v_mfma_f32_16x16x32_bf16 v[160:163], v[20:23], v[76:79], v[160:163]
    v_mfma_f32_16x16x32_bf16 v[164:167], v[24:27], v[64:67], v[164:167]
    ds_read_b64_tr_b16 v[52:53], v250 offset:0
    v_mfma_f32_16x16x32_bf16 v[168:171], v[24:27], v[68:71], v[168:171]
    ds_read_b64_tr_b16 v[54:55], v250 offset:2048
    v_mfma_f32_16x16x32_bf16 v[172:175], v[24:27], v[72:75], v[172:175]
    ds_read_b64_tr_b16 v[56:57], v251 offset:0
    v_mfma_f32_16x16x32_bf16 v[176:179], v[24:27], v[76:79], v[176:179]
    v_mfma_f32_16x16x32_bf16 v[180:183], v[28:31], v[64:67], v[180:183]
    ds_read_b64_tr_b16 v[58:59], v251 offset:2048
    v_mfma_f32_16x16x32_bf16 v[184:187], v[28:31], v[68:71], v[184:187]
    ds_read_b64_tr_b16 v[60:61], v252 offset:0
    v_mfma_f32_16x16x32_bf16 v[188:191], v[28:31], v[72:75], v[188:191]
    ds_read_b64_tr_b16 v[62:63], v252 offset:2048
    v_mfma_f32_16x16x32_bf16 v[192:195], v[28:31], v[76:79], v[192:195]
    v_mfma_f32_16x16x32_bf16 v[196:199], v[32:35], v[64:67], v[196:199]
    v_mfma_f32_16x16x32_bf16 v[200:203], v[32:35], v[68:71], v[200:203]
    v_mfma_f32_16x16x32_bf16 v[204:207], v[32:35], v[72:75], v[204:207]
    v_mfma_f32_16x16x32_bf16 v[208:211], v[32:35], v[76:79], v[208:211]
    s_waitcnt vmcnt(4) lgkmcnt(0)
    s_barrier
    v_mfma_f32_16x16x32_bf16 v[100:103], v[36:39], v[80:83], v[100:103]
    ds_read_b128 v[64:67], v243 offset:16384
    v_mfma_f32_16x16x32_bf16 v[104:107], v[36:39], v[84:87], v[104:107]
    ds_read_b128 v[68:71], v243 offset:18432
    v_mfma_f32_16x16x32_bf16 v[108:111], v[36:39], v[88:91], v[108:111]
    ds_read_b128 v[72:75], v243 offset:20480
    v_mfma_f32_16x16x32_bf16 v[112:115], v[36:39], v[92:95], v[112:115]
    s_add_u32 m0, s36, 0
    s_nop 0
    buffer_load_dwordx4 v241, s[8:11], s48 offen offset:0 lds
    v_mfma_f32_16x16x32_bf16 v[116:119], v[40:43], v[80:83], v[116:119]
    ds_read_b128 v[76:79], v243 offset:22528
    v_mfma_f32_16x16x32_bf16 v[120:123], v[40:43], v[84:87], v[120:123]
    ds_read_b64_tr_b16 v[8:9], v246 offset:16384
    v_mfma_f32_16x16x32_bf16 v[124:127], v[40:43], v[88:91], v[124:127]
    ds_read_b64_tr_b16 v[10:11], v246 offset:18432
    v_mfma_f32_16x16x32_bf16 v[128:131], v[40:43], v[92:95], v[128:131]
    buffer_load_dwordx4 v242, s[8:11], s49 offen offset:1024 lds
    v_mfma_f32_16x16x32_bf16 v[132:135], v[44:47], v[80:83], v[132:135]
    ds_read_b64_tr_b16 v[12:13], v247 offset:16384
    v_mfma_f32_16x16x32_bf16 v[136:139], v[44:47], v[84:87], v[136:139]
    ds_read_b64_tr_b16 v[14:15], v247 offset:18432
    v_mfma_f32_16x16x32_bf16 v[140:143], v[44:47], v[88:91], v[140:143]
    ds_read_b64_tr_b16 v[16:17], v248 offset:16384
    v_mfma_f32_16x16x32_bf16 v[144:147], v[44:47], v[92:95], v[144:147]
    buffer_load_dwordx4 v241, s[8:11], s50 offen offset:2048 lds
    v_mfma_f32_16x16x32_bf16 v[148:151], v[48:51], v[80:83], v[148:151]
    ds_read_b64_tr_b16 v[18:19], v248 offset:18432
    v_mfma_f32_16x16x32_bf16 v[152:155], v[48:51], v[84:87], v[152:155]
    ds_read_b64_tr_b16 v[20:21], v249 offset:16384
    buffer_load_dwordx4 v242, s[8:11], s51 offen offset:3072 lds
    s_add_u32 s8, s8, 229376
    s_addc_u32 s9, s9, 0
    v_mfma_f32_16x16x32_bf16 v[156:159], v[48:51], v[88:91], v[156:159]
    ds_read_b64_tr_b16 v[22:23], v249 offset:18432
    v_mfma_f32_16x16x32_bf16 v[160:163], v[48:51], v[92:95], v[160:163]
    s_add_u32 m0, s35, 0
    s_nop 0
    buffer_load_dwordx4 v240, s[4:7], s28 offen offset:0 lds
    v_mfma_f32_16x16x32_bf16 v[164:167], v[52:55], v[80:83], v[164:167]
    ds_read_b64_tr_b16 v[24:25], v250 offset:16384
    v_mfma_f32_16x16x32_bf16 v[168:171], v[52:55], v[84:87], v[168:171]
    ds_read_b64_tr_b16 v[26:27], v250 offset:18432
    v_mfma_f32_16x16x32_bf16 v[172:175], v[52:55], v[88:91], v[172:175]
    ds_read_b64_tr_b16 v[28:29], v251 offset:16384
    v_mfma_f32_16x16x32_bf16 v[176:179], v[52:55], v[92:95], v[176:179]
    buffer_load_dwordx4 v240, s[4:7], s29 offen offset:1024 lds
    v_mfma_f32_16x16x32_bf16 v[180:183], v[56:59], v[80:83], v[180:183]
    ds_read_b64_tr_b16 v[30:31], v251 offset:18432
    v_mfma_f32_16x16x32_bf16 v[184:187], v[56:59], v[84:87], v[184:187]
    ds_read_b64_tr_b16 v[32:33], v252 offset:16384
    v_mfma_f32_16x16x32_bf16 v[188:191], v[56:59], v[88:91], v[188:191]
    ds_read_b64_tr_b16 v[34:35], v252 offset:18432
    v_mfma_f32_16x16x32_bf16 v[192:195], v[56:59], v[92:95], v[192:195]
    buffer_load_dwordx4 v240, s[4:7], s30 offen offset:2048 lds
    v_mfma_f32_16x16x32_bf16 v[196:199], v[60:63], v[80:83], v[196:199]
    v_mfma_f32_16x16x32_bf16 v[200:203], v[60:63], v[84:87], v[200:203]
    v_mfma_f32_16x16x32_bf16 v[204:207], v[60:63], v[88:91], v[204:207]
    v_mfma_f32_16x16x32_bf16 v[208:211], v[60:63], v[92:95], v[208:211]
    buffer_load_dwordx4 v240, s[4:7], s31 offen offset:3072 lds
    s_add_u32 s4, s4, 128
    s_addc_u32 s5, s5, 0
    s_waitcnt vmcnt(8) lgkmcnt(0)
    s_barrier
    v_mfma_f32_16x16x32_bf16 v[100:103], v[8:11], v[64:67], v[100:103]
    ds_read_b128 v[80:83], v244 offset:16384
    v_mfma_f32_16x16x32_bf16 v[104:107], v[8:11], v[68:71], v[104:107]
    ds_read_b128 v[84:87], v244 offset:18432
    v_mfma_f32_16x16x32_bf16 v[108:111], v[8:11], v[72:75], v[108:111]
    ds_read_b128 v[88:91], v244 offset:20480
    v_mfma_f32_16x16x32_bf16 v[112:115], v[8:11], v[76:79], v[112:115]
    s_add_u32 m0, s36, 16384
    s_nop 0
    buffer_load_dwordx4 v241, s[8:11], s48 offen offset:0 lds
    v_mfma_f32_16x16x32_bf16 v[116:119], v[12:15], v[64:67], v[116:119]
    ds_read_b128 v[92:95], v244 offset:22528
    v_mfma_f32_16x16x32_bf16 v[120:123], v[12:15], v[68:71], v[120:123]
    ds_read_b64_tr_b16 v[36:37], v246 offset:32768
    v_mfma_f32_16x16x32_bf16 v[124:127], v[12:15], v[72:75], v[124:127]
    ds_read_b64_tr_b16 v[38:39], v246 offset:34816
    v_mfma_f32_16x16x32_bf16 v[128:131], v[12:15], v[76:79], v[128:131]
    buffer_load_dwordx4 v242, s[8:11], s49 offen offset:1024 lds
    v_mfma_f32_16x16x32_bf16 v[132:135], v[16:19], v[64:67], v[132:135]
    ds_read_b64_tr_b16 v[40:41], v247 offset:32768
    v_mfma_f32_16x16x32_bf16 v[136:139], v[16:19], v[68:71], v[136:139]
    ds_read_b64_tr_b16 v[42:43], v247 offset:34816
    v_mfma_f32_16x16x32_bf16 v[140:143], v[16:19], v[72:75], v[140:143]
    ds_read_b64_tr_b16 v[44:45], v248 offset:32768
    v_mfma_f32_16x16x32_bf16 v[144:147], v[16:19], v[76:79], v[144:147]
    buffer_load_dwordx4 v241, s[8:11], s50 offen offset:2048 lds
    v_mfma_f32_16x16x32_bf16 v[148:151], v[20:23], v[64:67], v[148:151]
    ds_read_b64_tr_b16 v[46:47], v248 offset:34816
    v_mfma_f32_16x16x32_bf16 v[152:155], v[20:23], v[68:71], v[152:155]
    ds_read_b64_tr_b16 v[48:49], v249 offset:32768
    buffer_load_dwordx4 v242, s[8:11], s51 offen offset:3072 lds
    s_add_u32 s8, s8, 229376
    s_addc_u32 s9, s9, 0
    v_mfma_f32_16x16x32_bf16 v[156:159], v[20:23], v[72:75], v[156:159]
    ds_read_b64_tr_b16 v[50:51], v249 offset:34816
    v_mfma_f32_16x16x32_bf16 v[160:163], v[20:23], v[76:79], v[160:163]
    v_mfma_f32_16x16x32_bf16 v[164:167], v[24:27], v[64:67], v[164:167]
    ds_read_b64_tr_b16 v[52:53], v250 offset:32768
    v_mfma_f32_16x16x32_bf16 v[168:171], v[24:27], v[68:71], v[168:171]
    ds_read_b64_tr_b16 v[54:55], v250 offset:34816
    v_mfma_f32_16x16x32_bf16 v[172:175], v[24:27], v[72:75], v[172:175]
    ds_read_b64_tr_b16 v[56:57], v251 offset:32768
    v_mfma_f32_16x16x32_bf16 v[176:179], v[24:27], v[76:79], v[176:179]
    v_mfma_f32_16x16x32_bf16 v[180:183], v[28:31], v[64:67], v[180:183]
    ds_read_b64_tr_b16 v[58:59], v251 offset:34816
    v_mfma_f32_16x16x32_bf16 v[184:187], v[28:31], v[68:71], v[184:187]
    ds_read_b64_tr_b16 v[60:61], v252 offset:32768
    v_mfma_f32_16x16x32_bf16 v[188:191], v[28:31], v[72:75], v[188:191]
    ds_read_b64_tr_b16 v[62:63], v252 offset:34816
    v_mfma_f32_16x16x32_bf16 v[192:195], v[28:31], v[76:79], v[192:195]
    v_mfma_f32_16x16x32_bf16 v[196:199], v[32:35], v[64:67], v[196:199]
    v_mfma_f32_16x16x32_bf16 v[200:203], v[32:35], v[68:71], v[200:203]
    v_mfma_f32_16x16x32_bf16 v[204:207], v[32:35], v[72:75], v[204:207]
    v_mfma_f32_16x16x32_bf16 v[208:211], v[32:35], v[76:79], v[208:211]
    s_waitcnt vmcnt(4) lgkmcnt(0)
    s_barrier
    v_mfma_f32_16x16x32_bf16 v[100:103], v[36:39], v[80:83], v[100:103]
    ds_read_b128 v[64:67], v243 offset:0
    v_mfma_f32_16x16x32_bf16 v[104:107], v[36:39], v[84:87], v[104:107]
    ds_read_b128 v[68:71], v243 offset:2048
    v_mfma_f32_16x16x32_bf16 v[108:111], v[36:39], v[88:91], v[108:111]
    ds_read_b128 v[72:75], v243 offset:4096
    v_mfma_f32_16x16x32_bf16 v[112:115], v[36:39], v[92:95], v[112:115]
    s_add_u32 m0, s36, 32768
    s_nop 0
    buffer_load_dwordx4 v241, s[8:11], s48 offen offset:0 lds
    v_mfma_f32_16x16x32_bf16 v[116:119], v[40:43], v[80:83], v[116:119]
    ds_read_b128 v[76:79], v243 offset:6144
    v_mfma_f32_16x16x32_bf16 v[120:123], v[40:43], v[84:87], v[120:123]
    ds_read_b64_tr_b16 v[8:9], v246 offset:0
    v_mfma_f32_16x16x32_bf16 v[124:127], v[40:43], v[88:91], v[124:127]
    ds_read_b64_tr_b16 v[10:11], v246 offset:2048
    v_mfma_f32_16x16x32_bf16 v[128:131], v[40:43], v[92:95], v[128:131]
    buffer_load_dwordx4 v242, s[8:11], s49 offen offset:1024 lds
    v_mfma_f32_16x16x32_bf16 v[132:135], v[44:47], v[80:83], v[132:135]
    ds_read_b64_tr_b16 v[12:13], v247 offset:0
    v_mfma_f32_16x16x32_bf16 v[136:139], v[44:47], v[84:87], v[136:139]
    ds_read_b64_tr_b16 v[14:15], v247 offset:2048
    v_mfma_f32_16x16x32_bf16 v[140:143], v[44:47], v[88:91], v[140:143]
    ds_read_b64_tr_b16 v[16:17], v248 offset:0
    v_mfma_f32_16x16x32_bf16 v[144:147], v[44:47], v[92:95], v[144:147]
    buffer_load_dwordx4 v241, s[8:11], s50 offen offset:2048 lds
    v_mfma_f32_16x16x32_bf16 v[148:151], v[48:51], v[80:83], v[148:151]
    ds_read_b64_tr_b16 v[18:19], v248 offset:2048
    v_mfma_f32_16x16x32_bf16 v[152:155], v[48:51], v[84:87], v[152:155]
    ds_read_b64_tr_b16 v[20:21], v249 offset:0
    buffer_load_dwordx4 v242, s[8:11], s51 offen offset:3072 lds
    s_add_u32 s8, s8, 229376
    s_addc_u32 s9, s9, 0
    v_mfma_f32_16x16x32_bf16 v[156:159], v[48:51], v[88:91], v[156:159]
    ds_read_b64_tr_b16 v[22:23], v249 offset:2048
    v_mfma_f32_16x16x32_bf16 v[160:163], v[48:51], v[92:95], v[160:163]
    s_add_u32 m0, s35, 16384
    s_nop 0
    buffer_load_dwordx4 v240, s[4:7], s28 offen offset:0 lds
    v_mfma_f32_16x16x32_bf16 v[164:167], v[52:55], v[80:83], v[164:167]
    ds_read_b64_tr_b16 v[24:25], v250 offset:0
    v_mfma_f32_16x16x32_bf16 v[168:171], v[52:55], v[84:87], v[168:171]
    ds_read_b64_tr_b16 v[26:27], v250 offset:2048
    v_mfma_f32_16x16x32_bf16 v[172:175], v[52:55], v[88:91], v[172:175]
    ds_read_b64_tr_b16 v[28:29], v251 offset:0
    v_mfma_f32_16x16x32_bf16 v[176:179], v[52:55], v[92:95], v[176:179]
    buffer_load_dwordx4 v240, s[4:7], s29 offen offset:1024 lds
    v_mfma_f32_16x16x32_bf16 v[180:183], v[56:59], v[80:83], v[180:183]
    ds_read_b64_tr_b16 v[30:31], v251 offset:2048
    v_mfma_f32_16x16x32_bf16 v[184:187], v[56:59], v[84:87], v[184:187]
    ds_read_b64_tr_b16 v[32:33], v252 offset:0
    v_mfma_f32_16x16x32_bf16 v[188:191], v[56:59], v[88:91], v[188:191]
    ds_read_b64_tr_b16 v[34:35], v252 offset:2048
    v_mfma_f32_16x16x32_bf16 v[192:195], v[56:59], v[92:95], v[192:195]
    buffer_load_dwordx4 v240, s[4:7], s30 offen offset:2048 lds
    v_mfma_f32_16x16x32_bf16 v[196:199], v[60:63], v[80:83], v[196:199]
    v_mfma_f32_16x16x32_bf16 v[200:203], v[60:63], v[84:87], v[200:203]
    v_mfma_f32_16x16x32_bf16 v[204:207], v[60:63], v[88:91], v[204:207]
    v_mfma_f32_16x16x32_bf16 v[208:211], v[60:63], v[92:95], v[208:211]
    buffer_load_dwordx4 v240, s[4:7], s31 offen offset:3072 lds
    s_add_u32 s94, s59, 3
    s_and_b32 s94, s94, 3
    s_add_u32 s94, s94, 4
    s_mul_i32 s94, s94, 256
    s_add_u32 s4, s60, s94
    s_addc_u32 s5, s61, 0
    s_waitcnt vmcnt(8) lgkmcnt(0)
    s_barrier
    v_mfma_f32_16x16x32_bf16 v[100:103], v[8:11], v[64:67], v[100:103]
    ds_read_b128 v[80:83], v244 offset:0
    v_mfma_f32_16x16x32_bf16 v[104:107], v[8:11], v[68:71], v[104:107]
    ds_read_b128 v[84:87], v244 offset:2048
    v_mfma_f32_16x16x32_bf16 v[108:111], v[8:11], v[72:75], v[108:111]
    ds_read_b128 v[88:91], v244 offset:4096
    v_mfma_f32_16x16x32_bf16 v[112:115], v[8:11], v[76:79], v[112:115]
    s_add_u32 m0, s36, 0
    s_nop 0
    buffer_load_dwordx4 v241, s[8:11], s48 offen offset:0 lds
    v_mfma_f32_16x16x32_bf16 v[116:119], v[12:15], v[64:67], v[116:119]
    ds_read_b128 v[92:95], v244 offset:6144
    v_mfma_f32_16x16x32_bf16 v[120:123], v[12:15], v[68:71], v[120:123]
    ds_read_b64_tr_b16 v[36:37], v246 offset:16384
    v_mfma_f32_16x16x32_bf16 v[124:127], v[12:15], v[72:75], v[124:127]
    ds_read_b64_tr_b16 v[38:39], v246 offset:18432
    v_mfma_f32_16x16x32_bf16 v[128:131], v[12:15], v[76:79], v[128:131]
    buffer_load_dwordx4 v242, s[8:11], s49 offen offset:1024 lds
    v_mfma_f32_16x16x32_bf16 v[132:135], v[16:19], v[64:67], v[132:135]
    ds_read_b64_tr_b16 v[40:41], v247 offset:16384
    v_mfma_f32_16x16x32_bf16 v[136:139], v[16:19], v[68:71], v[136:139]
    ds_read_b64_tr_b16 v[42:43], v247 offset:18432
    v_mfma_f32_16x16x32_bf16 v[140:143], v[16:19], v[72:75], v[140:143]
    ds_read_b64_tr_b16 v[44:45], v248 offset:16384
    v_mfma_f32_16x16x32_bf16 v[144:147], v[16:19], v[76:79], v[144:147]
    buffer_load_dwordx4 v241, s[8:11], s50 offen offset:2048 lds
    v_mfma_f32_16x16x32_bf16 v[148:151], v[20:23], v[64:67], v[148:151]
    ds_read_b64_tr_b16 v[46:47], v248 offset:18432
    v_mfma_f32_16x16x32_bf16 v[152:155], v[20:23], v[68:71], v[152:155]
    ds_read_b64_tr_b16 v[48:49], v249 offset:16384
    buffer_load_dwordx4 v242, s[8:11], s51 offen offset:3072 lds
    s_add_u32 s94, s59, 3
    s_and_b32 s94, s94, 3
    s_add_u32 s94, s94, 4
    s_mul_i32 s94, s94, 917504
    s_add_u32 s8, s12, s94
    s_addc_u32 s9, s13, 0
    v_mfma_f32_16x16x32_bf16 v[156:159], v[20:23], v[72:75], v[156:159]
    ds_read_b64_tr_b16 v[50:51], v249 offset:18432
    v_mfma_f32_16x16x32_bf16 v[160:163], v[20:23], v[76:79], v[160:163]
    v_mfma_f32_16x16x32_bf16 v[164:167], v[24:27], v[64:67], v[164:167]
    ds_read_b64_tr_b16 v[52:53], v250 offset:16384
    v_mfma_f32_16x16x32_bf16 v[168:171], v[24:27], v[68:71], v[168:171]
    ds_read_b64_tr_b16 v[54:55], v250 offset:18432
    v_mfma_f32_16x16x32_bf16 v[172:175], v[24:27], v[72:75], v[172:175]
    ds_read_b64_tr_b16 v[56:57], v251 offset:16384
    v_mfma_f32_16x16x32_bf16 v[176:179], v[24:27], v[76:79], v[176:179]
    v_mfma_f32_16x16x32_bf16 v[180:183], v[28:31], v[64:67], v[180:183]
    ds_read_b64_tr_b16 v[58:59], v251 offset:18432
    v_mfma_f32_16x16x32_bf16 v[184:187], v[28:31], v[68:71], v[184:187]
    ds_read_b64_tr_b16 v[60:61], v252 offset:16384
    v_mfma_f32_16x16x32_bf16 v[188:191], v[28:31], v[72:75], v[188:191]
    ds_read_b64_tr_b16 v[62:63], v252 offset:18432
    v_mfma_f32_16x16x32_bf16 v[192:195], v[28:31], v[76:79], v[192:195]
    v_mfma_f32_16x16x32_bf16 v[196:199], v[32:35], v[64:67], v[196:199]
    v_mfma_f32_16x16x32_bf16 v[200:203], v[32:35], v[68:71], v[200:203]
    v_mfma_f32_16x16x32_bf16 v[204:207], v[32:35], v[72:75], v[204:207]
    v_mfma_f32_16x16x32_bf16 v[208:211], v[32:35], v[76:79], v[208:211]
    s_waitcnt vmcnt(4) lgkmcnt(0)
    s_barrier
    v_mfma_f32_16x16x32_bf16 v[100:103], v[36:39], v[80:83], v[100:103]
    ds_read_b128 v[64:67], v243 offset:16384
    v_mfma_f32_16x16x32_bf16 v[104:107], v[36:39], v[84:87], v[104:107]
    ds_read_b128 v[68:71], v243 offset:18432
    v_mfma_f32_16x16x32_bf16 v[108:111], v[36:39], v[88:91], v[108:111]
    ds_read_b128 v[72:75], v243 offset:20480
    v_mfma_f32_16x16x32_bf16 v[112:115], v[36:39], v[92:95], v[112:115]
    s_add_u32 m0, s36, 16384
    s_nop 0
    buffer_load_dwordx4 v241, s[8:11], s48 offen offset:0 lds
    v_mfma_f32_16x16x32_bf16 v[116:119], v[40:43], v[80:83], v[116:119]
    ds_read_b128 v[76:79], v243 offset:22528
    v_mfma_f32_16x16x32_bf16 v[120:123], v[40:43], v[84:87], v[120:123]
    ds_read_b64_tr_b16 v[8:9], v246 offset:32768
    v_mfma_f32_16x16x32_bf16 v[124:127], v[40:43], v[88:91], v[124:127]
    ds_read_b64_tr_b16 v[10:11], v246 offset:34816
    v_mfma_f32_16x16x32_bf16 v[128:131], v[40:43], v[92:95], v[128:131]
    buffer_load_dwordx4 v242, s[8:11], s49 offen offset:1024 lds
    v_mfma_f32_16x16x32_bf16 v[132:135], v[44:47], v[80:83], v[132:135]
    ds_read_b64_tr_b16 v[12:13], v247 offset:32768
    v_mfma_f32_16x16x32_bf16 v[136:139], v[44:47], v[84:87], v[136:139]
    ds_read_b64_tr_b16 v[14:15], v247 offset:34816
    v_mfma_f32_16x16x32_bf16 v[140:143], v[44:47], v[88:91], v[140:143]
    ds_read_b64_tr_b16 v[16:17], v248 offset:32768
    v_mfma_f32_16x16x32_bf16 v[144:147], v[44:47], v[92:95], v[144:147]
    buffer_load_dwordx4 v241, s[8:11], s50 offen offset:2048 lds
    v_mfma_f32_16x16x32_bf16 v[148:151], v[48:51], v[80:83], v[148:151]
    ds_read_b64_tr_b16 v[18:19], v248 offset:34816
    v_mfma_f32_16x16x32_bf16 v[152:155], v[48:51], v[84:87], v[152:155]
    ds_read_b64_tr_b16 v[20:21], v249 offset:32768
    buffer_load_dwordx4 v242, s[8:11], s51 offen offset:3072 lds
    s_add_u32 s8, s8, 229376
    s_addc_u32 s9, s9, 0
    v_mfma_f32_16x16x32_bf16 v[156:159], v[48:51], v[88:91], v[156:159]
    ds_read_b64_tr_b16 v[22:23], v249 offset:34816
    v_mfma_f32_16x16x32_bf16 v[160:163], v[48:51], v[92:95], v[160:163]
    s_add_u32 m0, s35, 0
    s_nop 0
    buffer_load_dwordx4 v240, s[4:7], s28 offen offset:0 lds
    v_mfma_f32_16x16x32_bf16 v[164:167], v[52:55], v[80:83], v[164:167]
    ds_read_b64_tr_b16 v[24:25], v250 offset:32768
    v_mfma_f32_16x16x32_bf16 v[168:171], v[52:55], v[84:87], v[168:171]
    ds_read_b64_tr_b16 v[26:27], v250 offset:34816
    v_mfma_f32_16x16x32_bf16 v[172:175], v[52:55], v[88:91], v[172:175]
    ds_read_b64_tr_b16 v[28:29], v251 offset:32768
    v_mfma_f32_16x16x32_bf16 v[176:179], v[52:55], v[92:95], v[176:179]
    buffer_load_dwordx4 v240, s[4:7], s29 offen offset:1024 lds
    v_mfma_f32_16x16x32_bf16 v[180:183], v[56:59], v[80:83], v[180:183]
    ds_read_b64_tr_b16 v[30:31], v251 offset:34816
    v_mfma_f32_16x16x32_bf16 v[184:187], v[56:59], v[84:87], v[184:187]
    ds_read_b64_tr_b16 v[32:33], v252 offset:32768
    v_mfma_f32_16x16x32_bf16 v[188:191], v[56:59], v[88:91], v[188:191]
    ds_read_b64_tr_b16 v[34:35], v252 offset:34816
    v_mfma_f32_16x16x32_bf16 v[192:195], v[56:59], v[92:95], v[192:195]
    buffer_load_dwordx4 v240, s[4:7], s30 offen offset:2048 lds
    v_mfma_f32_16x16x32_bf16 v[196:199], v[60:63], v[80:83], v[196:199]
    v_mfma_f32_16x16x32_bf16 v[200:203], v[60:63], v[84:87], v[200:203]
    v_mfma_f32_16x16x32_bf16 v[204:207], v[60:63], v[88:91], v[204:207]
    v_mfma_f32_16x16x32_bf16 v[208:211], v[60:63], v[92:95], v[208:211]
    buffer_load_dwordx4 v240, s[4:7], s31 offen offset:3072 lds
    s_add_u32 s4, s4, 128
    s_addc_u32 s5, s5, 0
    s_waitcnt vmcnt(8) lgkmcnt(0)
    s_barrier
    v_mfma_f32_16x16x32_bf16 v[100:103], v[8:11], v[64:67], v[100:103]
    ds_read_b128 v[80:83], v244 offset:16384
    v_mfma_f32_16x16x32_bf16 v[104:107], v[8:11], v[68:71], v[104:107]
    ds_read_b128 v[84:87], v244 offset:18432
    v_mfma_f32_16x16x32_bf16 v[108:111], v[8:11], v[72:75], v[108:111]
    ds_read_b128 v[88:91], v244 offset:20480
    v_mfma_f32_16x16x32_bf16 v[112:115], v[8:11], v[76:79], v[112:115]
    s_add_u32 m0, s36, 32768
    s_nop 0
    buffer_load_dwordx4 v241, s[8:11], s48 offen offset:0 lds
    v_mfma_f32_16x16x32_bf16 v[116:119], v[12:15], v[64:67], v[116:119]
    ds_read_b128 v[92:95], v244 offset:22528
    v_mfma_f32_16x16x32_bf16 v[120:123], v[12:15], v[68:71], v[120:123]
    ds_read_b64_tr_b16 v[36:37], v246 offset:0
    v_mfma_f32_16x16x32_bf16 v[124:127], v[12:15], v[72:75], v[124:127]
    ds_read_b64_tr_b16 v[38:39], v246 offset:2048
    v_mfma_f32_16x16x32_bf16 v[128:131], v[12:15], v[76:79], v[128:131]
    buffer_load_dwordx4 v242, s[8:11], s49 offen offset:1024 lds
    v_mfma_f32_16x16x32_bf16 v[132:135], v[16:19], v[64:67], v[132:135]
    ds_read_b64_tr_b16 v[40:41], v247 offset:0
    v_mfma_f32_16x16x32_bf16 v[136:139], v[16:19], v[68:71], v[136:139]
    ds_read_b64_tr_b16 v[42:43], v247 offset:2048
    v_mfma_f32_16x16x32_bf16 v[140:143], v[16:19], v[72:75], v[140:143]
    ds_read_b64_tr_b16 v[44:45], v248 offset:0
    v_mfma_f32_16x16x32_bf16 v[144:147], v[16:19], v[76:79], v[144:147]
    buffer_load_dwordx4 v241, s[8:11], s50 offen offset:2048 lds
    v_mfma_f32_16x16x32_bf16 v[148:151], v[20:23], v[64:67], v[148:151]
    ds_read_b64_tr_b16 v[46:47], v248 offset:2048
    v_mfma_f32_16x16x32_bf16 v[152:155], v[20:23], v[68:71], v[152:155]
    ds_read_b64_tr_b16 v[48:49], v249 offset:0
    buffer_load_dwordx4 v242, s[8:11], s51 offen offset:3072 lds
    s_add_u32 s8, s8, 229376
    s_addc_u32 s9, s9, 0
    v_mfma_f32_16x16x32_bf16 v[156:159], v[20:23], v[72:75], v[156:159]
    ds_read_b64_tr_b16 v[50:51], v249 offset:2048
    v_mfma_f32_16x16x32_bf16 v[160:163], v[20:23], v[76:79], v[160:163]
    v_mfma_f32_16x16x32_bf16 v[164:167], v[24:27], v[64:67], v[164:167]
    ds_read_b64_tr_b16 v[52:53], v250 offset:0
    v_mfma_f32_16x16x32_bf16 v[168:171], v[24:27], v[68:71], v[168:171]
    ds_read_b64_tr_b16 v[54:55], v250 offset:2048
    v_mfma_f32_16x16x32_bf16 v[172:175], v[24:27], v[72:75], v[172:175]
    ds_read_b64_tr_b16 v[56:57], v251 offset:0
    v_mfma_f32_16x16x32_bf16 v[176:179], v[24:27], v[76:79], v[176:179]
    v_mfma_f32_16x16x32_bf16 v[180:183], v[28:31], v[64:67], v[180:183]
    ds_read_b64_tr_b16 v[58:59], v251 offset:2048
    v_mfma_f32_16x16x32_bf16 v[184:187], v[28:31], v[68:71], v[184:187]
    ds_read_b64_tr_b16 v[60:61], v252 offset:0
    v_mfma_f32_16x16x32_bf16 v[188:191], v[28:31], v[72:75], v[188:191]
    ds_read_b64_tr_b16 v[62:63], v252 offset:2048
    v_mfma_f32_16x16x32_bf16 v[192:195], v[28:31], v[76:79], v[192:195]
    v_mfma_f32_16x16x32_bf16 v[196:199], v[32:35], v[64:67], v[196:199]
    v_mfma_f32_16x16x32_bf16 v[200:203], v[32:35], v[68:71], v[200:203]
    v_mfma_f32_16x16x32_bf16 v[204:207], v[32:35], v[72:75], v[204:207]
    v_mfma_f32_16x16x32_bf16 v[208:211], v[32:35], v[76:79], v[208:211]
    s_waitcnt vmcnt(4) lgkmcnt(0)
    s_barrier
    v_mfma_f32_16x16x32_bf16 v[100:103], v[36:39], v[80:83], v[100:103]
    ds_read_b128 v[64:67], v243 offset:0
    v_mfma_f32_16x16x32_bf16 v[104:107], v[36:39], v[84:87], v[104:107]
    ds_read_b128 v[68:71], v243 offset:2048
    v_mfma_f32_16x16x32_bf16 v[108:111], v[36:39], v[88:91], v[108:111]
    ds_read_b128 v[72:75], v243 offset:4096
    v_mfma_f32_16x16x32_bf16 v[112:115], v[36:39], v[92:95], v[112:115]
    s_add_u32 m0, s36, 0
    s_nop 0
    buffer_load_dwordx4 v241, s[8:11], s48 offen offset:0 lds
    v_mfma_f32_16x16x32_bf16 v[116:119], v[40:43], v[80:83], v[116:119]
    ds_read_b128 v[76:79], v243 offset:6144
    v_mfma_f32_16x16x32_bf16 v[120:123], v[40:43], v[84:87], v[120:123]
    ds_read_b64_tr_b16 v[8:9], v246 offset:16384
    v_mfma_f32_16x16x32_bf16 v[124:127], v[40:43], v[88:91], v[124:127]
    ds_read_b64_tr_b16 v[10:11], v246 offset:18432
    v_mfma_f32_16x16x32_bf16 v[128:131], v[40:43], v[92:95], v[128:131]
    buffer_load_dwordx4 v242, s[8:11], s49 offen offset:1024 lds
    v_mfma_f32_16x16x32_bf16 v[132:135], v[44:47], v[80:83], v[132:135]
    ds_read_b64_tr_b16 v[12:13], v247 offset:16384
    v_mfma_f32_16x16x32_bf16 v[136:139], v[44:47], v[84:87], v[136:139]
    ds_read_b64_tr_b16 v[14:15], v247 offset:18432
    v_mfma_f32_16x16x32_bf16 v[140:143], v[44:47], v[88:91], v[140:143]
    ds_read_b64_tr_b16 v[16:17], v248 offset:16384
    v_mfma_f32_16x16x32_bf16 v[144:147], v[44:47], v[92:95], v[144:147]
    buffer_load_dwordx4 v241, s[8:11], s50 offen offset:2048 lds
    v_mfma_f32_16x16x32_bf16 v[148:151], v[48:51], v[80:83], v[148:151]
    ds_read_b64_tr_b16 v[18:19], v248 offset:18432
    v_mfma_f32_16x16x32_bf16 v[152:155], v[48:51], v[84:87], v[152:155]
    ds_read_b64_tr_b16 v[20:21], v249 offset:16384
    buffer_load_dwordx4 v242, s[8:11], s51 offen offset:3072 lds
    s_add_u32 s8, s8, 229376
    s_addc_u32 s9, s9, 0
    v_mfma_f32_16x16x32_bf16 v[156:159], v[48:51], v[88:91], v[156:159]
    ds_read_b64_tr_b16 v[22:23], v249 offset:18432
    v_mfma_f32_16x16x32_bf16 v[160:163], v[48:51], v[92:95], v[160:163]
    s_add_u32 m0, s35, 16384
    s_nop 0
    buffer_load_dwordx4 v240, s[4:7], s28 offen offset:0 lds
    v_mfma_f32_16x16x32_bf16 v[164:167], v[52:55], v[80:83], v[164:167]
    ds_read_b64_tr_b16 v[24:25], v250 offset:16384
    v_mfma_f32_16x16x32_bf16 v[168:171], v[52:55], v[84:87], v[168:171]
    ds_read_b64_tr_b16 v[26:27], v250 offset:18432
    v_mfma_f32_16x16x32_bf16 v[172:175], v[52:55], v[88:91], v[172:175]
    ds_read_b64_tr_b16 v[28:29], v251 offset:16384
    v_mfma_f32_16x16x32_bf16 v[176:179], v[52:55], v[92:95], v[176:179]
    buffer_load_dwordx4 v240, s[4:7], s29 offen offset:1024 lds
    v_mfma_f32_16x16x32_bf16 v[180:183], v[56:59], v[80:83], v[180:183]
    ds_read_b64_tr_b16 v[30:31], v251 offset:18432
    v_mfma_f32_16x16x32_bf16 v[184:187], v[56:59], v[84:87], v[184:187]
    ds_read_b64_tr_b16 v[32:33], v252 offset:16384
    v_mfma_f32_16x16x32_bf16 v[188:191], v[56:59], v[88:91], v[188:191]
    ds_read_b64_tr_b16 v[34:35], v252 offset:18432
    v_mfma_f32_16x16x32_bf16 v[192:195], v[56:59], v[92:95], v[192:195]
    buffer_load_dwordx4 v240, s[4:7], s30 offen offset:2048 lds
    v_mfma_f32_16x16x32_bf16 v[196:199], v[60:63], v[80:83], v[196:199]
    v_mfma_f32_16x16x32_bf16 v[200:203], v[60:63], v[84:87], v[200:203]
    v_mfma_f32_16x16x32_bf16 v[204:207], v[60:63], v[88:91], v[204:207]
    v_mfma_f32_16x16x32_bf16 v[208:211], v[60:63], v[92:95], v[208:211]
    buffer_load_dwordx4 v240, s[4:7], s31 offen offset:3072 lds
    s_waitcnt vmcnt(8) lgkmcnt(0)
    s_barrier
    v_mfma_f32_16x16x32_bf16 v[100:103], v[8:11], v[64:67], v[100:103]
    ds_read_b128 v[80:83], v244 offset:0
    v_mfma_f32_16x16x32_bf16 v[104:107], v[8:11], v[68:71], v[104:107]
    ds_read_b128 v[84:87], v244 offset:2048
    v_mfma_f32_16x16x32_bf16 v[108:111], v[8:11], v[72:75], v[108:111]
    ds_read_b128 v[88:91], v244 offset:4096
    v_mfma_f32_16x16x32_bf16 v[112:115], v[8:11], v[76:79], v[112:115]
    s_add_u32 m0, s36, 16384
    s_nop 0
    buffer_load_dwordx4 v241, s[8:11], s48 offen offset:0 lds
    v_mfma_f32_16x16x32_bf16 v[116:119], v[12:15], v[64:67], v[116:119]
    ds_read_b128 v[92:95], v244 offset:6144
    v_mfma_f32_16x16x32_bf16 v[120:123], v[12:15], v[68:71], v[120:123]
    ds_read_b64_tr_b16 v[36:37], v246 offset:32768
    v_mfma_f32_16x16x32_bf16 v[124:127], v[12:15], v[72:75], v[124:127]
    ds_read_b64_tr_b16 v[38:39], v246 offset:34816
    v_mfma_f32_16x16x32_bf16 v[128:131], v[12:15], v[76:79], v[128:131]
    buffer_load_dwordx4 v242, s[8:11], s49 offen offset:1024 lds
    v_mfma_f32_16x16x32_bf16 v[132:135], v[16:19], v[64:67], v[132:135]
    ds_read_b64_tr_b16 v[40:41], v247 offset:32768
    v_mfma_f32_16x16x32_bf16 v[136:139], v[16:19], v[68:71], v[136:139]
    ds_read_b64_tr_b16 v[42:43], v247 offset:34816
    v_mfma_f32_16x16x32_bf16 v[140:143], v[16:19], v[72:75], v[140:143]
    ds_read_b64_tr_b16 v[44:45], v248 offset:32768
    v_mfma_f32_16x16x32_bf16 v[144:147], v[16:19], v[76:79], v[144:147]
    buffer_load_dwordx4 v241, s[8:11], s50 offen offset:2048 lds
    v_mfma_f32_16x16x32_bf16 v[148:151], v[20:23], v[64:67], v[148:151]
    ds_read_b64_tr_b16 v[46:47], v248 offset:34816
    v_mfma_f32_16x16x32_bf16 v[152:155], v[20:23], v[68:71], v[152:155]
    ds_read_b64_tr_b16 v[48:49], v249 offset:32768
    buffer_load_dwordx4 v242, s[8:11], s51 offen offset:3072 lds
    v_mfma_f32_16x16x32_bf16 v[156:159], v[20:23], v[72:75], v[156:159]
    ds_read_b64_tr_b16 v[50:51], v249 offset:34816
    v_mfma_f32_16x16x32_bf16 v[160:163], v[20:23], v[76:79], v[160:163]
    v_mfma_f32_16x16x32_bf16 v[164:167], v[24:27], v[64:67], v[164:167]
    ds_read_b64_tr_b16 v[52:53], v250 offset:32768
    v_mfma_f32_16x16x32_bf16 v[168:171], v[24:27], v[68:71], v[168:171]
    ds_read_b64_tr_b16 v[54:55], v250 offset:34816
    v_mfma_f32_16x16x32_bf16 v[172:175], v[24:27], v[72:75], v[172:175]
    ds_read_b64_tr_b16 v[56:57], v251 offset:32768
    v_mfma_f32_16x16x32_bf16 v[176:179], v[24:27], v[76:79], v[176:179]
    v_mfma_f32_16x16x32_bf16 v[180:183], v[28:31], v[64:67], v[180:183]
    ds_read_b64_tr_b16 v[58:59], v251 offset:34816
    v_mfma_f32_16x16x32_bf16 v[184:187], v[28:31], v[68:71], v[184:187]
    ds_read_b64_tr_b16 v[60:61], v252 offset:32768
    v_mfma_f32_16x16x32_bf16 v[188:191], v[28:31], v[72:75], v[188:191]
    ds_read_b64_tr_b16 v[62:63], v252 offset:34816
    v_mfma_f32_16x16x32_bf16 v[192:195], v[28:31], v[76:79], v[192:195]
    v_mfma_f32_16x16x32_bf16 v[196:199], v[32:35], v[64:67], v[196:199]
    v_mfma_f32_16x16x32_bf16 v[200:203], v[32:35], v[68:71], v[200:203]
    v_mfma_f32_16x16x32_bf16 v[204:207], v[32:35], v[72:75], v[204:207]
    v_mfma_f32_16x16x32_bf16 v[208:211], v[32:35], v[76:79], v[208:211]
    s_waitcnt vmcnt(4) lgkmcnt(0)
    s_barrier
    v_mfma_f32_16x16x32_bf16 v[100:103], v[36:39], v[80:83], v[100:103]
    ds_read_b128 v[64:67], v243 offset:16384
    v_mfma_f32_16x16x32_bf16 v[104:107], v[36:39], v[84:87], v[104:107]
    ds_read_b128 v[68:71], v243 offset:18432
    v_mfma_f32_16x16x32_bf16 v[108:111], v[36:39], v[88:91], v[108:111]
    ds_read_b128 v[72:75], v243 offset:20480
    v_mfma_f32_16x16x32_bf16 v[112:115], v[36:39], v[92:95], v[112:115]
    v_mfma_f32_16x16x32_bf16 v[116:119], v[40:43], v[80:83], v[116:119]
    ds_read_b128 v[76:79], v243 offset:22528
    v_mfma_f32_16x16x32_bf16 v[120:123], v[40:43], v[84:87], v[120:123]
    ds_read_b64_tr_b16 v[8:9], v246 offset:0
    v_mfma_f32_16x16x32_bf16 v[124:127], v[40:43], v[88:91], v[124:127]
    ds_read_b64_tr_b16 v[10:11], v246 offset:2048
    v_mfma_f32_16x16x32_bf16 v[128:131], v[40:43], v[92:95], v[128:131]
    v_mfma_f32_16x16x32_bf16 v[132:135], v[44:47], v[80:83], v[132:135]
    ds_read_b64_tr_b16 v[12:13], v247 offset:0
    v_mfma_f32_16x16x32_bf16 v[136:139], v[44:47], v[84:87], v[136:139]
    ds_read_b64_tr_b16 v[14:15], v247 offset:2048
    v_mfma_f32_16x16x32_bf16 v[140:143], v[44:47], v[88:91], v[140:143]
    ds_read_b64_tr_b16 v[16:17], v248 offset:0
    v_mfma_f32_16x16x32_bf16 v[144:147], v[44:47], v[92:95], v[144:147]
    v_mfma_f32_16x16x32_bf16 v[148:151], v[48:51], v[80:83], v[148:151]
    ds_read_b64_tr_b16 v[18:19], v248 offset:2048
    v_mfma_f32_16x16x32_bf16 v[152:155], v[48:51], v[84:87], v[152:155]
    ds_read_b64_tr_b16 v[20:21], v249 offset:0
    v_mfma_f32_16x16x32_bf16 v[156:159], v[48:51], v[88:91], v[156:159]
    ds_read_b64_tr_b16 v[22:23], v249 offset:2048
    v_mfma_f32_16x16x32_bf16 v[160:163], v[48:51], v[92:95], v[160:163]
    v_mfma_f32_16x16x32_bf16 v[164:167], v[52:55], v[80:83], v[164:167]
    ds_read_b64_tr_b16 v[24:25], v250 offset:0
    v_mfma_f32_16x16x32_bf16 v[168:171], v[52:55], v[84:87], v[168:171]
    ds_read_b64_tr_b16 v[26:27], v250 offset:2048
    v_mfma_f32_16x16x32_bf16 v[172:175], v[52:55], v[88:91], v[172:175]
    ds_read_b64_tr_b16 v[28:29], v251 offset:0
    v_mfma_f32_16x16x32_bf16 v[176:179], v[52:55], v[92:95], v[176:179]
    v_mfma_f32_16x16x32_bf16 v[180:183], v[56:59], v[80:83], v[180:183]
    ds_read_b64_tr_b16 v[30:31], v251 offset:2048
    v_mfma_f32_16x16x32_bf16 v[184:187], v[56:59], v[84:87], v[184:187]
    ds_read_b64_tr_b16 v[32:33], v252 offset:0
    v_mfma_f32_16x16x32_bf16 v[188:191], v[56:59], v[88:91], v[188:191]
    ds_read_b64_tr_b16 v[34:35], v252 offset:2048
    v_mfma_f32_16x16x32_bf16 v[192:195], v[56:59], v[92:95], v[192:195]
    v_mfma_f32_16x16x32_bf16 v[196:199], v[60:63], v[80:83], v[196:199]
    v_mfma_f32_16x16x32_bf16 v[200:203], v[60:63], v[84:87], v[200:203]
    v_mfma_f32_16x16x32_bf16 v[204:207], v[60:63], v[88:91], v[204:207]
    v_mfma_f32_16x16x32_bf16 v[208:211], v[60:63], v[92:95], v[208:211]
    s_waitcnt vmcnt(0) lgkmcnt(0)
    s_barrier
    v_mfma_f32_16x16x32_bf16 v[100:103], v[8:11], v[64:67], v[100:103]
    ds_read_b128 v[80:83], v244 offset:16384
    v_mfma_f32_16x16x32_bf16 v[104:107], v[8:11], v[68:71], v[104:107]
    ds_read_b128 v[84:87], v244 offset:18432
    v_mfma_f32_16x16x32_bf16 v[108:111], v[8:11], v[72:75], v[108:111]
    ds_read_b128 v[88:91], v244 offset:20480
    v_mfma_f32_16x16x32_bf16 v[112:115], v[8:11], v[76:79], v[112:115]
    v_mfma_f32_16x16x32_bf16 v[116:119], v[12:15], v[64:67], v[116:119]
    ds_read_b128 v[92:95], v244 offset:22528
    v_mfma_f32_16x16x32_bf16 v[120:123], v[12:15], v[68:71], v[120:123]
    ds_read_b64_tr_b16 v[36:37], v246 offset:16384
    v_mfma_f32_16x16x32_bf16 v[124:127], v[12:15], v[72:75], v[124:127]
    ds_read_b64_tr_b16 v[38:39], v246 offset:18432
    v_mfma_f32_16x16x32_bf16 v[128:131], v[12:15], v[76:79], v[128:131]
    v_mfma_f32_16x16x32_bf16 v[132:135], v[16:19], v[64:67], v[132:135]
    ds_read_b64_tr_b16 v[40:41], v247 offset:16384
    v_mfma_f32_16x16x32_bf16 v[136:139], v[16:19], v[68:71], v[136:139]
    ds_read_b64_tr_b16 v[42:43], v247 offset:18432
    v_mfma_f32_16x16x32_bf16 v[140:143], v[16:19], v[72:75], v[140:143]
    ds_read_b64_tr_b16 v[44:45], v248 offset:16384
    v_mfma_f32_16x16x32_bf16 v[144:147], v[16:19], v[76:79], v[144:147]
    v_mfma_f32_16x16x32_bf16 v[148:151], v[20:23], v[64:67], v[148:151]
    ds_read_b64_tr_b16 v[46:47], v248 offset:18432
    v_mfma_f32_16x16x32_bf16 v[152:155], v[20:23], v[68:71], v[152:155]
    ds_read_b64_tr_b16 v[48:49], v249 offset:16384
    v_mfma_f32_16x16x32_bf16 v[156:159], v[20:23], v[72:75], v[156:159]
    ds_read_b64_tr_b16 v[50:51], v249 offset:18432
    v_mfma_f32_16x16x32_bf16 v[160:163], v[20:23], v[76:79], v[160:163]
    v_mfma_f32_16x16x32_bf16 v[164:167], v[24:27], v[64:67], v[164:167]
    ds_read_b64_tr_b16 v[52:53], v250 offset:16384
    v_mfma_f32_16x16x32_bf16 v[168:171], v[24:27], v[68:71], v[168:171]
    ds_read_b64_tr_b16 v[54:55], v250 offset:18432
    v_mfma_f32_16x16x32_bf16 v[172:175], v[24:27], v[72:75], v[172:175]
    ds_read_b64_tr_b16 v[56:57], v251 offset:16384
    v_mfma_f32_16x16x32_bf16 v[176:179], v[24:27], v[76:79], v[176:179]
    v_mfma_f32_16x16x32_bf16 v[180:183], v[28:31], v[64:67], v[180:183]
    ds_read_b64_tr_b16 v[58:59], v251 offset:18432
    v_mfma_f32_16x16x32_bf16 v[184:187], v[28:31], v[68:71], v[184:187]
    ds_read_b64_tr_b16 v[60:61], v252 offset:16384
    v_mfma_f32_16x16x32_bf16 v[188:191], v[28:31], v[72:75], v[188:191]
    ds_read_b64_tr_b16 v[62:63], v252 offset:18432
    v_mfma_f32_16x16x32_bf16 v[192:195], v[28:31], v[76:79], v[192:195]
    v_mfma_f32_16x16x32_bf16 v[196:199], v[32:35], v[64:67], v[196:199]
    v_mfma_f32_16x16x32_bf16 v[200:203], v[32:35], v[68:71], v[200:203]
    v_mfma_f32_16x16x32_bf16 v[204:207], v[32:35], v[72:75], v[204:207]
    v_mfma_f32_16x16x32_bf16 v[208:211], v[32:35], v[76:79], v[208:211]
    s_waitcnt lgkmcnt(0)
    s_barrier
    v_lshrrev_b32 v3, 3, v1
    v_bfe_u32 v4, v1, 4, 1
    v_lshlrev_b32 v4, 2, v4
    v_and_b32 v5, 7, v1
    v_xor_b32 v4, v4, v5
    v_lshlrev_b32 v4, 4, v4
    v_lshl_add_u32 v10, v3, 11, v4
    s_lshl_b32 s33, s86, 15
    s_add_u32 s32, s33, 15360
    s_lshl_b32 s35, s86, 11
    s_lshl_b32 s34, s88, 7
    s_add_u32 s92, s76, s34
    s_addc_u32 s93, s77, 0
    s_mov_b32 s16, s92
    s_mov_b32 s17, s93
    s_mov_b32 s18, 0x700000
    s_mov_b32 s19, 0x00020000
    s_add_u32 s92, s68, s34
    s_addc_u32 s93, s69, 0
    s_mov_b32 s40, s92
    s_mov_b32 s41, s93
    s_mov_b32 s42, 0x200000
    s_mov_b32 s43, 0x00020000
    s_mul_i32 s94, s87, 1
    s_add_u32 s36, s94, s88
    s_and_b32 s36, s36, 3
    s_mov_b32 s12, s16
    s_mov_b32 s13, s17
    s_mov_b32 s14, s40
    s_mov_b32 s15, s41
    s_add_u32 s94, s36, 0
    s_and_b32 s94, s94, 3
    s_mul_i32 s94, s94, 262144
    s_add_u32 s16, s12, s94
    s_addc_u32 s17, s13, 0
    s_add_u32 s94, s36, 0
    s_and_b32 s94, s94, 3
    s_mul_i32 s94, s94, 262144
    s_add_u32 s40, s14, s94
    s_addc_u32 s41, s15, 0
    s_add_u32 m0, s35, 0
    s_nop 0
    buffer_load_dwordx4 v10, s[16:19], s33 offen lds
    buffer_load_dwordx4 v10, s[16:19], s32 offen offset:1024 lds
    s_add_u32 s16, s16, 131072
    s_addc_u32 s17, s17, 0
    s_add_u32 m0, s35, 8192
    s_nop 0
    buffer_load_dwordx4 v10, s[16:19], s33 offen lds
    buffer_load_dwordx4 v10, s[16:19], s32 offen offset:1024 lds
    s_add_u32 s94, s36, 1
    s_and_b32 s94, s94, 3
    s_mul_i32 s94, s94, 262144
    s_add_u32 s16, s12, s94
    s_addc_u32 s17, s13, 0
    s_add_u32 m0, s35, 16384
    s_nop 0
    buffer_load_dwordx4 v10, s[16:19], s33 offen lds
    buffer_load_dwordx4 v10, s[16:19], s32 offen offset:1024 lds
    s_add_u32 s16, s16, 131072
    s_addc_u32 s17, s17, 0
    s_add_u32 m0, s35, 24576
    s_nop 0
    buffer_load_dwordx4 v10, s[16:19], s33 offen lds
    buffer_load_dwordx4 v10, s[16:19], s32 offen offset:1024 lds
    s_add_u32 s94, s36, 2
    s_and_b32 s94, s94, 3
    s_mul_i32 s94, s94, 262144
    s_add_u32 s16, s12, s94
    s_addc_u32 s17, s13, 0
    v_mfma_f32_16x16x32_bf16 v[100:103], v[36:39], v[80:83], v[100:103]
    v_mfma_f32_16x16x32_bf16 v[104:107], v[36:39], v[84:87], v[104:107]
    v_mfma_f32_16x16x32_bf16 v[108:111], v[36:39], v[88:91], v[108:111]
    v_mfma_f32_16x16x32_bf16 v[112:115], v[36:39], v[92:95], v[112:115]
    v_mfma_f32_16x16x32_bf16 v[116:119], v[40:43], v[80:83], v[116:119]
    v_mfma_f32_16x16x32_bf16 v[120:123], v[40:43], v[84:87], v[120:123]
    v_mfma_f32_16x16x32_bf16 v[124:127], v[40:43], v[88:91], v[124:127]
    v_mfma_f32_16x16x32_bf16 v[128:131], v[40:43], v[92:95], v[128:131]
    v_mfma_f32_16x16x32_bf16 v[132:135], v[44:47], v[80:83], v[132:135]
    v_mfma_f32_16x16x32_bf16 v[136:139], v[44:47], v[84:87], v[136:139]
    v_mfma_f32_16x16x32_bf16 v[140:143], v[44:47], v[88:91], v[140:143]
    v_mfma_f32_16x16x32_bf16 v[144:147], v[44:47], v[92:95], v[144:147]
    v_mfma_f32_16x16x32_bf16 v[148:151], v[48:51], v[80:83], v[148:151]
    v_mfma_f32_16x16x32_bf16 v[152:155], v[48:51], v[84:87], v[152:155]
    v_mfma_f32_16x16x32_bf16 v[156:159], v[48:51], v[88:91], v[156:159]
    v_mfma_f32_16x16x32_bf16 v[160:163], v[48:51], v[92:95], v[160:163]
    v_mfma_f32_16x16x32_bf16 v[164:167], v[52:55], v[80:83], v[164:167]
    v_mfma_f32_16x16x32_bf16 v[168:171], v[52:55], v[84:87], v[168:171]
    v_mfma_f32_16x16x32_bf16 v[172:175], v[52:55], v[88:91], v[172:175]
    v_mfma_f32_16x16x32_bf16 v[176:179], v[52:55], v[92:95], v[176:179]
    v_mfma_f32_16x16x32_bf16 v[180:183], v[56:59], v[80:83], v[180:183]
    v_mfma_f32_16x16x32_bf16 v[184:187], v[56:59], v[84:87], v[184:187]
    v_mfma_f32_16x16x32_bf16 v[188:191], v[56:59], v[88:91], v[188:191]
    v_mfma_f32_16x16x32_bf16 v[192:195], v[56:59], v[92:95], v[192:195]
    v_mfma_f32_16x16x32_bf16 v[196:199], v[60:63], v[80:83], v[196:199]
    v_mfma_f32_16x16x32_bf16 v[200:203], v[60:63], v[84:87], v[200:203]
    v_mfma_f32_16x16x32_bf16 v[204:207], v[60:63], v[88:91], v[204:207]
    v_mfma_f32_16x16x32_bf16 v[208:211], v[60:63], v[92:95], v[208:211]
    s_setprio 3
    s_mov_b32 s44, 0x3fb8aa3b
    s_mov_b32 s45, s44
    s_mov_b32 s46, 0xc0000000
    s_mov_b32 s47, s46
    s_add_u32 s92, s84, 0x400000
    s_addc_u32 s93, s85, 0
    s_mov_b32 s20, s92
    s_mov_b32 s21, s93
    s_mov_b32 s22, 0xe00000
    s_mov_b32 s23, 0x00020000
    s_lshl_b32 s91, s87, 2
    s_lshl_b32 s94, s37, 1
    s_add_u32 s91, s91, s94
    s_mul_i32 s91, s91, 224
    s_mul_i32 s94, s88, 14
    s_add_u32 s91, s91, s94
    s_mul_i32 s94, s38, 7
    s_add_u32 s91, s91, s94
    s_lshl_b32 s56, s91, 10
    s_add_u32 s57, s56, 229376
    s_add_u32 s58, s56, 4096
    s_add_u32 s59, s57, 4096
    s_nop 7
    v_pk_mul_f32 v[212:213], v[100:101], s[44:45]
    v_pk_mul_f32 v[214:215], v[102:103], s[44:45]
    v_pk_mul_f32 v[216:217], v[104:105], s[44:45]
    v_pk_mul_f32 v[218:219], v[106:107], s[44:45]
    v_exp_f32 v212, v212
    v_exp_f32 v213, v213
    v_exp_f32 v214, v214
    v_exp_f32 v215, v215
    v_exp_f32 v216, v216
    v_exp_f32 v217, v217
    v_exp_f32 v218, v218
    v_exp_f32 v219, v219
    v_pk_add_f32 v[220:221], v[212:213], 2.0 op_sel_hi:[1,0]
    v_pk_add_f32 v[222:223], v[214:215], 2.0 op_sel_hi:[1,0]
    v_pk_add_f32 v[224:225], v[216:217], 2.0 op_sel_hi:[1,0]
    v_pk_add_f32 v[226:227], v[218:219], 2.0 op_sel_hi:[1,0]
    v_pk_fma_f32 v[212:213], v[212:213], v[220:221], 2.0 op_sel_hi:[1,1,0]
    v_pk_fma_f32 v[214:215], v[214:215], v[222:223], 2.0 op_sel_hi:[1,1,0]
    v_pk_fma_f32 v[216:217], v[216:217], v[224:225], 2.0 op_sel_hi:[1,1,0]
    v_pk_fma_f32 v[218:219], v[218:219], v[226:227], 2.0 op_sel_hi:[1,1,0]
    v_rcp_f32 v212, v212
    v_rcp_f32 v213, v213
    v_rcp_f32 v214, v214
    v_rcp_f32 v215, v215
    v_rcp_f32 v216, v216
    v_rcp_f32 v217, v217
    v_rcp_f32 v218, v218
    v_rcp_f32 v219, v219
    v_pk_fma_f32 v[212:213], v[212:213], s[46:47], 1.0 op_sel_hi:[1,1,0]
    v_pk_fma_f32 v[214:215], v[214:215], s[46:47], 1.0 op_sel_hi:[1,1,0]
    v_pk_fma_f32 v[216:217], v[216:217], s[46:47], 1.0 op_sel_hi:[1,1,0]
    v_pk_fma_f32 v[218:219], v[218:219], s[46:47], 1.0 op_sel_hi:[1,1,0]
    v_pk_mul_f32 v[212:213], v[212:213], v[100:101]
    v_pk_mul_f32 v[214:215], v[214:215], v[102:103]
    v_pk_mul_f32 v[216:217], v[216:217], v[104:105]
    v_pk_mul_f32 v[218:219], v[218:219], v[106:107]
    v_cvt_pk_bf16_f32 v224, v212, v213
    v_cvt_pk_bf16_f32 v225, v214, v215
    v_cvt_pk_bf16_f32 v226, v216, v217
    v_cvt_pk_bf16_f32 v227, v218, v219
    s_nop 1
    v_permlane16_swap_b32 v224, v226
    v_permlane16_swap_b32 v225, v227
    buffer_store_dwordx4 v[224:227], v2, s[20:23], s56 offen offset:0 sc1
    v_pk_mul_f32 v[228:229], v[108:109], s[44:45]
    v_pk_mul_f32 v[230:231], v[110:111], s[44:45]
    v_pk_mul_f32 v[232:233], v[112:113], s[44:45]
    v_pk_mul_f32 v[234:235], v[114:115], s[44:45]
    v_exp_f32 v228, v228
    v_exp_f32 v229, v229
    v_exp_f32 v230, v230
    v_exp_f32 v231, v231
    v_exp_f32 v232, v232
    v_exp_f32 v233, v233
    v_exp_f32 v234, v234
    v_exp_f32 v235, v235
    v_pk_add_f32 v[236:237], v[228:229], 2.0 op_sel_hi:[1,0]
    v_pk_add_f32 v[238:239], v[230:231], 2.0 op_sel_hi:[1,0]
    v_pk_add_f32 v[240:241], v[232:233], 2.0 op_sel_hi:[1,0]
    v_pk_add_f32 v[242:243], v[234:235], 2.0 op_sel_hi:[1,0]
    v_pk_fma_f32 v[228:229], v[228:229], v[236:237], 2.0 op_sel_hi:[1,1,0]
    v_pk_fma_f32 v[230:231], v[230:231], v[238:239], 2.0 op_sel_hi:[1,1,0]
    v_pk_fma_f32 v[232:233], v[232:233], v[240:241], 2.0 op_sel_hi:[1,1,0]
    v_pk_fma_f32 v[234:235], v[234:235], v[242:243], 2.0 op_sel_hi:[1,1,0]
    v_rcp_f32 v228, v228
    v_rcp_f32 v229, v229
    v_rcp_f32 v230, v230
    v_rcp_f32 v231, v231
    v_rcp_f32 v232, v232
    v_rcp_f32 v233, v233
    v_rcp_f32 v234, v234
    v_rcp_f32 v235, v235
    v_pk_fma_f32 v[228:229], v[228:229], s[46:47], 1.0 op_sel_hi:[1,1,0]
    v_pk_fma_f32 v[230:231], v[230:231], s[46:47], 1.0 op_sel_hi:[1,1,0]
    v_pk_fma_f32 v[232:233], v[232:233], s[46:47], 1.0 op_sel_hi:[1,1,0]
    v_pk_fma_f32 v[234:235], v[234:235], s[46:47], 1.0 op_sel_hi:[1,1,0]
    v_pk_mul_f32 v[228:229], v[228:229], v[108:109]
    v_pk_mul_f32 v[230:231], v[230:231], v[110:111]
    v_pk_mul_f32 v[232:233], v[232:233], v[112:113]
    v_pk_mul_f32 v[234:235], v[234:235], v[114:115]
    v_cvt_pk_bf16_f32 v240, v228, v229
    v_cvt_pk_bf16_f32 v241, v230, v231
    v_cvt_pk_bf16_f32 v242, v232, v233
    v_cvt_pk_bf16_f32 v243, v234, v235
    s_nop 1
    v_permlane16_swap_b32 v240, v242
    v_permlane16_swap_b32 v241, v243
    buffer_store_dwordx4 v[240:243], v2, s[20:23], s57 offen offset:0 sc1
    v_pk_mul_f32 v[212:213], v[116:117], s[44:45]
    v_pk_mul_f32 v[214:215], v[118:119], s[44:45]
    v_pk_mul_f32 v[216:217], v[120:121], s[44:45]
    v_pk_mul_f32 v[218:219], v[122:123], s[44:45]
    v_exp_f32 v212, v212
    v_exp_f32 v213, v213
    v_exp_f32 v214, v214
    v_exp_f32 v215, v215
    v_exp_f32 v216, v216
    v_exp_f32 v217, v217
    v_exp_f32 v218, v218
    v_exp_f32 v219, v219
    v_pk_add_f32 v[220:221], v[212:213], 2.0 op_sel_hi:[1,0]
    v_pk_add_f32 v[222:223], v[214:215], 2.0 op_sel_hi:[1,0]
    v_pk_add_f32 v[224:225], v[216:217], 2.0 op_sel_hi:[1,0]
    v_pk_add_f32 v[226:227], v[218:219], 2.0 op_sel_hi:[1,0]
    v_pk_fma_f32 v[212:213], v[212:213], v[220:221], 2.0 op_sel_hi:[1,1,0]
    v_pk_fma_f32 v[214:215], v[214:215], v[222:223], 2.0 op_sel_hi:[1,1,0]
    v_pk_fma_f32 v[216:217], v[216:217], v[224:225], 2.0 op_sel_hi:[1,1,0]
    v_pk_fma_f32 v[218:219], v[218:219], v[226:227], 2.0 op_sel_hi:[1,1,0]
    v_rcp_f32 v212, v212
    v_rcp_f32 v213, v213
    v_rcp_f32 v214, v214
    v_rcp_f32 v215, v215
    v_rcp_f32 v216, v216
    v_rcp_f32 v217, v217
    v_rcp_f32 v218, v218
    v_rcp_f32 v219, v219
    v_pk_fma_f32 v[212:213], v[212:213], s[46:47], 1.0 op_sel_hi:[1,1,0]
    v_pk_fma_f32 v[214:215], v[214:215], s[46:47], 1.0 op_sel_hi:[1,1,0]
    v_pk_fma_f32 v[216:217], v[216:217], s[46:47], 1.0 op_sel_hi:[1,1,0]
    v_pk_fma_f32 v[218:219], v[218:219], s[46:47], 1.0 op_sel_hi:[1,1,0]
    v_pk_mul_f32 v[212:213], v[212:213], v[116:117]
    v_pk_mul_f32 v[214:215], v[214:215], v[118:119]
    v_pk_mul_f32 v[216:217], v[216:217], v[120:121]
    v_pk_mul_f32 v[218:219], v[218:219], v[122:123]
    v_cvt_pk_bf16_f32 v224, v212, v213
    v_cvt_pk_bf16_f32 v225, v214, v215
    v_cvt_pk_bf16_f32 v226, v216, v217
    v_cvt_pk_bf16_f32 v227, v218, v219
    s_nop 1
    v_permlane16_swap_b32 v224, v226
    v_permlane16_swap_b32 v225, v227
    buffer_store_dwordx4 v[224:227], v2, s[20:23], s56 offen offset:1024 sc1
    v_pk_mul_f32 v[228:229], v[124:125], s[44:45]
    v_pk_mul_f32 v[230:231], v[126:127], s[44:45]
    v_pk_mul_f32 v[232:233], v[128:129], s[44:45]
    v_pk_mul_f32 v[234:235], v[130:131], s[44:45]
    v_exp_f32 v228, v228
    v_exp_f32 v229, v229
    v_exp_f32 v230, v230
    v_exp_f32 v231, v231
    v_exp_f32 v232, v232
    v_exp_f32 v233, v233
    v_exp_f32 v234, v234
    v_exp_f32 v235, v235
    v_pk_add_f32 v[236:237], v[228:229], 2.0 op_sel_hi:[1,0]
    v_pk_add_f32 v[238:239], v[230:231], 2.0 op_sel_hi:[1,0]
    v_pk_add_f32 v[240:241], v[232:233], 2.0 op_sel_hi:[1,0]
    v_pk_add_f32 v[242:243], v[234:235], 2.0 op_sel_hi:[1,0]
    v_pk_fma_f32 v[228:229], v[228:229], v[236:237], 2.0 op_sel_hi:[1,1,0]
    v_pk_fma_f32 v[230:231], v[230:231], v[238:239], 2.0 op_sel_hi:[1,1,0]
    v_pk_fma_f32 v[232:233], v[232:233], v[240:241], 2.0 op_sel_hi:[1,1,0]
    v_pk_fma_f32 v[234:235], v[234:235], v[242:243], 2.0 op_sel_hi:[1,1,0]
    v_rcp_f32 v228, v228
    v_rcp_f32 v229, v229
    v_rcp_f32 v230, v230
    v_rcp_f32 v231, v231
    v_rcp_f32 v232, v232
    v_rcp_f32 v233, v233
    v_rcp_f32 v234, v234
    v_rcp_f32 v235, v235
    v_pk_fma_f32 v[228:229], v[228:229], s[46:47], 1.0 op_sel_hi:[1,1,0]
    v_pk_fma_f32 v[230:231], v[230:231], s[46:47], 1.0 op_sel_hi:[1,1,0]
    v_pk_fma_f32 v[232:233], v[232:233], s[46:47], 1.0 op_sel_hi:[1,1,0]
    v_pk_fma_f32 v[234:235], v[234:235], s[46:47], 1.0 op_sel_hi:[1,1,0]
    v_pk_mul_f32 v[228:229], v[228:229], v[124:125]
    v_pk_mul_f32 v[230:231], v[230:231], v[126:127]
    v_pk_mul_f32 v[232:233], v[232:233], v[128:129]
    v_pk_mul_f32 v[234:235], v[234:235], v[130:131]
    v_cvt_pk_bf16_f32 v240, v228, v229
    v_cvt_pk_bf16_f32 v241, v230, v231
    v_cvt_pk_bf16_f32 v242, v232, v233
    v_cvt_pk_bf16_f32 v243, v234, v235
    s_nop 1
    v_permlane16_swap_b32 v240, v242
    v_permlane16_swap_b32 v241, v243
    buffer_store_dwordx4 v[240:243], v2, s[20:23], s57 offen offset:1024 sc1
    v_pk_mul_f32 v[212:213], v[132:133], s[44:45]
    v_pk_mul_f32 v[214:215], v[134:135], s[44:45]
    v_pk_mul_f32 v[216:217], v[136:137], s[44:45]
    v_pk_mul_f32 v[218:219], v[138:139], s[44:45]
    v_exp_f32 v212, v212
    v_exp_f32 v213, v213
    v_exp_f32 v214, v214
    v_exp_f32 v215, v215
    v_exp_f32 v216, v216
    v_exp_f32 v217, v217
    v_exp_f32 v218, v218
    v_exp_f32 v219, v219
    v_pk_add_f32 v[220:221], v[212:213], 2.0 op_sel_hi:[1,0]
    v_pk_add_f32 v[222:223], v[214:215], 2.0 op_sel_hi:[1,0]
    v_pk_add_f32 v[224:225], v[216:217], 2.0 op_sel_hi:[1,0]
    v_pk_add_f32 v[226:227], v[218:219], 2.0 op_sel_hi:[1,0]
    v_pk_fma_f32 v[212:213], v[212:213], v[220:221], 2.0 op_sel_hi:[1,1,0]
    v_pk_fma_f32 v[214:215], v[214:215], v[222:223], 2.0 op_sel_hi:[1,1,0]
    v_pk_fma_f32 v[216:217], v[216:217], v[224:225], 2.0 op_sel_hi:[1,1,0]
    v_pk_fma_f32 v[218:219], v[218:219], v[226:227], 2.0 op_sel_hi:[1,1,0]
    v_rcp_f32 v212, v212
    v_rcp_f32 v213, v213
    v_rcp_f32 v214, v214
    v_rcp_f32 v215, v215
    v_rcp_f32 v216, v216
    v_rcp_f32 v217, v217
    v_rcp_f32 v218, v218
    v_rcp_f32 v219, v219
    v_pk_fma_f32 v[212:213], v[212:213], s[46:47], 1.0 op_sel_hi:[1,1,0]
    v_pk_fma_f32 v[214:215], v[214:215], s[46:47], 1.0 op_sel_hi:[1,1,0]
    v_pk_fma_f32 v[216:217], v[216:217], s[46:47], 1.0 op_sel_hi:[1,1,0]
    v_pk_fma_f32 v[218:219], v[218:219], s[46:47], 1.0 op_sel_hi:[1,1,0]
    v_pk_mul_f32 v[212:213], v[212:213], v[132:133]
    v_pk_mul_f32 v[214:215], v[214:215], v[134:135]
    v_pk_mul_f32 v[216:217], v[216:217], v[136:137]
    v_pk_mul_f32 v[218:219], v[218:219], v[138:139]
    v_cvt_pk_bf16_f32 v224, v212, v213
    v_cvt_pk_bf16_f32 v225, v214, v215
    v_cvt_pk_bf16_f32 v226, v216, v217
    v_cvt_pk_bf16_f32 v227, v218, v219
    s_nop 1
    v_permlane16_swap_b32 v224, v226
    v_permlane16_swap_b32 v225, v227
    buffer_store_dwordx4 v[224:227], v2, s[20:23], s56 offen offset:2048 sc1
    v_pk_mul_f32 v[228:229], v[140:141], s[44:45]
    v_pk_mul_f32 v[230:231], v[142:143], s[44:45]
    v_pk_mul_f32 v[232:233], v[144:145], s[44:45]
    v_pk_mul_f32 v[234:235], v[146:147], s[44:45]
    v_exp_f32 v228, v228
    v_exp_f32 v229, v229
    v_exp_f32 v230, v230
    v_exp_f32 v231, v231
    v_exp_f32 v232, v232
    v_exp_f32 v233, v233
    v_exp_f32 v234, v234
    v_exp_f32 v235, v235
    v_pk_add_f32 v[236:237], v[228:229], 2.0 op_sel_hi:[1,0]
    v_pk_add_f32 v[238:239], v[230:231], 2.0 op_sel_hi:[1,0]
    v_pk_add_f32 v[240:241], v[232:233], 2.0 op_sel_hi:[1,0]
    v_pk_add_f32 v[242:243], v[234:235], 2.0 op_sel_hi:[1,0]
    v_pk_fma_f32 v[228:229], v[228:229], v[236:237], 2.0 op_sel_hi:[1,1,0]
    v_pk_fma_f32 v[230:231], v[230:231], v[238:239], 2.0 op_sel_hi:[1,1,0]
    v_pk_fma_f32 v[232:233], v[232:233], v[240:241], 2.0 op_sel_hi:[1,1,0]
    v_pk_fma_f32 v[234:235], v[234:235], v[242:243], 2.0 op_sel_hi:[1,1,0]
    v_rcp_f32 v228, v228
    v_rcp_f32 v229, v229
    v_rcp_f32 v230, v230
    v_rcp_f32 v231, v231
    v_rcp_f32 v232, v232
    v_rcp_f32 v233, v233
    v_rcp_f32 v234, v234
    v_rcp_f32 v235, v235
    v_pk_fma_f32 v[228:229], v[228:229], s[46:47], 1.0 op_sel_hi:[1,1,0]
    v_pk_fma_f32 v[230:231], v[230:231], s[46:47], 1.0 op_sel_hi:[1,1,0]
    v_pk_fma_f32 v[232:233], v[232:233], s[46:47], 1.0 op_sel_hi:[1,1,0]
    v_pk_fma_f32 v[234:235], v[234:235], s[46:47], 1.0 op_sel_hi:[1,1,0]
    v_pk_mul_f32 v[228:229], v[228:229], v[140:141]
    v_pk_mul_f32 v[230:231], v[230:231], v[142:143]
    v_pk_mul_f32 v[232:233], v[232:233], v[144:145]
    v_pk_mul_f32 v[234:235], v[234:235], v[146:147]
    v_cvt_pk_bf16_f32 v240, v228, v229
    v_cvt_pk_bf16_f32 v241, v230, v231
    v_cvt_pk_bf16_f32 v242, v232, v233
    v_cvt_pk_bf16_f32 v243, v234, v235
    s_nop 1
    v_permlane16_swap_b32 v240, v242
    v_permlane16_swap_b32 v241, v243
    buffer_store_dwordx4 v[240:243], v2, s[20:23], s57 offen offset:2048 sc1
    v_pk_mul_f32 v[212:213], v[148:149], s[44:45]
    v_pk_mul_f32 v[214:215], v[150:151], s[44:45]
    v_pk_mul_f32 v[216:217], v[152:153], s[44:45]
    v_pk_mul_f32 v[218:219], v[154:155], s[44:45]
    v_exp_f32 v212, v212
    v_exp_f32 v213, v213
    v_exp_f32 v214, v214
    v_exp_f32 v215, v215
    v_exp_f32 v216, v216
    v_exp_f32 v217, v217
    v_exp_f32 v218, v218
    v_exp_f32 v219, v219
    v_pk_add_f32 v[220:221], v[212:213], 2.0 op_sel_hi:[1,0]
    v_pk_add_f32 v[222:223], v[214:215], 2.0 op_sel_hi:[1,0]
    v_pk_add_f32 v[224:225], v[216:217], 2.0 op_sel_hi:[1,0]
    v_pk_add_f32 v[226:227], v[218:219], 2.0 op_sel_hi:[1,0]
    v_pk_fma_f32 v[212:213], v[212:213], v[220:221], 2.0 op_sel_hi:[1,1,0]
    v_pk_fma_f32 v[214:215], v[214:215], v[222:223], 2.0 op_sel_hi:[1,1,0]
    v_pk_fma_f32 v[216:217], v[216:217], v[224:225], 2.0 op_sel_hi:[1,1,0]
    v_pk_fma_f32 v[218:219], v[218:219], v[226:227], 2.0 op_sel_hi:[1,1,0]
    v_rcp_f32 v212, v212
    v_rcp_f32 v213, v213
    v_rcp_f32 v214, v214
    v_rcp_f32 v215, v215
    v_rcp_f32 v216, v216
    v_rcp_f32 v217, v217
    v_rcp_f32 v218, v218
    v_rcp_f32 v219, v219
    v_pk_fma_f32 v[212:213], v[212:213], s[46:47], 1.0 op_sel_hi:[1,1,0]
    v_pk_fma_f32 v[214:215], v[214:215], s[46:47], 1.0 op_sel_hi:[1,1,0]
    v_pk_fma_f32 v[216:217], v[216:217], s[46:47], 1.0 op_sel_hi:[1,1,0]
    v_pk_fma_f32 v[218:219], v[218:219], s[46:47], 1.0 op_sel_hi:[1,1,0]
    v_pk_mul_f32 v[212:213], v[212:213], v[148:149]
    v_pk_mul_f32 v[214:215], v[214:215], v[150:151]
    v_pk_mul_f32 v[216:217], v[216:217], v[152:153]
    v_pk_mul_f32 v[218:219], v[218:219], v[154:155]
    v_cvt_pk_bf16_f32 v224, v212, v213
    v_cvt_pk_bf16_f32 v225, v214, v215
    v_cvt_pk_bf16_f32 v226, v216, v217
    v_cvt_pk_bf16_f32 v227, v218, v219
    s_nop 1
    v_permlane16_swap_b32 v224, v226
    v_permlane16_swap_b32 v225, v227
    buffer_store_dwordx4 v[224:227], v2, s[20:23], s56 offen offset:3072 sc1
    v_pk_mul_f32 v[228:229], v[156:157], s[44:45]
    v_pk_mul_f32 v[230:231], v[158:159], s[44:45]
    v_pk_mul_f32 v[232:233], v[160:161], s[44:45]
    v_pk_mul_f32 v[234:235], v[162:163], s[44:45]
    v_exp_f32 v228, v228
    v_exp_f32 v229, v229
    v_exp_f32 v230, v230
    v_exp_f32 v231, v231
    v_exp_f32 v232, v232
    v_exp_f32 v233, v233
    v_exp_f32 v234, v234
    v_exp_f32 v235, v235
    v_pk_add_f32 v[236:237], v[228:229], 2.0 op_sel_hi:[1,0]
    v_pk_add_f32 v[238:239], v[230:231], 2.0 op_sel_hi:[1,0]
    v_pk_add_f32 v[240:241], v[232:233], 2.0 op_sel_hi:[1,0]
    v_pk_add_f32 v[242:243], v[234:235], 2.0 op_sel_hi:[1,0]
    v_pk_fma_f32 v[228:229], v[228:229], v[236:237], 2.0 op_sel_hi:[1,1,0]
    v_pk_fma_f32 v[230:231], v[230:231], v[238:239], 2.0 op_sel_hi:[1,1,0]
    v_pk_fma_f32 v[232:233], v[232:233], v[240:241], 2.0 op_sel_hi:[1,1,0]
    v_pk_fma_f32 v[234:235], v[234:235], v[242:243], 2.0 op_sel_hi:[1,1,0]
    v_rcp_f32 v228, v228
    v_rcp_f32 v229, v229
    v_rcp_f32 v230, v230
    v_rcp_f32 v231, v231
    v_rcp_f32 v232, v232
    v_rcp_f32 v233, v233
    v_rcp_f32 v234, v234
    v_rcp_f32 v235, v235
    v_pk_fma_f32 v[228:229], v[228:229], s[46:47], 1.0 op_sel_hi:[1,1,0]
    v_pk_fma_f32 v[230:231], v[230:231], s[46:47], 1.0 op_sel_hi:[1,1,0]
    v_pk_fma_f32 v[232:233], v[232:233], s[46:47], 1.0 op_sel_hi:[1,1,0]
    v_pk_fma_f32 v[234:235], v[234:235], s[46:47], 1.0 op_sel_hi:[1,1,0]
    v_pk_mul_f32 v[228:229], v[228:229], v[156:157]
    v_pk_mul_f32 v[230:231], v[230:231], v[158:159]
    v_pk_mul_f32 v[232:233], v[232:233], v[160:161]
    v_pk_mul_f32 v[234:235], v[234:235], v[162:163]
    v_cvt_pk_bf16_f32 v240, v228, v229
    v_cvt_pk_bf16_f32 v241, v230, v231
    v_cvt_pk_bf16_f32 v242, v232, v233
    v_cvt_pk_bf16_f32 v243, v234, v235
    s_nop 1
    v_permlane16_swap_b32 v240, v242
    v_permlane16_swap_b32 v241, v243
    buffer_store_dwordx4 v[240:243], v2, s[20:23], s57 offen offset:3072 sc1
    v_pk_mul_f32 v[212:213], v[164:165], s[44:45]
    v_pk_mul_f32 v[214:215], v[166:167], s[44:45]
    v_pk_mul_f32 v[216:217], v[168:169], s[44:45]
    v_pk_mul_f32 v[218:219], v[170:171], s[44:45]
    v_exp_f32 v212, v212
    v_exp_f32 v213, v213
    v_exp_f32 v214, v214
    v_exp_f32 v215, v215
    v_exp_f32 v216, v216
    v_exp_f32 v217, v217
    v_exp_f32 v218, v218
    v_exp_f32 v219, v219
    v_pk_add_f32 v[220:221], v[212:213], 2.0 op_sel_hi:[1,0]
    v_pk_add_f32 v[222:223], v[214:215], 2.0 op_sel_hi:[1,0]
    v_pk_add_f32 v[224:225], v[216:217], 2.0 op_sel_hi:[1,0]
    v_pk_add_f32 v[226:227], v[218:219], 2.0 op_sel_hi:[1,0]
    v_pk_fma_f32 v[212:213], v[212:213], v[220:221], 2.0 op_sel_hi:[1,1,0]
    v_pk_fma_f32 v[214:215], v[214:215], v[222:223], 2.0 op_sel_hi:[1,1,0]
    v_pk_fma_f32 v[216:217], v[216:217], v[224:225], 2.0 op_sel_hi:[1,1,0]
    v_pk_fma_f32 v[218:219], v[218:219], v[226:227], 2.0 op_sel_hi:[1,1,0]
    v_rcp_f32 v212, v212
    v_rcp_f32 v213, v213
    v_rcp_f32 v214, v214
    v_rcp_f32 v215, v215
    v_rcp_f32 v216, v216
    v_rcp_f32 v217, v217
    v_rcp_f32 v218, v218
    v_rcp_f32 v219, v219
    v_pk_fma_f32 v[212:213], v[212:213], s[46:47], 1.0 op_sel_hi:[1,1,0]
    v_pk_fma_f32 v[214:215], v[214:215], s[46:47], 1.0 op_sel_hi:[1,1,0]
    v_pk_fma_f32 v[216:217], v[216:217], s[46:47], 1.0 op_sel_hi:[1,1,0]
    v_pk_fma_f32 v[218:219], v[218:219], s[46:47], 1.0 op_sel_hi:[1,1,0]
    v_pk_mul_f32 v[212:213], v[212:213], v[164:165]
    v_pk_mul_f32 v[214:215], v[214:215], v[166:167]
    v_pk_mul_f32 v[216:217], v[216:217], v[168:169]
    v_pk_mul_f32 v[218:219], v[218:219], v[170:171]
    v_cvt_pk_bf16_f32 v224, v212, v213
    v_cvt_pk_bf16_f32 v225, v214, v215
    v_cvt_pk_bf16_f32 v226, v216, v217
    v_cvt_pk_bf16_f32 v227, v218, v219
    s_nop 1
    v_permlane16_swap_b32 v224, v226
    v_permlane16_swap_b32 v225, v227
    buffer_store_dwordx4 v[224:227], v2, s[20:23], s58 offen offset:0 sc1
    v_pk_mul_f32 v[228:229], v[172:173], s[44:45]
    v_pk_mul_f32 v[230:231], v[174:175], s[44:45]
    v_pk_mul_f32 v[232:233], v[176:177], s[44:45]
    v_pk_mul_f32 v[234:235], v[178:179], s[44:45]
    v_exp_f32 v228, v228
    v_exp_f32 v229, v229
    v_exp_f32 v230, v230
    v_exp_f32 v231, v231
    v_exp_f32 v232, v232
    v_exp_f32 v233, v233
    v_exp_f32 v234, v234
    v_exp_f32 v235, v235
    v_pk_add_f32 v[236:237], v[228:229], 2.0 op_sel_hi:[1,0]
    v_pk_add_f32 v[238:239], v[230:231], 2.0 op_sel_hi:[1,0]
    v_pk_add_f32 v[240:241], v[232:233], 2.0 op_sel_hi:[1,0]
    v_pk_add_f32 v[242:243], v[234:235], 2.0 op_sel_hi:[1,0]
    v_pk_fma_f32 v[228:229], v[228:229], v[236:237], 2.0 op_sel_hi:[1,1,0]
    v_pk_fma_f32 v[230:231], v[230:231], v[238:239], 2.0 op_sel_hi:[1,1,0]
    v_pk_fma_f32 v[232:233], v[232:233], v[240:241], 2.0 op_sel_hi:[1,1,0]
    v_pk_fma_f32 v[234:235], v[234:235], v[242:243], 2.0 op_sel_hi:[1,1,0]
    v_rcp_f32 v228, v228
    v_rcp_f32 v229, v229
    v_rcp_f32 v230, v230
    v_rcp_f32 v231, v231
    v_rcp_f32 v232, v232
    v_rcp_f32 v233, v233
    v_rcp_f32 v234, v234
    v_rcp_f32 v235, v235
    v_pk_fma_f32 v[228:229], v[228:229], s[46:47], 1.0 op_sel_hi:[1,1,0]
    v_pk_fma_f32 v[230:231], v[230:231], s[46:47], 1.0 op_sel_hi:[1,1,0]
    v_pk_fma_f32 v[232:233], v[232:233], s[46:47], 1.0 op_sel_hi:[1,1,0]
    v_pk_fma_f32 v[234:235], v[234:235], s[46:47], 1.0 op_sel_hi:[1,1,0]
    v_pk_mul_f32 v[228:229], v[228:229], v[172:173]
    v_pk_mul_f32 v[230:231], v[230:231], v[174:175]
    v_pk_mul_f32 v[232:233], v[232:233], v[176:177]
    v_pk_mul_f32 v[234:235], v[234:235], v[178:179]
    v_cvt_pk_bf16_f32 v240, v228, v229
    v_cvt_pk_bf16_f32 v241, v230, v231
    v_cvt_pk_bf16_f32 v242, v232, v233
    v_cvt_pk_bf16_f32 v243, v234, v235
    s_nop 1
    v_permlane16_swap_b32 v240, v242
    v_permlane16_swap_b32 v241, v243
    buffer_store_dwordx4 v[240:243], v2, s[20:23], s59 offen offset:0 sc1
    v_pk_mul_f32 v[212:213], v[180:181], s[44:45]
    v_pk_mul_f32 v[214:215], v[182:183], s[44:45]
    v_pk_mul_f32 v[216:217], v[184:185], s[44:45]
    v_pk_mul_f32 v[218:219], v[186:187], s[44:45]
    v_exp_f32 v212, v212
    v_exp_f32 v213, v213
    v_exp_f32 v214, v214
    v_exp_f32 v215, v215
    v_exp_f32 v216, v216
    v_exp_f32 v217, v217
    v_exp_f32 v218, v218
    v_exp_f32 v219, v219
    v_pk_add_f32 v[220:221], v[212:213], 2.0 op_sel_hi:[1,0]
    v_pk_add_f32 v[222:223], v[214:215], 2.0 op_sel_hi:[1,0]
    v_pk_add_f32 v[224:225], v[216:217], 2.0 op_sel_hi:[1,0]
    v_pk_add_f32 v[226:227], v[218:219], 2.0 op_sel_hi:[1,0]
    v_pk_fma_f32 v[212:213], v[212:213], v[220:221], 2.0 op_sel_hi:[1,1,0]
    v_pk_fma_f32 v[214:215], v[214:215], v[222:223], 2.0 op_sel_hi:[1,1,0]
    v_pk_fma_f32 v[216:217], v[216:217], v[224:225], 2.0 op_sel_hi:[1,1,0]
    v_pk_fma_f32 v[218:219], v[218:219], v[226:227], 2.0 op_sel_hi:[1,1,0]
    v_rcp_f32 v212, v212
    v_rcp_f32 v213, v213
    v_rcp_f32 v214, v214
    v_rcp_f32 v215, v215
    v_rcp_f32 v216, v216
    v_rcp_f32 v217, v217
    v_rcp_f32 v218, v218
    v_rcp_f32 v219, v219
    v_pk_fma_f32 v[212:213], v[212:213], s[46:47], 1.0 op_sel_hi:[1,1,0]
    v_pk_fma_f32 v[214:215], v[214:215], s[46:47], 1.0 op_sel_hi:[1,1,0]
    v_pk_fma_f32 v[216:217], v[216:217], s[46:47], 1.0 op_sel_hi:[1,1,0]
    v_pk_fma_f32 v[218:219], v[218:219], s[46:47], 1.0 op_sel_hi:[1,1,0]
    v_pk_mul_f32 v[212:213], v[212:213], v[180:181]
    v_pk_mul_f32 v[214:215], v[214:215], v[182:183]
    v_pk_mul_f32 v[216:217], v[216:217], v[184:185]
    v_pk_mul_f32 v[218:219], v[218:219], v[186:187]
    v_cvt_pk_bf16_f32 v224, v212, v213
    v_cvt_pk_bf16_f32 v225, v214, v215
    v_cvt_pk_bf16_f32 v226, v216, v217
    v_cvt_pk_bf16_f32 v227, v218, v219
    s_nop 1
    v_permlane16_swap_b32 v224, v226
    v_permlane16_swap_b32 v225, v227
    buffer_store_dwordx4 v[224:227], v2, s[20:23], s58 offen offset:1024 sc1
    v_pk_mul_f32 v[228:229], v[188:189], s[44:45]
    v_pk_mul_f32 v[230:231], v[190:191], s[44:45]
    v_pk_mul_f32 v[232:233], v[192:193], s[44:45]
    v_pk_mul_f32 v[234:235], v[194:195], s[44:45]
    v_exp_f32 v228, v228
    v_exp_f32 v229, v229
    v_exp_f32 v230, v230
    v_exp_f32 v231, v231
    v_exp_f32 v232, v232
    v_exp_f32 v233, v233
    v_exp_f32 v234, v234
    v_exp_f32 v235, v235
    v_pk_add_f32 v[236:237], v[228:229], 2.0 op_sel_hi:[1,0]
    v_pk_add_f32 v[238:239], v[230:231], 2.0 op_sel_hi:[1,0]
    v_pk_add_f32 v[240:241], v[232:233], 2.0 op_sel_hi:[1,0]
    v_pk_add_f32 v[242:243], v[234:235], 2.0 op_sel_hi:[1,0]
    v_pk_fma_f32 v[228:229], v[228:229], v[236:237], 2.0 op_sel_hi:[1,1,0]
    v_pk_fma_f32 v[230:231], v[230:231], v[238:239], 2.0 op_sel_hi:[1,1,0]
    v_pk_fma_f32 v[232:233], v[232:233], v[240:241], 2.0 op_sel_hi:[1,1,0]
    v_pk_fma_f32 v[234:235], v[234:235], v[242:243], 2.0 op_sel_hi:[1,1,0]
    v_rcp_f32 v228, v228
    v_rcp_f32 v229, v229
    v_rcp_f32 v230, v230
    v_rcp_f32 v231, v231
    v_rcp_f32 v232, v232
    v_rcp_f32 v233, v233
    v_rcp_f32 v234, v234
    v_rcp_f32 v235, v235
    v_pk_fma_f32 v[228:229], v[228:229], s[46:47], 1.0 op_sel_hi:[1,1,0]
    v_pk_fma_f32 v[230:231], v[230:231], s[46:47], 1.0 op_sel_hi:[1,1,0]
    v_pk_fma_f32 v[232:233], v[232:233], s[46:47], 1.0 op_sel_hi:[1,1,0]
    v_pk_fma_f32 v[234:235], v[234:235], s[46:47], 1.0 op_sel_hi:[1,1,0]
    v_pk_mul_f32 v[228:229], v[228:229], v[188:189]
    v_pk_mul_f32 v[230:231], v[230:231], v[190:191]
    v_pk_mul_f32 v[232:233], v[232:233], v[192:193]
    v_pk_mul_f32 v[234:235], v[234:235], v[194:195]
    v_cvt_pk_bf16_f32 v240, v228, v229
    v_cvt_pk_bf16_f32 v241, v230, v231
    v_cvt_pk_bf16_f32 v242, v232, v233
    v_cvt_pk_bf16_f32 v243, v234, v235
    s_nop 1
    v_permlane16_swap_b32 v240, v242
    v_permlane16_swap_b32 v241, v243
    buffer_store_dwordx4 v[240:243], v2, s[20:23], s59 offen offset:1024 sc1
    v_pk_mul_f32 v[212:213], v[196:197], s[44:45]
    v_pk_mul_f32 v[214:215], v[198:199], s[44:45]
    v_pk_mul_f32 v[216:217], v[200:201], s[44:45]
    v_pk_mul_f32 v[218:219], v[202:203], s[44:45]
    v_exp_f32 v212, v212
    v_exp_f32 v213, v213
    v_exp_f32 v214, v214
    v_exp_f32 v215, v215
    v_exp_f32 v216, v216
    v_exp_f32 v217, v217
    v_exp_f32 v218, v218
    v_exp_f32 v219, v219
    v_pk_add_f32 v[220:221], v[212:213], 2.0 op_sel_hi:[1,0]
    v_pk_add_f32 v[222:223], v[214:215], 2.0 op_sel_hi:[1,0]
    v_pk_add_f32 v[224:225], v[216:217], 2.0 op_sel_hi:[1,0]
    v_pk_add_f32 v[226:227], v[218:219], 2.0 op_sel_hi:[1,0]
    v_pk_fma_f32 v[212:213], v[212:213], v[220:221], 2.0 op_sel_hi:[1,1,0]
    v_pk_fma_f32 v[214:215], v[214:215], v[222:223], 2.0 op_sel_hi:[1,1,0]
    v_pk_fma_f32 v[216:217], v[216:217], v[224:225], 2.0 op_sel_hi:[1,1,0]
    v_pk_fma_f32 v[218:219], v[218:219], v[226:227], 2.0 op_sel_hi:[1,1,0]
    v_rcp_f32 v212, v212
    v_rcp_f32 v213, v213
    v_rcp_f32 v214, v214
    v_rcp_f32 v215, v215
    v_rcp_f32 v216, v216
    v_rcp_f32 v217, v217
    v_rcp_f32 v218, v218
    v_rcp_f32 v219, v219
    v_pk_fma_f32 v[212:213], v[212:213], s[46:47], 1.0 op_sel_hi:[1,1,0]
    v_pk_fma_f32 v[214:215], v[214:215], s[46:47], 1.0 op_sel_hi:[1,1,0]
    v_pk_fma_f32 v[216:217], v[216:217], s[46:47], 1.0 op_sel_hi:[1,1,0]
    v_pk_fma_f32 v[218:219], v[218:219], s[46:47], 1.0 op_sel_hi:[1,1,0]
    v_pk_mul_f32 v[212:213], v[212:213], v[196:197]
    v_pk_mul_f32 v[214:215], v[214:215], v[198:199]
    v_pk_mul_f32 v[216:217], v[216:217], v[200:201]
    v_pk_mul_f32 v[218:219], v[218:219], v[202:203]
    v_cvt_pk_bf16_f32 v224, v212, v213
    v_cvt_pk_bf16_f32 v225, v214, v215
    v_cvt_pk_bf16_f32 v226, v216, v217
    v_cvt_pk_bf16_f32 v227, v218, v219
    s_nop 1
    v_permlane16_swap_b32 v224, v226
    v_permlane16_swap_b32 v225, v227
    buffer_store_dwordx4 v[224:227], v2, s[20:23], s58 offen offset:2048 sc1
    v_pk_mul_f32 v[228:229], v[204:205], s[44:45]
    v_pk_mul_f32 v[230:231], v[206:207], s[44:45]
    v_pk_mul_f32 v[232:233], v[208:209], s[44:45]
    v_pk_mul_f32 v[234:235], v[210:211], s[44:45]
    v_exp_f32 v228, v228
    v_exp_f32 v229, v229
    v_exp_f32 v230, v230
    v_exp_f32 v231, v231
    v_exp_f32 v232, v232
    v_exp_f32 v233, v233
    v_exp_f32 v234, v234
    v_exp_f32 v235, v235
    v_pk_add_f32 v[236:237], v[228:229], 2.0 op_sel_hi:[1,0]
    v_pk_add_f32 v[238:239], v[230:231], 2.0 op_sel_hi:[1,0]
    v_pk_add_f32 v[240:241], v[232:233], 2.0 op_sel_hi:[1,0]
    v_pk_add_f32 v[242:243], v[234:235], 2.0 op_sel_hi:[1,0]
    v_pk_fma_f32 v[228:229], v[228:229], v[236:237], 2.0 op_sel_hi:[1,1,0]
    v_pk_fma_f32 v[230:231], v[230:231], v[238:239], 2.0 op_sel_hi:[1,1,0]
    v_pk_fma_f32 v[232:233], v[232:233], v[240:241], 2.0 op_sel_hi:[1,1,0]
    v_pk_fma_f32 v[234:235], v[234:235], v[242:243], 2.0 op_sel_hi:[1,1,0]
    v_rcp_f32 v228, v228
    v_rcp_f32 v229, v229
    v_rcp_f32 v230, v230
    v_rcp_f32 v231, v231
    v_rcp_f32 v232, v232
    v_rcp_f32 v233, v233
    v_rcp_f32 v234, v234
    v_rcp_f32 v235, v235
    v_pk_fma_f32 v[228:229], v[228:229], s[46:47], 1.0 op_sel_hi:[1,1,0]
    v_pk_fma_f32 v[230:231], v[230:231], s[46:47], 1.0 op_sel_hi:[1,1,0]
    v_pk_fma_f32 v[232:233], v[232:233], s[46:47], 1.0 op_sel_hi:[1,1,0]
    v_pk_fma_f32 v[234:235], v[234:235], s[46:47], 1.0 op_sel_hi:[1,1,0]
    v_pk_mul_f32 v[228:229], v[228:229], v[204:205]
    v_pk_mul_f32 v[230:231], v[230:231], v[206:207]
    v_pk_mul_f32 v[232:233], v[232:233], v[208:209]
    v_pk_mul_f32 v[234:235], v[234:235], v[210:211]
    v_cvt_pk_bf16_f32 v240, v228, v229
    v_cvt_pk_bf16_f32 v241, v230, v231
    v_cvt_pk_bf16_f32 v242, v232, v233
    v_cvt_pk_bf16_f32 v243, v234, v235
    s_nop 1
    v_permlane16_swap_b32 v240, v242
    v_permlane16_swap_b32 v241, v243
    buffer_store_dwordx4 v[240:243], v2, s[20:23], s59 offen offset:2048 sc1
    s_add_u32 m0, s35, 32768
    s_nop 0
    buffer_load_dwordx4 v10, s[16:19], s33 offen lds
    buffer_load_dwordx4 v10, s[16:19], s32 offen offset:1024 lds
    s_add_u32 s16, s16, 131072
    s_addc_u32 s17, s17, 0
    s_add_u32 m0, s35, 40960
    s_nop 0
    buffer_load_dwordx4 v10, s[16:19], s33 offen lds
    buffer_load_dwordx4 v10, s[16:19], s32 offen offset:1024 lds
    s_add_u32 s94, s36, 3
    s_and_b32 s94, s94, 3
    s_mul_i32 s94, s94, 262144
    s_add_u32 s16, s12, s94
    s_addc_u32 s17, s13, 0
    s_add_u32 m0, s35, 49152
    s_nop 0
    buffer_load_dwordx4 v10, s[16:19], s33 offen lds
    buffer_load_dwordx4 v10, s[16:19], s32 offen offset:1024 lds
    s_add_u32 s16, s16, 131072
    s_addc_u32 s17, s17, 0
    s_waitcnt vmcnt(0)
    s_barrier
    s_cmp_lg_u32 s86, 0
    s_cbranch_scc1 gated_mix__grouped_kv_mqa__dense_activation_mish__prompt_kernel_hw
    v_readfirstlane_b32 s97, v253
    s_nop 3
    s_cmp_eq_u32 s97, 1
    s_cbranch_scc1 gated_mix__grouped_kv_mqa__dense_activation_mish__prompt_kernel_clrb_ok
    s_mov_b32 s52, s82
    s_mov_b32 s53, s83
    s_mov_b32 s54, 0x100
    s_mov_b32 s55, 0x00020000
    s_and_b32 s97, s2, 1
    s_lshl_b32 s97, s97, 7
    v_mov_b32 v4, s97
    s_mov_b32 s96, 0x40000
gated_mix__grouped_kv_mqa__dense_activation_mish__prompt_kernel_clrb:
    buffer_load_dword v5, v4, s[52:55], 0 offen sc1
    s_waitcnt vmcnt(0)
    v_cmp_eq_u32 vcc, 1, v5
    s_nop 3
    s_cmp_eq_u64 vcc, exec
    s_cbranch_scc1 gated_mix__grouped_kv_mqa__dense_activation_mish__prompt_kernel_clrb_ok
    s_sleep 6
    s_sub_u32 s96, s96, 1
    s_cmp_lg_u32 s96, 0
    s_cbranch_scc1 gated_mix__grouped_kv_mqa__dense_activation_mish__prompt_kernel_clrb
gated_mix__grouped_kv_mqa__dense_activation_mish__prompt_kernel_clrb_ok:
    s_lshl_b32 s28, s87, 8
    s_add_u32 s29, s28, 8192
    s_lshl_b32 s91, s88, 2
    s_add_u32 s28, s29, s91
    s_add_u32 s92, s84, 0x1b00000
    s_addc_u32 s93, s85, 0
    s_mov_b32 s52, s92
    s_mov_b32 s53, s93
    s_mov_b32 s54, 0x4000
    s_mov_b32 s55, 0x00020000
    v_lshlrev_b32 v6, 8, v1
    v_add_u32 v6, s28, v6
    v_mov_b32 v4, 1
    v_cmp_gt_u32 vcc, 1, v1
    s_nop 1
    s_and_saveexec_b64 s[90:91], vcc
    buffer_store_dword v4, v6, s[52:55], 0 offen sc1
    s_mov_b64 exec, s[90:91]
    s_add_u32 s92, s84, 0x1b00000
    s_addc_u32 s93, s85, 0
    s_mov_b32 s52, s92
    s_mov_b32 s53, s93
    s_mov_b32 s54, 0x4000
    s_mov_b32 s55, 0x00020000
    v_and_b32 v4, 15, v1
    v_lshlrev_b32 v4, 2, v4
    s_mov_b32 s96, 0x40000
gated_mix__grouped_kv_mqa__dense_activation_mish__prompt_kernel_hp:
    buffer_load_dword v5, v4, s[52:55], s29 offen sc1
    s_waitcnt vmcnt(0)
    v_cmp_eq_u32 vcc, 1, v5
    s_nop 3
    s_cmp_eq_u64 vcc, exec
    s_cbranch_scc1 gated_mix__grouped_kv_mqa__dense_activation_mish__prompt_kernel_hp_ok
    s_sleep 6
    s_sub_u32 s96, s96, 1
    s_cmp_lg_u32 s96, 0
    s_cbranch_scc1 gated_mix__grouped_kv_mqa__dense_activation_mish__prompt_kernel_hp
gated_mix__grouped_kv_mqa__dense_activation_mish__prompt_kernel_hp_ok:
gated_mix__grouped_kv_mqa__dense_activation_mish__prompt_kernel_hw:
    s_lshl_b32 s90, s87, 2
    s_add_u32 s56, s90, s86
    s_mul_i32 s31, s56, 229376
    s_lshl_b32 s38, s56, 16
    s_mov_b32 s57, s31
    s_mov_b32 s58, s38
    s_add_u32 s94, s36, 0
    s_and_b32 s94, s94, 3
    s_mul_i32 s94, s94, 8192
    s_add_u32 s31, s57, s94
    s_add_u32 s94, s36, 0
    s_and_b32 s94, s94, 3
    s_mul_i32 s94, s94, 8192
    s_add_u32 s38, s58, s94
    s_add_u32 s92, s84, 0x400000
    s_addc_u32 s93, s85, 0
    s_mov_b32 s8, s92
    s_mov_b32 s9, s93
    s_mov_b32 s10, 0xe00000
    s_mov_b32 s11, 0x00020000
    s_add_u32 s92, s84, 0x1500000
    s_addc_u32 s93, s85, 0
    s_mov_b32 s4, s92
    s_mov_b32 s5, s93
    s_mov_b32 s6, 0x400000
    s_mov_b32 s7, 0x00020000
    s_add_u32 s92, s84, 0x1900000
    s_addc_u32 s93, s85, 0
    s_mov_b32 s20, s92
    s_mov_b32 s21, s93
    s_mov_b32 s22, 0x8000
    s_mov_b32 s23, 0x00020000
    s_mov_b32 s24, s80
    s_mov_b32 s25, s81
    s_mov_b32 s26, 0x400000
    s_mov_b32 s27, 0x00020000
    v_lshrrev_b32 v3, 5, v1
    v_bfe_u32 v4, v1, 2, 2
    v_bfe_u32 v5, v1, 4, 1
    v_and_b32 v6, 3, v1
    v_lshrrev_b32 v7, 1, v4
    v_lshlrev_b32 v7, 6, v7
    v_lshl_add_u32 v7, v5, 5, v7
    v_lshl_add_u32 v7, v6, 3, v7
    v_lshl_add_u32 v8, v3, 3, v4
    v_lshl_add_u32 v12, v8, 7, v7
    v_xor_b32 v13, 64, v12
    v_lshl_add_u32 v8, v3, 2, v4
    v_lshl_add_u32 v14, v8, 7, v7
    v_xor_b32 v15, 64, v14
    v_and_b32 v4, 31, v1
    s_lshl_b32 s91, s56, 5
    v_add_u32 v4, s91, v4
    v_lshrrev_b32 v5, 3, v4
    v_and_b32 v6, 7, v4
    v_lshlrev_b32 v6, 2, v6
    v_lshl_add_u32 v16, v5, 7, v6
    v_lshlrev_b32 v17, 11, v4
    v_lshl_add_u32 v17, v3, 4, v17
    s_lshl_b32 s37, s87, 8
    s_add_u32 s37, s37, 12288
    s_barrier
    s_setprio 0
    buffer_load_dwordx4 v[32:35], v2, s[8:11], s31 offen offset:0 sc1
    buffer_load_dwordx4 v[36:39], v2, s[8:11], s31 offen offset:1024 sc1
    buffer_load_dwordx4 v[40:43], v2, s[8:11], s31 offen offset:2048 sc1
    buffer_load_dwordx4 v[44:47], v2, s[8:11], s31 offen offset:3072 sc1
    s_add_u32 s31, s31, 4096
    buffer_load_dwordx4 v[48:51], v2, s[8:11], s31 offen offset:0 sc1
    buffer_load_dwordx4 v[52:55], v2, s[8:11], s31 offen offset:1024 sc1
    buffer_load_dwordx4 v[56:59], v2, s[8:11], s31 offen offset:2048 sc1
    buffer_load_dwordx4 v[60:63], v2, s[8:11], s31 offen offset:3072 sc1
    s_add_u32 s94, s36, 1
    s_and_b32 s94, s94, 3
    s_mul_i32 s94, s94, 8192
    s_add_u32 s31, s57, s94
    ds_read_b64_tr_b16 v[144:145], v12 offset:0
    ds_read_b64_tr_b16 v[146:147], v12 offset:512
    ds_read_b64_tr_b16 v[148:149], v13 offset:0
    ds_read_b64_tr_b16 v[150:151], v13 offset:512
    ds_read_b64_tr_b16 v[152:153], v12 offset:2048
    ds_read_b64_tr_b16 v[154:155], v12 offset:2560
    ds_read_b64_tr_b16 v[156:157], v13 offset:2048
    ds_read_b64_tr_b16 v[158:159], v13 offset:2560
    ds_read_b64_tr_b16 v[160:161], v12 offset:4096
    ds_read_b64_tr_b16 v[162:163], v12 offset:4608
    ds_read_b64_tr_b16 v[164:165], v13 offset:4096
    ds_read_b64_tr_b16 v[166:167], v13 offset:4608
    s_waitcnt vmcnt(7) lgkmcnt(8)
    v_mfma_f32_32x32x16_bf16 v[168:183], v[144:147], v[32:35], 0
    v_mfma_f32_32x32x16_bf16 v[184:199], v[148:151], v[32:35], 0
    buffer_load_dwordx4 v[64:67], v2, s[8:11], s31 offen offset:0 sc1
    buffer_load_dwordx4 v[68:71], v2, s[8:11], s31 offen offset:1024 sc1
    s_add_u32 m0, s35, 57344
    s_nop 0
    buffer_load_dwordx4 v10, s[16:19], s33 offen lds
    buffer_load_dwordx4 v10, s[16:19], s32 offen offset:1024 lds
    s_add_u32 s94, s36, 0
    s_and_b32 s94, s94, 3
    s_add_u32 s94, s94, 4
    s_mul_i32 s94, s94, 262144
    s_add_u32 s16, s12, s94
    s_addc_u32 s17, s13, 0
    ds_read_b64_tr_b16 v[144:145], v12 offset:6144
    ds_read_b64_tr_b16 v[146:147], v12 offset:6656
    ds_read_b64_tr_b16 v[148:149], v13 offset:6144
    ds_read_b64_tr_b16 v[150:151], v13 offset:6656
    s_waitcnt vmcnt(10) lgkmcnt(8)
    v_mfma_f32_32x32x16_bf16 v[168:183], v[152:155], v[36:39], v[168:183]
    v_mfma_f32_32x32x16_bf16 v[184:199], v[156:159], v[36:39], v[184:199]
    buffer_load_dwordx4 v[72:75], v2, s[8:11], s31 offen offset:2048 sc1
    buffer_load_dwordx4 v[76:79], v2, s[8:11], s31 offen offset:3072 sc1
    s_add_u32 s31, s31, 4096
    s_barrier
    ds_read_b64_tr_b16 v[152:153], v12 offset:8192
    ds_read_b64_tr_b16 v[154:155], v12 offset:8704
    ds_read_b64_tr_b16 v[156:157], v13 offset:8192
    ds_read_b64_tr_b16 v[158:159], v13 offset:8704
    s_waitcnt vmcnt(11) lgkmcnt(8)
    v_mfma_f32_32x32x16_bf16 v[168:183], v[160:163], v[40:43], v[168:183]
    v_mfma_f32_32x32x16_bf16 v[184:199], v[164:167], v[40:43], v[184:199]
    buffer_load_dwordx4 v[80:83], v2, s[8:11], s31 offen offset:0 sc1
    buffer_load_dwordx4 v[84:87], v2, s[8:11], s31 offen offset:1024 sc1
    ds_read_b64_tr_b16 v[160:161], v12 offset:10240
    ds_read_b64_tr_b16 v[162:163], v12 offset:10752
    ds_read_b64_tr_b16 v[164:165], v13 offset:10240
    ds_read_b64_tr_b16 v[166:167], v13 offset:10752
    s_waitcnt vmcnt(12) lgkmcnt(8)
    v_mfma_f32_32x32x16_bf16 v[168:183], v[144:147], v[44:47], v[168:183]
    v_mfma_f32_32x32x16_bf16 v[184:199], v[148:151], v[44:47], v[184:199]
    buffer_load_dwordx4 v[88:91], v2, s[8:11], s31 offen offset:2048 sc1
    buffer_load_dwordx4 v[92:95], v2, s[8:11], s31 offen offset:3072 sc1
    s_add_u32 s94, s36, 2
    s_and_b32 s94, s94, 3
    s_mul_i32 s94, s94, 8192
    s_add_u32 s31, s57, s94
    ds_read_b64_tr_b16 v[144:145], v12 offset:12288
    ds_read_b64_tr_b16 v[146:147], v12 offset:12800
    ds_read_b64_tr_b16 v[148:149], v13 offset:12288
    ds_read_b64_tr_b16 v[150:151], v13 offset:12800
    s_waitcnt vmcnt(13) lgkmcnt(8)
    v_mfma_f32_32x32x16_bf16 v[168:183], v[152:155], v[48:51], v[168:183]
    v_mfma_f32_32x32x16_bf16 v[184:199], v[156:159], v[48:51], v[184:199]
    buffer_load_dwordx4 v[96:99], v2, s[8:11], s31 offen offset:0 sc1
    buffer_load_dwordx4 v[100:103], v2, s[8:11], s31 offen offset:1024 sc1
    ds_read_b64_tr_b16 v[152:153], v12 offset:14336
    ds_read_b64_tr_b16 v[154:155], v12 offset:14848
    ds_read_b64_tr_b16 v[156:157], v13 offset:14336
    ds_read_b64_tr_b16 v[158:159], v13 offset:14848
    s_waitcnt vmcnt(14) lgkmcnt(8)
    v_mfma_f32_32x32x16_bf16 v[168:183], v[160:163], v[52:55], v[168:183]
    v_mfma_f32_32x32x16_bf16 v[184:199], v[164:167], v[52:55], v[184:199]
    buffer_load_dwordx4 v[104:107], v2, s[8:11], s31 offen offset:2048 sc1
    buffer_load_dwordx4 v[108:111], v2, s[8:11], s31 offen offset:3072 sc1
    s_add_u32 s31, s31, 4096
    s_barrier
    ds_read_b64_tr_b16 v[160:161], v12 offset:16384
    ds_read_b64_tr_b16 v[162:163], v12 offset:16896
    ds_read_b64_tr_b16 v[164:165], v13 offset:16384
    ds_read_b64_tr_b16 v[166:167], v13 offset:16896
    s_waitcnt vmcnt(15) lgkmcnt(8)
    v_mfma_f32_32x32x16_bf16 v[168:183], v[144:147], v[56:59], v[168:183]
    v_mfma_f32_32x32x16_bf16 v[184:199], v[148:151], v[56:59], v[184:199]
    buffer_load_dwordx4 v[32:35], v2, s[8:11], s31 offen offset:0 sc1
    buffer_load_dwordx4 v[36:39], v2, s[8:11], s31 offen offset:1024 sc1
    s_add_u32 m0, s35, 0
    s_nop 0
    buffer_load_dwordx4 v10, s[16:19], s33 offen lds
    buffer_load_dwordx4 v10, s[16:19], s32 offen offset:1024 lds
    s_add_u32 s16, s16, 131072
    s_addc_u32 s17, s17, 0
    ds_read_b64_tr_b16 v[144:145], v12 offset:18432
    ds_read_b64_tr_b16 v[146:147], v12 offset:18944
    ds_read_b64_tr_b16 v[148:149], v13 offset:18432
    ds_read_b64_tr_b16 v[150:151], v13 offset:18944
    s_waitcnt vmcnt(18) lgkmcnt(8)
    v_mfma_f32_32x32x16_bf16 v[168:183], v[152:155], v[60:63], v[168:183]
    v_mfma_f32_32x32x16_bf16 v[184:199], v[156:159], v[60:63], v[184:199]
    buffer_load_dwordx4 v[40:43], v2, s[8:11], s31 offen offset:2048 sc1
    buffer_load_dwordx4 v[44:47], v2, s[8:11], s31 offen offset:3072 sc1
    s_add_u32 s94, s36, 3
    s_and_b32 s94, s94, 3
    s_mul_i32 s94, s94, 8192
    s_add_u32 s31, s57, s94
    ds_read_b64_tr_b16 v[152:153], v12 offset:20480
    ds_read_b64_tr_b16 v[154:155], v12 offset:20992
    ds_read_b64_tr_b16 v[156:157], v13 offset:20480
    ds_read_b64_tr_b16 v[158:159], v13 offset:20992
    s_waitcnt vmcnt(19) lgkmcnt(8)
    v_mfma_f32_32x32x16_bf16 v[168:183], v[160:163], v[64:67], v[168:183]
    v_mfma_f32_32x32x16_bf16 v[184:199], v[164:167], v[64:67], v[184:199]
    buffer_load_dwordx4 v[48:51], v2, s[8:11], s31 offen offset:0 sc1
    buffer_load_dwordx4 v[52:55], v2, s[8:11], s31 offen offset:1024 sc1
    ds_read_b64_tr_b16 v[160:161], v12 offset:22528
    ds_read_b64_tr_b16 v[162:163], v12 offset:23040
    ds_read_b64_tr_b16 v[164:165], v13 offset:22528
    ds_read_b64_tr_b16 v[166:167], v13 offset:23040
    s_waitcnt vmcnt(20) lgkmcnt(8)
    v_mfma_f32_32x32x16_bf16 v[168:183], v[144:147], v[68:71], v[168:183]
    v_mfma_f32_32x32x16_bf16 v[184:199], v[148:151], v[68:71], v[184:199]
    buffer_load_dwordx4 v[56:59], v2, s[8:11], s31 offen offset:2048 sc1
    buffer_load_dwordx4 v[60:63], v2, s[8:11], s31 offen offset:3072 sc1
    s_add_u32 s31, s31, 4096
    s_barrier
    ds_read_b64_tr_b16 v[144:145], v12 offset:24576
    ds_read_b64_tr_b16 v[146:147], v12 offset:25088
    ds_read_b64_tr_b16 v[148:149], v13 offset:24576
    ds_read_b64_tr_b16 v[150:151], v13 offset:25088
    s_waitcnt vmcnt(19) lgkmcnt(8)
    v_mfma_f32_32x32x16_bf16 v[168:183], v[152:155], v[72:75], v[168:183]
    v_mfma_f32_32x32x16_bf16 v[184:199], v[156:159], v[72:75], v[184:199]
    buffer_load_dwordx4 v[64:67], v2, s[8:11], s31 offen offset:0 sc1
    buffer_load_dwordx4 v[68:71], v2, s[8:11], s31 offen offset:1024 sc1
    s_add_u32 m0, s35, 8192
    s_nop 0
    buffer_load_dwordx4 v10, s[16:19], s33 offen lds
    buffer_load_dwordx4 v10, s[16:19], s32 offen offset:1024 lds
    s_add_u32 s94, s36, 1
    s_and_b32 s94, s94, 3
    s_add_u32 s94, s94, 4
    s_mul_i32 s94, s94, 262144
    s_add_u32 s16, s12, s94
    s_addc_u32 s17, s13, 0
    ds_read_b64_tr_b16 v[152:153], v12 offset:26624
    ds_read_b64_tr_b16 v[154:155], v12 offset:27136
    ds_read_b64_tr_b16 v[156:157], v13 offset:26624
    ds_read_b64_tr_b16 v[158:159], v13 offset:27136
    s_waitcnt vmcnt(22) lgkmcnt(8)
    v_mfma_f32_32x32x16_bf16 v[168:183], v[160:163], v[76:79], v[168:183]
    v_mfma_f32_32x32x16_bf16 v[184:199], v[164:167], v[76:79], v[184:199]
    buffer_load_dwordx4 v[72:75], v2, s[8:11], s31 offen offset:2048 sc1
    buffer_load_dwordx4 v[76:79], v2, s[8:11], s31 offen offset:3072 sc1
    s_add_u32 s94, s36, 0
    s_and_b32 s94, s94, 3
    s_add_u32 s94, s94, 4
    s_mul_i32 s94, s94, 8192
    s_add_u32 s31, s57, s94
    ds_read_b64_tr_b16 v[160:161], v12 offset:28672
    ds_read_b64_tr_b16 v[162:163], v12 offset:29184
    ds_read_b64_tr_b16 v[164:165], v13 offset:28672
    ds_read_b64_tr_b16 v[166:167], v13 offset:29184
    s_waitcnt vmcnt(23) lgkmcnt(8)
    v_mfma_f32_32x32x16_bf16 v[168:183], v[144:147], v[80:83], v[168:183]
    v_mfma_f32_32x32x16_bf16 v[184:199], v[148:151], v[80:83], v[184:199]
    buffer_load_dwordx4 v[80:83], v2, s[8:11], s31 offen offset:0 sc1
    ds_read_b64_tr_b16 v[144:145], v12 offset:30720
    ds_read_b64_tr_b16 v[146:147], v12 offset:31232
    ds_read_b64_tr_b16 v[148:149], v13 offset:30720
    ds_read_b64_tr_b16 v[150:151], v13 offset:31232
    s_waitcnt vmcnt(23) lgkmcnt(8)
    v_mfma_f32_32x32x16_bf16 v[168:183], v[152:155], v[84:87], v[168:183]
    v_mfma_f32_32x32x16_bf16 v[184:199], v[156:159], v[84:87], v[184:199]
    buffer_load_dwordx4 v[84:87], v2, s[8:11], s31 offen offset:1024 sc1
    s_barrier
    ds_read_b64_tr_b16 v[152:153], v12 offset:32768
    ds_read_b64_tr_b16 v[154:155], v12 offset:33280
    ds_read_b64_tr_b16 v[156:157], v13 offset:32768
    ds_read_b64_tr_b16 v[158:159], v13 offset:33280
    s_waitcnt vmcnt(23) lgkmcnt(8)
    v_mfma_f32_32x32x16_bf16 v[168:183], v[160:163], v[88:91], v[168:183]
    v_mfma_f32_32x32x16_bf16 v[184:199], v[164:167], v[88:91], v[184:199]
    buffer_load_dwordx4 v[88:91], v2, s[8:11], s31 offen offset:2048 sc1
    s_add_u32 m0, s35, 16384
    s_nop 0
    buffer_load_dwordx4 v10, s[16:19], s33 offen lds
    buffer_load_dwordx4 v10, s[16:19], s32 offen offset:1024 lds
    s_add_u32 s16, s16, 131072
    s_addc_u32 s17, s17, 0
    ds_read_b64_tr_b16 v[160:161], v12 offset:34816
    ds_read_b64_tr_b16 v[162:163], v12 offset:35328
    ds_read_b64_tr_b16 v[164:165], v13 offset:34816
    ds_read_b64_tr_b16 v[166:167], v13 offset:35328
    s_waitcnt vmcnt(25) lgkmcnt(8)
    v_mfma_f32_32x32x16_bf16 v[168:183], v[144:147], v[92:95], v[168:183]
    v_mfma_f32_32x32x16_bf16 v[184:199], v[148:151], v[92:95], v[184:199]
    buffer_load_dwordx4 v[92:95], v2, s[8:11], s31 offen offset:3072 sc1
    s_add_u32 s31, s31, 4096
    ds_read_b64_tr_b16 v[144:145], v12 offset:36864
    ds_read_b64_tr_b16 v[146:147], v12 offset:37376
    ds_read_b64_tr_b16 v[148:149], v13 offset:36864
    ds_read_b64_tr_b16 v[150:151], v13 offset:37376
    s_waitcnt vmcnt(25) lgkmcnt(8)
    v_mfma_f32_32x32x16_bf16 v[168:183], v[152:155], v[96:99], v[168:183]
    v_mfma_f32_32x32x16_bf16 v[184:199], v[156:159], v[96:99], v[184:199]
    buffer_load_dwordx4 v[96:99], v2, s[8:11], s31 offen offset:0 sc1
    ds_read_b64_tr_b16 v[152:153], v12 offset:38912
    ds_read_b64_tr_b16 v[154:155], v12 offset:39424
    ds_read_b64_tr_b16 v[156:157], v13 offset:38912
    ds_read_b64_tr_b16 v[158:159], v13 offset:39424
    s_waitcnt vmcnt(25) lgkmcnt(8)
    v_mfma_f32_32x32x16_bf16 v[168:183], v[160:163], v[100:103], v[168:183]
    v_mfma_f32_32x32x16_bf16 v[184:199], v[164:167], v[100:103], v[184:199]
    buffer_load_dwordx4 v[100:103], v2, s[8:11], s31 offen offset:1024 sc1
    s_barrier
    ds_read_b64_tr_b16 v[160:161], v12 offset:40960
    ds_read_b64_tr_b16 v[162:163], v12 offset:41472
    ds_read_b64_tr_b16 v[164:165], v13 offset:40960
    ds_read_b64_tr_b16 v[166:167], v13 offset:41472
    s_waitcnt vmcnt(25) lgkmcnt(8)
    v_mfma_f32_32x32x16_bf16 v[168:183], v[144:147], v[104:107], v[168:183]
    v_mfma_f32_32x32x16_bf16 v[184:199], v[148:151], v[104:107], v[184:199]
    buffer_load_dwordx4 v[104:107], v2, s[8:11], s31 offen offset:2048 sc1
    s_add_u32 m0, s35, 24576
    s_nop 0
    buffer_load_dwordx4 v10, s[16:19], s33 offen lds
    buffer_load_dwordx4 v10, s[16:19], s32 offen offset:1024 lds
    s_add_u32 s94, s36, 2
    s_and_b32 s94, s94, 3
    s_add_u32 s94, s94, 4
    s_mul_i32 s94, s94, 262144
    s_add_u32 s16, s12, s94
    s_addc_u32 s17, s13, 0
    ds_read_b64_tr_b16 v[144:145], v12 offset:43008
    ds_read_b64_tr_b16 v[146:147], v12 offset:43520
    ds_read_b64_tr_b16 v[148:149], v13 offset:43008
    ds_read_b64_tr_b16 v[150:151], v13 offset:43520
    s_waitcnt vmcnt(27) lgkmcnt(8)
    v_mfma_f32_32x32x16_bf16 v[168:183], v[152:155], v[108:111], v[168:183]
    v_mfma_f32_32x32x16_bf16 v[184:199], v[156:159], v[108:111], v[184:199]
    buffer_load_dwordx4 v[108:111], v2, s[8:11], s31 offen offset:3072 sc1
    s_add_u32 s94, s36, 1
    s_and_b32 s94, s94, 3
    s_add_u32 s94, s94, 4
    s_mul_i32 s94, s94, 8192
    s_add_u32 s31, s57, s94
    ds_read_b64_tr_b16 v[152:153], v12 offset:45056
    ds_read_b64_tr_b16 v[154:155], v12 offset:45568
    ds_read_b64_tr_b16 v[156:157], v13 offset:45056
    ds_read_b64_tr_b16 v[158:159], v13 offset:45568
    s_waitcnt vmcnt(27) lgkmcnt(8)
    v_mfma_f32_32x32x16_bf16 v[168:183], v[160:163], v[32:35], v[168:183]
    v_mfma_f32_32x32x16_bf16 v[184:199], v[164:167], v[32:35], v[184:199]
    buffer_load_dwordx4 v[32:35], v2, s[8:11], s31 offen offset:0 sc1
    ds_read_b64_tr_b16 v[160:161], v12 offset:47104
    ds_read_b64_tr_b16 v[162:163], v12 offset:47616
    ds_read_b64_tr_b16 v[164:165], v13 offset:47104
    ds_read_b64_tr_b16 v[166:167], v13 offset:47616
    s_waitcnt vmcnt(27) lgkmcnt(8)
    v_mfma_f32_32x32x16_bf16 v[168:183], v[144:147], v[36:39], v[168:183]
    v_mfma_f32_32x32x16_bf16 v[184:199], v[148:151], v[36:39], v[184:199]
    buffer_load_dwordx4 v[36:39], v2, s[8:11], s31 offen offset:1024 sc1
    s_barrier
    ds_read_b64_tr_b16 v[144:145], v12 offset:49152
    ds_read_b64_tr_b16 v[146:147], v12 offset:49664
    ds_read_b64_tr_b16 v[148:149], v13 offset:49152
    ds_read_b64_tr_b16 v[150:151], v13 offset:49664
    s_waitcnt vmcnt(25) lgkmcnt(8)
    v_mfma_f32_32x32x16_bf16 v[168:183], v[152:155], v[40:43], v[168:183]
    v_mfma_f32_32x32x16_bf16 v[184:199], v[156:159], v[40:43], v[184:199]
    buffer_load_dwordx4 v[40:43], v2, s[8:11], s31 offen offset:2048 sc1
    s_add_u32 m0, s35, 32768
    s_nop 0
    buffer_load_dwordx4 v10, s[16:19], s33 offen lds
    buffer_load_dwordx4 v10, s[16:19], s32 offen offset:1024 lds
    s_add_u32 s16, s16, 131072
    s_addc_u32 s17, s17, 0
    ds_read_b64_tr_b16 v[152:153], v12 offset:51200
    ds_read_b64_tr_b16 v[154:155], v12 offset:51712
    ds_read_b64_tr_b16 v[156:157], v13 offset:51200
    ds_read_b64_tr_b16 v[158:159], v13 offset:51712
    s_waitcnt vmcnt(27) lgkmcnt(8)
    v_mfma_f32_32x32x16_bf16 v[168:183], v[160:163], v[44:47], v[168:183]
    v_mfma_f32_32x32x16_bf16 v[184:199], v[164:167], v[44:47], v[184:199]
    buffer_load_dwordx4 v[44:47], v2, s[8:11], s31 offen offset:3072 sc1
    s_add_u32 s31, s31, 4096
    ds_read_b64_tr_b16 v[160:161], v12 offset:53248
    ds_read_b64_tr_b16 v[162:163], v12 offset:53760
    ds_read_b64_tr_b16 v[164:165], v13 offset:53248
    ds_read_b64_tr_b16 v[166:167], v13 offset:53760
    s_waitcnt vmcnt(27) lgkmcnt(8)
    v_mfma_f32_32x32x16_bf16 v[168:183], v[144:147], v[48:51], v[168:183]
    v_mfma_f32_32x32x16_bf16 v[184:199], v[148:151], v[48:51], v[184:199]
    buffer_load_dwordx4 v[48:51], v2, s[8:11], s31 offen offset:0 sc1
    ds_read_b64_tr_b16 v[144:145], v12 offset:55296
    ds_read_b64_tr_b16 v[146:147], v12 offset:55808
    ds_read_b64_tr_b16 v[148:149], v13 offset:55296
    ds_read_b64_tr_b16 v[150:151], v13 offset:55808
    s_waitcnt vmcnt(27) lgkmcnt(8)
    v_mfma_f32_32x32x16_bf16 v[168:183], v[152:155], v[52:55], v[168:183]
    v_mfma_f32_32x32x16_bf16 v[184:199], v[156:159], v[52:55], v[184:199]
    buffer_load_dwordx4 v[52:55], v2, s[8:11], s31 offen offset:1024 sc1
    s_barrier
    ds_read_b64_tr_b16 v[152:153], v12 offset:57344
    ds_read_b64_tr_b16 v[154:155], v12 offset:57856
    ds_read_b64_tr_b16 v[156:157], v13 offset:57344
    ds_read_b64_tr_b16 v[158:159], v13 offset:57856
    s_waitcnt vmcnt(27) lgkmcnt(8)
    v_mfma_f32_32x32x16_bf16 v[168:183], v[160:163], v[56:59], v[168:183]
    v_mfma_f32_32x32x16_bf16 v[184:199], v[164:167], v[56:59], v[184:199]
    buffer_load_dwordx4 v[56:59], v2, s[8:11], s31 offen offset:2048 sc1
    s_add_u32 m0, s35, 40960
    s_nop 0
    buffer_load_dwordx4 v10, s[16:19], s33 offen lds
    buffer_load_dwordx4 v10, s[16:19], s32 offen offset:1024 lds
    s_add_u32 s94, s36, 3
    s_and_b32 s94, s94, 3
    s_add_u32 s94, s94, 4
    s_mul_i32 s94, s94, 262144
    s_add_u32 s16, s12, s94
    s_addc_u32 s17, s13, 0
    ds_read_b64_tr_b16 v[160:161], v12 offset:59392
    ds_read_b64_tr_b16 v[162:163], v12 offset:59904
    ds_read_b64_tr_b16 v[164:165], v13 offset:59392
    ds_read_b64_tr_b16 v[166:167], v13 offset:59904
    s_waitcnt vmcnt(29) lgkmcnt(8)
    v_mfma_f32_32x32x16_bf16 v[168:183], v[144:147], v[60:63], v[168:183]
    v_mfma_f32_32x32x16_bf16 v[184:199], v[148:151], v[60:63], v[184:199]
    buffer_load_dwordx4 v[60:63], v2, s[8:11], s31 offen offset:3072 sc1
    s_add_u32 s94, s36, 2
    s_and_b32 s94, s94, 3
    s_add_u32 s94, s94, 4
    s_mul_i32 s94, s94, 8192
    s_add_u32 s31, s57, s94
    ds_read_b64_tr_b16 v[144:145], v12 offset:61440
    ds_read_b64_tr_b16 v[146:147], v12 offset:61952
    ds_read_b64_tr_b16 v[148:149], v13 offset:61440
    ds_read_b64_tr_b16 v[150:151], v13 offset:61952
    s_waitcnt vmcnt(29) lgkmcnt(8)
    v_mfma_f32_32x32x16_bf16 v[168:183], v[152:155], v[64:67], v[168:183]
    v_mfma_f32_32x32x16_bf16 v[184:199], v[156:159], v[64:67], v[184:199]
    buffer_load_dwordx4 v[64:67], v2, s[8:11], s31 offen offset:0 sc1
    ds_read_b64_tr_b16 v[152:153], v12 offset:63488
    ds_read_b64_tr_b16 v[154:155], v12 offset:64000
    ds_read_b64_tr_b16 v[156:157], v13 offset:63488
    ds_read_b64_tr_b16 v[158:159], v13 offset:64000
    s_waitcnt vmcnt(29) lgkmcnt(8)
    v_mfma_f32_32x32x16_bf16 v[168:183], v[160:163], v[68:71], v[168:183]
    v_mfma_f32_32x32x16_bf16 v[184:199], v[164:167], v[68:71], v[184:199]
    buffer_load_dwordx4 v[68:71], v2, s[8:11], s31 offen offset:1024 sc1
    s_barrier
    ds_read_b64_tr_b16 v[160:161], v12 offset:0
    ds_read_b64_tr_b16 v[162:163], v12 offset:512
    ds_read_b64_tr_b16 v[164:165], v13 offset:0
    ds_read_b64_tr_b16 v[166:167], v13 offset:512
    s_waitcnt vmcnt(27) lgkmcnt(8)
    v_mfma_f32_32x32x16_bf16 v[168:183], v[144:147], v[72:75], v[168:183]
    v_mfma_f32_32x32x16_bf16 v[184:199], v[148:151], v[72:75], v[184:199]
    buffer_load_dwordx4 v[72:75], v2, s[8:11], s31 offen offset:2048 sc1
    s_add_u32 m0, s35, 49152
    s_nop 0
    buffer_load_dwordx4 v10, s[16:19], s33 offen lds
    buffer_load_dwordx4 v10, s[16:19], s32 offen offset:1024 lds
    s_add_u32 s16, s16, 131072
    s_addc_u32 s17, s17, 0
    ds_read_b64_tr_b16 v[144:145], v12 offset:2048
    ds_read_b64_tr_b16 v[146:147], v12 offset:2560
    ds_read_b64_tr_b16 v[148:149], v13 offset:2048
    ds_read_b64_tr_b16 v[150:151], v13 offset:2560
    s_waitcnt vmcnt(29) lgkmcnt(8)
    v_mfma_f32_32x32x16_bf16 v[168:183], v[152:155], v[76:79], v[168:183]
    v_mfma_f32_32x32x16_bf16 v[184:199], v[156:159], v[76:79], v[184:199]
    buffer_load_dwordx4 v[76:79], v2, s[8:11], s31 offen offset:3072 sc1
    s_add_u32 s31, s31, 4096
    ds_read_b64_tr_b16 v[152:153], v12 offset:4096
    ds_read_b64_tr_b16 v[154:155], v12 offset:4608
    ds_read_b64_tr_b16 v[156:157], v13 offset:4096
    ds_read_b64_tr_b16 v[158:159], v13 offset:4608
    s_waitcnt vmcnt(29) lgkmcnt(8)
    v_mfma_f32_32x32x16_bf16 v[168:183], v[160:163], v[80:83], v[168:183]
    v_mfma_f32_32x32x16_bf16 v[184:199], v[164:167], v[80:83], v[184:199]
    buffer_load_dwordx4 v[80:83], v2, s[8:11], s31 offen offset:0 sc1
    ds_read_b64_tr_b16 v[160:161], v12 offset:6144
    ds_read_b64_tr_b16 v[162:163], v12 offset:6656
    ds_read_b64_tr_b16 v[164:165], v13 offset:6144
    ds_read_b64_tr_b16 v[166:167], v13 offset:6656
    s_waitcnt vmcnt(29) lgkmcnt(8)
    v_mfma_f32_32x32x16_bf16 v[168:183], v[144:147], v[84:87], v[168:183]
    v_mfma_f32_32x32x16_bf16 v[184:199], v[148:151], v[84:87], v[184:199]
    buffer_load_dwordx4 v[84:87], v2, s[8:11], s31 offen offset:1024 sc1
    s_barrier
    ds_read_b64_tr_b16 v[144:145], v12 offset:8192
    ds_read_b64_tr_b16 v[146:147], v12 offset:8704
    ds_read_b64_tr_b16 v[148:149], v13 offset:8192
    ds_read_b64_tr_b16 v[150:151], v13 offset:8704
    s_waitcnt vmcnt(29) lgkmcnt(8)
    v_mfma_f32_32x32x16_bf16 v[168:183], v[152:155], v[88:91], v[168:183]
    v_mfma_f32_32x32x16_bf16 v[184:199], v[156:159], v[88:91], v[184:199]
    buffer_load_dwordx4 v[88:91], v2, s[8:11], s31 offen offset:2048 sc1
    s_add_u32 m0, s35, 57344
    s_nop 0
    buffer_load_dwordx4 v10, s[16:19], s33 offen lds
    buffer_load_dwordx4 v10, s[16:19], s32 offen offset:1024 lds
    s_add_u32 s94, s36, 0
    s_and_b32 s94, s94, 3
    s_add_u32 s94, s94, 8
    s_mul_i32 s94, s94, 262144
    s_add_u32 s16, s12, s94
    s_addc_u32 s17, s13, 0
    ds_read_b64_tr_b16 v[152:153], v12 offset:10240
    ds_read_b64_tr_b16 v[154:155], v12 offset:10752
    ds_read_b64_tr_b16 v[156:157], v13 offset:10240
    ds_read_b64_tr_b16 v[158:159], v13 offset:10752
    s_waitcnt vmcnt(29) lgkmcnt(8)
    v_mfma_f32_32x32x16_bf16 v[168:183], v[160:163], v[92:95], v[168:183]
    v_mfma_f32_32x32x16_bf16 v[184:199], v[164:167], v[92:95], v[184:199]
    buffer_load_dwordx4 v[92:95], v2, s[8:11], s31 offen offset:3072 sc1
    s_add_u32 s94, s36, 3
    s_and_b32 s94, s94, 3
    s_add_u32 s94, s94, 4
    s_mul_i32 s94, s94, 8192
    s_add_u32 s31, s57, s94
    ds_read_b64_tr_b16 v[160:161], v12 offset:12288
    ds_read_b64_tr_b16 v[162:163], v12 offset:12800
    ds_read_b64_tr_b16 v[164:165], v13 offset:12288
    ds_read_b64_tr_b16 v[166:167], v13 offset:12800
    s_waitcnt vmcnt(29) lgkmcnt(8)
    v_mfma_f32_32x32x16_bf16 v[168:183], v[144:147], v[96:99], v[168:183]
    v_mfma_f32_32x32x16_bf16 v[184:199], v[148:151], v[96:99], v[184:199]
    buffer_load_dwordx4 v[96:99], v2, s[8:11], s31 offen offset:0 sc1
    ds_read_b64_tr_b16 v[144:145], v12 offset:14336
    ds_read_b64_tr_b16 v[146:147], v12 offset:14848
    ds_read_b64_tr_b16 v[148:149], v13 offset:14336
    ds_read_b64_tr_b16 v[150:151], v13 offset:14848
    s_waitcnt vmcnt(29) lgkmcnt(8)
    v_mfma_f32_32x32x16_bf16 v[168:183], v[152:155], v[100:103], v[168:183]
    v_mfma_f32_32x32x16_bf16 v[184:199], v[156:159], v[100:103], v[184:199]
    buffer_load_dwordx4 v[100:103], v2, s[8:11], s31 offen offset:1024 sc1
    s_barrier
    ds_read_b64_tr_b16 v[152:153], v12 offset:16384
    ds_read_b64_tr_b16 v[154:155], v12 offset:16896
    ds_read_b64_tr_b16 v[156:157], v13 offset:16384
    ds_read_b64_tr_b16 v[158:159], v13 offset:16896
    s_waitcnt vmcnt(29) lgkmcnt(8)
    v_mfma_f32_32x32x16_bf16 v[168:183], v[160:163], v[104:107], v[168:183]
    v_mfma_f32_32x32x16_bf16 v[184:199], v[164:167], v[104:107], v[184:199]
    buffer_load_dwordx4 v[104:107], v2, s[8:11], s31 offen offset:2048 sc1
    s_add_u32 m0, s35, 0
    s_nop 0
    buffer_load_dwordx4 v10, s[16:19], s33 offen lds
    buffer_load_dwordx4 v10, s[16:19], s32 offen offset:1024 lds
    s_add_u32 s16, s16, 131072
    s_addc_u32 s17, s17, 0
    ds_read_b64_tr_b16 v[160:161], v12 offset:18432
    ds_read_b64_tr_b16 v[162:163], v12 offset:18944
    ds_read_b64_tr_b16 v[164:165], v13 offset:18432
    ds_read_b64_tr_b16 v[166:167], v13 offset:18944
    s_waitcnt vmcnt(29) lgkmcnt(8)
    v_mfma_f32_32x32x16_bf16 v[168:183], v[144:147], v[108:111], v[168:183]
    v_mfma_f32_32x32x16_bf16 v[184:199], v[148:151], v[108:111], v[184:199]
    buffer_load_dwordx4 v[108:111], v2, s[8:11], s31 offen offset:3072 sc1
    s_add_u32 s31, s31, 4096
    ds_read_b64_tr_b16 v[144:145], v12 offset:20480
    ds_read_b64_tr_b16 v[146:147], v12 offset:20992
    ds_read_b64_tr_b16 v[148:149], v13 offset:20480
    ds_read_b64_tr_b16 v[150:151], v13 offset:20992
    s_waitcnt vmcnt(29) lgkmcnt(8)
    v_mfma_f32_32x32x16_bf16 v[168:183], v[152:155], v[32:35], v[168:183]
    v_mfma_f32_32x32x16_bf16 v[184:199], v[156:159], v[32:35], v[184:199]
    buffer_load_dwordx4 v[32:35], v2, s[8:11], s31 offen offset:0 sc1
    ds_read_b64_tr_b16 v[152:153], v12 offset:22528
    ds_read_b64_tr_b16 v[154:155], v12 offset:23040
    ds_read_b64_tr_b16 v[156:157], v13 offset:22528
    ds_read_b64_tr_b16 v[158:159], v13 offset:23040
    s_waitcnt vmcnt(29) lgkmcnt(8)
    v_mfma_f32_32x32x16_bf16 v[168:183], v[160:163], v[36:39], v[168:183]
    v_mfma_f32_32x32x16_bf16 v[184:199], v[164:167], v[36:39], v[184:199]
    buffer_load_dwordx4 v[36:39], v2, s[8:11], s31 offen offset:1024 sc1
    s_barrier
    ds_read_b64_tr_b16 v[160:161], v12 offset:24576
    ds_read_b64_tr_b16 v[162:163], v12 offset:25088
    ds_read_b64_tr_b16 v[164:165], v13 offset:24576
    ds_read_b64_tr_b16 v[166:167], v13 offset:25088
    s_waitcnt vmcnt(29) lgkmcnt(8)
    v_mfma_f32_32x32x16_bf16 v[168:183], v[144:147], v[40:43], v[168:183]
    v_mfma_f32_32x32x16_bf16 v[184:199], v[148:151], v[40:43], v[184:199]
    buffer_load_dwordx4 v[40:43], v2, s[8:11], s31 offen offset:2048 sc1
    s_add_u32 m0, s35, 8192
    s_nop 0
    buffer_load_dwordx4 v10, s[16:19], s33 offen lds
    buffer_load_dwordx4 v10, s[16:19], s32 offen offset:1024 lds
    s_add_u32 s94, s36, 1
    s_and_b32 s94, s94, 3
    s_add_u32 s94, s94, 8
    s_mul_i32 s94, s94, 262144
    s_add_u32 s16, s12, s94
    s_addc_u32 s17, s13, 0
    ds_read_b64_tr_b16 v[144:145], v12 offset:26624
    ds_read_b64_tr_b16 v[146:147], v12 offset:27136
    ds_read_b64_tr_b16 v[148:149], v13 offset:26624
    ds_read_b64_tr_b16 v[150:151], v13 offset:27136
    s_waitcnt vmcnt(29) lgkmcnt(8)
    v_mfma_f32_32x32x16_bf16 v[168:183], v[152:155], v[44:47], v[168:183]
    v_mfma_f32_32x32x16_bf16 v[184:199], v[156:159], v[44:47], v[184:199]
    buffer_load_dwordx4 v[44:47], v2, s[8:11], s31 offen offset:3072 sc1
    s_add_u32 s94, s36, 0
    s_and_b32 s94, s94, 3
    s_add_u32 s94, s94, 8
    s_mul_i32 s94, s94, 8192
    s_add_u32 s31, s57, s94
    ds_read_b64_tr_b16 v[152:153], v12 offset:28672
    ds_read_b64_tr_b16 v[154:155], v12 offset:29184
    ds_read_b64_tr_b16 v[156:157], v13 offset:28672
    ds_read_b64_tr_b16 v[158:159], v13 offset:29184
    s_waitcnt vmcnt(29) lgkmcnt(8)
    v_mfma_f32_32x32x16_bf16 v[168:183], v[160:163], v[48:51], v[168:183]
    v_mfma_f32_32x32x16_bf16 v[184:199], v[164:167], v[48:51], v[184:199]
    buffer_load_dwordx4 v[48:51], v2, s[8:11], s31 offen offset:0 sc1
    ds_read_b64_tr_b16 v[160:161], v12 offset:30720
    ds_read_b64_tr_b16 v[162:163], v12 offset:31232
    ds_read_b64_tr_b16 v[164:165], v13 offset:30720
    ds_read_b64_tr_b16 v[166:167], v13 offset:31232
    s_waitcnt vmcnt(29) lgkmcnt(8)
    v_mfma_f32_32x32x16_bf16 v[168:183], v[144:147], v[52:55], v[168:183]
    v_mfma_f32_32x32x16_bf16 v[184:199], v[148:151], v[52:55], v[184:199]
    buffer_load_dwordx4 v[52:55], v2, s[8:11], s31 offen offset:1024 sc1
    s_barrier
    ds_read_b64_tr_b16 v[144:145], v12 offset:32768
    ds_read_b64_tr_b16 v[146:147], v12 offset:33280
    ds_read_b64_tr_b16 v[148:149], v13 offset:32768
    ds_read_b64_tr_b16 v[150:151], v13 offset:33280
    s_waitcnt vmcnt(29) lgkmcnt(8)
    v_mfma_f32_32x32x16_bf16 v[168:183], v[152:155], v[56:59], v[168:183]
    v_mfma_f32_32x32x16_bf16 v[184:199], v[156:159], v[56:59], v[184:199]
    buffer_load_dwordx4 v[56:59], v2, s[8:11], s31 offen offset:2048 sc1
    s_add_u32 m0, s35, 16384
    s_nop 0
    buffer_load_dwordx4 v10, s[16:19], s33 offen lds
    buffer_load_dwordx4 v10, s[16:19], s32 offen offset:1024 lds
    s_add_u32 s16, s16, 131072
    s_addc_u32 s17, s17, 0
    ds_read_b64_tr_b16 v[152:153], v12 offset:34816
    ds_read_b64_tr_b16 v[154:155], v12 offset:35328
    ds_read_b64_tr_b16 v[156:157], v13 offset:34816
    ds_read_b64_tr_b16 v[158:159], v13 offset:35328
    s_waitcnt vmcnt(29) lgkmcnt(8)
    v_mfma_f32_32x32x16_bf16 v[168:183], v[160:163], v[60:63], v[168:183]
    v_mfma_f32_32x32x16_bf16 v[184:199], v[164:167], v[60:63], v[184:199]
    buffer_load_dwordx4 v[60:63], v2, s[8:11], s31 offen offset:3072 sc1
    s_add_u32 s31, s31, 4096
    ds_read_b64_tr_b16 v[160:161], v12 offset:36864
    ds_read_b64_tr_b16 v[162:163], v12 offset:37376
    ds_read_b64_tr_b16 v[164:165], v13 offset:36864
    ds_read_b64_tr_b16 v[166:167], v13 offset:37376
    s_waitcnt vmcnt(29) lgkmcnt(8)
    v_mfma_f32_32x32x16_bf16 v[168:183], v[144:147], v[64:67], v[168:183]
    v_mfma_f32_32x32x16_bf16 v[184:199], v[148:151], v[64:67], v[184:199]
    buffer_load_dwordx4 v[64:67], v2, s[8:11], s31 offen offset:0 sc1
    ds_read_b64_tr_b16 v[144:145], v12 offset:38912
    ds_read_b64_tr_b16 v[146:147], v12 offset:39424
    ds_read_b64_tr_b16 v[148:149], v13 offset:38912
    ds_read_b64_tr_b16 v[150:151], v13 offset:39424
    s_waitcnt vmcnt(29) lgkmcnt(8)
    v_mfma_f32_32x32x16_bf16 v[168:183], v[152:155], v[68:71], v[168:183]
    v_mfma_f32_32x32x16_bf16 v[184:199], v[156:159], v[68:71], v[184:199]
    buffer_load_dwordx4 v[68:71], v2, s[8:11], s31 offen offset:1024 sc1
    s_barrier
    ds_read_b64_tr_b16 v[152:153], v12 offset:40960
    ds_read_b64_tr_b16 v[154:155], v12 offset:41472
    ds_read_b64_tr_b16 v[156:157], v13 offset:40960
    ds_read_b64_tr_b16 v[158:159], v13 offset:41472
    s_waitcnt vmcnt(29) lgkmcnt(8)
    v_mfma_f32_32x32x16_bf16 v[168:183], v[160:163], v[72:75], v[168:183]
    v_mfma_f32_32x32x16_bf16 v[184:199], v[164:167], v[72:75], v[184:199]
    buffer_load_dwordx4 v[72:75], v2, s[8:11], s31 offen offset:2048 sc1
    s_add_u32 m0, s35, 24576
    s_nop 0
    buffer_load_dwordx4 v10, s[16:19], s33 offen lds
    buffer_load_dwordx4 v10, s[16:19], s32 offen offset:1024 lds
    s_add_u32 s94, s36, 2
    s_and_b32 s94, s94, 3
    s_add_u32 s94, s94, 8
    s_mul_i32 s94, s94, 262144
    s_add_u32 s16, s12, s94
    s_addc_u32 s17, s13, 0
    ds_read_b64_tr_b16 v[160:161], v12 offset:43008
    ds_read_b64_tr_b16 v[162:163], v12 offset:43520
    ds_read_b64_tr_b16 v[164:165], v13 offset:43008
    ds_read_b64_tr_b16 v[166:167], v13 offset:43520
    s_waitcnt vmcnt(29) lgkmcnt(8)
    v_mfma_f32_32x32x16_bf16 v[168:183], v[144:147], v[76:79], v[168:183]
    v_mfma_f32_32x32x16_bf16 v[184:199], v[148:151], v[76:79], v[184:199]
    buffer_load_dwordx4 v[76:79], v2, s[8:11], s31 offen offset:3072 sc1
    s_add_u32 s94, s36, 1
    s_and_b32 s94, s94, 3
    s_add_u32 s94, s94, 8
    s_mul_i32 s94, s94, 8192
    s_add_u32 s31, s57, s94
    ds_read_b64_tr_b16 v[144:145], v12 offset:45056
    ds_read_b64_tr_b16 v[146:147], v12 offset:45568
    ds_read_b64_tr_b16 v[148:149], v13 offset:45056
    ds_read_b64_tr_b16 v[150:151], v13 offset:45568
    s_waitcnt vmcnt(29) lgkmcnt(8)
    v_mfma_f32_32x32x16_bf16 v[168:183], v[152:155], v[80:83], v[168:183]
    v_mfma_f32_32x32x16_bf16 v[184:199], v[156:159], v[80:83], v[184:199]
    buffer_load_dwordx4 v[80:83], v2, s[8:11], s31 offen offset:0 sc1
    ds_read_b64_tr_b16 v[152:153], v12 offset:47104
    ds_read_b64_tr_b16 v[154:155], v12 offset:47616
    ds_read_b64_tr_b16 v[156:157], v13 offset:47104
    ds_read_b64_tr_b16 v[158:159], v13 offset:47616
    s_waitcnt vmcnt(29) lgkmcnt(8)
    v_mfma_f32_32x32x16_bf16 v[168:183], v[160:163], v[84:87], v[168:183]
    v_mfma_f32_32x32x16_bf16 v[184:199], v[164:167], v[84:87], v[184:199]
    buffer_load_dwordx4 v[84:87], v2, s[8:11], s31 offen offset:1024 sc1
    s_barrier
    ds_read_b64_tr_b16 v[160:161], v12 offset:49152
    ds_read_b64_tr_b16 v[162:163], v12 offset:49664
    ds_read_b64_tr_b16 v[164:165], v13 offset:49152
    ds_read_b64_tr_b16 v[166:167], v13 offset:49664
    s_waitcnt vmcnt(29) lgkmcnt(8)
    v_mfma_f32_32x32x16_bf16 v[168:183], v[144:147], v[88:91], v[168:183]
    v_mfma_f32_32x32x16_bf16 v[184:199], v[148:151], v[88:91], v[184:199]
    buffer_load_dwordx4 v[88:91], v2, s[8:11], s31 offen offset:2048 sc1
    s_add_u32 m0, s35, 32768
    s_nop 0
    buffer_load_dwordx4 v10, s[16:19], s33 offen lds
    buffer_load_dwordx4 v10, s[16:19], s32 offen offset:1024 lds
    s_add_u32 s16, s16, 131072
    s_addc_u32 s17, s17, 0
    ds_read_b64_tr_b16 v[144:145], v12 offset:51200
    ds_read_b64_tr_b16 v[146:147], v12 offset:51712
    ds_read_b64_tr_b16 v[148:149], v13 offset:51200
    ds_read_b64_tr_b16 v[150:151], v13 offset:51712
    s_waitcnt vmcnt(29) lgkmcnt(8)
    v_mfma_f32_32x32x16_bf16 v[168:183], v[152:155], v[92:95], v[168:183]
    v_mfma_f32_32x32x16_bf16 v[184:199], v[156:159], v[92:95], v[184:199]
    buffer_load_dwordx4 v[92:95], v2, s[8:11], s31 offen offset:3072 sc1
    s_add_u32 s31, s31, 4096
    ds_read_b64_tr_b16 v[152:153], v12 offset:53248
    ds_read_b64_tr_b16 v[154:155], v12 offset:53760
    ds_read_b64_tr_b16 v[156:157], v13 offset:53248
    ds_read_b64_tr_b16 v[158:159], v13 offset:53760
    s_waitcnt vmcnt(29) lgkmcnt(8)
    v_mfma_f32_32x32x16_bf16 v[168:183], v[160:163], v[96:99], v[168:183]
    v_mfma_f32_32x32x16_bf16 v[184:199], v[164:167], v[96:99], v[184:199]
    buffer_load_dwordx4 v[96:99], v2, s[8:11], s31 offen offset:0 sc1
    ds_read_b64_tr_b16 v[160:161], v12 offset:55296
    ds_read_b64_tr_b16 v[162:163], v12 offset:55808
    ds_read_b64_tr_b16 v[164:165], v13 offset:55296
    ds_read_b64_tr_b16 v[166:167], v13 offset:55808
    s_waitcnt vmcnt(29) lgkmcnt(8)
    v_mfma_f32_32x32x16_bf16 v[168:183], v[144:147], v[100:103], v[168:183]
    v_mfma_f32_32x32x16_bf16 v[184:199], v[148:151], v[100:103], v[184:199]
    buffer_load_dwordx4 v[100:103], v2, s[8:11], s31 offen offset:1024 sc1
    s_barrier
    ds_read_b64_tr_b16 v[144:145], v12 offset:57344
    ds_read_b64_tr_b16 v[146:147], v12 offset:57856
    ds_read_b64_tr_b16 v[148:149], v13 offset:57344
    ds_read_b64_tr_b16 v[150:151], v13 offset:57856
    s_waitcnt vmcnt(29) lgkmcnt(8)
    v_mfma_f32_32x32x16_bf16 v[168:183], v[152:155], v[104:107], v[168:183]
    v_mfma_f32_32x32x16_bf16 v[184:199], v[156:159], v[104:107], v[184:199]
    buffer_load_dwordx4 v[104:107], v2, s[8:11], s31 offen offset:2048 sc1
    s_add_u32 m0, s35, 40960
    s_nop 0
    buffer_load_dwordx4 v10, s[16:19], s33 offen lds
    buffer_load_dwordx4 v10, s[16:19], s32 offen offset:1024 lds
    s_add_u32 s94, s36, 3
    s_and_b32 s94, s94, 3
    s_add_u32 s94, s94, 8
    s_mul_i32 s94, s94, 262144
    s_add_u32 s16, s12, s94
    s_addc_u32 s17, s13, 0
    ds_read_b64_tr_b16 v[152:153], v12 offset:59392
    ds_read_b64_tr_b16 v[154:155], v12 offset:59904
    ds_read_b64_tr_b16 v[156:157], v13 offset:59392
    ds_read_b64_tr_b16 v[158:159], v13 offset:59904
    s_waitcnt vmcnt(29) lgkmcnt(8)
    v_mfma_f32_32x32x16_bf16 v[168:183], v[160:163], v[108:111], v[168:183]
    v_mfma_f32_32x32x16_bf16 v[184:199], v[164:167], v[108:111], v[184:199]
    buffer_load_dwordx4 v[108:111], v2, s[8:11], s31 offen offset:3072 sc1
    s_add_u32 s94, s36, 2
    s_and_b32 s94, s94, 3
    s_add_u32 s94, s94, 8
    s_mul_i32 s94, s94, 8192
    s_add_u32 s31, s57, s94
    ds_read_b64_tr_b16 v[160:161], v12 offset:61440
    ds_read_b64_tr_b16 v[162:163], v12 offset:61952
    ds_read_b64_tr_b16 v[164:165], v13 offset:61440
    ds_read_b64_tr_b16 v[166:167], v13 offset:61952
    s_waitcnt vmcnt(29) lgkmcnt(8)
    v_mfma_f32_32x32x16_bf16 v[168:183], v[144:147], v[32:35], v[168:183]
    v_mfma_f32_32x32x16_bf16 v[184:199], v[148:151], v[32:35], v[184:199]
    buffer_load_dwordx4 v[32:35], v2, s[8:11], s31 offen offset:0 sc1
    ds_read_b64_tr_b16 v[144:145], v12 offset:63488
    ds_read_b64_tr_b16 v[146:147], v12 offset:64000
    ds_read_b64_tr_b16 v[148:149], v13 offset:63488
    ds_read_b64_tr_b16 v[150:151], v13 offset:64000
    s_waitcnt vmcnt(29) lgkmcnt(8)
    v_mfma_f32_32x32x16_bf16 v[168:183], v[152:155], v[36:39], v[168:183]
    v_mfma_f32_32x32x16_bf16 v[184:199], v[156:159], v[36:39], v[184:199]
    buffer_load_dwordx4 v[36:39], v2, s[8:11], s31 offen offset:1024 sc1
    s_barrier
    ds_read_b64_tr_b16 v[152:153], v12 offset:0
    ds_read_b64_tr_b16 v[154:155], v12 offset:512
    ds_read_b64_tr_b16 v[156:157], v13 offset:0
    ds_read_b64_tr_b16 v[158:159], v13 offset:512
    s_waitcnt vmcnt(29) lgkmcnt(8)
    v_mfma_f32_32x32x16_bf16 v[168:183], v[160:163], v[40:43], v[168:183]
    v_mfma_f32_32x32x16_bf16 v[184:199], v[164:167], v[40:43], v[184:199]
    buffer_load_dwordx4 v[40:43], v2, s[8:11], s31 offen offset:2048 sc1
    s_add_u32 m0, s35, 49152
    s_nop 0
    buffer_load_dwordx4 v10, s[16:19], s33 offen lds
    buffer_load_dwordx4 v10, s[16:19], s32 offen offset:1024 lds
    s_add_u32 s16, s16, 131072
    s_addc_u32 s17, s17, 0
    ds_read_b64_tr_b16 v[160:161], v12 offset:2048
    ds_read_b64_tr_b16 v[162:163], v12 offset:2560
    ds_read_b64_tr_b16 v[164:165], v13 offset:2048
    ds_read_b64_tr_b16 v[166:167], v13 offset:2560
    s_waitcnt vmcnt(29) lgkmcnt(8)
    v_mfma_f32_32x32x16_bf16 v[168:183], v[144:147], v[44:47], v[168:183]
    v_mfma_f32_32x32x16_bf16 v[184:199], v[148:151], v[44:47], v[184:199]
    buffer_load_dwordx4 v[44:47], v2, s[8:11], s31 offen offset:3072 sc1
    s_add_u32 s31, s31, 4096
    ds_read_b64_tr_b16 v[144:145], v12 offset:4096
    ds_read_b64_tr_b16 v[146:147], v12 offset:4608
    ds_read_b64_tr_b16 v[148:149], v13 offset:4096
    ds_read_b64_tr_b16 v[150:151], v13 offset:4608
    s_waitcnt vmcnt(29) lgkmcnt(8)
    v_mfma_f32_32x32x16_bf16 v[168:183], v[152:155], v[48:51], v[168:183]
    v_mfma_f32_32x32x16_bf16 v[184:199], v[156:159], v[48:51], v[184:199]
    buffer_load_dwordx4 v[48:51], v2, s[8:11], s31 offen offset:0 sc1
    ds_read_b64_tr_b16 v[152:153], v12 offset:6144
    ds_read_b64_tr_b16 v[154:155], v12 offset:6656
    ds_read_b64_tr_b16 v[156:157], v13 offset:6144
    ds_read_b64_tr_b16 v[158:159], v13 offset:6656
    s_waitcnt vmcnt(29) lgkmcnt(8)
    v_mfma_f32_32x32x16_bf16 v[168:183], v[160:163], v[52:55], v[168:183]
    v_mfma_f32_32x32x16_bf16 v[184:199], v[164:167], v[52:55], v[184:199]
    buffer_load_dwordx4 v[52:55], v2, s[8:11], s31 offen offset:1024 sc1
    s_barrier
    ds_read_b64_tr_b16 v[160:161], v12 offset:8192
    ds_read_b64_tr_b16 v[162:163], v12 offset:8704
    ds_read_b64_tr_b16 v[164:165], v13 offset:8192
    ds_read_b64_tr_b16 v[166:167], v13 offset:8704
    s_waitcnt vmcnt(29) lgkmcnt(8)
    v_mfma_f32_32x32x16_bf16 v[168:183], v[144:147], v[56:59], v[168:183]
    v_mfma_f32_32x32x16_bf16 v[184:199], v[148:151], v[56:59], v[184:199]
    buffer_load_dwordx4 v[56:59], v2, s[8:11], s31 offen offset:2048 sc1
    s_add_u32 m0, s35, 57344
    s_nop 0
    buffer_load_dwordx4 v10, s[16:19], s33 offen lds
    buffer_load_dwordx4 v10, s[16:19], s32 offen offset:1024 lds
    s_add_u32 s94, s36, 0
    s_and_b32 s94, s94, 3
    s_add_u32 s94, s94, 12
    s_mul_i32 s94, s94, 262144
    s_add_u32 s16, s12, s94
    s_addc_u32 s17, s13, 0
    ds_read_b64_tr_b16 v[144:145], v12 offset:10240
    ds_read_b64_tr_b16 v[146:147], v12 offset:10752
    ds_read_b64_tr_b16 v[148:149], v13 offset:10240
    ds_read_b64_tr_b16 v[150:151], v13 offset:10752
    s_waitcnt vmcnt(29) lgkmcnt(8)
    v_mfma_f32_32x32x16_bf16 v[168:183], v[152:155], v[60:63], v[168:183]
    v_mfma_f32_32x32x16_bf16 v[184:199], v[156:159], v[60:63], v[184:199]
    buffer_load_dwordx4 v[60:63], v2, s[8:11], s31 offen offset:3072 sc1
    s_add_u32 s94, s36, 3
    s_and_b32 s94, s94, 3
    s_add_u32 s94, s94, 8
    s_mul_i32 s94, s94, 8192
    s_add_u32 s31, s57, s94
    ds_read_b64_tr_b16 v[152:153], v12 offset:12288
    ds_read_b64_tr_b16 v[154:155], v12 offset:12800
    ds_read_b64_tr_b16 v[156:157], v13 offset:12288
    ds_read_b64_tr_b16 v[158:159], v13 offset:12800
    s_waitcnt vmcnt(29) lgkmcnt(8)
    v_mfma_f32_32x32x16_bf16 v[168:183], v[160:163], v[64:67], v[168:183]
    v_mfma_f32_32x32x16_bf16 v[184:199], v[164:167], v[64:67], v[184:199]
    buffer_load_dwordx4 v[64:67], v2, s[8:11], s31 offen offset:0 sc1
    ds_read_b64_tr_b16 v[160:161], v12 offset:14336
    ds_read_b64_tr_b16 v[162:163], v12 offset:14848
    ds_read_b64_tr_b16 v[164:165], v13 offset:14336
    ds_read_b64_tr_b16 v[166:167], v13 offset:14848
    s_waitcnt vmcnt(29) lgkmcnt(8)
    v_mfma_f32_32x32x16_bf16 v[168:183], v[144:147], v[68:71], v[168:183]
    v_mfma_f32_32x32x16_bf16 v[184:199], v[148:151], v[68:71], v[184:199]
    buffer_load_dwordx4 v[68:71], v2, s[8:11], s31 offen offset:1024 sc1
    s_barrier
    ds_read_b64_tr_b16 v[144:145], v12 offset:16384
    ds_read_b64_tr_b16 v[146:147], v12 offset:16896
    ds_read_b64_tr_b16 v[148:149], v13 offset:16384
    ds_read_b64_tr_b16 v[150:151], v13 offset:16896
    s_waitcnt vmcnt(29) lgkmcnt(8)
    v_mfma_f32_32x32x16_bf16 v[168:183], v[152:155], v[72:75], v[168:183]
    v_mfma_f32_32x32x16_bf16 v[184:199], v[156:159], v[72:75], v[184:199]
    buffer_load_dwordx4 v[72:75], v2, s[8:11], s31 offen offset:2048 sc1
    s_add_u32 m0, s35, 0
    s_nop 0
    buffer_load_dwordx4 v10, s[16:19], s33 offen lds
    buffer_load_dwordx4 v10, s[16:19], s32 offen offset:1024 lds
    s_add_u32 s16, s16, 131072
    s_addc_u32 s17, s17, 0
    ds_read_b64_tr_b16 v[152:153], v12 offset:18432
    ds_read_b64_tr_b16 v[154:155], v12 offset:18944
    ds_read_b64_tr_b16 v[156:157], v13 offset:18432
    ds_read_b64_tr_b16 v[158:159], v13 offset:18944
    s_waitcnt vmcnt(29) lgkmcnt(8)
    v_mfma_f32_32x32x16_bf16 v[168:183], v[160:163], v[76:79], v[168:183]
    v_mfma_f32_32x32x16_bf16 v[184:199], v[164:167], v[76:79], v[184:199]
    buffer_load_dwordx4 v[76:79], v2, s[8:11], s31 offen offset:3072 sc1
    s_add_u32 s31, s31, 4096
    ds_read_b64_tr_b16 v[160:161], v12 offset:20480
    ds_read_b64_tr_b16 v[162:163], v12 offset:20992
    ds_read_b64_tr_b16 v[164:165], v13 offset:20480
    ds_read_b64_tr_b16 v[166:167], v13 offset:20992
    s_waitcnt vmcnt(29) lgkmcnt(8)
    v_mfma_f32_32x32x16_bf16 v[168:183], v[144:147], v[80:83], v[168:183]
    v_mfma_f32_32x32x16_bf16 v[184:199], v[148:151], v[80:83], v[184:199]
    buffer_load_dwordx4 v[80:83], v2, s[8:11], s31 offen offset:0 sc1
    ds_read_b64_tr_b16 v[144:145], v12 offset:22528
    ds_read_b64_tr_b16 v[146:147], v12 offset:23040
    ds_read_b64_tr_b16 v[148:149], v13 offset:22528
    ds_read_b64_tr_b16 v[150:151], v13 offset:23040
    s_waitcnt vmcnt(29) lgkmcnt(8)
    v_mfma_f32_32x32x16_bf16 v[168:183], v[152:155], v[84:87], v[168:183]
    v_mfma_f32_32x32x16_bf16 v[184:199], v[156:159], v[84:87], v[184:199]
    buffer_load_dwordx4 v[84:87], v2, s[8:11], s31 offen offset:1024 sc1
    s_barrier
    ds_read_b64_tr_b16 v[152:153], v12 offset:24576
    ds_read_b64_tr_b16 v[154:155], v12 offset:25088
    ds_read_b64_tr_b16 v[156:157], v13 offset:24576
    ds_read_b64_tr_b16 v[158:159], v13 offset:25088
    s_waitcnt vmcnt(29) lgkmcnt(8)
    v_mfma_f32_32x32x16_bf16 v[168:183], v[160:163], v[88:91], v[168:183]
    v_mfma_f32_32x32x16_bf16 v[184:199], v[164:167], v[88:91], v[184:199]
    buffer_load_dwordx4 v[88:91], v2, s[8:11], s31 offen offset:2048 sc1
    s_add_u32 m0, s35, 8192
    s_nop 0
    buffer_load_dwordx4 v10, s[16:19], s33 offen lds
    buffer_load_dwordx4 v10, s[16:19], s32 offen offset:1024 lds
    s_add_u32 s94, s36, 1
    s_and_b32 s94, s94, 3
    s_add_u32 s94, s94, 12
    s_mul_i32 s94, s94, 262144
    s_add_u32 s16, s12, s94
    s_addc_u32 s17, s13, 0
    ds_read_b64_tr_b16 v[160:161], v12 offset:26624
    ds_read_b64_tr_b16 v[162:163], v12 offset:27136
    ds_read_b64_tr_b16 v[164:165], v13 offset:26624
    ds_read_b64_tr_b16 v[166:167], v13 offset:27136
    s_waitcnt vmcnt(29) lgkmcnt(8)
    v_mfma_f32_32x32x16_bf16 v[168:183], v[144:147], v[92:95], v[168:183]
    v_mfma_f32_32x32x16_bf16 v[184:199], v[148:151], v[92:95], v[184:199]
    buffer_load_dwordx4 v[92:95], v2, s[8:11], s31 offen offset:3072 sc1
    s_add_u32 s94, s36, 0
    s_and_b32 s94, s94, 3
    s_add_u32 s94, s94, 12
    s_mul_i32 s94, s94, 8192
    s_add_u32 s31, s57, s94
    ds_read_b64_tr_b16 v[144:145], v12 offset:28672
    ds_read_b64_tr_b16 v[146:147], v12 offset:29184
    ds_read_b64_tr_b16 v[148:149], v13 offset:28672
    ds_read_b64_tr_b16 v[150:151], v13 offset:29184
    s_waitcnt vmcnt(29) lgkmcnt(8)
    v_mfma_f32_32x32x16_bf16 v[168:183], v[152:155], v[96:99], v[168:183]
    v_mfma_f32_32x32x16_bf16 v[184:199], v[156:159], v[96:99], v[184:199]
    buffer_load_dwordx4 v[96:99], v2, s[8:11], s31 offen offset:0 sc1
    ds_read_b64_tr_b16 v[152:153], v12 offset:30720
    ds_read_b64_tr_b16 v[154:155], v12 offset:31232
    ds_read_b64_tr_b16 v[156:157], v13 offset:30720
    ds_read_b64_tr_b16 v[158:159], v13 offset:31232
    s_waitcnt vmcnt(29) lgkmcnt(8)
    v_mfma_f32_32x32x16_bf16 v[168:183], v[160:163], v[100:103], v[168:183]
    v_mfma_f32_32x32x16_bf16 v[184:199], v[164:167], v[100:103], v[184:199]
    buffer_load_dwordx4 v[100:103], v2, s[8:11], s31 offen offset:1024 sc1
    s_barrier
    ds_read_b64_tr_b16 v[160:161], v12 offset:32768
    ds_read_b64_tr_b16 v[162:163], v12 offset:33280
    ds_read_b64_tr_b16 v[164:165], v13 offset:32768
    ds_read_b64_tr_b16 v[166:167], v13 offset:33280
    s_waitcnt vmcnt(29) lgkmcnt(8)
    v_mfma_f32_32x32x16_bf16 v[168:183], v[144:147], v[104:107], v[168:183]
    v_mfma_f32_32x32x16_bf16 v[184:199], v[148:151], v[104:107], v[184:199]
    buffer_load_dwordx4 v[104:107], v2, s[8:11], s31 offen offset:2048 sc1
    s_add_u32 m0, s35, 16384
    s_nop 0
    buffer_load_dwordx4 v10, s[16:19], s33 offen lds
    buffer_load_dwordx4 v10, s[16:19], s32 offen offset:1024 lds
    s_add_u32 s16, s16, 131072
    s_addc_u32 s17, s17, 0
    ds_read_b64_tr_b16 v[144:145], v12 offset:34816
    ds_read_b64_tr_b16 v[146:147], v12 offset:35328
    ds_read_b64_tr_b16 v[148:149], v13 offset:34816
    ds_read_b64_tr_b16 v[150:151], v13 offset:35328
    s_waitcnt vmcnt(29) lgkmcnt(8)
    v_mfma_f32_32x32x16_bf16 v[168:183], v[152:155], v[108:111], v[168:183]
    v_mfma_f32_32x32x16_bf16 v[184:199], v[156:159], v[108:111], v[184:199]
    buffer_load_dwordx4 v[108:111], v2, s[8:11], s31 offen offset:3072 sc1
    s_add_u32 s31, s31, 4096
    ds_read_b64_tr_b16 v[152:153], v12 offset:36864
    ds_read_b64_tr_b16 v[154:155], v12 offset:37376
    ds_read_b64_tr_b16 v[156:157], v13 offset:36864
    ds_read_b64_tr_b16 v[158:159], v13 offset:37376
    s_waitcnt vmcnt(29) lgkmcnt(8)
    v_mfma_f32_32x32x16_bf16 v[168:183], v[160:163], v[32:35], v[168:183]
    v_mfma_f32_32x32x16_bf16 v[184:199], v[164:167], v[32:35], v[184:199]
    buffer_load_dwordx4 v[32:35], v2, s[8:11], s31 offen offset:0 sc1
    ds_read_b64_tr_b16 v[160:161], v12 offset:38912
    ds_read_b64_tr_b16 v[162:163], v12 offset:39424
    ds_read_b64_tr_b16 v[164:165], v13 offset:38912
    ds_read_b64_tr_b16 v[166:167], v13 offset:39424
    s_waitcnt vmcnt(29) lgkmcnt(8)
    v_mfma_f32_32x32x16_bf16 v[168:183], v[144:147], v[36:39], v[168:183]
    v_mfma_f32_32x32x16_bf16 v[184:199], v[148:151], v[36:39], v[184:199]
    buffer_load_dwordx4 v[36:39], v2, s[8:11], s31 offen offset:1024 sc1
    s_barrier
    ds_read_b64_tr_b16 v[144:145], v12 offset:40960
    ds_read_b64_tr_b16 v[146:147], v12 offset:41472
    ds_read_b64_tr_b16 v[148:149], v13 offset:40960
    ds_read_b64_tr_b16 v[150:151], v13 offset:41472
    s_waitcnt vmcnt(29) lgkmcnt(8)
    v_mfma_f32_32x32x16_bf16 v[168:183], v[152:155], v[40:43], v[168:183]
    v_mfma_f32_32x32x16_bf16 v[184:199], v[156:159], v[40:43], v[184:199]
    buffer_load_dwordx4 v[40:43], v2, s[8:11], s31 offen offset:2048 sc1
    s_add_u32 m0, s35, 24576
    s_nop 0
    buffer_load_dwordx4 v10, s[16:19], s33 offen lds
    buffer_load_dwordx4 v10, s[16:19], s32 offen offset:1024 lds
    s_add_u32 s94, s36, 2
    s_and_b32 s94, s94, 3
    s_add_u32 s94, s94, 12
    s_mul_i32 s94, s94, 262144
    s_add_u32 s16, s12, s94
    s_addc_u32 s17, s13, 0
    ds_read_b64_tr_b16 v[152:153], v12 offset:43008
    ds_read_b64_tr_b16 v[154:155], v12 offset:43520
    ds_read_b64_tr_b16 v[156:157], v13 offset:43008
    ds_read_b64_tr_b16 v[158:159], v13 offset:43520
    s_waitcnt vmcnt(29) lgkmcnt(8)
    v_mfma_f32_32x32x16_bf16 v[168:183], v[160:163], v[44:47], v[168:183]
    v_mfma_f32_32x32x16_bf16 v[184:199], v[164:167], v[44:47], v[184:199]
    buffer_load_dwordx4 v[44:47], v2, s[8:11], s31 offen offset:3072 sc1
    s_add_u32 s94, s36, 1
    s_and_b32 s94, s94, 3
    s_add_u32 s94, s94, 12
    s_mul_i32 s94, s94, 8192
    s_add_u32 s31, s57, s94
    ds_read_b64_tr_b16 v[160:161], v12 offset:45056
    ds_read_b64_tr_b16 v[162:163], v12 offset:45568
    ds_read_b64_tr_b16 v[164:165], v13 offset:45056
    ds_read_b64_tr_b16 v[166:167], v13 offset:45568
    s_waitcnt vmcnt(29) lgkmcnt(8)
    v_mfma_f32_32x32x16_bf16 v[168:183], v[144:147], v[48:51], v[168:183]
    v_mfma_f32_32x32x16_bf16 v[184:199], v[148:151], v[48:51], v[184:199]
    buffer_load_dwordx4 v[48:51], v2, s[8:11], s31 offen offset:0 sc1
    ds_read_b64_tr_b16 v[144:145], v12 offset:47104
    ds_read_b64_tr_b16 v[146:147], v12 offset:47616
    ds_read_b64_tr_b16 v[148:149], v13 offset:47104
    ds_read_b64_tr_b16 v[150:151], v13 offset:47616
    s_waitcnt vmcnt(29) lgkmcnt(8)
    v_mfma_f32_32x32x16_bf16 v[168:183], v[152:155], v[52:55], v[168:183]
    v_mfma_f32_32x32x16_bf16 v[184:199], v[156:159], v[52:55], v[184:199]
    buffer_load_dwordx4 v[52:55], v2, s[8:11], s31 offen offset:1024 sc1
    s_barrier
    ds_read_b64_tr_b16 v[152:153], v12 offset:49152
    ds_read_b64_tr_b16 v[154:155], v12 offset:49664
    ds_read_b64_tr_b16 v[156:157], v13 offset:49152
    ds_read_b64_tr_b16 v[158:159], v13 offset:49664
    s_waitcnt vmcnt(29) lgkmcnt(8)
    v_mfma_f32_32x32x16_bf16 v[168:183], v[160:163], v[56:59], v[168:183]
    v_mfma_f32_32x32x16_bf16 v[184:199], v[164:167], v[56:59], v[184:199]
    buffer_load_dwordx4 v[56:59], v2, s[8:11], s31 offen offset:2048 sc1
    s_add_u32 m0, s35, 32768
    s_nop 0
    buffer_load_dwordx4 v10, s[16:19], s33 offen lds
    buffer_load_dwordx4 v10, s[16:19], s32 offen offset:1024 lds
    s_add_u32 s16, s16, 131072
    s_addc_u32 s17, s17, 0
    ds_read_b64_tr_b16 v[160:161], v12 offset:51200
    ds_read_b64_tr_b16 v[162:163], v12 offset:51712
    ds_read_b64_tr_b16 v[164:165], v13 offset:51200
    ds_read_b64_tr_b16 v[166:167], v13 offset:51712
    s_waitcnt vmcnt(29) lgkmcnt(8)
    v_mfma_f32_32x32x16_bf16 v[168:183], v[144:147], v[60:63], v[168:183]
    v_mfma_f32_32x32x16_bf16 v[184:199], v[148:151], v[60:63], v[184:199]
    buffer_load_dwordx4 v[60:63], v2, s[8:11], s31 offen offset:3072 sc1
    s_add_u32 s31, s31, 4096
    ds_read_b64_tr_b16 v[144:145], v12 offset:53248
    ds_read_b64_tr_b16 v[146:147], v12 offset:53760
    ds_read_b64_tr_b16 v[148:149], v13 offset:53248
    ds_read_b64_tr_b16 v[150:151], v13 offset:53760
    s_waitcnt vmcnt(29) lgkmcnt(8)
    v_mfma_f32_32x32x16_bf16 v[168:183], v[152:155], v[64:67], v[168:183]
    v_mfma_f32_32x32x16_bf16 v[184:199], v[156:159], v[64:67], v[184:199]
    buffer_load_dwordx4 v[64:67], v2, s[8:11], s31 offen offset:0 sc1
    ds_read_b64_tr_b16 v[152:153], v12 offset:55296
    ds_read_b64_tr_b16 v[154:155], v12 offset:55808
    ds_read_b64_tr_b16 v[156:157], v13 offset:55296
    ds_read_b64_tr_b16 v[158:159], v13 offset:55808
    s_waitcnt vmcnt(29) lgkmcnt(8)
    v_mfma_f32_32x32x16_bf16 v[168:183], v[160:163], v[68:71], v[168:183]
    v_mfma_f32_32x32x16_bf16 v[184:199], v[164:167], v[68:71], v[184:199]
    buffer_load_dwordx4 v[68:71], v2, s[8:11], s31 offen offset:1024 sc1
    s_barrier
    ds_read_b64_tr_b16 v[160:161], v12 offset:57344
    ds_read_b64_tr_b16 v[162:163], v12 offset:57856
    ds_read_b64_tr_b16 v[164:165], v13 offset:57344
    ds_read_b64_tr_b16 v[166:167], v13 offset:57856
    s_waitcnt vmcnt(29) lgkmcnt(8)
    v_mfma_f32_32x32x16_bf16 v[168:183], v[144:147], v[72:75], v[168:183]
    v_mfma_f32_32x32x16_bf16 v[184:199], v[148:151], v[72:75], v[184:199]
    buffer_load_dwordx4 v[72:75], v2, s[8:11], s31 offen offset:2048 sc1
    s_add_u32 m0, s35, 40960
    s_nop 0
    buffer_load_dwordx4 v10, s[16:19], s33 offen lds
    buffer_load_dwordx4 v10, s[16:19], s32 offen offset:1024 lds
    s_add_u32 s94, s36, 3
    s_and_b32 s94, s94, 3
    s_add_u32 s94, s94, 12
    s_mul_i32 s94, s94, 262144
    s_add_u32 s16, s12, s94
    s_addc_u32 s17, s13, 0
    ds_read_b64_tr_b16 v[144:145], v12 offset:59392
    ds_read_b64_tr_b16 v[146:147], v12 offset:59904
    ds_read_b64_tr_b16 v[148:149], v13 offset:59392
    ds_read_b64_tr_b16 v[150:151], v13 offset:59904
    s_waitcnt vmcnt(29) lgkmcnt(8)
    v_mfma_f32_32x32x16_bf16 v[168:183], v[152:155], v[76:79], v[168:183]
    v_mfma_f32_32x32x16_bf16 v[184:199], v[156:159], v[76:79], v[184:199]
    buffer_load_dwordx4 v[76:79], v2, s[8:11], s31 offen offset:3072 sc1
    s_add_u32 s94, s36, 2
    s_and_b32 s94, s94, 3
    s_add_u32 s94, s94, 12
    s_mul_i32 s94, s94, 8192
    s_add_u32 s31, s57, s94
    ds_read_b64_tr_b16 v[152:153], v12 offset:61440
    ds_read_b64_tr_b16 v[154:155], v12 offset:61952
    ds_read_b64_tr_b16 v[156:157], v13 offset:61440
    ds_read_b64_tr_b16 v[158:159], v13 offset:61952
    s_waitcnt vmcnt(29) lgkmcnt(8)
    v_mfma_f32_32x32x16_bf16 v[168:183], v[160:163], v[80:83], v[168:183]
    v_mfma_f32_32x32x16_bf16 v[184:199], v[164:167], v[80:83], v[184:199]
    buffer_load_dwordx4 v[80:83], v2, s[8:11], s31 offen offset:0 sc1
    ds_read_b64_tr_b16 v[160:161], v12 offset:63488
    ds_read_b64_tr_b16 v[162:163], v12 offset:64000
    ds_read_b64_tr_b16 v[164:165], v13 offset:63488
    ds_read_b64_tr_b16 v[166:167], v13 offset:64000
    s_waitcnt vmcnt(29) lgkmcnt(8)
    v_mfma_f32_32x32x16_bf16 v[168:183], v[144:147], v[84:87], v[168:183]
    v_mfma_f32_32x32x16_bf16 v[184:199], v[148:151], v[84:87], v[184:199]
    buffer_load_dwordx4 v[84:87], v2, s[8:11], s31 offen offset:1024 sc1
    s_barrier
    ds_read_b64_tr_b16 v[144:145], v12 offset:0
    ds_read_b64_tr_b16 v[146:147], v12 offset:512
    ds_read_b64_tr_b16 v[148:149], v13 offset:0
    ds_read_b64_tr_b16 v[150:151], v13 offset:512
    s_waitcnt vmcnt(29) lgkmcnt(8)
    v_mfma_f32_32x32x16_bf16 v[168:183], v[152:155], v[88:91], v[168:183]
    v_mfma_f32_32x32x16_bf16 v[184:199], v[156:159], v[88:91], v[184:199]
    buffer_load_dwordx4 v[88:91], v2, s[8:11], s31 offen offset:2048 sc1
    s_add_u32 m0, s35, 49152
    s_nop 0
    buffer_load_dwordx4 v10, s[16:19], s33 offen lds
    buffer_load_dwordx4 v10, s[16:19], s32 offen offset:1024 lds
    s_add_u32 s16, s16, 131072
    s_addc_u32 s17, s17, 0
    ds_read_b64_tr_b16 v[152:153], v12 offset:2048
    ds_read_b64_tr_b16 v[154:155], v12 offset:2560
    ds_read_b64_tr_b16 v[156:157], v13 offset:2048
    ds_read_b64_tr_b16 v[158:159], v13 offset:2560
    s_waitcnt vmcnt(29) lgkmcnt(8)
    v_mfma_f32_32x32x16_bf16 v[168:183], v[160:163], v[92:95], v[168:183]
    v_mfma_f32_32x32x16_bf16 v[184:199], v[164:167], v[92:95], v[184:199]
    buffer_load_dwordx4 v[92:95], v2, s[8:11], s31 offen offset:3072 sc1
    s_add_u32 s31, s31, 4096
    ds_read_b64_tr_b16 v[160:161], v12 offset:4096
    ds_read_b64_tr_b16 v[162:163], v12 offset:4608
    ds_read_b64_tr_b16 v[164:165], v13 offset:4096
    ds_read_b64_tr_b16 v[166:167], v13 offset:4608
    s_waitcnt vmcnt(29) lgkmcnt(8)
    v_mfma_f32_32x32x16_bf16 v[168:183], v[144:147], v[96:99], v[168:183]
    v_mfma_f32_32x32x16_bf16 v[184:199], v[148:151], v[96:99], v[184:199]
    buffer_load_dwordx4 v[96:99], v2, s[8:11], s31 offen offset:0 sc1
    ds_read_b64_tr_b16 v[144:145], v12 offset:6144
    ds_read_b64_tr_b16 v[146:147], v12 offset:6656
    ds_read_b64_tr_b16 v[148:149], v13 offset:6144
    ds_read_b64_tr_b16 v[150:151], v13 offset:6656
    s_waitcnt vmcnt(29) lgkmcnt(8)
    v_mfma_f32_32x32x16_bf16 v[168:183], v[152:155], v[100:103], v[168:183]
    v_mfma_f32_32x32x16_bf16 v[184:199], v[156:159], v[100:103], v[184:199]
    buffer_load_dwordx4 v[100:103], v2, s[8:11], s31 offen offset:1024 sc1
    s_barrier
    ds_read_b64_tr_b16 v[152:153], v12 offset:8192
    ds_read_b64_tr_b16 v[154:155], v12 offset:8704
    ds_read_b64_tr_b16 v[156:157], v13 offset:8192
    ds_read_b64_tr_b16 v[158:159], v13 offset:8704
    s_waitcnt vmcnt(29) lgkmcnt(8)
    v_mfma_f32_32x32x16_bf16 v[168:183], v[160:163], v[104:107], v[168:183]
    v_mfma_f32_32x32x16_bf16 v[184:199], v[164:167], v[104:107], v[184:199]
    buffer_load_dwordx4 v[104:107], v2, s[8:11], s31 offen offset:2048 sc1
    s_add_u32 m0, s35, 57344
    s_nop 0
    buffer_load_dwordx4 v10, s[16:19], s33 offen lds
    buffer_load_dwordx4 v10, s[16:19], s32 offen offset:1024 lds
    s_add_u32 s94, s36, 0
    s_and_b32 s94, s94, 3
    s_add_u32 s94, s94, 16
    s_mul_i32 s94, s94, 262144
    s_add_u32 s16, s12, s94
    s_addc_u32 s17, s13, 0
    ds_read_b64_tr_b16 v[160:161], v12 offset:10240
    ds_read_b64_tr_b16 v[162:163], v12 offset:10752
    ds_read_b64_tr_b16 v[164:165], v13 offset:10240
    ds_read_b64_tr_b16 v[166:167], v13 offset:10752
    s_waitcnt vmcnt(29) lgkmcnt(8)
    v_mfma_f32_32x32x16_bf16 v[168:183], v[144:147], v[108:111], v[168:183]
    v_mfma_f32_32x32x16_bf16 v[184:199], v[148:151], v[108:111], v[184:199]
    buffer_load_dwordx4 v[108:111], v2, s[8:11], s31 offen offset:3072 sc1
    s_add_u32 s94, s36, 3
    s_and_b32 s94, s94, 3
    s_add_u32 s94, s94, 12
    s_mul_i32 s94, s94, 8192
    s_add_u32 s31, s57, s94
    ds_read_b64_tr_b16 v[144:145], v12 offset:12288
    ds_read_b64_tr_b16 v[146:147], v12 offset:12800
    ds_read_b64_tr_b16 v[148:149], v13 offset:12288
    ds_read_b64_tr_b16 v[150:151], v13 offset:12800
    s_waitcnt vmcnt(29) lgkmcnt(8)
    v_mfma_f32_32x32x16_bf16 v[168:183], v[152:155], v[32:35], v[168:183]
    v_mfma_f32_32x32x16_bf16 v[184:199], v[156:159], v[32:35], v[184:199]
    buffer_load_dwordx4 v[32:35], v2, s[8:11], s31 offen offset:0 sc1
    ds_read_b64_tr_b16 v[152:153], v12 offset:14336
    ds_read_b64_tr_b16 v[154:155], v12 offset:14848
    ds_read_b64_tr_b16 v[156:157], v13 offset:14336
    ds_read_b64_tr_b16 v[158:159], v13 offset:14848
    s_waitcnt vmcnt(29) lgkmcnt(8)
    v_mfma_f32_32x32x16_bf16 v[168:183], v[160:163], v[36:39], v[168:183]
    v_mfma_f32_32x32x16_bf16 v[184:199], v[164:167], v[36:39], v[184:199]
    buffer_load_dwordx4 v[36:39], v2, s[8:11], s31 offen offset:1024 sc1
    s_barrier
    ds_read_b64_tr_b16 v[160:161], v12 offset:16384
    ds_read_b64_tr_b16 v[162:163], v12 offset:16896
    ds_read_b64_tr_b16 v[164:165], v13 offset:16384
    ds_read_b64_tr_b16 v[166:167], v13 offset:16896
    s_waitcnt vmcnt(29) lgkmcnt(8)
    v_mfma_f32_32x32x16_bf16 v[168:183], v[144:147], v[40:43], v[168:183]
    v_mfma_f32_32x32x16_bf16 v[184:199], v[148:151], v[40:43], v[184:199]
    buffer_load_dwordx4 v[40:43], v2, s[8:11], s31 offen offset:2048 sc1
    s_add_u32 m0, s35, 0
    s_nop 0
    buffer_load_dwordx4 v10, s[16:19], s33 offen lds
    buffer_load_dwordx4 v10, s[16:19], s32 offen offset:1024 lds
    s_add_u32 s16, s16, 131072
    s_addc_u32 s17, s17, 0
    ds_read_b64_tr_b16 v[144:145], v12 offset:18432
    ds_read_b64_tr_b16 v[146:147], v12 offset:18944
    ds_read_b64_tr_b16 v[148:149], v13 offset:18432
    ds_read_b64_tr_b16 v[150:151], v13 offset:18944
    s_waitcnt vmcnt(29) lgkmcnt(8)
    v_mfma_f32_32x32x16_bf16 v[168:183], v[152:155], v[44:47], v[168:183]
    v_mfma_f32_32x32x16_bf16 v[184:199], v[156:159], v[44:47], v[184:199]
    buffer_load_dwordx4 v[44:47], v2, s[8:11], s31 offen offset:3072 sc1
    s_add_u32 s31, s31, 4096
    ds_read_b64_tr_b16 v[152:153], v12 offset:20480
    ds_read_b64_tr_b16 v[154:155], v12 offset:20992
    ds_read_b64_tr_b16 v[156:157], v13 offset:20480
    ds_read_b64_tr_b16 v[158:159], v13 offset:20992
    s_waitcnt vmcnt(29) lgkmcnt(8)
    v_mfma_f32_32x32x16_bf16 v[168:183], v[160:163], v[48:51], v[168:183]
    v_mfma_f32_32x32x16_bf16 v[184:199], v[164:167], v[48:51], v[184:199]
    buffer_load_dwordx4 v[48:51], v2, s[8:11], s31 offen offset:0 sc1
    ds_read_b64_tr_b16 v[160:161], v12 offset:22528
    ds_read_b64_tr_b16 v[162:163], v12 offset:23040
    ds_read_b64_tr_b16 v[164:165], v13 offset:22528
    ds_read_b64_tr_b16 v[166:167], v13 offset:23040
    s_waitcnt vmcnt(29) lgkmcnt(8)
    v_mfma_f32_32x32x16_bf16 v[168:183], v[144:147], v[52:55], v[168:183]
    v_mfma_f32_32x32x16_bf16 v[184:199], v[148:151], v[52:55], v[184:199]
    buffer_load_dwordx4 v[52:55], v2, s[8:11], s31 offen offset:1024 sc1
    s_barrier
    ds_read_b64_tr_b16 v[144:145], v12 offset:24576
    ds_read_b64_tr_b16 v[146:147], v12 offset:25088
    ds_read_b64_tr_b16 v[148:149], v13 offset:24576
    ds_read_b64_tr_b16 v[150:151], v13 offset:25088
    s_waitcnt vmcnt(29) lgkmcnt(8)
    v_mfma_f32_32x32x16_bf16 v[168:183], v[152:155], v[56:59], v[168:183]
    v_mfma_f32_32x32x16_bf16 v[184:199], v[156:159], v[56:59], v[184:199]
    buffer_load_dwordx4 v[56:59], v2, s[8:11], s31 offen offset:2048 sc1
    s_add_u32 m0, s35, 8192
    s_nop 0
    buffer_load_dwordx4 v10, s[16:19], s33 offen lds
    buffer_load_dwordx4 v10, s[16:19], s32 offen offset:1024 lds
    s_add_u32 s94, s36, 1
    s_and_b32 s94, s94, 3
    s_add_u32 s94, s94, 16
    s_mul_i32 s94, s94, 262144
    s_add_u32 s16, s12, s94
    s_addc_u32 s17, s13, 0
    ds_read_b64_tr_b16 v[152:153], v12 offset:26624
    ds_read_b64_tr_b16 v[154:155], v12 offset:27136
    ds_read_b64_tr_b16 v[156:157], v13 offset:26624
    ds_read_b64_tr_b16 v[158:159], v13 offset:27136
    s_waitcnt vmcnt(29) lgkmcnt(8)
    v_mfma_f32_32x32x16_bf16 v[168:183], v[160:163], v[60:63], v[168:183]
    v_mfma_f32_32x32x16_bf16 v[184:199], v[164:167], v[60:63], v[184:199]
    buffer_load_dwordx4 v[60:63], v2, s[8:11], s31 offen offset:3072 sc1
    s_add_u32 s94, s36, 0
    s_and_b32 s94, s94, 3
    s_add_u32 s94, s94, 16
    s_mul_i32 s94, s94, 8192
    s_add_u32 s31, s57, s94
    ds_read_b64_tr_b16 v[160:161], v12 offset:28672
    ds_read_b64_tr_b16 v[162:163], v12 offset:29184
    ds_read_b64_tr_b16 v[164:165], v13 offset:28672
    ds_read_b64_tr_b16 v[166:167], v13 offset:29184
    s_waitcnt vmcnt(29) lgkmcnt(8)
    v_mfma_f32_32x32x16_bf16 v[168:183], v[144:147], v[64:67], v[168:183]
    v_mfma_f32_32x32x16_bf16 v[184:199], v[148:151], v[64:67], v[184:199]
    buffer_load_dwordx4 v[64:67], v2, s[8:11], s31 offen offset:0 sc1
    ds_read_b64_tr_b16 v[144:145], v12 offset:30720
    ds_read_b64_tr_b16 v[146:147], v12 offset:31232
    ds_read_b64_tr_b16 v[148:149], v13 offset:30720
    ds_read_b64_tr_b16 v[150:151], v13 offset:31232
    s_waitcnt vmcnt(29) lgkmcnt(8)
    v_mfma_f32_32x32x16_bf16 v[168:183], v[152:155], v[68:71], v[168:183]
    v_mfma_f32_32x32x16_bf16 v[184:199], v[156:159], v[68:71], v[184:199]
    buffer_load_dwordx4 v[68:71], v2, s[8:11], s31 offen offset:1024 sc1
    s_barrier
    ds_read_b64_tr_b16 v[152:153], v12 offset:32768
    ds_read_b64_tr_b16 v[154:155], v12 offset:33280
    ds_read_b64_tr_b16 v[156:157], v13 offset:32768
    ds_read_b64_tr_b16 v[158:159], v13 offset:33280
    s_waitcnt vmcnt(29) lgkmcnt(8)
    v_mfma_f32_32x32x16_bf16 v[168:183], v[160:163], v[72:75], v[168:183]
    v_mfma_f32_32x32x16_bf16 v[184:199], v[164:167], v[72:75], v[184:199]
    buffer_load_dwordx4 v[72:75], v2, s[8:11], s31 offen offset:2048 sc1
    s_add_u32 m0, s35, 16384
    s_nop 0
    buffer_load_dwordx4 v10, s[16:19], s33 offen lds
    buffer_load_dwordx4 v10, s[16:19], s32 offen offset:1024 lds
    s_add_u32 s16, s16, 131072
    s_addc_u32 s17, s17, 0
    ds_read_b64_tr_b16 v[160:161], v12 offset:34816
    ds_read_b64_tr_b16 v[162:163], v12 offset:35328
    ds_read_b64_tr_b16 v[164:165], v13 offset:34816
    ds_read_b64_tr_b16 v[166:167], v13 offset:35328
    s_waitcnt vmcnt(29) lgkmcnt(8)
    v_mfma_f32_32x32x16_bf16 v[168:183], v[144:147], v[76:79], v[168:183]
    v_mfma_f32_32x32x16_bf16 v[184:199], v[148:151], v[76:79], v[184:199]
    buffer_load_dwordx4 v[76:79], v2, s[8:11], s31 offen offset:3072 sc1
    s_add_u32 s31, s31, 4096
    ds_read_b64_tr_b16 v[144:145], v12 offset:36864
    ds_read_b64_tr_b16 v[146:147], v12 offset:37376
    ds_read_b64_tr_b16 v[148:149], v13 offset:36864
    ds_read_b64_tr_b16 v[150:151], v13 offset:37376
    s_waitcnt vmcnt(29) lgkmcnt(8)
    v_mfma_f32_32x32x16_bf16 v[168:183], v[152:155], v[80:83], v[168:183]
    v_mfma_f32_32x32x16_bf16 v[184:199], v[156:159], v[80:83], v[184:199]
    buffer_load_dwordx4 v[80:83], v2, s[8:11], s31 offen offset:0 sc1
    ds_read_b64_tr_b16 v[152:153], v12 offset:38912
    ds_read_b64_tr_b16 v[154:155], v12 offset:39424
    ds_read_b64_tr_b16 v[156:157], v13 offset:38912
    ds_read_b64_tr_b16 v[158:159], v13 offset:39424
    s_waitcnt vmcnt(29) lgkmcnt(8)
    v_mfma_f32_32x32x16_bf16 v[168:183], v[160:163], v[84:87], v[168:183]
    v_mfma_f32_32x32x16_bf16 v[184:199], v[164:167], v[84:87], v[184:199]
    buffer_load_dwordx4 v[84:87], v2, s[8:11], s31 offen offset:1024 sc1
    s_barrier
    ds_read_b64_tr_b16 v[160:161], v12 offset:40960
    ds_read_b64_tr_b16 v[162:163], v12 offset:41472
    ds_read_b64_tr_b16 v[164:165], v13 offset:40960
    ds_read_b64_tr_b16 v[166:167], v13 offset:41472
    s_waitcnt vmcnt(29) lgkmcnt(8)
    v_mfma_f32_32x32x16_bf16 v[168:183], v[144:147], v[88:91], v[168:183]
    v_mfma_f32_32x32x16_bf16 v[184:199], v[148:151], v[88:91], v[184:199]
    buffer_load_dwordx4 v[88:91], v2, s[8:11], s31 offen offset:2048 sc1
    s_add_u32 m0, s35, 24576
    s_nop 0
    buffer_load_dwordx4 v10, s[16:19], s33 offen lds
    buffer_load_dwordx4 v10, s[16:19], s32 offen offset:1024 lds
    s_add_u32 s94, s36, 2
    s_and_b32 s94, s94, 3
    s_add_u32 s94, s94, 16
    s_mul_i32 s94, s94, 262144
    s_add_u32 s16, s12, s94
    s_addc_u32 s17, s13, 0
    ds_read_b64_tr_b16 v[144:145], v12 offset:43008
    ds_read_b64_tr_b16 v[146:147], v12 offset:43520
    ds_read_b64_tr_b16 v[148:149], v13 offset:43008
    ds_read_b64_tr_b16 v[150:151], v13 offset:43520
    s_waitcnt vmcnt(29) lgkmcnt(8)
    v_mfma_f32_32x32x16_bf16 v[168:183], v[152:155], v[92:95], v[168:183]
    v_mfma_f32_32x32x16_bf16 v[184:199], v[156:159], v[92:95], v[184:199]
    buffer_load_dwordx4 v[92:95], v2, s[8:11], s31 offen offset:3072 sc1
    s_add_u32 s94, s36, 1
    s_and_b32 s94, s94, 3
    s_add_u32 s94, s94, 16
    s_mul_i32 s94, s94, 8192
    s_add_u32 s31, s57, s94
    ds_read_b64_tr_b16 v[152:153], v12 offset:45056
    ds_read_b64_tr_b16 v[154:155], v12 offset:45568
    ds_read_b64_tr_b16 v[156:157], v13 offset:45056
    ds_read_b64_tr_b16 v[158:159], v13 offset:45568
    s_waitcnt vmcnt(29) lgkmcnt(8)
    v_mfma_f32_32x32x16_bf16 v[168:183], v[160:163], v[96:99], v[168:183]
    v_mfma_f32_32x32x16_bf16 v[184:199], v[164:167], v[96:99], v[184:199]
    buffer_load_dwordx4 v[96:99], v2, s[8:11], s31 offen offset:0 sc1
    ds_read_b64_tr_b16 v[160:161], v12 offset:47104
    ds_read_b64_tr_b16 v[162:163], v12 offset:47616
    ds_read_b64_tr_b16 v[164:165], v13 offset:47104
    ds_read_b64_tr_b16 v[166:167], v13 offset:47616
    s_waitcnt vmcnt(29) lgkmcnt(8)
    v_mfma_f32_32x32x16_bf16 v[168:183], v[144:147], v[100:103], v[168:183]
    v_mfma_f32_32x32x16_bf16 v[184:199], v[148:151], v[100:103], v[184:199]
    buffer_load_dwordx4 v[100:103], v2, s[8:11], s31 offen offset:1024 sc1
    s_barrier
    ds_read_b64_tr_b16 v[144:145], v12 offset:49152
    ds_read_b64_tr_b16 v[146:147], v12 offset:49664
    ds_read_b64_tr_b16 v[148:149], v13 offset:49152
    ds_read_b64_tr_b16 v[150:151], v13 offset:49664
    s_waitcnt vmcnt(29) lgkmcnt(8)
    v_mfma_f32_32x32x16_bf16 v[168:183], v[152:155], v[104:107], v[168:183]
    v_mfma_f32_32x32x16_bf16 v[184:199], v[156:159], v[104:107], v[184:199]
    buffer_load_dwordx4 v[104:107], v2, s[8:11], s31 offen offset:2048 sc1
    s_add_u32 m0, s35, 32768
    s_nop 0
    buffer_load_dwordx4 v10, s[16:19], s33 offen lds
    buffer_load_dwordx4 v10, s[16:19], s32 offen offset:1024 lds
    s_add_u32 s16, s16, 131072
    s_addc_u32 s17, s17, 0
    ds_read_b64_tr_b16 v[152:153], v12 offset:51200
    ds_read_b64_tr_b16 v[154:155], v12 offset:51712
    ds_read_b64_tr_b16 v[156:157], v13 offset:51200
    ds_read_b64_tr_b16 v[158:159], v13 offset:51712
    s_waitcnt vmcnt(29) lgkmcnt(8)
    v_mfma_f32_32x32x16_bf16 v[168:183], v[160:163], v[108:111], v[168:183]
    v_mfma_f32_32x32x16_bf16 v[184:199], v[164:167], v[108:111], v[184:199]
    buffer_load_dwordx4 v[108:111], v2, s[8:11], s31 offen offset:3072 sc1
    s_add_u32 s31, s31, 4096
    ds_read_b64_tr_b16 v[160:161], v12 offset:53248
    ds_read_b64_tr_b16 v[162:163], v12 offset:53760
    ds_read_b64_tr_b16 v[164:165], v13 offset:53248
    ds_read_b64_tr_b16 v[166:167], v13 offset:53760
    s_waitcnt vmcnt(29) lgkmcnt(8)
    v_mfma_f32_32x32x16_bf16 v[168:183], v[144:147], v[32:35], v[168:183]
    v_mfma_f32_32x32x16_bf16 v[184:199], v[148:151], v[32:35], v[184:199]
    buffer_load_dwordx4 v[32:35], v2, s[8:11], s31 offen offset:0 sc1
    ds_read_b64_tr_b16 v[144:145], v12 offset:55296
    ds_read_b64_tr_b16 v[146:147], v12 offset:55808
    ds_read_b64_tr_b16 v[148:149], v13 offset:55296
    ds_read_b64_tr_b16 v[150:151], v13 offset:55808
    s_waitcnt vmcnt(29) lgkmcnt(8)
    v_mfma_f32_32x32x16_bf16 v[168:183], v[152:155], v[36:39], v[168:183]
    v_mfma_f32_32x32x16_bf16 v[184:199], v[156:159], v[36:39], v[184:199]
    buffer_load_dwordx4 v[36:39], v2, s[8:11], s31 offen offset:1024 sc1
    s_barrier
    ds_read_b64_tr_b16 v[152:153], v12 offset:57344
    ds_read_b64_tr_b16 v[154:155], v12 offset:57856
    ds_read_b64_tr_b16 v[156:157], v13 offset:57344
    ds_read_b64_tr_b16 v[158:159], v13 offset:57856
    s_waitcnt vmcnt(29) lgkmcnt(8)
    v_mfma_f32_32x32x16_bf16 v[168:183], v[160:163], v[40:43], v[168:183]
    v_mfma_f32_32x32x16_bf16 v[184:199], v[164:167], v[40:43], v[184:199]
    buffer_load_dwordx4 v[40:43], v2, s[8:11], s31 offen offset:2048 sc1
    s_add_u32 m0, s35, 40960
    s_nop 0
    buffer_load_dwordx4 v10, s[16:19], s33 offen lds
    buffer_load_dwordx4 v10, s[16:19], s32 offen offset:1024 lds
    s_add_u32 s94, s36, 3
    s_and_b32 s94, s94, 3
    s_add_u32 s94, s94, 16
    s_mul_i32 s94, s94, 262144
    s_add_u32 s16, s12, s94
    s_addc_u32 s17, s13, 0
    ds_read_b64_tr_b16 v[160:161], v12 offset:59392
    ds_read_b64_tr_b16 v[162:163], v12 offset:59904
    ds_read_b64_tr_b16 v[164:165], v13 offset:59392
    ds_read_b64_tr_b16 v[166:167], v13 offset:59904
    s_waitcnt vmcnt(29) lgkmcnt(8)
    v_mfma_f32_32x32x16_bf16 v[168:183], v[144:147], v[44:47], v[168:183]
    v_mfma_f32_32x32x16_bf16 v[184:199], v[148:151], v[44:47], v[184:199]
    buffer_load_dwordx4 v[44:47], v2, s[8:11], s31 offen offset:3072 sc1
    s_add_u32 s94, s36, 2
    s_and_b32 s94, s94, 3
    s_add_u32 s94, s94, 16
    s_mul_i32 s94, s94, 8192
    s_add_u32 s31, s57, s94
    ds_read_b64_tr_b16 v[144:145], v12 offset:61440
    ds_read_b64_tr_b16 v[146:147], v12 offset:61952
    ds_read_b64_tr_b16 v[148:149], v13 offset:61440
    ds_read_b64_tr_b16 v[150:151], v13 offset:61952
    s_waitcnt vmcnt(29) lgkmcnt(8)
    v_mfma_f32_32x32x16_bf16 v[168:183], v[152:155], v[48:51], v[168:183]
    v_mfma_f32_32x32x16_bf16 v[184:199], v[156:159], v[48:51], v[184:199]
    buffer_load_dwordx4 v[48:51], v2, s[8:11], s31 offen offset:0 sc1
    ds_read_b64_tr_b16 v[152:153], v12 offset:63488
    ds_read_b64_tr_b16 v[154:155], v12 offset:64000
    ds_read_b64_tr_b16 v[156:157], v13 offset:63488
    ds_read_b64_tr_b16 v[158:159], v13 offset:64000
    s_waitcnt vmcnt(29) lgkmcnt(8)
    v_mfma_f32_32x32x16_bf16 v[168:183], v[160:163], v[52:55], v[168:183]
    v_mfma_f32_32x32x16_bf16 v[184:199], v[164:167], v[52:55], v[184:199]
    buffer_load_dwordx4 v[52:55], v2, s[8:11], s31 offen offset:1024 sc1
    s_barrier
    ds_read_b64_tr_b16 v[160:161], v12 offset:0
    ds_read_b64_tr_b16 v[162:163], v12 offset:512
    ds_read_b64_tr_b16 v[164:165], v13 offset:0
    ds_read_b64_tr_b16 v[166:167], v13 offset:512
    s_waitcnt vmcnt(29) lgkmcnt(8)
    v_mfma_f32_32x32x16_bf16 v[168:183], v[144:147], v[56:59], v[168:183]
    v_mfma_f32_32x32x16_bf16 v[184:199], v[148:151], v[56:59], v[184:199]
    buffer_load_dwordx4 v[56:59], v2, s[8:11], s31 offen offset:2048 sc1
    s_add_u32 m0, s35, 49152
    s_nop 0
    buffer_load_dwordx4 v10, s[16:19], s33 offen lds
    buffer_load_dwordx4 v10, s[16:19], s32 offen offset:1024 lds
    s_add_u32 s16, s16, 131072
    s_addc_u32 s17, s17, 0
    ds_read_b64_tr_b16 v[144:145], v12 offset:2048
    ds_read_b64_tr_b16 v[146:147], v12 offset:2560
    ds_read_b64_tr_b16 v[148:149], v13 offset:2048
    ds_read_b64_tr_b16 v[150:151], v13 offset:2560
    s_waitcnt vmcnt(29) lgkmcnt(8)
    v_mfma_f32_32x32x16_bf16 v[168:183], v[152:155], v[60:63], v[168:183]
    v_mfma_f32_32x32x16_bf16 v[184:199], v[156:159], v[60:63], v[184:199]
    buffer_load_dwordx4 v[60:63], v2, s[8:11], s31 offen offset:3072 sc1
    s_add_u32 s31, s31, 4096
    ds_read_b64_tr_b16 v[152:153], v12 offset:4096
    ds_read_b64_tr_b16 v[154:155], v12 offset:4608
    ds_read_b64_tr_b16 v[156:157], v13 offset:4096
    ds_read_b64_tr_b16 v[158:159], v13 offset:4608
    s_waitcnt vmcnt(29) lgkmcnt(8)
    v_mfma_f32_32x32x16_bf16 v[168:183], v[160:163], v[64:67], v[168:183]
    v_mfma_f32_32x32x16_bf16 v[184:199], v[164:167], v[64:67], v[184:199]
    buffer_load_dwordx4 v[64:67], v2, s[8:11], s31 offen offset:0 sc1
    ds_read_b64_tr_b16 v[160:161], v12 offset:6144
    ds_read_b64_tr_b16 v[162:163], v12 offset:6656
    ds_read_b64_tr_b16 v[164:165], v13 offset:6144
    ds_read_b64_tr_b16 v[166:167], v13 offset:6656
    s_waitcnt vmcnt(29) lgkmcnt(8)
    v_mfma_f32_32x32x16_bf16 v[168:183], v[144:147], v[68:71], v[168:183]
    v_mfma_f32_32x32x16_bf16 v[184:199], v[148:151], v[68:71], v[184:199]
    buffer_load_dwordx4 v[68:71], v2, s[8:11], s31 offen offset:1024 sc1
    s_barrier
    ds_read_b64_tr_b16 v[144:145], v12 offset:8192
    ds_read_b64_tr_b16 v[146:147], v12 offset:8704
    ds_read_b64_tr_b16 v[148:149], v13 offset:8192
    ds_read_b64_tr_b16 v[150:151], v13 offset:8704
    s_waitcnt vmcnt(29) lgkmcnt(8)
    v_mfma_f32_32x32x16_bf16 v[168:183], v[152:155], v[72:75], v[168:183]
    v_mfma_f32_32x32x16_bf16 v[184:199], v[156:159], v[72:75], v[184:199]
    buffer_load_dwordx4 v[72:75], v2, s[8:11], s31 offen offset:2048 sc1
    s_add_u32 m0, s35, 57344
    s_nop 0
    buffer_load_dwordx4 v10, s[16:19], s33 offen lds
    buffer_load_dwordx4 v10, s[16:19], s32 offen offset:1024 lds
    s_add_u32 s94, s36, 0
    s_and_b32 s94, s94, 3
    s_add_u32 s94, s94, 20
    s_mul_i32 s94, s94, 262144
    s_add_u32 s16, s12, s94
    s_addc_u32 s17, s13, 0
    ds_read_b64_tr_b16 v[152:153], v12 offset:10240
    ds_read_b64_tr_b16 v[154:155], v12 offset:10752
    ds_read_b64_tr_b16 v[156:157], v13 offset:10240
    ds_read_b64_tr_b16 v[158:159], v13 offset:10752
    s_waitcnt vmcnt(29) lgkmcnt(8)
    v_mfma_f32_32x32x16_bf16 v[168:183], v[160:163], v[76:79], v[168:183]
    v_mfma_f32_32x32x16_bf16 v[184:199], v[164:167], v[76:79], v[184:199]
    buffer_load_dwordx4 v[76:79], v2, s[8:11], s31 offen offset:3072 sc1
    s_add_u32 s94, s36, 3
    s_and_b32 s94, s94, 3
    s_add_u32 s94, s94, 16
    s_mul_i32 s94, s94, 8192
    s_add_u32 s31, s57, s94
    ds_read_b64_tr_b16 v[160:161], v12 offset:12288
    ds_read_b64_tr_b16 v[162:163], v12 offset:12800
    ds_read_b64_tr_b16 v[164:165], v13 offset:12288
    ds_read_b64_tr_b16 v[166:167], v13 offset:12800
    s_waitcnt vmcnt(29) lgkmcnt(8)
    v_mfma_f32_32x32x16_bf16 v[168:183], v[144:147], v[80:83], v[168:183]
    v_mfma_f32_32x32x16_bf16 v[184:199], v[148:151], v[80:83], v[184:199]
    buffer_load_dwordx4 v[80:83], v2, s[8:11], s31 offen offset:0 sc1
    ds_read_b64_tr_b16 v[144:145], v12 offset:14336
    ds_read_b64_tr_b16 v[146:147], v12 offset:14848
    ds_read_b64_tr_b16 v[148:149], v13 offset:14336
    ds_read_b64_tr_b16 v[150:151], v13 offset:14848
    s_waitcnt vmcnt(29) lgkmcnt(8)
    v_mfma_f32_32x32x16_bf16 v[168:183], v[152:155], v[84:87], v[168:183]
    v_mfma_f32_32x32x16_bf16 v[184:199], v[156:159], v[84:87], v[184:199]
    buffer_load_dwordx4 v[84:87], v2, s[8:11], s31 offen offset:1024 sc1
    s_barrier
    ds_read_b64_tr_b16 v[152:153], v12 offset:16384
    ds_read_b64_tr_b16 v[154:155], v12 offset:16896
    ds_read_b64_tr_b16 v[156:157], v13 offset:16384
    ds_read_b64_tr_b16 v[158:159], v13 offset:16896
    s_waitcnt vmcnt(29) lgkmcnt(8)
    v_mfma_f32_32x32x16_bf16 v[168:183], v[160:163], v[88:91], v[168:183]
    v_mfma_f32_32x32x16_bf16 v[184:199], v[164:167], v[88:91], v[184:199]
    buffer_load_dwordx4 v[88:91], v2, s[8:11], s31 offen offset:2048 sc1
    s_add_u32 m0, s35, 0
    s_nop 0
    buffer_load_dwordx4 v10, s[16:19], s33 offen lds
    buffer_load_dwordx4 v10, s[16:19], s32 offen offset:1024 lds
    s_add_u32 s16, s16, 131072
    s_addc_u32 s17, s17, 0
    ds_read_b64_tr_b16 v[160:161], v12 offset:18432
    ds_read_b64_tr_b16 v[162:163], v12 offset:18944
    ds_read_b64_tr_b16 v[164:165], v13 offset:18432
    ds_read_b64_tr_b16 v[166:167], v13 offset:18944
    s_waitcnt vmcnt(29) lgkmcnt(8)
    v_mfma_f32_32x32x16_bf16 v[168:183], v[144:147], v[92:95], v[168:183]
    v_mfma_f32_32x32x16_bf16 v[184:199], v[148:151], v[92:95], v[184:199]
    buffer_load_dwordx4 v[92:95], v2, s[8:11], s31 offen offset:3072 sc1
    s_add_u32 s31, s31, 4096
    ds_read_b64_tr_b16 v[144:145], v12 offset:20480
    ds_read_b64_tr_b16 v[146:147], v12 offset:20992
    ds_read_b64_tr_b16 v[148:149], v13 offset:20480
    ds_read_b64_tr_b16 v[150:151], v13 offset:20992
    s_waitcnt vmcnt(29) lgkmcnt(8)
    v_mfma_f32_32x32x16_bf16 v[168:183], v[152:155], v[96:99], v[168:183]
    v_mfma_f32_32x32x16_bf16 v[184:199], v[156:159], v[96:99], v[184:199]
    buffer_load_dwordx4 v[96:99], v2, s[8:11], s31 offen offset:0 sc1
    ds_read_b64_tr_b16 v[152:153], v12 offset:22528
    ds_read_b64_tr_b16 v[154:155], v12 offset:23040
    ds_read_b64_tr_b16 v[156:157], v13 offset:22528
    ds_read_b64_tr_b16 v[158:159], v13 offset:23040
    s_waitcnt vmcnt(29) lgkmcnt(8)
    v_mfma_f32_32x32x16_bf16 v[168:183], v[160:163], v[100:103], v[168:183]
    v_mfma_f32_32x32x16_bf16 v[184:199], v[164:167], v[100:103], v[184:199]
    buffer_load_dwordx4 v[100:103], v2, s[8:11], s31 offen offset:1024 sc1
    s_barrier
    ds_read_b64_tr_b16 v[160:161], v12 offset:24576
    ds_read_b64_tr_b16 v[162:163], v12 offset:25088
    ds_read_b64_tr_b16 v[164:165], v13 offset:24576
    ds_read_b64_tr_b16 v[166:167], v13 offset:25088
    s_waitcnt vmcnt(29) lgkmcnt(8)
    v_mfma_f32_32x32x16_bf16 v[168:183], v[144:147], v[104:107], v[168:183]
    v_mfma_f32_32x32x16_bf16 v[184:199], v[148:151], v[104:107], v[184:199]
    buffer_load_dwordx4 v[104:107], v2, s[8:11], s31 offen offset:2048 sc1
    s_add_u32 m0, s35, 8192
    s_nop 0
    buffer_load_dwordx4 v10, s[16:19], s33 offen lds
    buffer_load_dwordx4 v10, s[16:19], s32 offen offset:1024 lds
    s_add_u32 s94, s36, 1
    s_and_b32 s94, s94, 3
    s_add_u32 s94, s94, 20
    s_mul_i32 s94, s94, 262144
    s_add_u32 s16, s12, s94
    s_addc_u32 s17, s13, 0
    ds_read_b64_tr_b16 v[144:145], v12 offset:26624
    ds_read_b64_tr_b16 v[146:147], v12 offset:27136
    ds_read_b64_tr_b16 v[148:149], v13 offset:26624
    ds_read_b64_tr_b16 v[150:151], v13 offset:27136
    s_waitcnt vmcnt(29) lgkmcnt(8)
    v_mfma_f32_32x32x16_bf16 v[168:183], v[152:155], v[108:111], v[168:183]
    v_mfma_f32_32x32x16_bf16 v[184:199], v[156:159], v[108:111], v[184:199]
    buffer_load_dwordx4 v[108:111], v2, s[8:11], s31 offen offset:3072 sc1
    s_add_u32 s94, s36, 0
    s_and_b32 s94, s94, 3
    s_add_u32 s94, s94, 20
    s_mul_i32 s94, s94, 8192
    s_add_u32 s31, s57, s94
    ds_read_b64_tr_b16 v[152:153], v12 offset:28672
    ds_read_b64_tr_b16 v[154:155], v12 offset:29184
    ds_read_b64_tr_b16 v[156:157], v13 offset:28672
    ds_read_b64_tr_b16 v[158:159], v13 offset:29184
    s_waitcnt vmcnt(29) lgkmcnt(8)
    v_mfma_f32_32x32x16_bf16 v[168:183], v[160:163], v[32:35], v[168:183]
    v_mfma_f32_32x32x16_bf16 v[184:199], v[164:167], v[32:35], v[184:199]
    buffer_load_dwordx4 v[32:35], v2, s[8:11], s31 offen offset:0 sc1
    ds_read_b64_tr_b16 v[160:161], v12 offset:30720
    ds_read_b64_tr_b16 v[162:163], v12 offset:31232
    ds_read_b64_tr_b16 v[164:165], v13 offset:30720
    ds_read_b64_tr_b16 v[166:167], v13 offset:31232
    s_waitcnt vmcnt(29) lgkmcnt(8)
    v_mfma_f32_32x32x16_bf16 v[168:183], v[144:147], v[36:39], v[168:183]
    v_mfma_f32_32x32x16_bf16 v[184:199], v[148:151], v[36:39], v[184:199]
    buffer_load_dwordx4 v[36:39], v2, s[8:11], s31 offen offset:1024 sc1
    s_barrier
    ds_read_b64_tr_b16 v[144:145], v12 offset:32768
    ds_read_b64_tr_b16 v[146:147], v12 offset:33280
    ds_read_b64_tr_b16 v[148:149], v13 offset:32768
    ds_read_b64_tr_b16 v[150:151], v13 offset:33280
    s_waitcnt vmcnt(29) lgkmcnt(8)
    v_mfma_f32_32x32x16_bf16 v[168:183], v[152:155], v[40:43], v[168:183]
    v_mfma_f32_32x32x16_bf16 v[184:199], v[156:159], v[40:43], v[184:199]
    buffer_load_dwordx4 v[40:43], v2, s[8:11], s31 offen offset:2048 sc1
    s_add_u32 m0, s35, 16384
    s_nop 0
    buffer_load_dwordx4 v10, s[16:19], s33 offen lds
    buffer_load_dwordx4 v10, s[16:19], s32 offen offset:1024 lds
    s_add_u32 s16, s16, 131072
    s_addc_u32 s17, s17, 0
    ds_read_b64_tr_b16 v[152:153], v12 offset:34816
    ds_read_b64_tr_b16 v[154:155], v12 offset:35328
    ds_read_b64_tr_b16 v[156:157], v13 offset:34816
    ds_read_b64_tr_b16 v[158:159], v13 offset:35328
    s_waitcnt vmcnt(29) lgkmcnt(8)
    v_mfma_f32_32x32x16_bf16 v[168:183], v[160:163], v[44:47], v[168:183]
    v_mfma_f32_32x32x16_bf16 v[184:199], v[164:167], v[44:47], v[184:199]
    buffer_load_dwordx4 v[44:47], v2, s[8:11], s31 offen offset:3072 sc1
    s_add_u32 s31, s31, 4096
    ds_read_b64_tr_b16 v[160:161], v12 offset:36864
    ds_read_b64_tr_b16 v[162:163], v12 offset:37376
    ds_read_b64_tr_b16 v[164:165], v13 offset:36864
    ds_read_b64_tr_b16 v[166:167], v13 offset:37376
    s_waitcnt vmcnt(29) lgkmcnt(8)
    v_mfma_f32_32x32x16_bf16 v[168:183], v[144:147], v[48:51], v[168:183]
    v_mfma_f32_32x32x16_bf16 v[184:199], v[148:151], v[48:51], v[184:199]
    buffer_load_dwordx4 v[48:51], v2, s[8:11], s31 offen offset:0 sc1
    ds_read_b64_tr_b16 v[144:145], v12 offset:38912
    ds_read_b64_tr_b16 v[146:147], v12 offset:39424
    ds_read_b64_tr_b16 v[148:149], v13 offset:38912
    ds_read_b64_tr_b16 v[150:151], v13 offset:39424
    s_waitcnt vmcnt(29) lgkmcnt(8)
    v_mfma_f32_32x32x16_bf16 v[168:183], v[152:155], v[52:55], v[168:183]
    v_mfma_f32_32x32x16_bf16 v[184:199], v[156:159], v[52:55], v[184:199]
    buffer_load_dwordx4 v[52:55], v2, s[8:11], s31 offen offset:1024 sc1
    s_barrier
    ds_read_b64_tr_b16 v[152:153], v12 offset:40960
    ds_read_b64_tr_b16 v[154:155], v12 offset:41472
    ds_read_b64_tr_b16 v[156:157], v13 offset:40960
    ds_read_b64_tr_b16 v[158:159], v13 offset:41472
    s_waitcnt vmcnt(29) lgkmcnt(8)
    v_mfma_f32_32x32x16_bf16 v[168:183], v[160:163], v[56:59], v[168:183]
    v_mfma_f32_32x32x16_bf16 v[184:199], v[164:167], v[56:59], v[184:199]
    buffer_load_dwordx4 v[56:59], v2, s[8:11], s31 offen offset:2048 sc1
    s_add_u32 m0, s35, 24576
    s_nop 0
    buffer_load_dwordx4 v10, s[16:19], s33 offen lds
    buffer_load_dwordx4 v10, s[16:19], s32 offen offset:1024 lds
    s_add_u32 s94, s36, 2
    s_and_b32 s94, s94, 3
    s_add_u32 s94, s94, 20
    s_mul_i32 s94, s94, 262144
    s_add_u32 s16, s12, s94
    s_addc_u32 s17, s13, 0
    ds_read_b64_tr_b16 v[160:161], v12 offset:43008
    ds_read_b64_tr_b16 v[162:163], v12 offset:43520
    ds_read_b64_tr_b16 v[164:165], v13 offset:43008
    ds_read_b64_tr_b16 v[166:167], v13 offset:43520
    s_waitcnt vmcnt(29) lgkmcnt(8)
    v_mfma_f32_32x32x16_bf16 v[168:183], v[144:147], v[60:63], v[168:183]
    v_mfma_f32_32x32x16_bf16 v[184:199], v[148:151], v[60:63], v[184:199]
    buffer_load_dwordx4 v[60:63], v2, s[8:11], s31 offen offset:3072 sc1
    s_add_u32 s94, s36, 1
    s_and_b32 s94, s94, 3
    s_add_u32 s94, s94, 20
    s_mul_i32 s94, s94, 8192
    s_add_u32 s31, s57, s94
    ds_read_b64_tr_b16 v[144:145], v12 offset:45056
    ds_read_b64_tr_b16 v[146:147], v12 offset:45568
    ds_read_b64_tr_b16 v[148:149], v13 offset:45056
    ds_read_b64_tr_b16 v[150:151], v13 offset:45568
    s_waitcnt vmcnt(29) lgkmcnt(8)
    v_mfma_f32_32x32x16_bf16 v[168:183], v[152:155], v[64:67], v[168:183]
    v_mfma_f32_32x32x16_bf16 v[184:199], v[156:159], v[64:67], v[184:199]
    buffer_load_dwordx4 v[64:67], v2, s[8:11], s31 offen offset:0 sc1
    ds_read_b64_tr_b16 v[152:153], v12 offset:47104
    ds_read_b64_tr_b16 v[154:155], v12 offset:47616
    ds_read_b64_tr_b16 v[156:157], v13 offset:47104
    ds_read_b64_tr_b16 v[158:159], v13 offset:47616
    s_waitcnt vmcnt(29) lgkmcnt(8)
    v_mfma_f32_32x32x16_bf16 v[168:183], v[160:163], v[68:71], v[168:183]
    v_mfma_f32_32x32x16_bf16 v[184:199], v[164:167], v[68:71], v[184:199]
    buffer_load_dwordx4 v[68:71], v2, s[8:11], s31 offen offset:1024 sc1
    s_barrier
    ds_read_b64_tr_b16 v[160:161], v12 offset:49152
    ds_read_b64_tr_b16 v[162:163], v12 offset:49664
    ds_read_b64_tr_b16 v[164:165], v13 offset:49152
    ds_read_b64_tr_b16 v[166:167], v13 offset:49664
    s_waitcnt vmcnt(29) lgkmcnt(8)
    v_mfma_f32_32x32x16_bf16 v[168:183], v[144:147], v[72:75], v[168:183]
    v_mfma_f32_32x32x16_bf16 v[184:199], v[148:151], v[72:75], v[184:199]
    buffer_load_dwordx4 v[72:75], v2, s[8:11], s31 offen offset:2048 sc1
    s_add_u32 m0, s35, 32768
    s_nop 0
    buffer_load_dwordx4 v10, s[16:19], s33 offen lds
    buffer_load_dwordx4 v10, s[16:19], s32 offen offset:1024 lds
    s_add_u32 s16, s16, 131072
    s_addc_u32 s17, s17, 0
    ds_read_b64_tr_b16 v[144:145], v12 offset:51200
    ds_read_b64_tr_b16 v[146:147], v12 offset:51712
    ds_read_b64_tr_b16 v[148:149], v13 offset:51200
    ds_read_b64_tr_b16 v[150:151], v13 offset:51712
    s_waitcnt vmcnt(29) lgkmcnt(8)
    v_mfma_f32_32x32x16_bf16 v[168:183], v[152:155], v[76:79], v[168:183]
    v_mfma_f32_32x32x16_bf16 v[184:199], v[156:159], v[76:79], v[184:199]
    buffer_load_dwordx4 v[76:79], v2, s[8:11], s31 offen offset:3072 sc1
    s_add_u32 s31, s31, 4096
    ds_read_b64_tr_b16 v[152:153], v12 offset:53248
    ds_read_b64_tr_b16 v[154:155], v12 offset:53760
    ds_read_b64_tr_b16 v[156:157], v13 offset:53248
    ds_read_b64_tr_b16 v[158:159], v13 offset:53760
    s_waitcnt vmcnt(29) lgkmcnt(8)
    v_mfma_f32_32x32x16_bf16 v[168:183], v[160:163], v[80:83], v[168:183]
    v_mfma_f32_32x32x16_bf16 v[184:199], v[164:167], v[80:83], v[184:199]
    buffer_load_dwordx4 v[80:83], v2, s[8:11], s31 offen offset:0 sc1
    ds_read_b64_tr_b16 v[160:161], v12 offset:55296
    ds_read_b64_tr_b16 v[162:163], v12 offset:55808
    ds_read_b64_tr_b16 v[164:165], v13 offset:55296
    ds_read_b64_tr_b16 v[166:167], v13 offset:55808
    s_waitcnt vmcnt(29) lgkmcnt(8)
    v_mfma_f32_32x32x16_bf16 v[168:183], v[144:147], v[84:87], v[168:183]
    v_mfma_f32_32x32x16_bf16 v[184:199], v[148:151], v[84:87], v[184:199]
    buffer_load_dwordx4 v[84:87], v2, s[8:11], s31 offen offset:1024 sc1
    s_barrier
    ds_read_b64_tr_b16 v[144:145], v12 offset:57344
    ds_read_b64_tr_b16 v[146:147], v12 offset:57856
    ds_read_b64_tr_b16 v[148:149], v13 offset:57344
    ds_read_b64_tr_b16 v[150:151], v13 offset:57856
    s_waitcnt vmcnt(29) lgkmcnt(8)
    v_mfma_f32_32x32x16_bf16 v[168:183], v[152:155], v[88:91], v[168:183]
    v_mfma_f32_32x32x16_bf16 v[184:199], v[156:159], v[88:91], v[184:199]
    buffer_load_dwordx4 v[88:91], v2, s[8:11], s31 offen offset:2048 sc1
    s_add_u32 m0, s35, 40960
    s_nop 0
    buffer_load_dwordx4 v10, s[16:19], s33 offen lds
    buffer_load_dwordx4 v10, s[16:19], s32 offen offset:1024 lds
    s_add_u32 s94, s36, 3
    s_and_b32 s94, s94, 3
    s_add_u32 s94, s94, 20
    s_mul_i32 s94, s94, 262144
    s_add_u32 s16, s12, s94
    s_addc_u32 s17, s13, 0
    ds_read_b64_tr_b16 v[152:153], v12 offset:59392
    ds_read_b64_tr_b16 v[154:155], v12 offset:59904
    ds_read_b64_tr_b16 v[156:157], v13 offset:59392
    ds_read_b64_tr_b16 v[158:159], v13 offset:59904
    s_waitcnt vmcnt(29) lgkmcnt(8)
    v_mfma_f32_32x32x16_bf16 v[168:183], v[160:163], v[92:95], v[168:183]
    v_mfma_f32_32x32x16_bf16 v[184:199], v[164:167], v[92:95], v[184:199]
    buffer_load_dwordx4 v[92:95], v2, s[8:11], s31 offen offset:3072 sc1
    s_add_u32 s94, s36, 2
    s_and_b32 s94, s94, 3
    s_add_u32 s94, s94, 20
    s_mul_i32 s94, s94, 8192
    s_add_u32 s31, s57, s94
    ds_read_b64_tr_b16 v[160:161], v12 offset:61440
    ds_read_b64_tr_b16 v[162:163], v12 offset:61952
    ds_read_b64_tr_b16 v[164:165], v13 offset:61440
    ds_read_b64_tr_b16 v[166:167], v13 offset:61952
    s_waitcnt vmcnt(29) lgkmcnt(8)
    v_mfma_f32_32x32x16_bf16 v[168:183], v[144:147], v[96:99], v[168:183]
    v_mfma_f32_32x32x16_bf16 v[184:199], v[148:151], v[96:99], v[184:199]
    buffer_load_dwordx4 v[96:99], v2, s[8:11], s31 offen offset:0 sc1
    ds_read_b64_tr_b16 v[144:145], v12 offset:63488
    ds_read_b64_tr_b16 v[146:147], v12 offset:64000
    ds_read_b64_tr_b16 v[148:149], v13 offset:63488
    ds_read_b64_tr_b16 v[150:151], v13 offset:64000
    s_waitcnt vmcnt(29) lgkmcnt(8)
    v_mfma_f32_32x32x16_bf16 v[168:183], v[152:155], v[100:103], v[168:183]
    v_mfma_f32_32x32x16_bf16 v[184:199], v[156:159], v[100:103], v[184:199]
    buffer_load_dwordx4 v[100:103], v2, s[8:11], s31 offen offset:1024 sc1
    s_barrier
    ds_read_b64_tr_b16 v[152:153], v12 offset:0
    ds_read_b64_tr_b16 v[154:155], v12 offset:512
    ds_read_b64_tr_b16 v[156:157], v13 offset:0
    ds_read_b64_tr_b16 v[158:159], v13 offset:512
    s_waitcnt vmcnt(29) lgkmcnt(8)
    v_mfma_f32_32x32x16_bf16 v[168:183], v[160:163], v[104:107], v[168:183]
    v_mfma_f32_32x32x16_bf16 v[184:199], v[164:167], v[104:107], v[184:199]
    buffer_load_dwordx4 v[104:107], v2, s[8:11], s31 offen offset:2048 sc1
    s_add_u32 m0, s35, 49152
    s_nop 0
    buffer_load_dwordx4 v10, s[16:19], s33 offen lds
    buffer_load_dwordx4 v10, s[16:19], s32 offen offset:1024 lds
    s_add_u32 s16, s16, 131072
    s_addc_u32 s17, s17, 0
    ds_read_b64_tr_b16 v[160:161], v12 offset:2048
    ds_read_b64_tr_b16 v[162:163], v12 offset:2560
    ds_read_b64_tr_b16 v[164:165], v13 offset:2048
    ds_read_b64_tr_b16 v[166:167], v13 offset:2560
    s_waitcnt vmcnt(29) lgkmcnt(8)
    v_mfma_f32_32x32x16_bf16 v[168:183], v[144:147], v[108:111], v[168:183]
    v_mfma_f32_32x32x16_bf16 v[184:199], v[148:151], v[108:111], v[184:199]
    buffer_load_dwordx4 v[108:111], v2, s[8:11], s31 offen offset:3072 sc1
    s_add_u32 s31, s31, 4096
    ds_read_b64_tr_b16 v[144:145], v12 offset:4096
    ds_read_b64_tr_b16 v[146:147], v12 offset:4608
    ds_read_b64_tr_b16 v[148:149], v13 offset:4096
    ds_read_b64_tr_b16 v[150:151], v13 offset:4608
    s_waitcnt vmcnt(29) lgkmcnt(8)
    v_mfma_f32_32x32x16_bf16 v[168:183], v[152:155], v[32:35], v[168:183]
    v_mfma_f32_32x32x16_bf16 v[184:199], v[156:159], v[32:35], v[184:199]
    buffer_load_dwordx4 v[32:35], v2, s[8:11], s31 offen offset:0 sc1
    ds_read_b64_tr_b16 v[152:153], v12 offset:6144
    ds_read_b64_tr_b16 v[154:155], v12 offset:6656
    ds_read_b64_tr_b16 v[156:157], v13 offset:6144
    ds_read_b64_tr_b16 v[158:159], v13 offset:6656
    s_waitcnt vmcnt(29) lgkmcnt(8)
    v_mfma_f32_32x32x16_bf16 v[168:183], v[160:163], v[36:39], v[168:183]
    v_mfma_f32_32x32x16_bf16 v[184:199], v[164:167], v[36:39], v[184:199]
    buffer_load_dwordx4 v[36:39], v2, s[8:11], s31 offen offset:1024 sc1
    s_barrier
    ds_read_b64_tr_b16 v[160:161], v12 offset:8192
    ds_read_b64_tr_b16 v[162:163], v12 offset:8704
    ds_read_b64_tr_b16 v[164:165], v13 offset:8192
    ds_read_b64_tr_b16 v[166:167], v13 offset:8704
    s_waitcnt vmcnt(29) lgkmcnt(8)
    v_mfma_f32_32x32x16_bf16 v[168:183], v[144:147], v[40:43], v[168:183]
    v_mfma_f32_32x32x16_bf16 v[184:199], v[148:151], v[40:43], v[184:199]
    buffer_load_dwordx4 v[40:43], v2, s[8:11], s31 offen offset:2048 sc1
    s_add_u32 m0, s35, 57344
    s_nop 0
    buffer_load_dwordx4 v10, s[16:19], s33 offen lds
    buffer_load_dwordx4 v10, s[16:19], s32 offen offset:1024 lds
    s_add_u32 s94, s36, 0
    s_and_b32 s94, s94, 3
    s_add_u32 s94, s94, 24
    s_mul_i32 s94, s94, 262144
    s_add_u32 s16, s12, s94
    s_addc_u32 s17, s13, 0
    ds_read_b64_tr_b16 v[144:145], v12 offset:10240
    ds_read_b64_tr_b16 v[146:147], v12 offset:10752
    ds_read_b64_tr_b16 v[148:149], v13 offset:10240
    ds_read_b64_tr_b16 v[150:151], v13 offset:10752
    s_waitcnt vmcnt(29) lgkmcnt(8)
    v_mfma_f32_32x32x16_bf16 v[168:183], v[152:155], v[44:47], v[168:183]
    v_mfma_f32_32x32x16_bf16 v[184:199], v[156:159], v[44:47], v[184:199]
    buffer_load_dwordx4 v[44:47], v2, s[8:11], s31 offen offset:3072 sc1
    s_add_u32 s94, s36, 3
    s_and_b32 s94, s94, 3
    s_add_u32 s94, s94, 20
    s_mul_i32 s94, s94, 8192
    s_add_u32 s31, s57, s94
    ds_read_b64_tr_b16 v[152:153], v12 offset:12288
    ds_read_b64_tr_b16 v[154:155], v12 offset:12800
    ds_read_b64_tr_b16 v[156:157], v13 offset:12288
    ds_read_b64_tr_b16 v[158:159], v13 offset:12800
    s_waitcnt vmcnt(29) lgkmcnt(8)
    v_mfma_f32_32x32x16_bf16 v[168:183], v[160:163], v[48:51], v[168:183]
    v_mfma_f32_32x32x16_bf16 v[184:199], v[164:167], v[48:51], v[184:199]
    buffer_load_dwordx4 v[48:51], v2, s[8:11], s31 offen offset:0 sc1
    ds_read_b64_tr_b16 v[160:161], v12 offset:14336
    ds_read_b64_tr_b16 v[162:163], v12 offset:14848
    ds_read_b64_tr_b16 v[164:165], v13 offset:14336
    ds_read_b64_tr_b16 v[166:167], v13 offset:14848
    s_waitcnt vmcnt(29) lgkmcnt(8)
    v_mfma_f32_32x32x16_bf16 v[168:183], v[144:147], v[52:55], v[168:183]
    v_mfma_f32_32x32x16_bf16 v[184:199], v[148:151], v[52:55], v[184:199]
    buffer_load_dwordx4 v[52:55], v2, s[8:11], s31 offen offset:1024 sc1
    s_barrier
    ds_read_b64_tr_b16 v[144:145], v12 offset:16384
    ds_read_b64_tr_b16 v[146:147], v12 offset:16896
    ds_read_b64_tr_b16 v[148:149], v13 offset:16384
    ds_read_b64_tr_b16 v[150:151], v13 offset:16896
    s_waitcnt vmcnt(29) lgkmcnt(8)
    v_mfma_f32_32x32x16_bf16 v[168:183], v[152:155], v[56:59], v[168:183]
    v_mfma_f32_32x32x16_bf16 v[184:199], v[156:159], v[56:59], v[184:199]
    buffer_load_dwordx4 v[56:59], v2, s[8:11], s31 offen offset:2048 sc1
    s_add_u32 m0, s35, 0
    s_nop 0
    buffer_load_dwordx4 v10, s[16:19], s33 offen lds
    buffer_load_dwordx4 v10, s[16:19], s32 offen offset:1024 lds
    s_add_u32 s16, s16, 131072
    s_addc_u32 s17, s17, 0
    ds_read_b64_tr_b16 v[152:153], v12 offset:18432
    ds_read_b64_tr_b16 v[154:155], v12 offset:18944
    ds_read_b64_tr_b16 v[156:157], v13 offset:18432
    ds_read_b64_tr_b16 v[158:159], v13 offset:18944
    s_waitcnt vmcnt(29) lgkmcnt(8)
    v_mfma_f32_32x32x16_bf16 v[168:183], v[160:163], v[60:63], v[168:183]
    v_mfma_f32_32x32x16_bf16 v[184:199], v[164:167], v[60:63], v[184:199]
    buffer_load_dwordx4 v[60:63], v2, s[8:11], s31 offen offset:3072 sc1
    s_add_u32 s31, s31, 4096
    ds_read_b64_tr_b16 v[160:161], v12 offset:20480
    ds_read_b64_tr_b16 v[162:163], v12 offset:20992
    ds_read_b64_tr_b16 v[164:165], v13 offset:20480
    ds_read_b64_tr_b16 v[166:167], v13 offset:20992
    s_waitcnt vmcnt(29) lgkmcnt(8)
    v_mfma_f32_32x32x16_bf16 v[168:183], v[144:147], v[64:67], v[168:183]
    v_mfma_f32_32x32x16_bf16 v[184:199], v[148:151], v[64:67], v[184:199]
    buffer_load_dwordx4 v[64:67], v2, s[8:11], s31 offen offset:0 sc1
    ds_read_b64_tr_b16 v[144:145], v12 offset:22528
    ds_read_b64_tr_b16 v[146:147], v12 offset:23040
    ds_read_b64_tr_b16 v[148:149], v13 offset:22528
    ds_read_b64_tr_b16 v[150:151], v13 offset:23040
    s_waitcnt vmcnt(29) lgkmcnt(8)
    v_mfma_f32_32x32x16_bf16 v[168:183], v[152:155], v[68:71], v[168:183]
    v_mfma_f32_32x32x16_bf16 v[184:199], v[156:159], v[68:71], v[184:199]
    buffer_load_dwordx4 v[68:71], v2, s[8:11], s31 offen offset:1024 sc1
    s_barrier
    ds_read_b64_tr_b16 v[152:153], v12 offset:24576
    ds_read_b64_tr_b16 v[154:155], v12 offset:25088
    ds_read_b64_tr_b16 v[156:157], v13 offset:24576
    ds_read_b64_tr_b16 v[158:159], v13 offset:25088
    s_waitcnt vmcnt(29) lgkmcnt(8)
    v_mfma_f32_32x32x16_bf16 v[168:183], v[160:163], v[72:75], v[168:183]
    v_mfma_f32_32x32x16_bf16 v[184:199], v[164:167], v[72:75], v[184:199]
    buffer_load_dwordx4 v[72:75], v2, s[8:11], s31 offen offset:2048 sc1
    s_add_u32 m0, s35, 8192
    s_nop 0
    buffer_load_dwordx4 v10, s[16:19], s33 offen lds
    buffer_load_dwordx4 v10, s[16:19], s32 offen offset:1024 lds
    s_add_u32 s94, s36, 1
    s_and_b32 s94, s94, 3
    s_add_u32 s94, s94, 24
    s_mul_i32 s94, s94, 262144
    s_add_u32 s16, s12, s94
    s_addc_u32 s17, s13, 0
    ds_read_b64_tr_b16 v[160:161], v12 offset:26624
    ds_read_b64_tr_b16 v[162:163], v12 offset:27136
    ds_read_b64_tr_b16 v[164:165], v13 offset:26624
    ds_read_b64_tr_b16 v[166:167], v13 offset:27136
    s_waitcnt vmcnt(29) lgkmcnt(8)
    v_mfma_f32_32x32x16_bf16 v[168:183], v[144:147], v[76:79], v[168:183]
    v_mfma_f32_32x32x16_bf16 v[184:199], v[148:151], v[76:79], v[184:199]
    buffer_load_dwordx4 v[76:79], v2, s[8:11], s31 offen offset:3072 sc1
    s_add_u32 s94, s36, 0
    s_and_b32 s94, s94, 3
    s_add_u32 s94, s94, 24
    s_mul_i32 s94, s94, 8192
    s_add_u32 s31, s57, s94
    ds_read_b64_tr_b16 v[144:145], v12 offset:28672
    ds_read_b64_tr_b16 v[146:147], v12 offset:29184
    ds_read_b64_tr_b16 v[148:149], v13 offset:28672
    ds_read_b64_tr_b16 v[150:151], v13 offset:29184
    s_waitcnt vmcnt(29) lgkmcnt(8)
    v_mfma_f32_32x32x16_bf16 v[168:183], v[152:155], v[80:83], v[168:183]
    v_mfma_f32_32x32x16_bf16 v[184:199], v[156:159], v[80:83], v[184:199]
    buffer_load_dwordx4 v[80:83], v2, s[8:11], s31 offen offset:0 sc1
    ds_read_b64_tr_b16 v[152:153], v12 offset:30720
    ds_read_b64_tr_b16 v[154:155], v12 offset:31232
    ds_read_b64_tr_b16 v[156:157], v13 offset:30720
    ds_read_b64_tr_b16 v[158:159], v13 offset:31232
    s_waitcnt vmcnt(29) lgkmcnt(8)
    v_mfma_f32_32x32x16_bf16 v[168:183], v[160:163], v[84:87], v[168:183]
    v_mfma_f32_32x32x16_bf16 v[184:199], v[164:167], v[84:87], v[184:199]
    buffer_load_dwordx4 v[84:87], v2, s[8:11], s31 offen offset:1024 sc1
    s_barrier
    ds_read_b64_tr_b16 v[160:161], v12 offset:32768
    ds_read_b64_tr_b16 v[162:163], v12 offset:33280
    ds_read_b64_tr_b16 v[164:165], v13 offset:32768
    ds_read_b64_tr_b16 v[166:167], v13 offset:33280
    s_waitcnt vmcnt(29) lgkmcnt(8)
    v_mfma_f32_32x32x16_bf16 v[168:183], v[144:147], v[88:91], v[168:183]
    v_mfma_f32_32x32x16_bf16 v[184:199], v[148:151], v[88:91], v[184:199]
    buffer_load_dwordx4 v[88:91], v2, s[8:11], s31 offen offset:2048 sc1
    s_add_u32 m0, s35, 16384
    s_nop 0
    buffer_load_dwordx4 v10, s[16:19], s33 offen lds
    buffer_load_dwordx4 v10, s[16:19], s32 offen offset:1024 lds
    s_add_u32 s16, s16, 131072
    s_addc_u32 s17, s17, 0
    ds_read_b64_tr_b16 v[144:145], v12 offset:34816
    ds_read_b64_tr_b16 v[146:147], v12 offset:35328
    ds_read_b64_tr_b16 v[148:149], v13 offset:34816
    ds_read_b64_tr_b16 v[150:151], v13 offset:35328
    s_waitcnt vmcnt(29) lgkmcnt(8)
    v_mfma_f32_32x32x16_bf16 v[168:183], v[152:155], v[92:95], v[168:183]
    v_mfma_f32_32x32x16_bf16 v[184:199], v[156:159], v[92:95], v[184:199]
    buffer_load_dwordx4 v[92:95], v2, s[8:11], s31 offen offset:3072 sc1
    s_add_u32 s31, s31, 4096
    ds_read_b64_tr_b16 v[152:153], v12 offset:36864
    ds_read_b64_tr_b16 v[154:155], v12 offset:37376
    ds_read_b64_tr_b16 v[156:157], v13 offset:36864
    ds_read_b64_tr_b16 v[158:159], v13 offset:37376
    s_waitcnt vmcnt(29) lgkmcnt(8)
    v_mfma_f32_32x32x16_bf16 v[168:183], v[160:163], v[96:99], v[168:183]
    v_mfma_f32_32x32x16_bf16 v[184:199], v[164:167], v[96:99], v[184:199]
    buffer_load_dwordx4 v[96:99], v2, s[8:11], s31 offen offset:0 sc1
    ds_read_b64_tr_b16 v[160:161], v12 offset:38912
    ds_read_b64_tr_b16 v[162:163], v12 offset:39424
    ds_read_b64_tr_b16 v[164:165], v13 offset:38912
    ds_read_b64_tr_b16 v[166:167], v13 offset:39424
    s_waitcnt vmcnt(29) lgkmcnt(8)
    v_mfma_f32_32x32x16_bf16 v[168:183], v[144:147], v[100:103], v[168:183]
    v_mfma_f32_32x32x16_bf16 v[184:199], v[148:151], v[100:103], v[184:199]
    buffer_load_dwordx4 v[100:103], v2, s[8:11], s31 offen offset:1024 sc1
    s_barrier
    ds_read_b64_tr_b16 v[144:145], v12 offset:40960
    ds_read_b64_tr_b16 v[146:147], v12 offset:41472
    ds_read_b64_tr_b16 v[148:149], v13 offset:40960
    ds_read_b64_tr_b16 v[150:151], v13 offset:41472
    s_waitcnt vmcnt(29) lgkmcnt(8)
    v_mfma_f32_32x32x16_bf16 v[168:183], v[152:155], v[104:107], v[168:183]
    v_mfma_f32_32x32x16_bf16 v[184:199], v[156:159], v[104:107], v[184:199]
    buffer_load_dwordx4 v[104:107], v2, s[8:11], s31 offen offset:2048 sc1
    s_add_u32 m0, s35, 24576
    s_nop 0
    buffer_load_dwordx4 v10, s[16:19], s33 offen lds
    buffer_load_dwordx4 v10, s[16:19], s32 offen offset:1024 lds
    s_add_u32 s94, s36, 2
    s_and_b32 s94, s94, 3
    s_add_u32 s94, s94, 24
    s_mul_i32 s94, s94, 262144
    s_add_u32 s16, s12, s94
    s_addc_u32 s17, s13, 0
    ds_read_b64_tr_b16 v[152:153], v12 offset:43008
    ds_read_b64_tr_b16 v[154:155], v12 offset:43520
    ds_read_b64_tr_b16 v[156:157], v13 offset:43008
    ds_read_b64_tr_b16 v[158:159], v13 offset:43520
    s_waitcnt vmcnt(29) lgkmcnt(8)
    v_mfma_f32_32x32x16_bf16 v[168:183], v[160:163], v[108:111], v[168:183]
    v_mfma_f32_32x32x16_bf16 v[184:199], v[164:167], v[108:111], v[184:199]
    buffer_load_dwordx4 v[108:111], v2, s[8:11], s31 offen offset:3072 sc1
    s_add_u32 s94, s36, 1
    s_and_b32 s94, s94, 3
    s_add_u32 s94, s94, 24
    s_mul_i32 s94, s94, 8192
    s_add_u32 s31, s57, s94
    ds_read_b64_tr_b16 v[160:161], v12 offset:45056
    ds_read_b64_tr_b16 v[162:163], v12 offset:45568
    ds_read_b64_tr_b16 v[164:165], v13 offset:45056
    ds_read_b64_tr_b16 v[166:167], v13 offset:45568
    s_waitcnt vmcnt(29) lgkmcnt(8)
    v_mfma_f32_32x32x16_bf16 v[168:183], v[144:147], v[32:35], v[168:183]
    v_mfma_f32_32x32x16_bf16 v[184:199], v[148:151], v[32:35], v[184:199]
    buffer_load_dwordx4 v[32:35], v2, s[8:11], s31 offen offset:0 sc1
    ds_read_b64_tr_b16 v[144:145], v12 offset:47104
    ds_read_b64_tr_b16 v[146:147], v12 offset:47616
    ds_read_b64_tr_b16 v[148:149], v13 offset:47104
    ds_read_b64_tr_b16 v[150:151], v13 offset:47616
    s_waitcnt vmcnt(29) lgkmcnt(8)
    v_mfma_f32_32x32x16_bf16 v[168:183], v[152:155], v[36:39], v[168:183]
    v_mfma_f32_32x32x16_bf16 v[184:199], v[156:159], v[36:39], v[184:199]
    buffer_load_dwordx4 v[36:39], v2, s[8:11], s31 offen offset:1024 sc1
    s_barrier
    ds_read_b64_tr_b16 v[152:153], v12 offset:49152
    ds_read_b64_tr_b16 v[154:155], v12 offset:49664
    ds_read_b64_tr_b16 v[156:157], v13 offset:49152
    ds_read_b64_tr_b16 v[158:159], v13 offset:49664
    s_waitcnt vmcnt(29) lgkmcnt(8)
    v_mfma_f32_32x32x16_bf16 v[168:183], v[160:163], v[40:43], v[168:183]
    v_mfma_f32_32x32x16_bf16 v[184:199], v[164:167], v[40:43], v[184:199]
    buffer_load_dwordx4 v[40:43], v2, s[8:11], s31 offen offset:2048 sc1
    s_add_u32 m0, s35, 32768
    s_nop 0
    buffer_load_dwordx4 v10, s[16:19], s33 offen lds
    buffer_load_dwordx4 v10, s[16:19], s32 offen offset:1024 lds
    s_add_u32 s16, s16, 131072
    s_addc_u32 s17, s17, 0
    ds_read_b64_tr_b16 v[160:161], v12 offset:51200
    ds_read_b64_tr_b16 v[162:163], v12 offset:51712
    ds_read_b64_tr_b16 v[164:165], v13 offset:51200
    ds_read_b64_tr_b16 v[166:167], v13 offset:51712
    s_waitcnt vmcnt(29) lgkmcnt(8)
    v_mfma_f32_32x32x16_bf16 v[168:183], v[144:147], v[44:47], v[168:183]
    v_mfma_f32_32x32x16_bf16 v[184:199], v[148:151], v[44:47], v[184:199]
    buffer_load_dwordx4 v[44:47], v2, s[8:11], s31 offen offset:3072 sc1
    s_add_u32 s31, s31, 4096
    ds_read_b64_tr_b16 v[144:145], v12 offset:53248
    ds_read_b64_tr_b16 v[146:147], v12 offset:53760
    ds_read_b64_tr_b16 v[148:149], v13 offset:53248
    ds_read_b64_tr_b16 v[150:151], v13 offset:53760
    s_waitcnt vmcnt(29) lgkmcnt(8)
    v_mfma_f32_32x32x16_bf16 v[168:183], v[152:155], v[48:51], v[168:183]
    v_mfma_f32_32x32x16_bf16 v[184:199], v[156:159], v[48:51], v[184:199]
    buffer_load_dwordx4 v[48:51], v2, s[8:11], s31 offen offset:0 sc1
    ds_read_b64_tr_b16 v[152:153], v12 offset:55296
    ds_read_b64_tr_b16 v[154:155], v12 offset:55808
    ds_read_b64_tr_b16 v[156:157], v13 offset:55296
    ds_read_b64_tr_b16 v[158:159], v13 offset:55808
    s_waitcnt vmcnt(29) lgkmcnt(8)
    v_mfma_f32_32x32x16_bf16 v[168:183], v[160:163], v[52:55], v[168:183]
    v_mfma_f32_32x32x16_bf16 v[184:199], v[164:167], v[52:55], v[184:199]
    buffer_load_dwordx4 v[52:55], v2, s[8:11], s31 offen offset:1024 sc1
    s_barrier
    ds_read_b64_tr_b16 v[160:161], v12 offset:57344
    ds_read_b64_tr_b16 v[162:163], v12 offset:57856
    ds_read_b64_tr_b16 v[164:165], v13 offset:57344
    ds_read_b64_tr_b16 v[166:167], v13 offset:57856
    s_waitcnt vmcnt(29) lgkmcnt(8)
    v_mfma_f32_32x32x16_bf16 v[168:183], v[144:147], v[56:59], v[168:183]
    v_mfma_f32_32x32x16_bf16 v[184:199], v[148:151], v[56:59], v[184:199]
    buffer_load_dwordx4 v[56:59], v2, s[8:11], s31 offen offset:2048 sc1
    s_add_u32 m0, s35, 40960
    s_nop 0
    buffer_load_dwordx4 v10, s[16:19], s33 offen lds
    buffer_load_dwordx4 v10, s[16:19], s32 offen offset:1024 lds
    s_add_u32 s94, s36, 3
    s_and_b32 s94, s94, 3
    s_add_u32 s94, s94, 24
    s_mul_i32 s94, s94, 262144
    s_add_u32 s16, s12, s94
    s_addc_u32 s17, s13, 0
    ds_read_b64_tr_b16 v[144:145], v12 offset:59392
    ds_read_b64_tr_b16 v[146:147], v12 offset:59904
    ds_read_b64_tr_b16 v[148:149], v13 offset:59392
    ds_read_b64_tr_b16 v[150:151], v13 offset:59904
    s_waitcnt vmcnt(29) lgkmcnt(8)
    v_mfma_f32_32x32x16_bf16 v[168:183], v[152:155], v[60:63], v[168:183]
    v_mfma_f32_32x32x16_bf16 v[184:199], v[156:159], v[60:63], v[184:199]
    buffer_load_dwordx4 v[60:63], v2, s[8:11], s31 offen offset:3072 sc1
    s_add_u32 s94, s36, 2
    s_and_b32 s94, s94, 3
    s_add_u32 s94, s94, 24
    s_mul_i32 s94, s94, 8192
    s_add_u32 s31, s57, s94
    ds_read_b64_tr_b16 v[152:153], v12 offset:61440
    ds_read_b64_tr_b16 v[154:155], v12 offset:61952
    ds_read_b64_tr_b16 v[156:157], v13 offset:61440
    ds_read_b64_tr_b16 v[158:159], v13 offset:61952
    s_waitcnt vmcnt(29) lgkmcnt(8)
    v_mfma_f32_32x32x16_bf16 v[168:183], v[160:163], v[64:67], v[168:183]
    v_mfma_f32_32x32x16_bf16 v[184:199], v[164:167], v[64:67], v[184:199]
    buffer_load_dwordx4 v[64:67], v2, s[8:11], s31 offen offset:0 sc1
    ds_read_b64_tr_b16 v[160:161], v12 offset:63488
    ds_read_b64_tr_b16 v[162:163], v12 offset:64000
    ds_read_b64_tr_b16 v[164:165], v13 offset:63488
    ds_read_b64_tr_b16 v[166:167], v13 offset:64000
    s_waitcnt vmcnt(29) lgkmcnt(8)
    v_mfma_f32_32x32x16_bf16 v[168:183], v[144:147], v[68:71], v[168:183]
    v_mfma_f32_32x32x16_bf16 v[184:199], v[148:151], v[68:71], v[184:199]
    buffer_load_dwordx4 v[68:71], v2, s[8:11], s31 offen offset:1024 sc1
    s_barrier
    ds_read_b64_tr_b16 v[144:145], v12 offset:0
    ds_read_b64_tr_b16 v[146:147], v12 offset:512
    ds_read_b64_tr_b16 v[148:149], v13 offset:0
    ds_read_b64_tr_b16 v[150:151], v13 offset:512
    s_waitcnt vmcnt(29) lgkmcnt(8)
    v_mfma_f32_32x32x16_bf16 v[168:183], v[152:155], v[72:75], v[168:183]
    v_mfma_f32_32x32x16_bf16 v[184:199], v[156:159], v[72:75], v[184:199]
    buffer_load_dwordx4 v[72:75], v2, s[8:11], s31 offen offset:2048 sc1
    s_add_u32 m0, s35, 49152
    s_nop 0
    buffer_load_dwordx4 v10, s[16:19], s33 offen lds
    buffer_load_dwordx4 v10, s[16:19], s32 offen offset:1024 lds
    s_add_u32 s16, s16, 131072
    s_addc_u32 s17, s17, 0
    ds_read_b64_tr_b16 v[152:153], v12 offset:2048
    ds_read_b64_tr_b16 v[154:155], v12 offset:2560
    ds_read_b64_tr_b16 v[156:157], v13 offset:2048
    ds_read_b64_tr_b16 v[158:159], v13 offset:2560
    s_waitcnt vmcnt(29) lgkmcnt(8)
    v_mfma_f32_32x32x16_bf16 v[168:183], v[160:163], v[76:79], v[168:183]
    v_mfma_f32_32x32x16_bf16 v[184:199], v[164:167], v[76:79], v[184:199]
    buffer_load_dwordx4 v[76:79], v2, s[8:11], s31 offen offset:3072 sc1
    s_add_u32 s31, s31, 4096
    ds_read_b64_tr_b16 v[160:161], v12 offset:4096
    ds_read_b64_tr_b16 v[162:163], v12 offset:4608
    ds_read_b64_tr_b16 v[164:165], v13 offset:4096
    ds_read_b64_tr_b16 v[166:167], v13 offset:4608
    s_waitcnt vmcnt(29) lgkmcnt(8)
    v_mfma_f32_32x32x16_bf16 v[168:183], v[144:147], v[80:83], v[168:183]
    v_mfma_f32_32x32x16_bf16 v[184:199], v[148:151], v[80:83], v[184:199]
    buffer_load_dwordx4 v[80:83], v2, s[8:11], s31 offen offset:0 sc1
    ds_read_b64_tr_b16 v[144:145], v12 offset:6144
    ds_read_b64_tr_b16 v[146:147], v12 offset:6656
    ds_read_b64_tr_b16 v[148:149], v13 offset:6144
    ds_read_b64_tr_b16 v[150:151], v13 offset:6656
    s_waitcnt vmcnt(29) lgkmcnt(8)
    v_mfma_f32_32x32x16_bf16 v[168:183], v[152:155], v[84:87], v[168:183]
    v_mfma_f32_32x32x16_bf16 v[184:199], v[156:159], v[84:87], v[184:199]
    buffer_load_dwordx4 v[84:87], v2, s[8:11], s31 offen offset:1024 sc1
    s_barrier
    ds_read_b64_tr_b16 v[152:153], v12 offset:8192
    ds_read_b64_tr_b16 v[154:155], v12 offset:8704
    ds_read_b64_tr_b16 v[156:157], v13 offset:8192
    ds_read_b64_tr_b16 v[158:159], v13 offset:8704
    s_waitcnt vmcnt(29) lgkmcnt(8)
    v_mfma_f32_32x32x16_bf16 v[168:183], v[160:163], v[88:91], v[168:183]
    v_mfma_f32_32x32x16_bf16 v[184:199], v[164:167], v[88:91], v[184:199]
    buffer_load_dwordx4 v[88:91], v2, s[8:11], s31 offen offset:2048 sc1
    s_add_u32 m0, s35, 57344
    s_nop 0
    buffer_load_dwordx4 v10, s[16:19], s33 offen lds
    buffer_load_dwordx4 v10, s[16:19], s32 offen offset:1024 lds
    ds_read_b64_tr_b16 v[160:161], v12 offset:10240
    ds_read_b64_tr_b16 v[162:163], v12 offset:10752
    ds_read_b64_tr_b16 v[164:165], v13 offset:10240
    ds_read_b64_tr_b16 v[166:167], v13 offset:10752
    s_waitcnt vmcnt(29) lgkmcnt(8)
    v_mfma_f32_32x32x16_bf16 v[168:183], v[144:147], v[92:95], v[168:183]
    v_mfma_f32_32x32x16_bf16 v[184:199], v[148:151], v[92:95], v[184:199]
    buffer_load_dwordx4 v[92:95], v2, s[8:11], s31 offen offset:3072 sc1
    s_add_u32 s94, s36, 3
    s_and_b32 s94, s94, 3
    s_add_u32 s94, s94, 24
    s_mul_i32 s94, s94, 8192
    s_add_u32 s31, s57, s94
    ds_read_b64_tr_b16 v[144:145], v12 offset:12288
    ds_read_b64_tr_b16 v[146:147], v12 offset:12800
    ds_read_b64_tr_b16 v[148:149], v13 offset:12288
    ds_read_b64_tr_b16 v[150:151], v13 offset:12800
    s_waitcnt vmcnt(29) lgkmcnt(8)
    v_mfma_f32_32x32x16_bf16 v[168:183], v[152:155], v[96:99], v[168:183]
    v_mfma_f32_32x32x16_bf16 v[184:199], v[156:159], v[96:99], v[184:199]
    buffer_load_dwordx4 v[96:99], v2, s[8:11], s31 offen offset:0 sc1
    ds_read_b64_tr_b16 v[152:153], v12 offset:14336
    ds_read_b64_tr_b16 v[154:155], v12 offset:14848
    ds_read_b64_tr_b16 v[156:157], v13 offset:14336
    ds_read_b64_tr_b16 v[158:159], v13 offset:14848
    s_waitcnt vmcnt(29) lgkmcnt(8)
    v_mfma_f32_32x32x16_bf16 v[168:183], v[160:163], v[100:103], v[168:183]
    v_mfma_f32_32x32x16_bf16 v[184:199], v[164:167], v[100:103], v[184:199]
    buffer_load_dwordx4 v[100:103], v2, s[8:11], s31 offen offset:1024 sc1
    s_barrier
    ds_read_b64_tr_b16 v[160:161], v12 offset:16384
    ds_read_b64_tr_b16 v[162:163], v12 offset:16896
    ds_read_b64_tr_b16 v[164:165], v13 offset:16384
    ds_read_b64_tr_b16 v[166:167], v13 offset:16896
    s_waitcnt vmcnt(29) lgkmcnt(8)
    v_mfma_f32_32x32x16_bf16 v[168:183], v[144:147], v[104:107], v[168:183]
    v_mfma_f32_32x32x16_bf16 v[184:199], v[148:151], v[104:107], v[184:199]
    buffer_load_dwordx4 v[104:107], v2, s[8:11], s31 offen offset:2048 sc1
    s_add_u32 m0, s35, 0
    s_nop 0
    buffer_load_dwordx4 v10, s[40:43], s33 offen lds
    buffer_load_dwordx4 v10, s[40:43], s32 offen offset:1024 lds
    s_add_u32 s40, s40, 131072
    s_addc_u32 s41, s41, 0
    ds_read_b64_tr_b16 v[144:145], v12 offset:18432
    ds_read_b64_tr_b16 v[146:147], v12 offset:18944
    ds_read_b64_tr_b16 v[148:149], v13 offset:18432
    ds_read_b64_tr_b16 v[150:151], v13 offset:18944
    s_waitcnt vmcnt(29) lgkmcnt(8)
    v_mfma_f32_32x32x16_bf16 v[168:183], v[152:155], v[108:111], v[168:183]
    v_mfma_f32_32x32x16_bf16 v[184:199], v[156:159], v[108:111], v[184:199]
    buffer_load_dwordx4 v[108:111], v2, s[8:11], s31 offen offset:3072 sc1
    s_add_u32 s31, s31, 4096
    ds_read_b64_tr_b16 v[152:153], v12 offset:20480
    ds_read_b64_tr_b16 v[154:155], v12 offset:20992
    ds_read_b64_tr_b16 v[156:157], v13 offset:20480
    ds_read_b64_tr_b16 v[158:159], v13 offset:20992
    s_waitcnt vmcnt(29) lgkmcnt(8)
    v_mfma_f32_32x32x16_bf16 v[168:183], v[160:163], v[32:35], v[168:183]
    v_mfma_f32_32x32x16_bf16 v[184:199], v[164:167], v[32:35], v[184:199]
    buffer_load_dwordx4 v[32:35], v2, s[8:11], s31 offen offset:0 sc1
    ds_read_b64_tr_b16 v[160:161], v12 offset:22528
    ds_read_b64_tr_b16 v[162:163], v12 offset:23040
    ds_read_b64_tr_b16 v[164:165], v13 offset:22528
    ds_read_b64_tr_b16 v[166:167], v13 offset:23040
    s_waitcnt vmcnt(29) lgkmcnt(8)
    v_mfma_f32_32x32x16_bf16 v[168:183], v[144:147], v[36:39], v[168:183]
    v_mfma_f32_32x32x16_bf16 v[184:199], v[148:151], v[36:39], v[184:199]
    buffer_load_dwordx4 v[36:39], v2, s[8:11], s31 offen offset:1024 sc1
    s_barrier
    ds_read_b64_tr_b16 v[144:145], v12 offset:24576
    ds_read_b64_tr_b16 v[146:147], v12 offset:25088
    ds_read_b64_tr_b16 v[148:149], v13 offset:24576
    ds_read_b64_tr_b16 v[150:151], v13 offset:25088
    s_waitcnt vmcnt(29) lgkmcnt(8)
    v_mfma_f32_32x32x16_bf16 v[168:183], v[152:155], v[40:43], v[168:183]
    v_mfma_f32_32x32x16_bf16 v[184:199], v[156:159], v[40:43], v[184:199]
    buffer_load_dwordx4 v[40:43], v2, s[8:11], s31 offen offset:2048 sc1
    s_add_u32 m0, s35, 8192
    s_nop 0
    buffer_load_dwordx4 v10, s[40:43], s33 offen lds
    buffer_load_dwordx4 v10, s[40:43], s32 offen offset:1024 lds
    s_add_u32 s94, s36, 1
    s_and_b32 s94, s94, 3
    s_mul_i32 s94, s94, 262144
    s_add_u32 s40, s14, s94
    s_addc_u32 s41, s15, 0
    ds_read_b64_tr_b16 v[152:153], v12 offset:26624
    ds_read_b64_tr_b16 v[154:155], v12 offset:27136
    ds_read_b64_tr_b16 v[156:157], v13 offset:26624
    ds_read_b64_tr_b16 v[158:159], v13 offset:27136
    s_waitcnt vmcnt(29) lgkmcnt(8)
    v_mfma_f32_32x32x16_bf16 v[168:183], v[160:163], v[44:47], v[168:183]
    v_mfma_f32_32x32x16_bf16 v[184:199], v[164:167], v[44:47], v[184:199]
    buffer_load_dwordx4 v[44:47], v2, s[8:11], s31 offen offset:3072 sc1
    ds_read_b64_tr_b16 v[160:161], v12 offset:28672
    ds_read_b64_tr_b16 v[162:163], v12 offset:29184
    ds_read_b64_tr_b16 v[164:165], v13 offset:28672
    ds_read_b64_tr_b16 v[166:167], v13 offset:29184
    s_waitcnt vmcnt(29) lgkmcnt(8)
    v_mfma_f32_32x32x16_bf16 v[168:183], v[144:147], v[48:51], v[168:183]
    v_mfma_f32_32x32x16_bf16 v[184:199], v[148:151], v[48:51], v[184:199]
    ds_read_b64_tr_b16 v[144:145], v12 offset:30720
    ds_read_b64_tr_b16 v[146:147], v12 offset:31232
    ds_read_b64_tr_b16 v[148:149], v13 offset:30720
    ds_read_b64_tr_b16 v[150:151], v13 offset:31232
    s_waitcnt vmcnt(28) lgkmcnt(8)
    v_mfma_f32_32x32x16_bf16 v[168:183], v[152:155], v[52:55], v[168:183]
    v_mfma_f32_32x32x16_bf16 v[184:199], v[156:159], v[52:55], v[184:199]
    s_barrier
    ds_read_b64_tr_b16 v[152:153], v12 offset:32768
    ds_read_b64_tr_b16 v[154:155], v12 offset:33280
    ds_read_b64_tr_b16 v[156:157], v13 offset:32768
    ds_read_b64_tr_b16 v[158:159], v13 offset:33280
    s_waitcnt vmcnt(27) lgkmcnt(8)
    v_mfma_f32_32x32x16_bf16 v[168:183], v[160:163], v[56:59], v[168:183]
    v_mfma_f32_32x32x16_bf16 v[184:199], v[164:167], v[56:59], v[184:199]
    s_add_u32 m0, s35, 16384
    s_nop 0
    buffer_load_dwordx4 v10, s[40:43], s33 offen lds
    buffer_load_dwordx4 v10, s[40:43], s32 offen offset:1024 lds
    s_add_u32 s40, s40, 131072
    s_addc_u32 s41, s41, 0
    ds_read_b64_tr_b16 v[160:161], v12 offset:34816
    ds_read_b64_tr_b16 v[162:163], v12 offset:35328
    ds_read_b64_tr_b16 v[164:165], v13 offset:34816
    ds_read_b64_tr_b16 v[166:167], v13 offset:35328
    s_waitcnt vmcnt(26) lgkmcnt(8)
    v_mfma_f32_32x32x16_bf16 v[168:183], v[144:147], v[60:63], v[168:183]
    v_mfma_f32_32x32x16_bf16 v[184:199], v[148:151], v[60:63], v[184:199]
    ds_read_b64_tr_b16 v[144:145], v12 offset:36864
    ds_read_b64_tr_b16 v[146:147], v12 offset:37376
    ds_read_b64_tr_b16 v[148:149], v13 offset:36864
    ds_read_b64_tr_b16 v[150:151], v13 offset:37376
    s_waitcnt vmcnt(25) lgkmcnt(8)
    v_mfma_f32_32x32x16_bf16 v[168:183], v[152:155], v[64:67], v[168:183]
    v_mfma_f32_32x32x16_bf16 v[184:199], v[156:159], v[64:67], v[184:199]
    ds_read_b64_tr_b16 v[152:153], v12 offset:38912
    ds_read_b64_tr_b16 v[154:155], v12 offset:39424
    ds_read_b64_tr_b16 v[156:157], v13 offset:38912
    ds_read_b64_tr_b16 v[158:159], v13 offset:39424
    s_waitcnt vmcnt(24) lgkmcnt(8)
    v_mfma_f32_32x32x16_bf16 v[168:183], v[160:163], v[68:71], v[168:183]
    v_mfma_f32_32x32x16_bf16 v[184:199], v[164:167], v[68:71], v[184:199]
    s_barrier
    ds_read_b64_tr_b16 v[160:161], v12 offset:40960
    ds_read_b64_tr_b16 v[162:163], v12 offset:41472
    ds_read_b64_tr_b16 v[164:165], v13 offset:40960
    ds_read_b64_tr_b16 v[166:167], v13 offset:41472
    s_waitcnt vmcnt(23) lgkmcnt(8)
    v_mfma_f32_32x32x16_bf16 v[168:183], v[144:147], v[72:75], v[168:183]
    v_mfma_f32_32x32x16_bf16 v[184:199], v[148:151], v[72:75], v[184:199]
    s_add_u32 m0, s35, 24576
    s_nop 0
    buffer_load_dwordx4 v10, s[40:43], s33 offen lds
    buffer_load_dwordx4 v10, s[40:43], s32 offen offset:1024 lds
    s_add_u32 s94, s36, 2
    s_and_b32 s94, s94, 3
    s_mul_i32 s94, s94, 262144
    s_add_u32 s40, s14, s94
    s_addc_u32 s41, s15, 0
    ds_read_b64_tr_b16 v[144:145], v12 offset:43008
    ds_read_b64_tr_b16 v[146:147], v12 offset:43520
    ds_read_b64_tr_b16 v[148:149], v13 offset:43008
    ds_read_b64_tr_b16 v[150:151], v13 offset:43520
    s_waitcnt vmcnt(22) lgkmcnt(8)
    v_mfma_f32_32x32x16_bf16 v[168:183], v[152:155], v[76:79], v[168:183]
    v_mfma_f32_32x32x16_bf16 v[184:199], v[156:159], v[76:79], v[184:199]
    ds_read_b64_tr_b16 v[152:153], v12 offset:45056
    ds_read_b64_tr_b16 v[154:155], v12 offset:45568
    ds_read_b64_tr_b16 v[156:157], v13 offset:45056
    ds_read_b64_tr_b16 v[158:159], v13 offset:45568
    s_waitcnt vmcnt(21) lgkmcnt(8)
    v_mfma_f32_32x32x16_bf16 v[168:183], v[160:163], v[80:83], v[168:183]
    v_mfma_f32_32x32x16_bf16 v[184:199], v[164:167], v[80:83], v[184:199]
    ds_read_b64_tr_b16 v[160:161], v12 offset:47104
    ds_read_b64_tr_b16 v[162:163], v12 offset:47616
    ds_read_b64_tr_b16 v[164:165], v13 offset:47104
    ds_read_b64_tr_b16 v[166:167], v13 offset:47616
    s_waitcnt vmcnt(20) lgkmcnt(8)
    v_mfma_f32_32x32x16_bf16 v[168:183], v[144:147], v[84:87], v[168:183]
    v_mfma_f32_32x32x16_bf16 v[184:199], v[148:151], v[84:87], v[184:199]
    s_barrier
    ds_read_b64_tr_b16 v[144:145], v12 offset:49152
    ds_read_b64_tr_b16 v[146:147], v12 offset:49664
    ds_read_b64_tr_b16 v[148:149], v13 offset:49152
    ds_read_b64_tr_b16 v[150:151], v13 offset:49664
    s_waitcnt vmcnt(19) lgkmcnt(8)
    v_mfma_f32_32x32x16_bf16 v[168:183], v[152:155], v[88:91], v[168:183]
    v_mfma_f32_32x32x16_bf16 v[184:199], v[156:159], v[88:91], v[184:199]
    s_add_u32 m0, s35, 32768
    s_nop 0
    buffer_load_dwordx4 v10, s[40:43], s33 offen lds
    buffer_load_dwordx4 v10, s[40:43], s32 offen offset:1024 lds
    s_add_u32 s40, s40, 131072
    s_addc_u32 s41, s41, 0
    ds_read_b64_tr_b16 v[152:153], v12 offset:51200
    ds_read_b64_tr_b16 v[154:155], v12 offset:51712
    ds_read_b64_tr_b16 v[156:157], v13 offset:51200
    ds_read_b64_tr_b16 v[158:159], v13 offset:51712
    s_waitcnt vmcnt(18) lgkmcnt(8)
    v_mfma_f32_32x32x16_bf16 v[168:183], v[160:163], v[92:95], v[168:183]
    v_mfma_f32_32x32x16_bf16 v[184:199], v[164:167], v[92:95], v[184:199]
    ds_read_b64_tr_b16 v[160:161], v12 offset:53248
    ds_read_b64_tr_b16 v[162:163], v12 offset:53760
    ds_read_b64_tr_b16 v[164:165], v13 offset:53248
    ds_read_b64_tr_b16 v[166:167], v13 offset:53760
    s_waitcnt vmcnt(17) lgkmcnt(8)
    v_mfma_f32_32x32x16_bf16 v[168:183], v[144:147], v[96:99], v[168:183]
    v_mfma_f32_32x32x16_bf16 v[184:199], v[148:151], v[96:99], v[184:199]
    ds_read_b64_tr_b16 v[144:145], v12 offset:55296
    ds_read_b64_tr_b16 v[146:147], v12 offset:55808
    ds_read_b64_tr_b16 v[148:149], v13 offset:55296
    ds_read_b64_tr_b16 v[150:151], v13 offset:55808
    s_waitcnt vmcnt(16) lgkmcnt(8)
    v_mfma_f32_32x32x16_bf16 v[168:183], v[152:155], v[100:103], v[168:183]
    v_mfma_f32_32x32x16_bf16 v[184:199], v[156:159], v[100:103], v[184:199]
    s_barrier
    ds_read_b64_tr_b16 v[152:153], v12 offset:57344
    ds_read_b64_tr_b16 v[154:155], v12 offset:57856
    ds_read_b64_tr_b16 v[156:157], v13 offset:57344
    ds_read_b64_tr_b16 v[158:159], v13 offset:57856
    s_waitcnt vmcnt(15) lgkmcnt(8)
    v_mfma_f32_32x32x16_bf16 v[168:183], v[160:163], v[104:107], v[168:183]
    v_mfma_f32_32x32x16_bf16 v[184:199], v[164:167], v[104:107], v[184:199]
    s_add_u32 m0, s35, 40960
    s_nop 0
    buffer_load_dwordx4 v10, s[40:43], s33 offen lds
    buffer_load_dwordx4 v10, s[40:43], s32 offen offset:1024 lds
    s_add_u32 s94, s36, 3
    s_and_b32 s94, s94, 3
    s_mul_i32 s94, s94, 262144
    s_add_u32 s40, s14, s94
    s_addc_u32 s41, s15, 0
    ds_read_b64_tr_b16 v[160:161], v12 offset:59392
    ds_read_b64_tr_b16 v[162:163], v12 offset:59904
    ds_read_b64_tr_b16 v[164:165], v13 offset:59392
    ds_read_b64_tr_b16 v[166:167], v13 offset:59904
    s_waitcnt vmcnt(14) lgkmcnt(8)
    v_mfma_f32_32x32x16_bf16 v[168:183], v[144:147], v[108:111], v[168:183]
    v_mfma_f32_32x32x16_bf16 v[184:199], v[148:151], v[108:111], v[184:199]
    ds_read_b64_tr_b16 v[144:145], v12 offset:61440
    ds_read_b64_tr_b16 v[146:147], v12 offset:61952
    ds_read_b64_tr_b16 v[148:149], v13 offset:61440
    ds_read_b64_tr_b16 v[150:151], v13 offset:61952
    s_waitcnt vmcnt(13) lgkmcnt(8)
    v_mfma_f32_32x32x16_bf16 v[168:183], v[152:155], v[32:35], v[168:183]
    v_mfma_f32_32x32x16_bf16 v[184:199], v[156:159], v[32:35], v[184:199]
    ds_read_b64_tr_b16 v[152:153], v12 offset:63488
    ds_read_b64_tr_b16 v[154:155], v12 offset:64000
    ds_read_b64_tr_b16 v[156:157], v13 offset:63488
    ds_read_b64_tr_b16 v[158:159], v13 offset:64000
    s_waitcnt vmcnt(12) lgkmcnt(8)
    v_mfma_f32_32x32x16_bf16 v[168:183], v[160:163], v[36:39], v[168:183]
    v_mfma_f32_32x32x16_bf16 v[184:199], v[164:167], v[36:39], v[184:199]
    s_cmp_lg_u32 s86, 0
    s_cbranch_scc1 gated_mix__grouped_kv_mqa__dense_activation_mish__prompt_kernel_polled
    s_add_u32 s92, s84, 0x1b00000
    s_addc_u32 s93, s85, 0
    s_mov_b32 s52, s92
    s_mov_b32 s53, s93
    s_mov_b32 s54, 0x4000
    s_mov_b32 s55, 0x00020000
    v_and_b32 v4, 15, v1
    v_lshlrev_b32 v4, 2, v4
    s_mov_b32 s96, 0x40000
gated_mix__grouped_kv_mqa__dense_activation_mish__prompt_kernel_op:
    buffer_load_dword v5, v4, s[52:55], s37 offen sc1
    s_waitcnt vmcnt(0)
    v_cmp_eq_u32 vcc, 1, v5
    s_nop 3
    s_cmp_eq_u64 vcc, exec
    s_cbranch_scc1 gated_mix__grouped_kv_mqa__dense_activation_mish__prompt_kernel_op_ok
    s_sleep 6
    s_sub_u32 s96, s96, 1
    s_cmp_lg_u32 s96, 0
    s_cbranch_scc1 gated_mix__grouped_kv_mqa__dense_activation_mish__prompt_kernel_op
gated_mix__grouped_kv_mqa__dense_activation_mish__prompt_kernel_op_ok:
gated_mix__grouped_kv_mqa__dense_activation_mish__prompt_kernel_polled:
    s_barrier
    buffer_load_dword v22, v16, s[20:23], 0 offen sc1
    ds_read_b64_tr_b16 v[160:161], v14 offset:0
    ds_read_b64_tr_b16 v[162:163], v14 offset:1024
    ds_read_b64_tr_b16 v[164:165], v15 offset:0
    ds_read_b64_tr_b16 v[166:167], v15 offset:1024
    s_waitcnt vmcnt(12) lgkmcnt(8)
    v_mfma_f32_32x32x16_bf16 v[168:183], v[144:147], v[40:43], v[168:183]
    v_mfma_f32_32x32x16_bf16 v[184:199], v[148:151], v[40:43], v[184:199]
    buffer_load_dwordx4 v[48:51], v2, s[4:7], s38 offen offset:0 sc1
    buffer_load_dwordx4 v[52:55], v2, s[4:7], s38 offen offset:1024 sc1
    buffer_load_dwordx4 v[56:59], v2, s[4:7], s38 offen offset:2048 sc1
    buffer_load_dwordx4 v[60:63], v2, s[4:7], s38 offen offset:3072 sc1
    s_add_u32 s38, s38, 4096
    s_add_u32 m0, s35, 49152
    s_nop 0
    buffer_load_dwordx4 v10, s[40:43], s33 offen lds
    buffer_load_dwordx4 v10, s[40:43], s32 offen offset:1024 lds
    s_add_u32 s40, s40, 131072
    s_addc_u32 s41, s41, 0
    ds_read_b64_tr_b16 v[144:145], v14 offset:2048
    ds_read_b64_tr_b16 v[146:147], v14 offset:3072
    ds_read_b64_tr_b16 v[148:149], v15 offset:2048
    ds_read_b64_tr_b16 v[150:151], v15 offset:3072
    s_waitcnt vmcnt(15) lgkmcnt(8)
    v_mfma_f32_32x32x16_bf16 v[168:183], v[152:155], v[44:47], v[168:183]
    v_mfma_f32_32x32x16_bf16 v[184:199], v[156:159], v[44:47], v[184:199]
    buffer_load_dwordx4 v[64:67], v2, s[4:7], s38 offen offset:0 sc1
    buffer_load_dwordx4 v[68:71], v2, s[4:7], s38 offen offset:1024 sc1
    buffer_load_dwordx4 v[72:75], v2, s[4:7], s38 offen offset:2048 sc1
    buffer_load_dwordx4 v[76:79], v2, s[4:7], s38 offen offset:3072 sc1
    s_add_u32 s94, s36, 1
    s_and_b32 s94, s94, 3
    s_mul_i32 s94, s94, 8192
    s_add_u32 s38, s58, s94
    ds_read_b64_tr_b16 v[152:153], v14 offset:4096
    ds_read_b64_tr_b16 v[154:155], v14 offset:5120
    ds_read_b64_tr_b16 v[156:157], v15 offset:4096
    ds_read_b64_tr_b16 v[158:159], v15 offset:5120
    s_waitcnt vmcnt(9) lgkmcnt(8)
    v_mfma_f32_32x32x16_bf16 v[200:215], v[160:163], v[48:51], 0
    v_mfma_f32_32x32x16_bf16 v[216:231], v[164:167], v[48:51], 0
    buffer_load_dwordx4 v[80:83], v2, s[4:7], s38 offen offset:0 sc1
    buffer_load_dwordx4 v[84:87], v2, s[4:7], s38 offen offset:1024 sc1
    buffer_load_dwordx4 v[88:91], v2, s[4:7], s38 offen offset:2048 sc1
    buffer_load_dwordx4 v[92:95], v2, s[4:7], s38 offen offset:3072 sc1
    s_add_u32 s38, s38, 4096
    ds_read_b64_tr_b16 v[160:161], v14 offset:6144
    ds_read_b64_tr_b16 v[162:163], v14 offset:7168
    ds_read_b64_tr_b16 v[164:165], v15 offset:6144
    ds_read_b64_tr_b16 v[166:167], v15 offset:7168
    s_waitcnt vmcnt(12) lgkmcnt(8)
    v_mfma_f32_32x32x16_bf16 v[200:215], v[144:147], v[52:55], v[200:215]
    v_mfma_f32_32x32x16_bf16 v[216:231], v[148:151], v[52:55], v[216:231]
    buffer_load_dwordx4 v[96:99], v2, s[4:7], s38 offen offset:0 sc1
    buffer_load_dwordx4 v[100:103], v2, s[4:7], s38 offen offset:1024 sc1
    buffer_load_dwordx4 v[104:107], v2, s[4:7], s38 offen offset:2048 sc1
    buffer_load_dwordx4 v[108:111], v2, s[4:7], s38 offen offset:3072 sc1
    s_add_u32 s94, s36, 2
    s_and_b32 s94, s94, 3
    s_mul_i32 s94, s94, 8192
    s_add_u32 s38, s58, s94
    s_barrier
    ds_read_b64_tr_b16 v[144:145], v14 offset:8192
    ds_read_b64_tr_b16 v[146:147], v14 offset:9216
    ds_read_b64_tr_b16 v[148:149], v15 offset:8192
    ds_read_b64_tr_b16 v[150:151], v15 offset:9216
    s_waitcnt vmcnt(15) lgkmcnt(8)
    v_mfma_f32_32x32x16_bf16 v[200:215], v[152:155], v[56:59], v[200:215]
    v_mfma_f32_32x32x16_bf16 v[216:231], v[156:159], v[56:59], v[216:231]
    buffer_load_dwordx4 v[32:35], v2, s[4:7], s38 offen offset:0 sc1
    buffer_load_dwordx4 v[36:39], v2, s[4:7], s38 offen offset:1024 sc1
    buffer_load_dwordx4 v[40:43], v2, s[4:7], s38 offen offset:2048 sc1
    buffer_load_dwordx4 v[44:47], v2, s[4:7], s38 offen offset:3072 sc1
    s_add_u32 s38, s38, 4096
    s_add_u32 m0, s35, 57344
    s_nop 0
    buffer_load_dwordx4 v10, s[40:43], s33 offen lds
    buffer_load_dwordx4 v10, s[40:43], s32 offen offset:1024 lds
    s_add_u32 s94, s36, 0
    s_and_b32 s94, s94, 3
    s_add_u32 s94, s94, 4
    s_mul_i32 s94, s94, 262144
    s_add_u32 s40, s14, s94
    s_addc_u32 s41, s15, 0
    ds_read_b64_tr_b16 v[152:153], v14 offset:10240
    ds_read_b64_tr_b16 v[154:155], v14 offset:11264
    ds_read_b64_tr_b16 v[156:157], v15 offset:10240
    ds_read_b64_tr_b16 v[158:159], v15 offset:11264
    s_waitcnt vmcnt(20) lgkmcnt(8)
    v_mfma_f32_32x32x16_bf16 v[200:215], v[160:163], v[60:63], v[200:215]
    v_mfma_f32_32x32x16_bf16 v[216:231], v[164:167], v[60:63], v[216:231]
    buffer_load_dwordx4 v[48:51], v2, s[4:7], s38 offen offset:0 sc1
    buffer_load_dwordx4 v[52:55], v2, s[4:7], s38 offen offset:1024 sc1
    buffer_load_dwordx4 v[56:59], v2, s[4:7], s38 offen offset:2048 sc1
    buffer_load_dwordx4 v[60:63], v2, s[4:7], s38 offen offset:3072 sc1
    s_add_u32 s94, s36, 3
    s_and_b32 s94, s94, 3
    s_mul_i32 s94, s94, 8192
    s_add_u32 s38, s58, s94
    ds_read_b64_tr_b16 v[160:161], v14 offset:12288
    ds_read_b64_tr_b16 v[162:163], v14 offset:13312
    ds_read_b64_tr_b16 v[164:165], v15 offset:12288
    ds_read_b64_tr_b16 v[166:167], v15 offset:13312
    s_waitcnt vmcnt(21) lgkmcnt(8)
    v_mfma_f32_32x32x16_bf16 v[200:215], v[144:147], v[64:67], v[200:215]
    v_mfma_f32_32x32x16_bf16 v[216:231], v[148:151], v[64:67], v[216:231]
    buffer_load_dwordx4 v[64:67], v2, s[4:7], s38 offen offset:0 sc1
    ds_read_b64_tr_b16 v[144:145], v14 offset:14336
    ds_read_b64_tr_b16 v[146:147], v14 offset:15360
    ds_read_b64_tr_b16 v[148:149], v15 offset:14336
    ds_read_b64_tr_b16 v[150:151], v15 offset:15360
    s_waitcnt vmcnt(21) lgkmcnt(8)
    v_mfma_f32_32x32x16_bf16 v[200:215], v[152:155], v[68:71], v[200:215]
    v_mfma_f32_32x32x16_bf16 v[216:231], v[156:159], v[68:71], v[216:231]
    buffer_load_dwordx4 v[68:71], v2, s[4:7], s38 offen offset:1024 sc1
    s_barrier
    ds_read_b64_tr_b16 v[152:153], v14 offset:16384
    ds_read_b64_tr_b16 v[154:155], v14 offset:17408
    ds_read_b64_tr_b16 v[156:157], v15 offset:16384
    ds_read_b64_tr_b16 v[158:159], v15 offset:17408
    s_waitcnt vmcnt(21) lgkmcnt(8)
    v_mfma_f32_32x32x16_bf16 v[200:215], v[160:163], v[72:75], v[200:215]
    v_mfma_f32_32x32x16_bf16 v[216:231], v[164:167], v[72:75], v[216:231]
    buffer_load_dwordx4 v[72:75], v2, s[4:7], s38 offen offset:2048 sc1
    s_add_u32 m0, s35, 0
    s_nop 0
    buffer_load_dwordx4 v10, s[40:43], s33 offen lds
    buffer_load_dwordx4 v10, s[40:43], s32 offen offset:1024 lds
    s_add_u32 s40, s40, 131072
    s_addc_u32 s41, s41, 0
    ds_read_b64_tr_b16 v[160:161], v14 offset:18432
    ds_read_b64_tr_b16 v[162:163], v14 offset:19456
    ds_read_b64_tr_b16 v[164:165], v15 offset:18432
    ds_read_b64_tr_b16 v[166:167], v15 offset:19456
    s_waitcnt vmcnt(23) lgkmcnt(8)
    v_mfma_f32_32x32x16_bf16 v[200:215], v[144:147], v[76:79], v[200:215]
    v_mfma_f32_32x32x16_bf16 v[216:231], v[148:151], v[76:79], v[216:231]
    buffer_load_dwordx4 v[76:79], v2, s[4:7], s38 offen offset:3072 sc1
    s_add_u32 s38, s38, 4096
    ds_read_b64_tr_b16 v[144:145], v14 offset:20480
    ds_read_b64_tr_b16 v[146:147], v14 offset:21504
    ds_read_b64_tr_b16 v[148:149], v15 offset:20480
    ds_read_b64_tr_b16 v[150:151], v15 offset:21504
    s_waitcnt vmcnt(23) lgkmcnt(8)
    v_mfma_f32_32x32x16_bf16 v[200:215], v[152:155], v[80:83], v[200:215]
    v_mfma_f32_32x32x16_bf16 v[216:231], v[156:159], v[80:83], v[216:231]
    buffer_load_dwordx4 v[80:83], v2, s[4:7], s38 offen offset:0 sc1
    ds_read_b64_tr_b16 v[152:153], v14 offset:22528
    ds_read_b64_tr_b16 v[154:155], v14 offset:23552
    ds_read_b64_tr_b16 v[156:157], v15 offset:22528
    ds_read_b64_tr_b16 v[158:159], v15 offset:23552
    s_waitcnt vmcnt(23) lgkmcnt(8)
    v_mfma_f32_32x32x16_bf16 v[200:215], v[160:163], v[84:87], v[200:215]
    v_mfma_f32_32x32x16_bf16 v[216:231], v[164:167], v[84:87], v[216:231]
    buffer_load_dwordx4 v[84:87], v2, s[4:7], s38 offen offset:1024 sc1
    s_barrier
    ds_read_b64_tr_b16 v[160:161], v14 offset:24576
    ds_read_b64_tr_b16 v[162:163], v14 offset:25600
    ds_read_b64_tr_b16 v[164:165], v15 offset:24576
    ds_read_b64_tr_b16 v[166:167], v15 offset:25600
    s_waitcnt vmcnt(23) lgkmcnt(8)
    v_mfma_f32_32x32x16_bf16 v[200:215], v[144:147], v[88:91], v[200:215]
    v_mfma_f32_32x32x16_bf16 v[216:231], v[148:151], v[88:91], v[216:231]
    buffer_load_dwordx4 v[88:91], v2, s[4:7], s38 offen offset:2048 sc1
    s_add_u32 m0, s35, 8192
    s_nop 0
    buffer_load_dwordx4 v10, s[40:43], s33 offen lds
    buffer_load_dwordx4 v10, s[40:43], s32 offen offset:1024 lds
    s_add_u32 s94, s36, 1
    s_and_b32 s94, s94, 3
    s_add_u32 s94, s94, 4
    s_mul_i32 s94, s94, 262144
    s_add_u32 s40, s14, s94
    s_addc_u32 s41, s15, 0
    ds_read_b64_tr_b16 v[144:145], v14 offset:26624
    ds_read_b64_tr_b16 v[146:147], v14 offset:27648
    ds_read_b64_tr_b16 v[148:149], v15 offset:26624
    ds_read_b64_tr_b16 v[150:151], v15 offset:27648
    s_waitcnt vmcnt(25) lgkmcnt(8)
    v_mfma_f32_32x32x16_bf16 v[200:215], v[152:155], v[92:95], v[200:215]
    v_mfma_f32_32x32x16_bf16 v[216:231], v[156:159], v[92:95], v[216:231]
    buffer_load_dwordx4 v[92:95], v2, s[4:7], s38 offen offset:3072 sc1
    s_add_u32 s94, s36, 0
    s_and_b32 s94, s94, 3
    s_add_u32 s94, s94, 4
    s_mul_i32 s94, s94, 8192
    s_add_u32 s38, s58, s94
    ds_read_b64_tr_b16 v[152:153], v14 offset:28672
    ds_read_b64_tr_b16 v[154:155], v14 offset:29696
    ds_read_b64_tr_b16 v[156:157], v15 offset:28672
    ds_read_b64_tr_b16 v[158:159], v15 offset:29696
    s_waitcnt vmcnt(25) lgkmcnt(8)
    v_mfma_f32_32x32x16_bf16 v[200:215], v[160:163], v[96:99], v[200:215]
    v_mfma_f32_32x32x16_bf16 v[216:231], v[164:167], v[96:99], v[216:231]
    buffer_load_dwordx4 v[96:99], v2, s[4:7], s38 offen offset:0 sc1
    ds_read_b64_tr_b16 v[160:161], v14 offset:30720
    ds_read_b64_tr_b16 v[162:163], v14 offset:31744
    ds_read_b64_tr_b16 v[164:165], v15 offset:30720
    ds_read_b64_tr_b16 v[166:167], v15 offset:31744
    s_waitcnt vmcnt(25) lgkmcnt(8)
    v_mfma_f32_32x32x16_bf16 v[200:215], v[144:147], v[100:103], v[200:215]
    v_mfma_f32_32x32x16_bf16 v[216:231], v[148:151], v[100:103], v[216:231]
    buffer_load_dwordx4 v[100:103], v2, s[4:7], s38 offen offset:1024 sc1
    s_barrier
    ds_read_b64_tr_b16 v[144:145], v14 offset:32768
    ds_read_b64_tr_b16 v[146:147], v14 offset:33792
    ds_read_b64_tr_b16 v[148:149], v15 offset:32768
    ds_read_b64_tr_b16 v[150:151], v15 offset:33792
    s_waitcnt vmcnt(25) lgkmcnt(8)
    v_mfma_f32_32x32x16_bf16 v[200:215], v[152:155], v[104:107], v[200:215]
    v_mfma_f32_32x32x16_bf16 v[216:231], v[156:159], v[104:107], v[216:231]
    buffer_load_dwordx4 v[104:107], v2, s[4:7], s38 offen offset:2048 sc1
    s_add_u32 m0, s35, 16384
    s_nop 0
    buffer_load_dwordx4 v10, s[40:43], s33 offen lds
    buffer_load_dwordx4 v10, s[40:43], s32 offen offset:1024 lds
    s_add_u32 s40, s40, 131072
    s_addc_u32 s41, s41, 0
    ds_read_b64_tr_b16 v[152:153], v14 offset:34816
    ds_read_b64_tr_b16 v[154:155], v14 offset:35840
    ds_read_b64_tr_b16 v[156:157], v15 offset:34816
    ds_read_b64_tr_b16 v[158:159], v15 offset:35840
    s_waitcnt vmcnt(27) lgkmcnt(8)
    v_mfma_f32_32x32x16_bf16 v[200:215], v[160:163], v[108:111], v[200:215]
    v_mfma_f32_32x32x16_bf16 v[216:231], v[164:167], v[108:111], v[216:231]
    buffer_load_dwordx4 v[108:111], v2, s[4:7], s38 offen offset:3072 sc1
    s_add_u32 s38, s38, 4096
    ds_read_b64_tr_b16 v[160:161], v14 offset:36864
    ds_read_b64_tr_b16 v[162:163], v14 offset:37888
    ds_read_b64_tr_b16 v[164:165], v15 offset:36864
    ds_read_b64_tr_b16 v[166:167], v15 offset:37888
    s_waitcnt vmcnt(27) lgkmcnt(8)
    v_mfma_f32_32x32x16_bf16 v[200:215], v[144:147], v[32:35], v[200:215]
    v_mfma_f32_32x32x16_bf16 v[216:231], v[148:151], v[32:35], v[216:231]
    buffer_load_dwordx4 v[32:35], v2, s[4:7], s38 offen offset:0 sc1
    ds_read_b64_tr_b16 v[144:145], v14 offset:38912
    ds_read_b64_tr_b16 v[146:147], v14 offset:39936
    ds_read_b64_tr_b16 v[148:149], v15 offset:38912
    ds_read_b64_tr_b16 v[150:151], v15 offset:39936
    s_waitcnt vmcnt(27) lgkmcnt(8)
    v_mfma_f32_32x32x16_bf16 v[200:215], v[152:155], v[36:39], v[200:215]
    v_mfma_f32_32x32x16_bf16 v[216:231], v[156:159], v[36:39], v[216:231]
    buffer_load_dwordx4 v[36:39], v2, s[4:7], s38 offen offset:1024 sc1
    s_barrier
    ds_read_b64_tr_b16 v[152:153], v14 offset:40960
    ds_read_b64_tr_b16 v[154:155], v14 offset:41984
    ds_read_b64_tr_b16 v[156:157], v15 offset:40960
    ds_read_b64_tr_b16 v[158:159], v15 offset:41984
    s_waitcnt vmcnt(27) lgkmcnt(8)
    v_mfma_f32_32x32x16_bf16 v[200:215], v[160:163], v[40:43], v[200:215]
    v_mfma_f32_32x32x16_bf16 v[216:231], v[164:167], v[40:43], v[216:231]
    buffer_load_dwordx4 v[40:43], v2, s[4:7], s38 offen offset:2048 sc1
    s_add_u32 m0, s35, 24576
    s_nop 0
    buffer_load_dwordx4 v10, s[40:43], s33 offen lds
    buffer_load_dwordx4 v10, s[40:43], s32 offen offset:1024 lds
    s_add_u32 s94, s36, 2
    s_and_b32 s94, s94, 3
    s_add_u32 s94, s94, 4
    s_mul_i32 s94, s94, 262144
    s_add_u32 s40, s14, s94
    s_addc_u32 s41, s15, 0
    ds_read_b64_tr_b16 v[160:161], v14 offset:43008
    ds_read_b64_tr_b16 v[162:163], v14 offset:44032
    ds_read_b64_tr_b16 v[164:165], v15 offset:43008
    ds_read_b64_tr_b16 v[166:167], v15 offset:44032
    s_waitcnt vmcnt(29) lgkmcnt(8)
    v_mfma_f32_32x32x16_bf16 v[200:215], v[144:147], v[44:47], v[200:215]
    v_mfma_f32_32x32x16_bf16 v[216:231], v[148:151], v[44:47], v[216:231]
    buffer_load_dwordx4 v[44:47], v2, s[4:7], s38 offen offset:3072 sc1
    s_add_u32 s94, s36, 1
    s_and_b32 s94, s94, 3
    s_add_u32 s94, s94, 4
    s_mul_i32 s94, s94, 8192
    s_add_u32 s38, s58, s94
    ds_read_b64_tr_b16 v[144:145], v14 offset:45056
    ds_read_b64_tr_b16 v[146:147], v14 offset:46080
    ds_read_b64_tr_b16 v[148:149], v15 offset:45056
    ds_read_b64_tr_b16 v[150:151], v15 offset:46080
    s_waitcnt vmcnt(27) lgkmcnt(8)
    v_mfma_f32_32x32x16_bf16 v[200:215], v[152:155], v[48:51], v[200:215]
    v_mfma_f32_32x32x16_bf16 v[216:231], v[156:159], v[48:51], v[216:231]
    buffer_load_dwordx4 v[48:51], v2, s[4:7], s38 offen offset:0 sc1
    ds_read_b64_tr_b16 v[152:153], v14 offset:47104
    ds_read_b64_tr_b16 v[154:155], v14 offset:48128
    ds_read_b64_tr_b16 v[156:157], v15 offset:47104
    ds_read_b64_tr_b16 v[158:159], v15 offset:48128
    s_waitcnt vmcnt(27) lgkmcnt(8)
    v_mfma_f32_32x32x16_bf16 v[200:215], v[160:163], v[52:55], v[200:215]
    v_mfma_f32_32x32x16_bf16 v[216:231], v[164:167], v[52:55], v[216:231]
    buffer_load_dwordx4 v[52:55], v2, s[4:7], s38 offen offset:1024 sc1
    s_barrier
    ds_read_b64_tr_b16 v[160:161], v14 offset:49152
    ds_read_b64_tr_b16 v[162:163], v14 offset:50176
    ds_read_b64_tr_b16 v[164:165], v15 offset:49152
    ds_read_b64_tr_b16 v[166:167], v15 offset:50176
    s_waitcnt vmcnt(27) lgkmcnt(8)
    v_mfma_f32_32x32x16_bf16 v[200:215], v[144:147], v[56:59], v[200:215]
    v_mfma_f32_32x32x16_bf16 v[216:231], v[148:151], v[56:59], v[216:231]
    buffer_load_dwordx4 v[56:59], v2, s[4:7], s38 offen offset:2048 sc1
    s_add_u32 m0, s35, 32768
    s_nop 0
    buffer_load_dwordx4 v10, s[40:43], s33 offen lds
    buffer_load_dwordx4 v10, s[40:43], s32 offen offset:1024 lds
    s_add_u32 s40, s40, 131072
    s_addc_u32 s41, s41, 0
    ds_read_b64_tr_b16 v[144:145], v14 offset:51200
    ds_read_b64_tr_b16 v[146:147], v14 offset:52224
    ds_read_b64_tr_b16 v[148:149], v15 offset:51200
    ds_read_b64_tr_b16 v[150:151], v15 offset:52224
    s_waitcnt vmcnt(29) lgkmcnt(8)
    v_mfma_f32_32x32x16_bf16 v[200:215], v[152:155], v[60:63], v[200:215]
    v_mfma_f32_32x32x16_bf16 v[216:231], v[156:159], v[60:63], v[216:231]
    buffer_load_dwordx4 v[60:63], v2, s[4:7], s38 offen offset:3072 sc1
    s_add_u32 s38, s38, 4096
    ds_read_b64_tr_b16 v[152:153], v14 offset:53248
    ds_read_b64_tr_b16 v[154:155], v14 offset:54272
    ds_read_b64_tr_b16 v[156:157], v15 offset:53248
    ds_read_b64_tr_b16 v[158:159], v15 offset:54272
    s_waitcnt vmcnt(29) lgkmcnt(8)
    v_mfma_f32_32x32x16_bf16 v[200:215], v[160:163], v[64:67], v[200:215]
    v_mfma_f32_32x32x16_bf16 v[216:231], v[164:167], v[64:67], v[216:231]
    buffer_load_dwordx4 v[64:67], v2, s[4:7], s38 offen offset:0 sc1
    ds_read_b64_tr_b16 v[160:161], v14 offset:55296
    ds_read_b64_tr_b16 v[162:163], v14 offset:56320
    ds_read_b64_tr_b16 v[164:165], v15 offset:55296
    ds_read_b64_tr_b16 v[166:167], v15 offset:56320
    s_waitcnt vmcnt(29) lgkmcnt(8)
    v_mfma_f32_32x32x16_bf16 v[200:215], v[144:147], v[68:71], v[200:215]
    v_mfma_f32_32x32x16_bf16 v[216:231], v[148:151], v[68:71], v[216:231]
    buffer_load_dwordx4 v[68:71], v2, s[4:7], s38 offen offset:1024 sc1
    s_barrier
    ds_read_b64_tr_b16 v[144:145], v14 offset:57344
    ds_read_b64_tr_b16 v[146:147], v14 offset:58368
    ds_read_b64_tr_b16 v[148:149], v15 offset:57344
    ds_read_b64_tr_b16 v[150:151], v15 offset:58368
    s_waitcnt vmcnt(29) lgkmcnt(8)
    v_mfma_f32_32x32x16_bf16 v[200:215], v[152:155], v[72:75], v[200:215]
    v_mfma_f32_32x32x16_bf16 v[216:231], v[156:159], v[72:75], v[216:231]
    buffer_load_dwordx4 v[72:75], v2, s[4:7], s38 offen offset:2048 sc1
    s_add_u32 m0, s35, 40960
    s_nop 0
    buffer_load_dwordx4 v10, s[40:43], s33 offen lds
    buffer_load_dwordx4 v10, s[40:43], s32 offen offset:1024 lds
    s_add_u32 s94, s36, 3
    s_and_b32 s94, s94, 3
    s_add_u32 s94, s94, 4
    s_mul_i32 s94, s94, 262144
    s_add_u32 s40, s14, s94
    s_addc_u32 s41, s15, 0
    ds_read_b64_tr_b16 v[152:153], v14 offset:59392
    ds_read_b64_tr_b16 v[154:155], v14 offset:60416
    ds_read_b64_tr_b16 v[156:157], v15 offset:59392
    ds_read_b64_tr_b16 v[158:159], v15 offset:60416
    s_waitcnt vmcnt(29) lgkmcnt(8)
    v_mfma_f32_32x32x16_bf16 v[200:215], v[160:163], v[76:79], v[200:215]
    v_mfma_f32_32x32x16_bf16 v[216:231], v[164:167], v[76:79], v[216:231]
    buffer_load_dwordx4 v[76:79], v2, s[4:7], s38 offen offset:3072 sc1
    s_add_u32 s94, s36, 2
    s_and_b32 s94, s94, 3
    s_add_u32 s94, s94, 4
    s_mul_i32 s94, s94, 8192
    s_add_u32 s38, s58, s94
    ds_read_b64_tr_b16 v[160:161], v14 offset:61440
    ds_read_b64_tr_b16 v[162:163], v14 offset:62464
    ds_read_b64_tr_b16 v[164:165], v15 offset:61440
    ds_read_b64_tr_b16 v[166:167], v15 offset:62464
    s_waitcnt vmcnt(29) lgkmcnt(8)
    v_mfma_f32_32x32x16_bf16 v[200:215], v[144:147], v[80:83], v[200:215]
    v_mfma_f32_32x32x16_bf16 v[216:231], v[148:151], v[80:83], v[216:231]
    buffer_load_dwordx4 v[80:83], v2, s[4:7], s38 offen offset:0 sc1
    ds_read_b64_tr_b16 v[144:145], v14 offset:63488
    ds_read_b64_tr_b16 v[146:147], v14 offset:64512
    ds_read_b64_tr_b16 v[148:149], v15 offset:63488
    ds_read_b64_tr_b16 v[150:151], v15 offset:64512
    s_waitcnt vmcnt(29) lgkmcnt(8)
    v_mfma_f32_32x32x16_bf16 v[200:215], v[152:155], v[84:87], v[200:215]
    v_mfma_f32_32x32x16_bf16 v[216:231], v[156:159], v[84:87], v[216:231]
    buffer_load_dwordx4 v[84:87], v2, s[4:7], s38 offen offset:1024 sc1
    s_barrier
    ds_read_b64_tr_b16 v[152:153], v14 offset:0
    ds_read_b64_tr_b16 v[154:155], v14 offset:1024
    ds_read_b64_tr_b16 v[156:157], v15 offset:0
    ds_read_b64_tr_b16 v[158:159], v15 offset:1024
    s_waitcnt vmcnt(29) lgkmcnt(8)
    v_mfma_f32_32x32x16_bf16 v[200:215], v[160:163], v[88:91], v[200:215]
    v_mfma_f32_32x32x16_bf16 v[216:231], v[164:167], v[88:91], v[216:231]
    buffer_load_dwordx4 v[88:91], v2, s[4:7], s38 offen offset:2048 sc1
    s_add_u32 m0, s35, 49152
    s_nop 0
    buffer_load_dwordx4 v10, s[40:43], s33 offen lds
    buffer_load_dwordx4 v10, s[40:43], s32 offen offset:1024 lds
    s_add_u32 s40, s40, 131072
    s_addc_u32 s41, s41, 0
    ds_read_b64_tr_b16 v[160:161], v14 offset:2048
    ds_read_b64_tr_b16 v[162:163], v14 offset:3072
    ds_read_b64_tr_b16 v[164:165], v15 offset:2048
    ds_read_b64_tr_b16 v[166:167], v15 offset:3072
    s_waitcnt vmcnt(29) lgkmcnt(8)
    v_mfma_f32_32x32x16_bf16 v[200:215], v[144:147], v[92:95], v[200:215]
    v_mfma_f32_32x32x16_bf16 v[216:231], v[148:151], v[92:95], v[216:231]
    buffer_load_dwordx4 v[92:95], v2, s[4:7], s38 offen offset:3072 sc1
    s_add_u32 s38, s38, 4096
    ds_read_b64_tr_b16 v[144:145], v14 offset:4096
    ds_read_b64_tr_b16 v[146:147], v14 offset:5120
    ds_read_b64_tr_b16 v[148:149], v15 offset:4096
    ds_read_b64_tr_b16 v[150:151], v15 offset:5120
    s_waitcnt vmcnt(29) lgkmcnt(8)
    v_mfma_f32_32x32x16_bf16 v[200:215], v[152:155], v[96:99], v[200:215]
    v_mfma_f32_32x32x16_bf16 v[216:231], v[156:159], v[96:99], v[216:231]
    buffer_load_dwordx4 v[96:99], v2, s[4:7], s38 offen offset:0 sc1
    ds_read_b64_tr_b16 v[152:153], v14 offset:6144
    ds_read_b64_tr_b16 v[154:155], v14 offset:7168
    ds_read_b64_tr_b16 v[156:157], v15 offset:6144
    ds_read_b64_tr_b16 v[158:159], v15 offset:7168
    s_waitcnt vmcnt(29) lgkmcnt(8)
    v_mfma_f32_32x32x16_bf16 v[200:215], v[160:163], v[100:103], v[200:215]
    v_mfma_f32_32x32x16_bf16 v[216:231], v[164:167], v[100:103], v[216:231]
    buffer_load_dwordx4 v[100:103], v2, s[4:7], s38 offen offset:1024 sc1
    s_barrier
    ds_read_b64_tr_b16 v[160:161], v14 offset:8192
    ds_read_b64_tr_b16 v[162:163], v14 offset:9216
    ds_read_b64_tr_b16 v[164:165], v15 offset:8192
    ds_read_b64_tr_b16 v[166:167], v15 offset:9216
    s_waitcnt vmcnt(29) lgkmcnt(8)
    v_mfma_f32_32x32x16_bf16 v[200:215], v[144:147], v[104:107], v[200:215]
    v_mfma_f32_32x32x16_bf16 v[216:231], v[148:151], v[104:107], v[216:231]
    buffer_load_dwordx4 v[104:107], v2, s[4:7], s38 offen offset:2048 sc1
    s_add_u32 m0, s35, 57344
    s_nop 0
    buffer_load_dwordx4 v10, s[40:43], s33 offen lds
    buffer_load_dwordx4 v10, s[40:43], s32 offen offset:1024 lds
    ds_read_b64_tr_b16 v[144:145], v14 offset:10240
    ds_read_b64_tr_b16 v[146:147], v14 offset:11264
    ds_read_b64_tr_b16 v[148:149], v15 offset:10240
    ds_read_b64_tr_b16 v[150:151], v15 offset:11264
    s_waitcnt vmcnt(29) lgkmcnt(8)
    v_mfma_f32_32x32x16_bf16 v[200:215], v[152:155], v[108:111], v[200:215]
    v_mfma_f32_32x32x16_bf16 v[216:231], v[156:159], v[108:111], v[216:231]
    buffer_load_dwordx4 v[108:111], v2, s[4:7], s38 offen offset:3072 sc1
    s_add_u32 s94, s36, 3
    s_and_b32 s94, s94, 3
    s_add_u32 s94, s94, 4
    s_mul_i32 s94, s94, 8192
    s_add_u32 s38, s58, s94
    ds_read_b64_tr_b16 v[152:153], v14 offset:12288
    ds_read_b64_tr_b16 v[154:155], v14 offset:13312
    ds_read_b64_tr_b16 v[156:157], v15 offset:12288
    ds_read_b64_tr_b16 v[158:159], v15 offset:13312
    s_waitcnt vmcnt(29) lgkmcnt(8)
    v_mfma_f32_32x32x16_bf16 v[200:215], v[160:163], v[32:35], v[200:215]
    v_mfma_f32_32x32x16_bf16 v[216:231], v[164:167], v[32:35], v[216:231]
    buffer_load_dwordx4 v[32:35], v2, s[4:7], s38 offen offset:0 sc1
    ds_read_b64_tr_b16 v[160:161], v14 offset:14336
    ds_read_b64_tr_b16 v[162:163], v14 offset:15360
    ds_read_b64_tr_b16 v[164:165], v15 offset:14336
    ds_read_b64_tr_b16 v[166:167], v15 offset:15360
    s_waitcnt vmcnt(29) lgkmcnt(8)
    v_mfma_f32_32x32x16_bf16 v[200:215], v[144:147], v[36:39], v[200:215]
    v_mfma_f32_32x32x16_bf16 v[216:231], v[148:151], v[36:39], v[216:231]
    buffer_load_dwordx4 v[36:39], v2, s[4:7], s38 offen offset:1024 sc1
    s_barrier
    ds_read_b64_tr_b16 v[144:145], v14 offset:16384
    ds_read_b64_tr_b16 v[146:147], v14 offset:17408
    ds_read_b64_tr_b16 v[148:149], v15 offset:16384
    ds_read_b64_tr_b16 v[150:151], v15 offset:17408
    s_waitcnt vmcnt(29) lgkmcnt(8)
    v_mfma_f32_32x32x16_bf16 v[200:215], v[152:155], v[40:43], v[200:215]
    v_mfma_f32_32x32x16_bf16 v[216:231], v[156:159], v[40:43], v[216:231]
    buffer_load_dwordx4 v[40:43], v2, s[4:7], s38 offen offset:2048 sc1
    ds_read_b64_tr_b16 v[152:153], v14 offset:18432
    ds_read_b64_tr_b16 v[154:155], v14 offset:19456
    ds_read_b64_tr_b16 v[156:157], v15 offset:18432
    ds_read_b64_tr_b16 v[158:159], v15 offset:19456
    s_waitcnt vmcnt(27) lgkmcnt(8)
    v_mfma_f32_32x32x16_bf16 v[200:215], v[160:163], v[44:47], v[200:215]
    v_mfma_f32_32x32x16_bf16 v[216:231], v[164:167], v[44:47], v[216:231]
    buffer_load_dwordx4 v[44:47], v2, s[4:7], s38 offen offset:3072 sc1
    s_add_u32 s38, s38, 4096
    ds_read_b64_tr_b16 v[160:161], v14 offset:20480
    ds_read_b64_tr_b16 v[162:163], v14 offset:21504
    ds_read_b64_tr_b16 v[164:165], v15 offset:20480
    ds_read_b64_tr_b16 v[166:167], v15 offset:21504
    s_waitcnt vmcnt(27) lgkmcnt(8)
    v_mfma_f32_32x32x16_bf16 v[200:215], v[144:147], v[48:51], v[200:215]
    v_mfma_f32_32x32x16_bf16 v[216:231], v[148:151], v[48:51], v[216:231]
    buffer_load_dwordx4 v[48:51], v2, s[4:7], s38 offen offset:0 sc1
    ds_read_b64_tr_b16 v[144:145], v14 offset:22528
    ds_read_b64_tr_b16 v[146:147], v14 offset:23552
    ds_read_b64_tr_b16 v[148:149], v15 offset:22528
    ds_read_b64_tr_b16 v[150:151], v15 offset:23552
    s_waitcnt vmcnt(27) lgkmcnt(8)
    v_mfma_f32_32x32x16_bf16 v[200:215], v[152:155], v[52:55], v[200:215]
    v_mfma_f32_32x32x16_bf16 v[216:231], v[156:159], v[52:55], v[216:231]
    buffer_load_dwordx4 v[52:55], v2, s[4:7], s38 offen offset:1024 sc1
    s_barrier
    ds_read_b64_tr_b16 v[152:153], v14 offset:24576
    ds_read_b64_tr_b16 v[154:155], v14 offset:25600
    ds_read_b64_tr_b16 v[156:157], v15 offset:24576
    ds_read_b64_tr_b16 v[158:159], v15 offset:25600
    s_waitcnt vmcnt(27) lgkmcnt(8)
    v_mfma_f32_32x32x16_bf16 v[200:215], v[160:163], v[56:59], v[200:215]
    v_mfma_f32_32x32x16_bf16 v[216:231], v[164:167], v[56:59], v[216:231]
    buffer_load_dwordx4 v[56:59], v2, s[4:7], s38 offen offset:2048 sc1
    ds_read_b64_tr_b16 v[160:161], v14 offset:26624
    ds_read_b64_tr_b16 v[162:163], v14 offset:27648
    ds_read_b64_tr_b16 v[164:165], v15 offset:26624
    ds_read_b64_tr_b16 v[166:167], v15 offset:27648
    s_waitcnt vmcnt(25) lgkmcnt(8)
    v_mfma_f32_32x32x16_bf16 v[200:215], v[144:147], v[60:63], v[200:215]
    v_mfma_f32_32x32x16_bf16 v[216:231], v[148:151], v[60:63], v[216:231]
    buffer_load_dwordx4 v[60:63], v2, s[4:7], s38 offen offset:3072 sc1
    ds_read_b64_tr_b16 v[144:145], v14 offset:28672
    ds_read_b64_tr_b16 v[146:147], v14 offset:29696
    ds_read_b64_tr_b16 v[148:149], v15 offset:28672
    ds_read_b64_tr_b16 v[150:151], v15 offset:29696
    s_waitcnt vmcnt(25) lgkmcnt(8)
    v_mfma_f32_32x32x16_bf16 v[200:215], v[152:155], v[64:67], v[200:215]
    v_mfma_f32_32x32x16_bf16 v[216:231], v[156:159], v[64:67], v[216:231]
    ds_read_b64_tr_b16 v[152:153], v14 offset:30720
    ds_read_b64_tr_b16 v[154:155], v14 offset:31744
    ds_read_b64_tr_b16 v[156:157], v15 offset:30720
    ds_read_b64_tr_b16 v[158:159], v15 offset:31744
    s_waitcnt vmcnt(24) lgkmcnt(8)
    v_mfma_f32_32x32x16_bf16 v[200:215], v[160:163], v[68:71], v[200:215]
    v_mfma_f32_32x32x16_bf16 v[216:231], v[164:167], v[68:71], v[216:231]
    s_barrier
    ds_read_b64_tr_b16 v[160:161], v14 offset:32768
    ds_read_b64_tr_b16 v[162:163], v14 offset:33792
    ds_read_b64_tr_b16 v[164:165], v15 offset:32768
    ds_read_b64_tr_b16 v[166:167], v15 offset:33792
    s_waitcnt vmcnt(23) lgkmcnt(8)
    v_mfma_f32_32x32x16_bf16 v[200:215], v[144:147], v[72:75], v[200:215]
    v_mfma_f32_32x32x16_bf16 v[216:231], v[148:151], v[72:75], v[216:231]
    ds_read_b64_tr_b16 v[144:145], v14 offset:34816
    ds_read_b64_tr_b16 v[146:147], v14 offset:35840
    ds_read_b64_tr_b16 v[148:149], v15 offset:34816
    ds_read_b64_tr_b16 v[150:151], v15 offset:35840
    s_waitcnt vmcnt(20) lgkmcnt(8)
    v_mfma_f32_32x32x16_bf16 v[200:215], v[152:155], v[76:79], v[200:215]
    v_mfma_f32_32x32x16_bf16 v[216:231], v[156:159], v[76:79], v[216:231]
    ds_read_b64_tr_b16 v[152:153], v14 offset:36864
    ds_read_b64_tr_b16 v[154:155], v14 offset:37888
    ds_read_b64_tr_b16 v[156:157], v15 offset:36864
    ds_read_b64_tr_b16 v[158:159], v15 offset:37888
    s_waitcnt vmcnt(19) lgkmcnt(8)
    v_mfma_f32_32x32x16_bf16 v[200:215], v[160:163], v[80:83], v[200:215]
    v_mfma_f32_32x32x16_bf16 v[216:231], v[164:167], v[80:83], v[216:231]
    ds_read_b64_tr_b16 v[160:161], v14 offset:38912
    ds_read_b64_tr_b16 v[162:163], v14 offset:39936
    ds_read_b64_tr_b16 v[164:165], v15 offset:38912
    ds_read_b64_tr_b16 v[166:167], v15 offset:39936
    s_waitcnt vmcnt(18) lgkmcnt(8)
    v_mfma_f32_32x32x16_bf16 v[200:215], v[144:147], v[84:87], v[200:215]
    v_mfma_f32_32x32x16_bf16 v[216:231], v[148:151], v[84:87], v[216:231]
    s_barrier
    ds_read_b64_tr_b16 v[144:145], v14 offset:40960
    ds_read_b64_tr_b16 v[146:147], v14 offset:41984
    ds_read_b64_tr_b16 v[148:149], v15 offset:40960
    ds_read_b64_tr_b16 v[150:151], v15 offset:41984
    s_waitcnt vmcnt(17) lgkmcnt(8)
    v_mfma_f32_32x32x16_bf16 v[200:215], v[152:155], v[88:91], v[200:215]
    v_mfma_f32_32x32x16_bf16 v[216:231], v[156:159], v[88:91], v[216:231]
    ds_read_b64_tr_b16 v[152:153], v14 offset:43008
    ds_read_b64_tr_b16 v[154:155], v14 offset:44032
    ds_read_b64_tr_b16 v[156:157], v15 offset:43008
    ds_read_b64_tr_b16 v[158:159], v15 offset:44032
    s_waitcnt vmcnt(14) lgkmcnt(8)
    v_mfma_f32_32x32x16_bf16 v[200:215], v[160:163], v[92:95], v[200:215]
    v_mfma_f32_32x32x16_bf16 v[216:231], v[164:167], v[92:95], v[216:231]
    ds_read_b64_tr_b16 v[160:161], v14 offset:45056
    ds_read_b64_tr_b16 v[162:163], v14 offset:46080
    ds_read_b64_tr_b16 v[164:165], v15 offset:45056
    ds_read_b64_tr_b16 v[166:167], v15 offset:46080
    s_waitcnt vmcnt(13) lgkmcnt(8)
    v_mfma_f32_32x32x16_bf16 v[200:215], v[144:147], v[96:99], v[200:215]
    v_mfma_f32_32x32x16_bf16 v[216:231], v[148:151], v[96:99], v[216:231]
    ds_read_b64_tr_b16 v[144:145], v14 offset:47104
    ds_read_b64_tr_b16 v[146:147], v14 offset:48128
    ds_read_b64_tr_b16 v[148:149], v15 offset:47104
    ds_read_b64_tr_b16 v[150:151], v15 offset:48128
    s_waitcnt vmcnt(12) lgkmcnt(8)
    v_mfma_f32_32x32x16_bf16 v[200:215], v[152:155], v[100:103], v[200:215]
    v_mfma_f32_32x32x16_bf16 v[216:231], v[156:159], v[100:103], v[216:231]
    s_barrier
    ds_read_b64_tr_b16 v[152:153], v14 offset:49152
    ds_read_b64_tr_b16 v[154:155], v14 offset:50176
    ds_read_b64_tr_b16 v[156:157], v15 offset:49152
    ds_read_b64_tr_b16 v[158:159], v15 offset:50176
    s_waitcnt vmcnt(11) lgkmcnt(8)
    v_mfma_f32_32x32x16_bf16 v[200:215], v[160:163], v[104:107], v[200:215]
    v_mfma_f32_32x32x16_bf16 v[216:231], v[164:167], v[104:107], v[216:231]
    ds_read_b64_tr_b16 v[160:161], v14 offset:51200
    ds_read_b64_tr_b16 v[162:163], v14 offset:52224
    ds_read_b64_tr_b16 v[164:165], v15 offset:51200
    ds_read_b64_tr_b16 v[166:167], v15 offset:52224
    s_waitcnt vmcnt(8) lgkmcnt(8)
    v_mfma_f32_32x32x16_bf16 v[200:215], v[144:147], v[108:111], v[200:215]
    v_mfma_f32_32x32x16_bf16 v[216:231], v[148:151], v[108:111], v[216:231]
    ds_read_b64_tr_b16 v[144:145], v14 offset:53248
    ds_read_b64_tr_b16 v[146:147], v14 offset:54272
    ds_read_b64_tr_b16 v[148:149], v15 offset:53248
    ds_read_b64_tr_b16 v[150:151], v15 offset:54272
    s_waitcnt vmcnt(7) lgkmcnt(8)
    v_mfma_f32_32x32x16_bf16 v[200:215], v[152:155], v[32:35], v[200:215]
    v_mfma_f32_32x32x16_bf16 v[216:231], v[156:159], v[32:35], v[216:231]
    ds_read_b64_tr_b16 v[152:153], v14 offset:55296
    ds_read_b64_tr_b16 v[154:155], v14 offset:56320
    ds_read_b64_tr_b16 v[156:157], v15 offset:55296
    ds_read_b64_tr_b16 v[158:159], v15 offset:56320
    s_waitcnt vmcnt(6) lgkmcnt(8)
    v_mfma_f32_32x32x16_bf16 v[200:215], v[160:163], v[36:39], v[200:215]
    v_mfma_f32_32x32x16_bf16 v[216:231], v[164:167], v[36:39], v[216:231]
    s_barrier
    ds_read_b64_tr_b16 v[160:161], v14 offset:57344
    ds_read_b64_tr_b16 v[162:163], v14 offset:58368
    ds_read_b64_tr_b16 v[164:165], v15 offset:57344
    ds_read_b64_tr_b16 v[166:167], v15 offset:58368
    s_waitcnt vmcnt(5) lgkmcnt(8)
    v_mfma_f32_32x32x16_bf16 v[200:215], v[144:147], v[40:43], v[200:215]
    v_mfma_f32_32x32x16_bf16 v[216:231], v[148:151], v[40:43], v[216:231]
    ds_read_b64_tr_b16 v[144:145], v14 offset:59392
    ds_read_b64_tr_b16 v[146:147], v14 offset:60416
    ds_read_b64_tr_b16 v[148:149], v15 offset:59392
    ds_read_b64_tr_b16 v[150:151], v15 offset:60416
    s_waitcnt vmcnt(4) lgkmcnt(8)
    v_mfma_f32_32x32x16_bf16 v[200:215], v[152:155], v[44:47], v[200:215]
    v_mfma_f32_32x32x16_bf16 v[216:231], v[156:159], v[44:47], v[216:231]
    ds_read_b64_tr_b16 v[152:153], v14 offset:61440
    ds_read_b64_tr_b16 v[154:155], v14 offset:62464
    ds_read_b64_tr_b16 v[156:157], v15 offset:61440
    ds_read_b64_tr_b16 v[158:159], v15 offset:62464
    s_waitcnt vmcnt(3) lgkmcnt(8)
    v_mfma_f32_32x32x16_bf16 v[200:215], v[160:163], v[48:51], v[200:215]
    v_mfma_f32_32x32x16_bf16 v[216:231], v[164:167], v[48:51], v[216:231]
    ds_read_b64_tr_b16 v[160:161], v14 offset:63488
    ds_read_b64_tr_b16 v[162:163], v14 offset:64512
    ds_read_b64_tr_b16 v[164:165], v15 offset:63488
    ds_read_b64_tr_b16 v[166:167], v15 offset:64512
    s_waitcnt vmcnt(2) lgkmcnt(8)
    v_mfma_f32_32x32x16_bf16 v[200:215], v[144:147], v[52:55], v[200:215]
    v_mfma_f32_32x32x16_bf16 v[216:231], v[148:151], v[52:55], v[216:231]
    s_waitcnt vmcnt(1) lgkmcnt(4)
    v_mfma_f32_32x32x16_bf16 v[200:215], v[152:155], v[56:59], v[200:215]
    v_mfma_f32_32x32x16_bf16 v[216:231], v[156:159], v[56:59], v[216:231]
    s_waitcnt vmcnt(0) lgkmcnt(0)
    v_mfma_f32_32x32x16_bf16 v[200:215], v[160:163], v[60:63], v[200:215]
    v_mfma_f32_32x32x16_bf16 v[216:231], v[164:167], v[60:63], v[216:231]
    v_sub_f32 v23, 1.0, v22
    v_mul_f32 v168, v168, v23
    v_mul_f32 v169, v169, v23
    v_mul_f32 v170, v170, v23
    v_mul_f32 v171, v171, v23
    v_mul_f32 v172, v172, v23
    v_mul_f32 v173, v173, v23
    v_mul_f32 v174, v174, v23
    v_mul_f32 v175, v175, v23
    v_mul_f32 v176, v176, v23
    v_mul_f32 v177, v177, v23
    v_mul_f32 v178, v178, v23
    v_mul_f32 v179, v179, v23
    v_mul_f32 v180, v180, v23
    v_mul_f32 v181, v181, v23
    v_mul_f32 v182, v182, v23
    v_mul_f32 v183, v183, v23
    v_mul_f32 v184, v184, v23
    v_mul_f32 v185, v185, v23
    v_mul_f32 v186, v186, v23
    v_mul_f32 v187, v187, v23
    v_mul_f32 v188, v188, v23
    v_mul_f32 v189, v189, v23
    v_mul_f32 v190, v190, v23
    v_mul_f32 v191, v191, v23
    v_mul_f32 v192, v192, v23
    v_mul_f32 v193, v193, v23
    v_mul_f32 v194, v194, v23
    v_mul_f32 v195, v195, v23
    v_mul_f32 v196, v196, v23
    v_mul_f32 v197, v197, v23
    v_mul_f32 v198, v198, v23
    v_mul_f32 v199, v199, v23
    v_fmac_f32 v168, v200, v22
    v_fmac_f32 v169, v201, v22
    v_fmac_f32 v170, v202, v22
    v_fmac_f32 v171, v203, v22
    v_fmac_f32 v172, v204, v22
    v_fmac_f32 v173, v205, v22
    v_fmac_f32 v174, v206, v22
    v_fmac_f32 v175, v207, v22
    v_fmac_f32 v176, v208, v22
    v_fmac_f32 v177, v209, v22
    v_fmac_f32 v178, v210, v22
    v_fmac_f32 v179, v211, v22
    v_fmac_f32 v180, v212, v22
    v_fmac_f32 v181, v213, v22
    v_fmac_f32 v182, v214, v22
    v_fmac_f32 v183, v215, v22
    v_fmac_f32 v184, v216, v22
    v_fmac_f32 v185, v217, v22
    v_fmac_f32 v186, v218, v22
    v_fmac_f32 v187, v219, v22
    v_fmac_f32 v188, v220, v22
    v_fmac_f32 v189, v221, v22
    v_fmac_f32 v190, v222, v22
    v_fmac_f32 v191, v223, v22
    v_fmac_f32 v192, v224, v22
    v_fmac_f32 v193, v225, v22
    v_fmac_f32 v194, v226, v22
    v_fmac_f32 v195, v227, v22
    v_fmac_f32 v196, v228, v22
    v_fmac_f32 v197, v229, v22
    v_fmac_f32 v198, v230, v22
    v_fmac_f32 v199, v231, v22
    v_cvt_pk_bf16_f32 v32, v168, v169
    v_cvt_pk_bf16_f32 v33, v170, v171
    v_cvt_pk_bf16_f32 v34, v172, v173
    v_cvt_pk_bf16_f32 v35, v174, v175
    v_cvt_pk_bf16_f32 v36, v176, v177
    v_cvt_pk_bf16_f32 v37, v178, v179
    v_cvt_pk_bf16_f32 v38, v180, v181
    v_cvt_pk_bf16_f32 v39, v182, v183
    v_cvt_pk_bf16_f32 v40, v184, v185
    v_cvt_pk_bf16_f32 v41, v186, v187
    v_cvt_pk_bf16_f32 v42, v188, v189
    v_cvt_pk_bf16_f32 v43, v190, v191
    v_cvt_pk_bf16_f32 v44, v192, v193
    v_cvt_pk_bf16_f32 v45, v194, v195
    v_cvt_pk_bf16_f32 v46, v196, v197
    v_cvt_pk_bf16_f32 v47, v198, v199
    s_nop 1
    v_permlane32_swap_b32 v32, v34
    v_permlane32_swap_b32 v33, v35
    v_permlane32_swap_b32 v36, v38
    v_permlane32_swap_b32 v37, v39
    v_permlane32_swap_b32 v40, v42
    v_permlane32_swap_b32 v41, v43
    v_permlane32_swap_b32 v44, v46
    v_permlane32_swap_b32 v45, v47
    buffer_store_dwordx4 v[32:35], v17, s[24:27], s34 offen offset:0
    buffer_store_dwordx4 v[36:39], v17, s[24:27], s34 offen offset:32
    buffer_store_dwordx4 v[40:43], v17, s[24:27], s34 offen offset:64
    buffer_store_dwordx4 v[44:47], v17, s[24:27], s34 offen offset:96
    s_endpgm
gated_mix__grouped_kv_mqa__dense_activation_mish__prompt_kernel_exit:
    s_endpgm
.section .rodata,"a"
.p2align 6
.amdhsa_kernel gated_mix__grouped_kv_mqa__dense_activation_mish__prompt_kernel
  .amdhsa_next_free_vgpr 256
  .amdhsa_next_free_sgpr 102
  .amdhsa_accum_offset 256
  .amdhsa_group_segment_fixed_size 0
  .amdhsa_kernarg_size 104
  .amdhsa_user_sgpr_count 2
  .amdhsa_user_sgpr_kernarg_segment_ptr 1
  .amdhsa_system_sgpr_workgroup_id_x 1
.end_amdhsa_kernel
```
